```python
import torch

def _softmax(x, axis=-1):
    return torch.softmax(x, dim=axis)

def _gelu(x):
    return torch.nn.functional.gelu(x, approximate='tanh')

def _silu(x):
    return torch.nn.functional.silu(x)

def _sigmoid(x):
    return torch.sigmoid(x)

def _layernorm(x, axis=-1, eps=1e-05):
    m = x.mean(dim=axis, keepdim=True)
    v = x.var(dim=axis, keepdim=True, unbiased=False)
    return (x - m) / torch.sqrt(v + eps)

def _scatter_add(tgt, idx, src, axis=0):
    return tgt.clone().index_add_(axis, idx, src)

def _segment_sum(src, seg, n):
    out = torch.zeros((n,) + src.shape[1:], dtype=src.dtype)
    return out.index_add_(0, seg, src)

def _pad(x, pw):
    flat = tuple((v for pair in reversed(pw) for v in pair))
    return torch.nn.functional.pad(x, flat)
kernel_name = 'interleave_layers__sliding_block__memory_aug_recurrent_mem_tr__prompt'

def setup_inputs():

    _w = lambda a: (lambda t: t.to(torch.bfloat16) if t.is_floating_point() else t)(torch.as_tensor(a))

    def _A_setup():
        B, S, D = (1, 2048, 576)
        return {'x': _w((lambda *s: torch.randn(*s, dtype=torch.bfloat16) * 0.05)(B, S, D)), 'wqkv': _w((lambda *s: torch.randn(*s, dtype=torch.bfloat16) * 0.05)(D, 3 * D)), 'wo': _w((lambda *s: torch.randn(*s, dtype=torch.bfloat16) * 0.05)(D, D))}
    _A_in = _A_setup()

    def _B_setup():
        B, S, Dm = (1, 2048, 576)
        H, Dh = (32, 128)
        M, seg = (8, 32)
        seg = min(seg, S)
        S = S // seg * seg
        return {'x': _w((lambda *s: torch.randn(*s, dtype=torch.bfloat16) * 0.05)(B, S, Dm)), 'mem0': _w((lambda *s: torch.randn(*s, dtype=torch.bfloat16) * 0.8)(B, M, Dm)), 'Wq': _w((lambda *s: torch.randn(*s, dtype=torch.bfloat16) * 1.6)(Dm, H, Dh) * Dm ** (-0.5)), 'Wk': _w((lambda *s: torch.randn(*s, dtype=torch.bfloat16) * 1.6)(Dm, H, Dh) * Dm ** (-0.5)), 'Wv': _w((lambda *s: torch.randn(*s, dtype=torch.bfloat16) * 0.8)(Dm, H, Dh) * Dm ** (-0.5)), 'Wo': _w((lambda *s: torch.randn(*s, dtype=torch.bfloat16) * 0.8)(H, Dh, Dm) * (H * Dh) ** (-0.5)), 'seg_len': seg}
    _B_in = _B_setup()
    return {'A_x': _A_in['x'], 'A_wqkv': _A_in['wqkv'], 'A_wo': _A_in['wo'], 'B_x': _B_in['x'], 'B_mem0': _B_in['mem0'], 'B_Wq': _B_in['Wq'], 'B_Wk': _B_in['Wk'], 'B_Wv': _B_in['Wv'], 'B_Wo': _B_in['Wo'], 'B_seg_len': _B_in['seg_len']}

def reference(A_x, A_wqkv, A_wo, B_x, B_mem0, B_Wq, B_Wk, B_Wv, B_Wo, B_seg_len):

    def _A_ref(x, wqkv, wo):
        B, S, D = x.shape
        H = 32
        Dh = D // H
        W = 256
        qkv = (lambda x, *d: x.permute(*d))((x @ wqkv).reshape(B, S, 3, H, Dh), 2, 0, 3, 1, 4)
        q, k, v = (qkv[0], qkv[1], qkv[2])
        scores = torch.einsum('bhqd,bhkd->bhqk', q, k) * Dh ** (-0.5)
        idx = torch.arange(S)
        mask = (idx[:, None] - idx[None, :] >= 0) & (idx[:, None] - idx[None, :] < W)
        scores = torch.where(mask[None, None], scores, -1000000000.0)
        p = _softmax(scores, axis=-1)
        o = torch.einsum('bhqk,bhkd->bhqd', p, v)
        return (lambda x, *d: x.permute(*d))(o, 0, 2, 1, 3).reshape(B, S, D) @ wo

    def _B_ref(x, mem0, Wq, Wk, Wv, Wo, seg_len):
        B, S, Dm = x.shape
        H, Dh = (Wq.shape[1], Wq.shape[2])
        M = mem0.shape[1]
        scale = Dh ** (-0.5)
        n_seg = S // seg_len
        L = M + seg_len
        idx = torch.arange(L)
        mask = (idx[:, None] < M) | (idx[:, None] >= idx[None, :])
        mem = mem0
        outs = []
        for s in range(n_seg):
            xs = x[:, s * seg_len:(s + 1) * seg_len, :].clone()
            h = torch.concatenate([mem, xs], axis=1)
            q = torch.einsum('btd,dhe->bhte', h, Wq)
            k = torch.einsum('btd,dhe->bhte', h, Wk)
            v = torch.einsum('btd,dhe->bhte', h, Wv)
            scores = torch.einsum('bhqe,bhke->bhqk', q, k) * scale
            scores = torch.where(mask[None, None], scores, -1000000000.0)
            p = _softmax(scores, axis=-1)
            o = torch.einsum('bhqk,bhke->bhqe', p, v)
            o = torch.einsum('bhte,hed->btd', o, Wo)
            mem = o[:, :M, :].clone()
            outs.append(o[:, M:, :])
        return torch.concatenate(outs, axis=1)
    x = A_x
    x = x + _A_ref(_layernorm(x, axis=-1), A_wqkv, A_wo)
    x = x + _B_ref(_layernorm(x, axis=-1), B_mem0, B_Wq, B_Wk, B_Wv, B_Wo, B_seg_len)
    x = x + _A_ref(_layernorm(x, axis=-1), A_wqkv, A_wo)
    x = x + _B_ref(_layernorm(x, axis=-1), B_mem0, B_Wq, B_Wk, B_Wv, B_Wo, B_seg_len)
    return x
```

```asm
; @launch grid=(256,1,1) block=(256,1,1) lds=163840
.amdgcn_target "amdgcn-amd-amdhsa--gfx950"
.text
.globl interleave_layers__sliding_block__memory_aug_recurrent_mem_tr__prompt_kernel
.p2align 8
.type interleave_layers__sliding_block__memory_aug_recurrent_mem_tr__prompt_kernel,@function
interleave_layers__sliding_block__memory_aug_recurrent_mem_tr__prompt_kernel:
	s_cmp_ge_u32 s2, 256
	s_cbranch_scc1 L_END
	s_load_dwordx2 s[22:23], s[0:1], 96
	s_load_dwordx2 s[12:13], s[0:1], 88
	s_getreg_b32 s16, hwreg(HW_REG_XCC_ID, 0, 4)
	v_lshrrev_b32 v1, 6, v0
	s_nop 0
	v_readfirstlane_b32 s15, v1
	s_waitcnt lgkmcnt(0)
	s_mov_b32 s4, s22
	s_and_b32 s5, s23, 0xffff
	s_mov_b32 s6, 0x10000000
	s_mov_b32 s7, 0x00020000
	s_and_b32 s16, s16, 7
	s_lshr_b32 s17, s16, 2
	s_mul_i32 s17, s17, 112
	s_lshl_b32 s18, s16, 2
	s_add_u32 s17, s17, s18
	v_mov_b32 v8, s17
	v_mov_b32 v9, 1
	s_cmp_lg_u32 s15, 0
	s_cbranch_scc1 .tk_1
	s_mov_b64 exec, 1
	global_atomic_add v10, v8, v9, s[12:13] offset:0 sc0
	s_mov_b64 exec, -1
.tk_1:
	s_cmp_ge_u32 s2, 248
	s_cselect_b32 s17, -1, 0
	v_mov_b32 v4, s17
	v_mov_b32 v5, s17
	v_mov_b32 v6, s17
	v_mov_b32 v7, s17
	s_lshl_b32 s18, s2, 13
	v_lshlrev_b32 v2, 4, v0
	buffer_store_dwordx4 v[4:7], v2, s[4:7], s18 offen sc1
	s_add_u32 s18, s18, 4096
	buffer_store_dwordx4 v[4:7], v2, s[4:7], s18 offen sc1
	s_cmp_lg_u32 s15, 0
	s_cbranch_scc1 .tk2_2
	s_waitcnt vmcnt(2)
	v_mov_b32 v5, 0
	s_mov_b64 exec, 1
	ds_write_b32 v5, v10
	s_mov_b64 exec, -1
.tk2_2:
	s_waitcnt vmcnt(0) lgkmcnt(0)
	s_barrier
	s_cmp_lg_u32 s15, 0
	s_cbranch_scc1 .tk3_3
	s_mov_b64 exec, 1
	global_atomic_add v8, v9, s[12:13] offset:16
	s_mov_b64 exec, -1
.tk3_3:
	v_mov_b32 v5, 0
	ds_read_b32 v4, v5
	s_waitcnt lgkmcnt(0)
	v_readfirstlane_b32 s14, v4
	s_barrier
	s_cmp_ge_u32 s14, 32
	s_cbranch_scc1 L_OVER
	s_lshl_b32 s17, s16, 5
	s_add_u32 s14, s14, s17
L_HAVEROLE:
	v_mov_b32 v74, 0
	s_sub_u32 s26, s14, 0
	s_cmp_ge_u32 s26, 32
	s_cbranch_scc1 .disp_4
	s_mov_b32 s27, 0
	s_branch L_CHAIN
.disp_4:
	s_sub_u32 s26, s14, 64
	s_cmp_ge_u32 s26, 32
	s_cbranch_scc1 .disp_5
	s_mov_b32 s27, 0
	s_branch L_B1
.disp_5:
	s_sub_u32 s26, s14, 132
	s_cmp_ge_u32 s26, 9
	s_cbranch_scc1 .disp_6
	s_mov_b32 s27, 0
	s_branch L_A1
.disp_6:
	s_sub_u32 s26, s14, 141
	s_cmp_ge_u32 s26, 16
	s_cbranch_scc1 .disp_7
	s_mov_b32 s27, 0
	s_branch L_ATTA
.disp_7:
	s_sub_u32 s26, s14, 157
	s_cmp_ge_u32 s26, 3
	s_cbranch_scc1 .disp_8
	s_mov_b32 s27, 0
	s_branch L_A3
.disp_8:
	s_sub_u32 s26, s14, 164
	s_cmp_ge_u32 s26, 8
	s_cbranch_scc1 .disp_9
	s_mov_b32 s27, 0
	s_branch L_ATTB
.disp_9:
	s_sub_u32 s26, s14, 172
	s_cmp_ge_u32 s26, 12
	s_cbranch_scc1 .disp_10
	s_mov_b32 s27, 0
	s_branch L_B3
.disp_10:
	s_sub_u32 s26, s14, 128
	s_cmp_ge_u32 s26, 4
	s_cbranch_scc1 .disp_11
	s_mov_b32 s27, 0
	s_branch L_RA0
.disp_11:
	s_sub_u32 s26, s14, 184
	s_cmp_ge_u32 s26, 8
	s_cbranch_scc1 .disp_12
	s_mov_b32 s27, 0
	s_branch L_RB0
.disp_12:
	s_sub_u32 s26, s14, 32
	s_cmp_ge_u32 s26, 32
	s_cbranch_scc1 .disp_13
	s_mov_b32 s27, 1
	s_branch L_CHAIN
.disp_13:
	s_sub_u32 s26, s14, 96
	s_cmp_ge_u32 s26, 32
	s_cbranch_scc1 .disp_14
	s_mov_b32 s27, 1
	s_branch L_B1
.disp_14:
	s_sub_u32 s26, s14, 196
	s_cmp_ge_u32 s26, 9
	s_cbranch_scc1 .disp_15
	s_mov_b32 s27, 1
	s_branch L_A1
.disp_15:
	s_sub_u32 s26, s14, 205
	s_cmp_ge_u32 s26, 16
	s_cbranch_scc1 .disp_16
	s_mov_b32 s27, 1
	s_branch L_ATTA
.disp_16:
	s_sub_u32 s26, s14, 221
	s_cmp_ge_u32 s26, 3
	s_cbranch_scc1 .disp_17
	s_mov_b32 s27, 1
	s_branch L_A3
.disp_17:
	s_sub_u32 s26, s14, 224
	s_cmp_ge_u32 s26, 8
	s_cbranch_scc1 .disp_18
	s_mov_b32 s27, 1
	s_branch L_ATTB
.disp_18:
	s_sub_u32 s26, s14, 232
	s_cmp_ge_u32 s26, 12
	s_cbranch_scc1 .disp_19
	s_mov_b32 s27, 1
	s_branch L_B3
.disp_19:
	s_sub_u32 s26, s14, 192
	s_cmp_ge_u32 s26, 4
	s_cbranch_scc1 .disp_20
	s_mov_b32 s27, 1
	s_branch L_RA1
.disp_20:
	s_sub_u32 s26, s14, 244
	s_cmp_ge_u32 s26, 8
	s_cbranch_scc1 .disp_21
	s_mov_b32 s27, 1
	s_branch L_RB1
.disp_21:
	s_sub_u32 s26, s14, 160
	s_cmp_ge_u32 s26, 4
	s_cbranch_scc1 .disp_22
	s_mov_b32 s27, 0
	s_branch L_R0
.disp_22:
	s_branch L_END
.p2align 6
L_CHAIN:
	s_cmp_eq_u32 s27, 0
	s_cbranch_scc1 .idef_23
	s_cmp_lg_u32 s15, 0
	s_cbranch_scc1 .idok_25
	s_mov_b32 s20, 400000
	v_mov_b32 v10, 0
.idre_24:
	global_load_dword v11, v10, s[12:13] offset:176 sc1
	s_waitcnt vmcnt(0)
	v_readfirstlane_b32 s17, v11
	s_nop 0
	s_cmp_ge_u32 s17, 64
	s_cbranch_scc1 .idok_25
	s_sleep 8
	s_sub_u32 s20, s20, 1
	s_cmp_lg_u32 s20, 0
	s_cbranch_scc1 .idre_24
	s_branch L_FAIL
.idok_25:
	s_barrier
.idef_23:
	v_mov_b32 v63, v0
	v_and_b32 v62, 63, v0
	v_and_b32 v61, 15, v62
	v_lshrrev_b32 v60, 4, v62
	v_lshlrev_b32 v10, 1, v60
	v_xor_b32 v10, v10, v61
	v_xor_b32 v11, 8, v10
	v_lshlrev_b32 v10, 4, v10
	v_lshlrev_b32 v11, 4, v11
	v_lshlrev_b32 v12, 13, v60
	v_add_u32 v8, v10, v12
	v_add_u32 v9, v11, v12
	v_lshlrev_b32 v12, 17, v60
	v_add_u32 v26, v10, v12
	v_add_u32 v27, v11, v12
	v_lshrrev_b32 v10, 2, v61
	v_and_b32 v11, 3, v61
	v_and_b32 v12, 1, v60
	v_lshlrev_b32 v12, 2, v12
	v_or_b32 v12, v12, v10
	v_lshlrev_b32 v12, 1, v12
	v_lshrrev_b32 v13, 1, v11
	s_lshl_b32 s17, s15, 2
	v_add_u32 v13, s17, v13
	v_and_b32 v11, 1, v11
	v_lshlrev_b32 v11, 3, v11
	v_lshlrev_b32 v14, 4, v60
	v_add_u32 v14, v14, v10
	v_lshlrev_b32 v14, 8, v14
	v_add_u32 v14, v14, v11
	v_xor_b32 v15, v13, v12
	v_add_u32 v13, 2, v13
	v_xor_b32 v16, v13, v12
	v_lshlrev_b32 v15, 4, v15
	v_lshlrev_b32 v16, 4, v16
	v_add_u32 v15, v15, v14
	v_add_u32 v16, v16, v14
	v_add_u32 v20, 16384, v15
	v_add_u32 v21, 16384, v16
	v_add_u32 v22, 65536, v15
	v_add_u32 v23, 65536, v16
	v_add_u32 v24, 114688, v15
	v_add_u32 v25, 114688, v16
	v_lshlrev_b32 v0, 4, v62
	v_lshlrev_b32 v1, 3, v62
	s_load_dwordx2 s[22:23], s[0:1], 40
	s_waitcnt lgkmcnt(0)
	s_mov_b32 s8, s22
	s_and_b32 s9, s23, 0xffff
	s_mov_b32 s10, 0x480000
	s_mov_b32 s11, 0x00020000
	s_lshl_b32 s70, s26, 8
	s_lshl_b32 s63, s15, 10
	s_add_u32 s63, s63, 16384
	s_lshl_b32 s62, s15, 13
	s_add_u32 s62, s62, s70
	s_add_u32 s62, s62, 131072
	s_mov_b32 m0, s63
	s_nop 0
	buffer_load_dwordx4 v26, s[8:11], s62 offen lds
	s_add_u32 s63, s63, 4096
	s_lshl_b32 s62, s15, 13
	s_add_u32 s62, s62, s70
	s_add_u32 s62, s62, 163840
	s_mov_b32 m0, s63
	s_nop 0
	buffer_load_dwordx4 v27, s[8:11], s62 offen lds
	s_add_u32 s63, s63, 4096
	s_lshl_b32 s62, s15, 13
	s_add_u32 s62, s62, s70
	s_add_u32 s62, s62, 196608
	s_mov_b32 m0, s63
	s_nop 0
	buffer_load_dwordx4 v26, s[8:11], s62 offen lds
	s_add_u32 s63, s63, 4096
	s_lshl_b32 s62, s15, 13
	s_add_u32 s62, s62, s70
	s_add_u32 s62, s62, 229376
	s_mov_b32 m0, s63
	s_nop 0
	buffer_load_dwordx4 v27, s[8:11], s62 offen lds
	s_add_u32 s63, s63, 4096
	s_lshl_b32 s62, s15, 13
	s_add_u32 s62, s62, s70
	s_add_u32 s62, s62, 655360
	s_mov_b32 m0, s63
	s_nop 0
	buffer_load_dwordx4 v26, s[8:11], s62 offen lds
	s_add_u32 s63, s63, 4096
	s_lshl_b32 s62, s15, 13
	s_add_u32 s62, s62, s70
	s_add_u32 s62, s62, 688128
	s_mov_b32 m0, s63
	s_nop 0
	buffer_load_dwordx4 v27, s[8:11], s62 offen lds
	s_add_u32 s63, s63, 4096
	s_lshl_b32 s62, s15, 13
	s_add_u32 s62, s62, s70
	s_add_u32 s62, s62, 720896
	s_mov_b32 m0, s63
	s_nop 0
	buffer_load_dwordx4 v26, s[8:11], s62 offen lds
	s_add_u32 s63, s63, 4096
	s_lshl_b32 s62, s15, 13
	s_add_u32 s62, s62, s70
	s_add_u32 s62, s62, 753664
	s_mov_b32 m0, s63
	s_nop 0
	buffer_load_dwordx4 v27, s[8:11], s62 offen lds
	s_add_u32 s63, s63, 4096
	s_lshl_b32 s62, s15, 13
	s_add_u32 s62, s62, s70
	s_add_u32 s62, s62, 1310720
	s_mov_b32 m0, s63
	s_nop 0
	buffer_load_dwordx4 v26, s[8:11], s62 offen lds
	s_add_u32 s63, s63, 4096
	s_lshl_b32 s62, s15, 13
	s_add_u32 s62, s62, s70
	s_add_u32 s62, s62, 1343488
	s_mov_b32 m0, s63
	s_nop 0
	buffer_load_dwordx4 v27, s[8:11], s62 offen lds
	s_add_u32 s63, s63, 4096
	s_lshl_b32 s62, s15, 13
	s_add_u32 s62, s62, s70
	s_add_u32 s62, s62, 1376256
	s_mov_b32 m0, s63
	s_nop 0
	buffer_load_dwordx4 v26, s[8:11], s62 offen lds
	s_add_u32 s63, s63, 4096
	s_lshl_b32 s62, s15, 13
	s_add_u32 s62, s62, s70
	s_add_u32 s62, s62, 1409024
	s_mov_b32 m0, s63
	s_nop 0
	buffer_load_dwordx4 v27, s[8:11], s62 offen lds
	s_load_dwordx2 s[22:23], s[0:1], 40
	s_waitcnt lgkmcnt(0)
	s_mov_b32 s8, s22
	s_and_b32 s9, s23, 0xffff
	s_mov_b32 s10, 0x480000
	s_mov_b32 s11, 0x00020000
	s_lshl_b32 s70, s26, 8
	s_lshl_b32 s63, s15, 10
	s_add_u32 s63, s63, 65536
	s_lshl_b32 s62, s15, 13
	s_add_u32 s62, s62, s70
	s_add_u32 s62, s62, 1835008
	s_mov_b32 m0, s63
	s_nop 0
	buffer_load_dwordx4 v26, s[8:11], s62 offen lds
	s_add_u32 s63, s63, 4096
	s_lshl_b32 s62, s15, 13
	s_add_u32 s62, s62, s70
	s_add_u32 s62, s62, 1867776
	s_mov_b32 m0, s63
	s_nop 0
	buffer_load_dwordx4 v27, s[8:11], s62 offen lds
	s_add_u32 s63, s63, 4096
	s_lshl_b32 s62, s15, 13
	s_add_u32 s62, s62, s70
	s_add_u32 s62, s62, 1900544
	s_mov_b32 m0, s63
	s_nop 0
	buffer_load_dwordx4 v26, s[8:11], s62 offen lds
	s_add_u32 s63, s63, 4096
	s_lshl_b32 s62, s15, 13
	s_add_u32 s62, s62, s70
	s_add_u32 s62, s62, 1933312
	s_mov_b32 m0, s63
	s_nop 0
	buffer_load_dwordx4 v27, s[8:11], s62 offen lds
	s_add_u32 s63, s63, 4096
	s_lshl_b32 s62, s15, 13
	s_add_u32 s62, s62, s70
	s_add_u32 s62, s62, 2490368
	s_mov_b32 m0, s63
	s_nop 0
	buffer_load_dwordx4 v26, s[8:11], s62 offen lds
	s_add_u32 s63, s63, 4096
	s_lshl_b32 s62, s15, 13
	s_add_u32 s62, s62, s70
	s_add_u32 s62, s62, 2523136
	s_mov_b32 m0, s63
	s_nop 0
	buffer_load_dwordx4 v27, s[8:11], s62 offen lds
	s_add_u32 s63, s63, 4096
	s_lshl_b32 s62, s15, 13
	s_add_u32 s62, s62, s70
	s_add_u32 s62, s62, 2555904
	s_mov_b32 m0, s63
	s_nop 0
	buffer_load_dwordx4 v26, s[8:11], s62 offen lds
	s_add_u32 s63, s63, 4096
	s_lshl_b32 s62, s15, 13
	s_add_u32 s62, s62, s70
	s_add_u32 s62, s62, 2588672
	s_mov_b32 m0, s63
	s_nop 0
	buffer_load_dwordx4 v27, s[8:11], s62 offen lds
	s_add_u32 s63, s63, 4096
	s_lshl_b32 s62, s15, 13
	s_add_u32 s62, s62, s70
	s_add_u32 s62, s62, 3014656
	s_mov_b32 m0, s63
	s_nop 0
	buffer_load_dwordx4 v26, s[8:11], s62 offen lds
	s_add_u32 s63, s63, 4096
	s_lshl_b32 s62, s15, 13
	s_add_u32 s62, s62, s70
	s_add_u32 s62, s62, 3047424
	s_mov_b32 m0, s63
	s_nop 0
	buffer_load_dwordx4 v27, s[8:11], s62 offen lds
	s_add_u32 s63, s63, 4096
	s_lshl_b32 s62, s15, 13
	s_add_u32 s62, s62, s70
	s_add_u32 s62, s62, 3080192
	s_mov_b32 m0, s63
	s_nop 0
	buffer_load_dwordx4 v26, s[8:11], s62 offen lds
	s_add_u32 s63, s63, 4096
	s_lshl_b32 s62, s15, 13
	s_add_u32 s62, s62, s70
	s_add_u32 s62, s62, 3112960
	s_mov_b32 m0, s63
	s_nop 0
	buffer_load_dwordx4 v27, s[8:11], s62 offen lds
	s_load_dwordx2 s[22:23], s[0:1], 40
	s_waitcnt lgkmcnt(0)
	s_mov_b32 s8, s22
	s_and_b32 s9, s23, 0xffff
	s_mov_b32 s10, 0x480000
	s_mov_b32 s11, 0x00020000
	s_lshl_b32 s70, s26, 8
	s_lshl_b32 s63, s15, 10
	s_add_u32 s63, s63, 114688
	s_lshl_b32 s62, s15, 13
	s_add_u32 s62, s62, s70
	s_add_u32 s62, s62, 3670016
	s_mov_b32 m0, s63
	s_nop 0
	buffer_load_dwordx4 v26, s[8:11], s62 offen lds
	s_add_u32 s63, s63, 4096
	s_lshl_b32 s62, s15, 13
	s_add_u32 s62, s62, s70
	s_add_u32 s62, s62, 3702784
	s_mov_b32 m0, s63
	s_nop 0
	buffer_load_dwordx4 v27, s[8:11], s62 offen lds
	s_add_u32 s63, s63, 4096
	s_lshl_b32 s62, s15, 13
	s_add_u32 s62, s62, s70
	s_add_u32 s62, s62, 3735552
	s_mov_b32 m0, s63
	s_nop 0
	buffer_load_dwordx4 v26, s[8:11], s62 offen lds
	s_add_u32 s63, s63, 4096
	s_lshl_b32 s62, s15, 13
	s_add_u32 s62, s62, s70
	s_add_u32 s62, s62, 3768320
	s_mov_b32 m0, s63
	s_nop 0
	buffer_load_dwordx4 v27, s[8:11], s62 offen lds
	s_add_u32 s63, s63, 4096
	s_lshl_b32 s62, s15, 13
	s_add_u32 s62, s62, s70
	s_add_u32 s62, s62, 4194304
	s_mov_b32 m0, s63
	s_nop 0
	buffer_load_dwordx4 v26, s[8:11], s62 offen lds
	s_add_u32 s63, s63, 4096
	s_lshl_b32 s62, s15, 13
	s_add_u32 s62, s62, s70
	s_add_u32 s62, s62, 4227072
	s_mov_b32 m0, s63
	s_nop 0
	buffer_load_dwordx4 v27, s[8:11], s62 offen lds
	s_add_u32 s63, s63, 4096
	s_lshl_b32 s62, s15, 13
	s_add_u32 s62, s62, s70
	s_add_u32 s62, s62, 4259840
	s_mov_b32 m0, s63
	s_nop 0
	buffer_load_dwordx4 v26, s[8:11], s62 offen lds
	s_add_u32 s63, s63, 4096
	s_lshl_b32 s62, s15, 13
	s_add_u32 s62, s62, s70
	s_add_u32 s62, s62, 4292608
	s_mov_b32 m0, s63
	s_nop 0
	buffer_load_dwordx4 v27, s[8:11], s62 offen lds
	s_add_u32 s63, s63, 4096
	s_lshl_b32 s62, s15, 15
	s_add_u32 s62, s62, s70
	s_mov_b32 m0, s63
	s_nop 0
	buffer_load_dwordx4 v8, s[8:11], s62 offen lds
	s_add_u32 s63, s63, 4096
	s_lshl_b32 s62, s15, 15
	s_add_u32 s62, s62, s70
	s_add_u32 s62, s62, 1179648
	s_mov_b32 m0, s63
	s_nop 0
	buffer_load_dwordx4 v9, s[8:11], s62 offen lds
	s_add_u32 s63, s63, 4096
	s_lshl_b32 s62, s15, 15
	s_add_u32 s62, s62, s70
	s_add_u32 s62, s62, 2359296
	s_mov_b32 m0, s63
	s_nop 0
	buffer_load_dwordx4 v8, s[8:11], s62 offen lds
	s_add_u32 s63, s63, 4096
	s_lshl_b32 s62, s15, 15
	s_add_u32 s62, s62, s70
	s_add_u32 s62, s62, 3538944
	s_mov_b32 m0, s63
	s_nop 0
	buffer_load_dwordx4 v9, s[8:11], s62 offen lds
	s_waitcnt vmcnt(24)
	s_barrier
	ds_read_b64_tr_b16 a[0:1], v20 offset:0
	ds_read_b64_tr_b16 a[2:3], v20 offset:1024
	ds_read_b64_tr_b16 a[4:5], v20 offset:2048
	ds_read_b64_tr_b16 a[6:7], v20 offset:3072
	ds_read_b64_tr_b16 a[8:9], v20 offset:16384
	ds_read_b64_tr_b16 a[10:11], v20 offset:17408
	ds_read_b64_tr_b16 a[12:13], v20 offset:18432
	ds_read_b64_tr_b16 a[14:15], v20 offset:19456
	s_waitcnt lgkmcnt(8)
	ds_read_b64_tr_b16 a[16:17], v20 offset:32768
	ds_read_b64_tr_b16 a[18:19], v20 offset:33792
	ds_read_b64_tr_b16 a[20:21], v20 offset:34816
	ds_read_b64_tr_b16 a[22:23], v20 offset:35840
	ds_read_b64_tr_b16 a[72:73], v21 offset:0
	ds_read_b64_tr_b16 a[74:75], v21 offset:1024
	ds_read_b64_tr_b16 a[76:77], v21 offset:2048
	ds_read_b64_tr_b16 a[78:79], v21 offset:3072
	s_waitcnt lgkmcnt(8)
	ds_read_b64_tr_b16 a[80:81], v21 offset:16384
	ds_read_b64_tr_b16 a[82:83], v21 offset:17408
	ds_read_b64_tr_b16 a[84:85], v21 offset:18432
	ds_read_b64_tr_b16 a[86:87], v21 offset:19456
	ds_read_b64_tr_b16 a[88:89], v21 offset:32768
	ds_read_b64_tr_b16 a[90:91], v21 offset:33792
	ds_read_b64_tr_b16 a[92:93], v21 offset:34816
	ds_read_b64_tr_b16 a[94:95], v21 offset:35840
	s_waitcnt lgkmcnt(0)
	s_barrier
	s_load_dwordx2 s[22:23], s[0:1], 48
	s_waitcnt lgkmcnt(0)
	s_mov_b32 s8, s22
	s_and_b32 s9, s23, 0xffff
	s_mov_b32 s10, 0x480000
	s_mov_b32 s11, 0x00020000
	s_lshl_b32 s70, s26, 8
	s_lshl_b32 s63, s15, 10
	s_add_u32 s63, s63, 16384
	s_lshl_b32 s62, s15, 13
	s_add_u32 s62, s62, s70
	s_add_u32 s62, s62, 131072
	s_mov_b32 m0, s63
	s_nop 0
	buffer_load_dwordx4 v26, s[8:11], s62 offen lds
	s_add_u32 s63, s63, 4096
	s_lshl_b32 s62, s15, 13
	s_add_u32 s62, s62, s70
	s_add_u32 s62, s62, 163840
	s_mov_b32 m0, s63
	s_nop 0
	buffer_load_dwordx4 v27, s[8:11], s62 offen lds
	s_add_u32 s63, s63, 4096
	s_lshl_b32 s62, s15, 13
	s_add_u32 s62, s62, s70
	s_add_u32 s62, s62, 196608
	s_mov_b32 m0, s63
	s_nop 0
	buffer_load_dwordx4 v26, s[8:11], s62 offen lds
	s_add_u32 s63, s63, 4096
	s_lshl_b32 s62, s15, 13
	s_add_u32 s62, s62, s70
	s_add_u32 s62, s62, 229376
	s_mov_b32 m0, s63
	s_nop 0
	buffer_load_dwordx4 v27, s[8:11], s62 offen lds
	s_add_u32 s63, s63, 4096
	s_lshl_b32 s62, s15, 13
	s_add_u32 s62, s62, s70
	s_add_u32 s62, s62, 655360
	s_mov_b32 m0, s63
	s_nop 0
	buffer_load_dwordx4 v26, s[8:11], s62 offen lds
	s_add_u32 s63, s63, 4096
	s_lshl_b32 s62, s15, 13
	s_add_u32 s62, s62, s70
	s_add_u32 s62, s62, 688128
	s_mov_b32 m0, s63
	s_nop 0
	buffer_load_dwordx4 v27, s[8:11], s62 offen lds
	s_add_u32 s63, s63, 4096
	s_lshl_b32 s62, s15, 13
	s_add_u32 s62, s62, s70
	s_add_u32 s62, s62, 720896
	s_mov_b32 m0, s63
	s_nop 0
	buffer_load_dwordx4 v26, s[8:11], s62 offen lds
	s_add_u32 s63, s63, 4096
	s_lshl_b32 s62, s15, 13
	s_add_u32 s62, s62, s70
	s_add_u32 s62, s62, 753664
	s_mov_b32 m0, s63
	s_nop 0
	buffer_load_dwordx4 v27, s[8:11], s62 offen lds
	s_add_u32 s63, s63, 4096
	s_lshl_b32 s62, s15, 13
	s_add_u32 s62, s62, s70
	s_add_u32 s62, s62, 1310720
	s_mov_b32 m0, s63
	s_nop 0
	buffer_load_dwordx4 v26, s[8:11], s62 offen lds
	s_add_u32 s63, s63, 4096
	s_lshl_b32 s62, s15, 13
	s_add_u32 s62, s62, s70
	s_add_u32 s62, s62, 1343488
	s_mov_b32 m0, s63
	s_nop 0
	buffer_load_dwordx4 v27, s[8:11], s62 offen lds
	s_add_u32 s63, s63, 4096
	s_lshl_b32 s62, s15, 13
	s_add_u32 s62, s62, s70
	s_add_u32 s62, s62, 1376256
	s_mov_b32 m0, s63
	s_nop 0
	buffer_load_dwordx4 v26, s[8:11], s62 offen lds
	s_add_u32 s63, s63, 4096
	s_lshl_b32 s62, s15, 13
	s_add_u32 s62, s62, s70
	s_add_u32 s62, s62, 1409024
	s_mov_b32 m0, s63
	s_nop 0
	buffer_load_dwordx4 v27, s[8:11], s62 offen lds
	s_waitcnt vmcnt(24)
	s_barrier
	ds_read_b64_tr_b16 a[24:25], v22 offset:0
	ds_read_b64_tr_b16 a[26:27], v22 offset:1024
	ds_read_b64_tr_b16 a[28:29], v22 offset:2048
	ds_read_b64_tr_b16 a[30:31], v22 offset:3072
	ds_read_b64_tr_b16 a[32:33], v22 offset:16384
	ds_read_b64_tr_b16 a[34:35], v22 offset:17408
	ds_read_b64_tr_b16 a[36:37], v22 offset:18432
	ds_read_b64_tr_b16 a[38:39], v22 offset:19456
	s_waitcnt lgkmcnt(8)
	ds_read_b64_tr_b16 a[40:41], v22 offset:32768
	ds_read_b64_tr_b16 a[42:43], v22 offset:33792
	ds_read_b64_tr_b16 a[44:45], v22 offset:34816
	ds_read_b64_tr_b16 a[46:47], v22 offset:35840
	ds_read_b64_tr_b16 a[96:97], v23 offset:0
	ds_read_b64_tr_b16 a[98:99], v23 offset:1024
	ds_read_b64_tr_b16 a[100:101], v23 offset:2048
	ds_read_b64_tr_b16 a[102:103], v23 offset:3072
	s_waitcnt lgkmcnt(8)
	ds_read_b64_tr_b16 a[104:105], v23 offset:16384
	ds_read_b64_tr_b16 a[106:107], v23 offset:17408
	ds_read_b64_tr_b16 a[108:109], v23 offset:18432
	ds_read_b64_tr_b16 a[110:111], v23 offset:19456
	ds_read_b64_tr_b16 a[112:113], v23 offset:32768
	ds_read_b64_tr_b16 a[114:115], v23 offset:33792
	ds_read_b64_tr_b16 a[116:117], v23 offset:34816
	ds_read_b64_tr_b16 a[118:119], v23 offset:35840
	s_waitcnt lgkmcnt(0)
	s_barrier
	s_load_dwordx2 s[22:23], s[0:1], 48
	s_waitcnt lgkmcnt(0)
	s_mov_b32 s8, s22
	s_and_b32 s9, s23, 0xffff
	s_mov_b32 s10, 0x480000
	s_mov_b32 s11, 0x00020000
	s_lshl_b32 s70, s26, 8
	s_lshl_b32 s63, s15, 10
	s_add_u32 s63, s63, 65536
	s_lshl_b32 s62, s15, 13
	s_add_u32 s62, s62, s70
	s_add_u32 s62, s62, 1835008
	s_mov_b32 m0, s63
	s_nop 0
	buffer_load_dwordx4 v26, s[8:11], s62 offen lds
	s_add_u32 s63, s63, 4096
	s_lshl_b32 s62, s15, 13
	s_add_u32 s62, s62, s70
	s_add_u32 s62, s62, 1867776
	s_mov_b32 m0, s63
	s_nop 0
	buffer_load_dwordx4 v27, s[8:11], s62 offen lds
	s_add_u32 s63, s63, 4096
	s_lshl_b32 s62, s15, 13
	s_add_u32 s62, s62, s70
	s_add_u32 s62, s62, 1900544
	s_mov_b32 m0, s63
	s_nop 0
	buffer_load_dwordx4 v26, s[8:11], s62 offen lds
	s_add_u32 s63, s63, 4096
	s_lshl_b32 s62, s15, 13
	s_add_u32 s62, s62, s70
	s_add_u32 s62, s62, 1933312
	s_mov_b32 m0, s63
	s_nop 0
	buffer_load_dwordx4 v27, s[8:11], s62 offen lds
	s_add_u32 s63, s63, 4096
	s_lshl_b32 s62, s15, 13
	s_add_u32 s62, s62, s70
	s_add_u32 s62, s62, 2490368
	s_mov_b32 m0, s63
	s_nop 0
	buffer_load_dwordx4 v26, s[8:11], s62 offen lds
	s_add_u32 s63, s63, 4096
	s_lshl_b32 s62, s15, 13
	s_add_u32 s62, s62, s70
	s_add_u32 s62, s62, 2523136
	s_mov_b32 m0, s63
	s_nop 0
	buffer_load_dwordx4 v27, s[8:11], s62 offen lds
	s_add_u32 s63, s63, 4096
	s_lshl_b32 s62, s15, 13
	s_add_u32 s62, s62, s70
	s_add_u32 s62, s62, 2555904
	s_mov_b32 m0, s63
	s_nop 0
	buffer_load_dwordx4 v26, s[8:11], s62 offen lds
	s_add_u32 s63, s63, 4096
	s_lshl_b32 s62, s15, 13
	s_add_u32 s62, s62, s70
	s_add_u32 s62, s62, 2588672
	s_mov_b32 m0, s63
	s_nop 0
	buffer_load_dwordx4 v27, s[8:11], s62 offen lds
	s_add_u32 s63, s63, 4096
	s_lshl_b32 s62, s15, 13
	s_add_u32 s62, s62, s70
	s_add_u32 s62, s62, 3014656
	s_mov_b32 m0, s63
	s_nop 0
	buffer_load_dwordx4 v26, s[8:11], s62 offen lds
	s_add_u32 s63, s63, 4096
	s_lshl_b32 s62, s15, 13
	s_add_u32 s62, s62, s70
	s_add_u32 s62, s62, 3047424
	s_mov_b32 m0, s63
	s_nop 0
	buffer_load_dwordx4 v27, s[8:11], s62 offen lds
	s_add_u32 s63, s63, 4096
	s_lshl_b32 s62, s15, 13
	s_add_u32 s62, s62, s70
	s_add_u32 s62, s62, 3080192
	s_mov_b32 m0, s63
	s_nop 0
	buffer_load_dwordx4 v26, s[8:11], s62 offen lds
	s_add_u32 s63, s63, 4096
	s_lshl_b32 s62, s15, 13
	s_add_u32 s62, s62, s70
	s_add_u32 s62, s62, 3112960
	s_mov_b32 m0, s63
	s_nop 0
	buffer_load_dwordx4 v27, s[8:11], s62 offen lds
	s_waitcnt vmcnt(24)
	s_barrier
	ds_read_b64_tr_b16 a[48:49], v24 offset:0
	ds_read_b64_tr_b16 a[50:51], v24 offset:1024
	ds_read_b64_tr_b16 a[52:53], v24 offset:2048
	ds_read_b64_tr_b16 a[54:55], v24 offset:3072
	ds_read_b64_tr_b16 a[56:57], v24 offset:16384
	ds_read_b64_tr_b16 a[58:59], v24 offset:17408
	ds_read_b64_tr_b16 a[60:61], v24 offset:18432
	ds_read_b64_tr_b16 a[62:63], v24 offset:19456
	s_waitcnt lgkmcnt(8)
	ds_read_b64_tr_b16 a[64:65], v24 offset:32768
	ds_read_b64_tr_b16 a[66:67], v24 offset:33792
	ds_read_b64_tr_b16 a[68:69], v24 offset:34816
	ds_read_b64_tr_b16 a[70:71], v24 offset:35840
	ds_read_b64_tr_b16 a[120:121], v25 offset:0
	ds_read_b64_tr_b16 a[122:123], v25 offset:1024
	ds_read_b64_tr_b16 a[124:125], v25 offset:2048
	ds_read_b64_tr_b16 a[126:127], v25 offset:3072
	s_waitcnt lgkmcnt(8)
	ds_read_b64_tr_b16 a[128:129], v25 offset:16384
	ds_read_b64_tr_b16 a[130:131], v25 offset:17408
	ds_read_b64_tr_b16 a[132:133], v25 offset:18432
	ds_read_b64_tr_b16 a[134:135], v25 offset:19456
	ds_read_b64_tr_b16 a[136:137], v25 offset:32768
	ds_read_b64_tr_b16 a[138:139], v25 offset:33792
	ds_read_b64_tr_b16 a[140:141], v25 offset:34816
	ds_read_b64_tr_b16 a[142:143], v25 offset:35840
	s_waitcnt lgkmcnt(0)
	s_barrier
	s_load_dwordx2 s[22:23], s[0:1], 48
	s_waitcnt lgkmcnt(0)
	s_mov_b32 s8, s22
	s_and_b32 s9, s23, 0xffff
	s_mov_b32 s10, 0x480000
	s_mov_b32 s11, 0x00020000
	s_lshl_b32 s70, s26, 8
	s_lshl_b32 s63, s15, 10
	s_add_u32 s63, s63, 114688
	s_lshl_b32 s62, s15, 13
	s_add_u32 s62, s62, s70
	s_add_u32 s62, s62, 3670016
	s_mov_b32 m0, s63
	s_nop 0
	buffer_load_dwordx4 v26, s[8:11], s62 offen lds
	s_add_u32 s63, s63, 4096
	s_lshl_b32 s62, s15, 13
	s_add_u32 s62, s62, s70
	s_add_u32 s62, s62, 3702784
	s_mov_b32 m0, s63
	s_nop 0
	buffer_load_dwordx4 v27, s[8:11], s62 offen lds
	s_add_u32 s63, s63, 4096
	s_lshl_b32 s62, s15, 13
	s_add_u32 s62, s62, s70
	s_add_u32 s62, s62, 3735552
	s_mov_b32 m0, s63
	s_nop 0
	buffer_load_dwordx4 v26, s[8:11], s62 offen lds
	s_add_u32 s63, s63, 4096
	s_lshl_b32 s62, s15, 13
	s_add_u32 s62, s62, s70
	s_add_u32 s62, s62, 3768320
	s_mov_b32 m0, s63
	s_nop 0
	buffer_load_dwordx4 v27, s[8:11], s62 offen lds
	s_add_u32 s63, s63, 4096
	s_lshl_b32 s62, s15, 13
	s_add_u32 s62, s62, s70
	s_add_u32 s62, s62, 4194304
	s_mov_b32 m0, s63
	s_nop 0
	buffer_load_dwordx4 v26, s[8:11], s62 offen lds
	s_add_u32 s63, s63, 4096
	s_lshl_b32 s62, s15, 13
	s_add_u32 s62, s62, s70
	s_add_u32 s62, s62, 4227072
	s_mov_b32 m0, s63
	s_nop 0
	buffer_load_dwordx4 v27, s[8:11], s62 offen lds
	s_add_u32 s63, s63, 4096
	s_lshl_b32 s62, s15, 13
	s_add_u32 s62, s62, s70
	s_add_u32 s62, s62, 4259840
	s_mov_b32 m0, s63
	s_nop 0
	buffer_load_dwordx4 v26, s[8:11], s62 offen lds
	s_add_u32 s63, s63, 4096
	s_lshl_b32 s62, s15, 13
	s_add_u32 s62, s62, s70
	s_add_u32 s62, s62, 4292608
	s_mov_b32 m0, s63
	s_nop 0
	buffer_load_dwordx4 v27, s[8:11], s62 offen lds
	s_add_u32 s63, s63, 4096
	s_lshl_b32 s62, s15, 15
	s_add_u32 s62, s62, s70
	s_mov_b32 m0, s63
	s_nop 0
	buffer_load_dwordx4 v8, s[8:11], s62 offen lds
	s_add_u32 s63, s63, 4096
	s_lshl_b32 s62, s15, 15
	s_add_u32 s62, s62, s70
	s_add_u32 s62, s62, 1179648
	s_mov_b32 m0, s63
	s_nop 0
	buffer_load_dwordx4 v9, s[8:11], s62 offen lds
	s_add_u32 s63, s63, 4096
	s_lshl_b32 s62, s15, 15
	s_add_u32 s62, s62, s70
	s_add_u32 s62, s62, 2359296
	s_mov_b32 m0, s63
	s_nop 0
	buffer_load_dwordx4 v8, s[8:11], s62 offen lds
	s_add_u32 s63, s63, 4096
	s_lshl_b32 s62, s15, 15
	s_add_u32 s62, s62, s70
	s_add_u32 s62, s62, 3538944
	s_mov_b32 m0, s63
	s_nop 0
	buffer_load_dwordx4 v9, s[8:11], s62 offen lds
	s_waitcnt vmcnt(24)
	s_barrier
	ds_read_b64_tr_b16 a[144:145], v20 offset:0
	ds_read_b64_tr_b16 a[146:147], v20 offset:1024
	ds_read_b64_tr_b16 a[148:149], v20 offset:2048
	ds_read_b64_tr_b16 a[150:151], v20 offset:3072
	ds_read_b64_tr_b16 a[152:153], v20 offset:16384
	ds_read_b64_tr_b16 a[154:155], v20 offset:17408
	ds_read_b64_tr_b16 a[156:157], v20 offset:18432
	ds_read_b64_tr_b16 a[158:159], v20 offset:19456
	s_waitcnt lgkmcnt(8)
	ds_read_b64_tr_b16 a[160:161], v20 offset:32768
	ds_read_b64_tr_b16 a[162:163], v20 offset:33792
	ds_read_b64_tr_b16 a[164:165], v20 offset:34816
	ds_read_b64_tr_b16 a[166:167], v20 offset:35840
	ds_read_b64_tr_b16 a[216:217], v21 offset:0
	ds_read_b64_tr_b16 a[218:219], v21 offset:1024
	ds_read_b64_tr_b16 a[220:221], v21 offset:2048
	ds_read_b64_tr_b16 a[222:223], v21 offset:3072
	s_waitcnt lgkmcnt(8)
	ds_read_b64_tr_b16 a[224:225], v21 offset:16384
	ds_read_b64_tr_b16 a[226:227], v21 offset:17408
	ds_read_b64_tr_b16 a[228:229], v21 offset:18432
	ds_read_b64_tr_b16 a[230:231], v21 offset:19456
	ds_read_b64_tr_b16 a[232:233], v21 offset:32768
	ds_read_b64_tr_b16 a[234:235], v21 offset:33792
	ds_read_b64_tr_b16 a[236:237], v21 offset:34816
	ds_read_b64_tr_b16 a[238:239], v21 offset:35840
	s_waitcnt lgkmcnt(0)
	s_barrier
	s_load_dwordx2 s[22:23], s[0:1], 56
	s_waitcnt lgkmcnt(0)
	s_mov_b32 s8, s22
	s_and_b32 s9, s23, 0xffff
	s_mov_b32 s10, 0x480000
	s_mov_b32 s11, 0x00020000
	s_lshl_b32 s70, s26, 8
	s_lshl_b32 s63, s15, 10
	s_add_u32 s63, s63, 16384
	s_lshl_b32 s62, s15, 13
	s_add_u32 s62, s62, s70
	s_add_u32 s62, s62, 131072
	s_mov_b32 m0, s63
	s_nop 0
	buffer_load_dwordx4 v26, s[8:11], s62 offen lds
	s_add_u32 s63, s63, 4096
	s_lshl_b32 s62, s15, 13
	s_add_u32 s62, s62, s70
	s_add_u32 s62, s62, 163840
	s_mov_b32 m0, s63
	s_nop 0
	buffer_load_dwordx4 v27, s[8:11], s62 offen lds
	s_add_u32 s63, s63, 4096
	s_lshl_b32 s62, s15, 13
	s_add_u32 s62, s62, s70
	s_add_u32 s62, s62, 196608
	s_mov_b32 m0, s63
	s_nop 0
	buffer_load_dwordx4 v26, s[8:11], s62 offen lds
	s_add_u32 s63, s63, 4096
	s_lshl_b32 s62, s15, 13
	s_add_u32 s62, s62, s70
	s_add_u32 s62, s62, 229376
	s_mov_b32 m0, s63
	s_nop 0
	buffer_load_dwordx4 v27, s[8:11], s62 offen lds
	s_add_u32 s63, s63, 4096
	s_lshl_b32 s62, s15, 13
	s_add_u32 s62, s62, s70
	s_add_u32 s62, s62, 655360
	s_mov_b32 m0, s63
	s_nop 0
	buffer_load_dwordx4 v26, s[8:11], s62 offen lds
	s_add_u32 s63, s63, 4096
	s_lshl_b32 s62, s15, 13
	s_add_u32 s62, s62, s70
	s_add_u32 s62, s62, 688128
	s_mov_b32 m0, s63
	s_nop 0
	buffer_load_dwordx4 v27, s[8:11], s62 offen lds
	s_add_u32 s63, s63, 4096
	s_lshl_b32 s62, s15, 13
	s_add_u32 s62, s62, s70
	s_add_u32 s62, s62, 720896
	s_mov_b32 m0, s63
	s_nop 0
	buffer_load_dwordx4 v26, s[8:11], s62 offen lds
	s_add_u32 s63, s63, 4096
	s_lshl_b32 s62, s15, 13
	s_add_u32 s62, s62, s70
	s_add_u32 s62, s62, 753664
	s_mov_b32 m0, s63
	s_nop 0
	buffer_load_dwordx4 v27, s[8:11], s62 offen lds
	s_add_u32 s63, s63, 4096
	s_lshl_b32 s62, s15, 13
	s_add_u32 s62, s62, s70
	s_add_u32 s62, s62, 1310720
	s_mov_b32 m0, s63
	s_nop 0
	buffer_load_dwordx4 v26, s[8:11], s62 offen lds
	s_add_u32 s63, s63, 4096
	s_lshl_b32 s62, s15, 13
	s_add_u32 s62, s62, s70
	s_add_u32 s62, s62, 1343488
	s_mov_b32 m0, s63
	s_nop 0
	buffer_load_dwordx4 v27, s[8:11], s62 offen lds
	s_add_u32 s63, s63, 4096
	s_lshl_b32 s62, s15, 13
	s_add_u32 s62, s62, s70
	s_add_u32 s62, s62, 1376256
	s_mov_b32 m0, s63
	s_nop 0
	buffer_load_dwordx4 v26, s[8:11], s62 offen lds
	s_add_u32 s63, s63, 4096
	s_lshl_b32 s62, s15, 13
	s_add_u32 s62, s62, s70
	s_add_u32 s62, s62, 1409024
	s_mov_b32 m0, s63
	s_nop 0
	buffer_load_dwordx4 v27, s[8:11], s62 offen lds
	s_waitcnt vmcnt(24)
	s_barrier
	ds_read_b64_tr_b16 a[168:169], v22 offset:0
	ds_read_b64_tr_b16 a[170:171], v22 offset:1024
	ds_read_b64_tr_b16 a[172:173], v22 offset:2048
	ds_read_b64_tr_b16 a[174:175], v22 offset:3072
	ds_read_b64_tr_b16 a[176:177], v22 offset:16384
	ds_read_b64_tr_b16 a[178:179], v22 offset:17408
	ds_read_b64_tr_b16 a[180:181], v22 offset:18432
	ds_read_b64_tr_b16 a[182:183], v22 offset:19456
	s_waitcnt lgkmcnt(8)
	ds_read_b64_tr_b16 a[184:185], v22 offset:32768
	ds_read_b64_tr_b16 a[186:187], v22 offset:33792
	ds_read_b64_tr_b16 a[188:189], v22 offset:34816
	ds_read_b64_tr_b16 a[190:191], v22 offset:35840
	ds_read_b64_tr_b16 a[240:241], v23 offset:0
	ds_read_b64_tr_b16 a[242:243], v23 offset:1024
	ds_read_b64_tr_b16 a[244:245], v23 offset:2048
	ds_read_b64_tr_b16 a[246:247], v23 offset:3072
	s_waitcnt lgkmcnt(8)
	ds_read_b64_tr_b16 a[248:249], v23 offset:16384
	ds_read_b64_tr_b16 a[250:251], v23 offset:17408
	ds_read_b64_tr_b16 a[252:253], v23 offset:18432
	ds_read_b64_tr_b16 a[254:255], v23 offset:19456
	ds_read_b64_tr_b16 v[64:65], v23 offset:32768
	ds_read_b64_tr_b16 v[66:67], v23 offset:33792
	ds_read_b64_tr_b16 v[68:69], v23 offset:34816
	ds_read_b64_tr_b16 v[70:71], v23 offset:35840
	s_waitcnt lgkmcnt(0)
	s_barrier
	s_load_dwordx2 s[22:23], s[0:1], 56
	s_waitcnt lgkmcnt(0)
	s_mov_b32 s8, s22
	s_and_b32 s9, s23, 0xffff
	s_mov_b32 s10, 0x480000
	s_mov_b32 s11, 0x00020000
	s_lshl_b32 s70, s26, 8
	s_lshl_b32 s63, s15, 10
	s_add_u32 s63, s63, 65536
	s_lshl_b32 s62, s15, 13
	s_add_u32 s62, s62, s70
	s_add_u32 s62, s62, 1835008
	s_mov_b32 m0, s63
	s_nop 0
	buffer_load_dwordx4 v26, s[8:11], s62 offen lds
	s_add_u32 s63, s63, 4096
	s_lshl_b32 s62, s15, 13
	s_add_u32 s62, s62, s70
	s_add_u32 s62, s62, 1867776
	s_mov_b32 m0, s63
	s_nop 0
	buffer_load_dwordx4 v27, s[8:11], s62 offen lds
	s_add_u32 s63, s63, 4096
	s_lshl_b32 s62, s15, 13
	s_add_u32 s62, s62, s70
	s_add_u32 s62, s62, 1900544
	s_mov_b32 m0, s63
	s_nop 0
	buffer_load_dwordx4 v26, s[8:11], s62 offen lds
	s_add_u32 s63, s63, 4096
	s_lshl_b32 s62, s15, 13
	s_add_u32 s62, s62, s70
	s_add_u32 s62, s62, 1933312
	s_mov_b32 m0, s63
	s_nop 0
	buffer_load_dwordx4 v27, s[8:11], s62 offen lds
	s_add_u32 s63, s63, 4096
	s_lshl_b32 s62, s15, 13
	s_add_u32 s62, s62, s70
	s_add_u32 s62, s62, 2490368
	s_mov_b32 m0, s63
	s_nop 0
	buffer_load_dwordx4 v26, s[8:11], s62 offen lds
	s_add_u32 s63, s63, 4096
	s_lshl_b32 s62, s15, 13
	s_add_u32 s62, s62, s70
	s_add_u32 s62, s62, 2523136
	s_mov_b32 m0, s63
	s_nop 0
	buffer_load_dwordx4 v27, s[8:11], s62 offen lds
	s_add_u32 s63, s63, 4096
	s_lshl_b32 s62, s15, 13
	s_add_u32 s62, s62, s70
	s_add_u32 s62, s62, 2555904
	s_mov_b32 m0, s63
	s_nop 0
	buffer_load_dwordx4 v26, s[8:11], s62 offen lds
	s_add_u32 s63, s63, 4096
	s_lshl_b32 s62, s15, 13
	s_add_u32 s62, s62, s70
	s_add_u32 s62, s62, 2588672
	s_mov_b32 m0, s63
	s_nop 0
	buffer_load_dwordx4 v27, s[8:11], s62 offen lds
	s_add_u32 s63, s63, 4096
	s_lshl_b32 s62, s15, 13
	s_add_u32 s62, s62, s70
	s_add_u32 s62, s62, 3014656
	s_mov_b32 m0, s63
	s_nop 0
	buffer_load_dwordx4 v26, s[8:11], s62 offen lds
	s_add_u32 s63, s63, 4096
	s_lshl_b32 s62, s15, 13
	s_add_u32 s62, s62, s70
	s_add_u32 s62, s62, 3047424
	s_mov_b32 m0, s63
	s_nop 0
	buffer_load_dwordx4 v27, s[8:11], s62 offen lds
	s_add_u32 s63, s63, 4096
	s_lshl_b32 s62, s15, 13
	s_add_u32 s62, s62, s70
	s_add_u32 s62, s62, 3080192
	s_mov_b32 m0, s63
	s_nop 0
	buffer_load_dwordx4 v26, s[8:11], s62 offen lds
	s_add_u32 s63, s63, 4096
	s_lshl_b32 s62, s15, 13
	s_add_u32 s62, s62, s70
	s_add_u32 s62, s62, 3112960
	s_mov_b32 m0, s63
	s_nop 0
	buffer_load_dwordx4 v27, s[8:11], s62 offen lds
	s_waitcnt vmcnt(24)
	s_barrier
	ds_read_b64_tr_b16 a[192:193], v24 offset:0
	ds_read_b64_tr_b16 a[194:195], v24 offset:1024
	ds_read_b64_tr_b16 a[196:197], v24 offset:2048
	ds_read_b64_tr_b16 a[198:199], v24 offset:3072
	ds_read_b64_tr_b16 a[200:201], v24 offset:16384
	ds_read_b64_tr_b16 a[202:203], v24 offset:17408
	ds_read_b64_tr_b16 a[204:205], v24 offset:18432
	ds_read_b64_tr_b16 a[206:207], v24 offset:19456
	s_waitcnt lgkmcnt(8)
	ds_read_b64_tr_b16 a[208:209], v24 offset:32768
	ds_read_b64_tr_b16 a[210:211], v24 offset:33792
	ds_read_b64_tr_b16 a[212:213], v24 offset:34816
	ds_read_b64_tr_b16 a[214:215], v24 offset:35840
	ds_read_b64_tr_b16 v[72:73], v25 offset:0
	ds_read_b64_tr_b16 v[74:75], v25 offset:1024
	ds_read_b64_tr_b16 v[76:77], v25 offset:2048
	ds_read_b64_tr_b16 v[78:79], v25 offset:3072
	s_waitcnt lgkmcnt(8)
	ds_read_b64_tr_b16 v[80:81], v25 offset:16384
	ds_read_b64_tr_b16 v[82:83], v25 offset:17408
	ds_read_b64_tr_b16 v[84:85], v25 offset:18432
	ds_read_b64_tr_b16 v[86:87], v25 offset:19456
	ds_read_b64_tr_b16 v[88:89], v25 offset:32768
	ds_read_b64_tr_b16 v[90:91], v25 offset:33792
	ds_read_b64_tr_b16 v[92:93], v25 offset:34816
	ds_read_b64_tr_b16 v[94:95], v25 offset:35840
	s_waitcnt lgkmcnt(0)
	s_barrier
	s_load_dwordx2 s[22:23], s[0:1], 56
	s_waitcnt lgkmcnt(0)
	s_mov_b32 s8, s22
	s_and_b32 s9, s23, 0xffff
	s_mov_b32 s10, 0x480000
	s_mov_b32 s11, 0x00020000
	s_lshl_b32 s70, s26, 8
	s_lshl_b32 s63, s15, 10
	s_add_u32 s63, s63, 114688
	s_lshl_b32 s62, s15, 13
	s_add_u32 s62, s62, s70
	s_add_u32 s62, s62, 3670016
	s_mov_b32 m0, s63
	s_nop 0
	buffer_load_dwordx4 v26, s[8:11], s62 offen lds
	s_add_u32 s63, s63, 4096
	s_lshl_b32 s62, s15, 13
	s_add_u32 s62, s62, s70
	s_add_u32 s62, s62, 3702784
	s_mov_b32 m0, s63
	s_nop 0
	buffer_load_dwordx4 v27, s[8:11], s62 offen lds
	s_add_u32 s63, s63, 4096
	s_lshl_b32 s62, s15, 13
	s_add_u32 s62, s62, s70
	s_add_u32 s62, s62, 3735552
	s_mov_b32 m0, s63
	s_nop 0
	buffer_load_dwordx4 v26, s[8:11], s62 offen lds
	s_add_u32 s63, s63, 4096
	s_lshl_b32 s62, s15, 13
	s_add_u32 s62, s62, s70
	s_add_u32 s62, s62, 3768320
	s_mov_b32 m0, s63
	s_nop 0
	buffer_load_dwordx4 v27, s[8:11], s62 offen lds
	s_add_u32 s63, s63, 4096
	s_lshl_b32 s62, s15, 13
	s_add_u32 s62, s62, s70
	s_add_u32 s62, s62, 4194304
	s_mov_b32 m0, s63
	s_nop 0
	buffer_load_dwordx4 v26, s[8:11], s62 offen lds
	s_add_u32 s63, s63, 4096
	s_lshl_b32 s62, s15, 13
	s_add_u32 s62, s62, s70
	s_add_u32 s62, s62, 4227072
	s_mov_b32 m0, s63
	s_nop 0
	buffer_load_dwordx4 v27, s[8:11], s62 offen lds
	s_add_u32 s63, s63, 4096
	s_lshl_b32 s62, s15, 13
	s_add_u32 s62, s62, s70
	s_add_u32 s62, s62, 4259840
	s_mov_b32 m0, s63
	s_nop 0
	buffer_load_dwordx4 v26, s[8:11], s62 offen lds
	s_add_u32 s63, s63, 4096
	s_lshl_b32 s62, s15, 13
	s_add_u32 s62, s62, s70
	s_add_u32 s62, s62, 4292608
	s_mov_b32 m0, s63
	s_nop 0
	buffer_load_dwordx4 v27, s[8:11], s62 offen lds
	s_add_u32 s63, s63, 4096
	s_lshl_b32 s62, s15, 15
	s_add_u32 s62, s62, s70
	s_mov_b32 m0, s63
	s_nop 0
	buffer_load_dwordx4 v8, s[8:11], s62 offen lds
	s_add_u32 s63, s63, 4096
	s_lshl_b32 s62, s15, 15
	s_add_u32 s62, s62, s70
	s_add_u32 s62, s62, 1179648
	s_mov_b32 m0, s63
	s_nop 0
	buffer_load_dwordx4 v9, s[8:11], s62 offen lds
	s_add_u32 s63, s63, 4096
	s_lshl_b32 s62, s15, 15
	s_add_u32 s62, s62, s70
	s_add_u32 s62, s62, 2359296
	s_mov_b32 m0, s63
	s_nop 0
	buffer_load_dwordx4 v8, s[8:11], s62 offen lds
	s_add_u32 s63, s63, 4096
	s_lshl_b32 s62, s15, 15
	s_add_u32 s62, s62, s70
	s_add_u32 s62, s62, 3538944
	s_mov_b32 m0, s63
	s_nop 0
	buffer_load_dwordx4 v9, s[8:11], s62 offen lds
	s_waitcnt vmcnt(24)
	s_barrier
	ds_read_b64_tr_b16 v[96:97], v20 offset:0
	ds_read_b64_tr_b16 v[98:99], v20 offset:1024
	ds_read_b64_tr_b16 v[100:101], v20 offset:2048
	ds_read_b64_tr_b16 v[102:103], v20 offset:3072
	ds_read_b64_tr_b16 v[104:105], v20 offset:16384
	ds_read_b64_tr_b16 v[106:107], v20 offset:17408
	ds_read_b64_tr_b16 v[108:109], v20 offset:18432
	ds_read_b64_tr_b16 v[110:111], v20 offset:19456
	s_waitcnt lgkmcnt(8)
	ds_read_b64_tr_b16 v[112:113], v20 offset:32768
	ds_read_b64_tr_b16 v[114:115], v20 offset:33792
	ds_read_b64_tr_b16 v[116:117], v20 offset:34816
	ds_read_b64_tr_b16 v[118:119], v20 offset:35840
	ds_read_b64_tr_b16 v[168:169], v21 offset:0
	ds_read_b64_tr_b16 v[170:171], v21 offset:1024
	ds_read_b64_tr_b16 v[172:173], v21 offset:2048
	ds_read_b64_tr_b16 v[174:175], v21 offset:3072
	s_waitcnt lgkmcnt(8)
	ds_read_b64_tr_b16 v[176:177], v21 offset:16384
	ds_read_b64_tr_b16 v[178:179], v21 offset:17408
	ds_read_b64_tr_b16 v[180:181], v21 offset:18432
	ds_read_b64_tr_b16 v[182:183], v21 offset:19456
	ds_read_b64_tr_b16 v[184:185], v21 offset:32768
	ds_read_b64_tr_b16 v[186:187], v21 offset:33792
	ds_read_b64_tr_b16 v[188:189], v21 offset:34816
	ds_read_b64_tr_b16 v[190:191], v21 offset:35840
	s_waitcnt lgkmcnt(0)
	s_barrier
	s_load_dwordx2 s[22:23], s[0:1], 64
	s_waitcnt lgkmcnt(0)
	s_mov_b32 s8, s22
	s_and_b32 s9, s23, 0xffff
	s_mov_b32 s10, 0x480000
	s_mov_b32 s11, 0x00020000
	s_mul_i32 s62, s26, 147456
	s_lshl_b32 s63, s15, 10
	s_add_u32 s62, s62, s63
	s_add_u32 s63, s63, 16384
	s_mov_b32 m0, s63
	s_nop 0
	buffer_load_dwordx4 v0, s[8:11], s62 offen lds
	s_add_u32 s62, s62, 4096
	s_add_u32 s63, s63, 4096
	s_mov_b32 m0, s63
	s_nop 0
	buffer_load_dwordx4 v0, s[8:11], s62 offen lds
	s_add_u32 s62, s62, 4096
	s_add_u32 s63, s63, 4096
	s_mov_b32 m0, s63
	s_nop 0
	buffer_load_dwordx4 v0, s[8:11], s62 offen lds
	s_add_u32 s62, s62, 4096
	s_add_u32 s63, s63, 4096
	s_mov_b32 m0, s63
	s_nop 0
	buffer_load_dwordx4 v0, s[8:11], s62 offen lds
	s_add_u32 s62, s62, 4096
	s_add_u32 s63, s63, 4096
	s_mov_b32 m0, s63
	s_nop 0
	buffer_load_dwordx4 v0, s[8:11], s62 offen lds
	s_add_u32 s62, s62, 4096
	s_add_u32 s63, s63, 4096
	s_mov_b32 m0, s63
	s_nop 0
	buffer_load_dwordx4 v0, s[8:11], s62 offen lds
	s_add_u32 s62, s62, 4096
	s_add_u32 s63, s63, 4096
	s_mov_b32 m0, s63
	s_nop 0
	buffer_load_dwordx4 v0, s[8:11], s62 offen lds
	s_add_u32 s62, s62, 4096
	s_add_u32 s63, s63, 4096
	s_mov_b32 m0, s63
	s_nop 0
	buffer_load_dwordx4 v0, s[8:11], s62 offen lds
	s_add_u32 s62, s62, 4096
	s_add_u32 s63, s63, 4096
	s_mov_b32 m0, s63
	s_nop 0
	buffer_load_dwordx4 v0, s[8:11], s62 offen lds
	s_waitcnt vmcnt(21)
	s_barrier
	ds_read_b64_tr_b16 v[120:121], v22 offset:0
	ds_read_b64_tr_b16 v[122:123], v22 offset:1024
	ds_read_b64_tr_b16 v[124:125], v22 offset:2048
	ds_read_b64_tr_b16 v[126:127], v22 offset:3072
	ds_read_b64_tr_b16 v[128:129], v22 offset:16384
	ds_read_b64_tr_b16 v[130:131], v22 offset:17408
	ds_read_b64_tr_b16 v[132:133], v22 offset:18432
	ds_read_b64_tr_b16 v[134:135], v22 offset:19456
	s_waitcnt lgkmcnt(8)
	ds_read_b64_tr_b16 v[136:137], v22 offset:32768
	ds_read_b64_tr_b16 v[138:139], v22 offset:33792
	ds_read_b64_tr_b16 v[140:141], v22 offset:34816
	ds_read_b64_tr_b16 v[142:143], v22 offset:35840
	ds_read_b64_tr_b16 v[192:193], v23 offset:0
	ds_read_b64_tr_b16 v[194:195], v23 offset:1024
	ds_read_b64_tr_b16 v[196:197], v23 offset:2048
	ds_read_b64_tr_b16 v[198:199], v23 offset:3072
	s_waitcnt lgkmcnt(8)
	ds_read_b64_tr_b16 v[200:201], v23 offset:16384
	ds_read_b64_tr_b16 v[202:203], v23 offset:17408
	ds_read_b64_tr_b16 v[204:205], v23 offset:18432
	ds_read_b64_tr_b16 v[206:207], v23 offset:19456
	ds_read_b64_tr_b16 v[208:209], v23 offset:32768
	ds_read_b64_tr_b16 v[210:211], v23 offset:33792
	ds_read_b64_tr_b16 v[212:213], v23 offset:34816
	ds_read_b64_tr_b16 v[214:215], v23 offset:35840
	s_waitcnt lgkmcnt(0)
	s_barrier
	s_load_dwordx2 s[22:23], s[0:1], 64
	s_waitcnt lgkmcnt(0)
	s_mov_b32 s8, s22
	s_and_b32 s9, s23, 0xffff
	s_mov_b32 s10, 0x480000
	s_mov_b32 s11, 0x00020000
	s_mul_i32 s62, s26, 147456
	s_lshl_b32 s63, s15, 10
	s_add_u32 s62, s62, s63
	s_add_u32 s62, s62, 36864
	s_add_u32 s63, s63, 53248
	s_mov_b32 m0, s63
	s_nop 0
	buffer_load_dwordx4 v0, s[8:11], s62 offen lds
	s_add_u32 s62, s62, 4096
	s_add_u32 s63, s63, 4096
	s_mov_b32 m0, s63
	s_nop 0
	buffer_load_dwordx4 v0, s[8:11], s62 offen lds
	s_add_u32 s62, s62, 4096
	s_add_u32 s63, s63, 4096
	s_mov_b32 m0, s63
	s_nop 0
	buffer_load_dwordx4 v0, s[8:11], s62 offen lds
	s_add_u32 s62, s62, 4096
	s_add_u32 s63, s63, 4096
	s_mov_b32 m0, s63
	s_nop 0
	buffer_load_dwordx4 v0, s[8:11], s62 offen lds
	s_add_u32 s62, s62, 4096
	s_add_u32 s63, s63, 4096
	s_mov_b32 m0, s63
	s_nop 0
	buffer_load_dwordx4 v0, s[8:11], s62 offen lds
	s_add_u32 s62, s62, 4096
	s_add_u32 s63, s63, 4096
	s_mov_b32 m0, s63
	s_nop 0
	buffer_load_dwordx4 v0, s[8:11], s62 offen lds
	s_add_u32 s62, s62, 4096
	s_add_u32 s63, s63, 4096
	s_mov_b32 m0, s63
	s_nop 0
	buffer_load_dwordx4 v0, s[8:11], s62 offen lds
	s_add_u32 s62, s62, 4096
	s_add_u32 s63, s63, 4096
	s_mov_b32 m0, s63
	s_nop 0
	buffer_load_dwordx4 v0, s[8:11], s62 offen lds
	s_add_u32 s62, s62, 4096
	s_add_u32 s63, s63, 4096
	s_mov_b32 m0, s63
	s_nop 0
	buffer_load_dwordx4 v0, s[8:11], s62 offen lds
	s_waitcnt vmcnt(18)
	s_barrier
	ds_read_b64_tr_b16 v[144:145], v24 offset:0
	ds_read_b64_tr_b16 v[146:147], v24 offset:1024
	ds_read_b64_tr_b16 v[148:149], v24 offset:2048
	ds_read_b64_tr_b16 v[150:151], v24 offset:3072
	ds_read_b64_tr_b16 v[152:153], v24 offset:16384
	ds_read_b64_tr_b16 v[154:155], v24 offset:17408
	ds_read_b64_tr_b16 v[156:157], v24 offset:18432
	ds_read_b64_tr_b16 v[158:159], v24 offset:19456
	s_waitcnt lgkmcnt(8)
	ds_read_b64_tr_b16 v[160:161], v24 offset:32768
	ds_read_b64_tr_b16 v[162:163], v24 offset:33792
	ds_read_b64_tr_b16 v[164:165], v24 offset:34816
	ds_read_b64_tr_b16 v[166:167], v24 offset:35840
	ds_read_b64_tr_b16 v[216:217], v25 offset:0
	ds_read_b64_tr_b16 v[218:219], v25 offset:1024
	ds_read_b64_tr_b16 v[220:221], v25 offset:2048
	ds_read_b64_tr_b16 v[222:223], v25 offset:3072
	s_waitcnt lgkmcnt(8)
	ds_read_b64_tr_b16 v[224:225], v25 offset:16384
	ds_read_b64_tr_b16 v[226:227], v25 offset:17408
	ds_read_b64_tr_b16 v[228:229], v25 offset:18432
	ds_read_b64_tr_b16 v[230:231], v25 offset:19456
	ds_read_b64_tr_b16 v[232:233], v25 offset:32768
	ds_read_b64_tr_b16 v[234:235], v25 offset:33792
	ds_read_b64_tr_b16 v[236:237], v25 offset:34816
	ds_read_b64_tr_b16 v[238:239], v25 offset:35840
	s_waitcnt lgkmcnt(0)
	s_barrier
	s_load_dwordx2 s[22:23], s[0:1], 64
	s_waitcnt lgkmcnt(0)
	s_mov_b32 s8, s22
	s_and_b32 s9, s23, 0xffff
	s_mov_b32 s10, 0x480000
	s_mov_b32 s11, 0x00020000
	s_mul_i32 s62, s26, 147456
	s_lshl_b32 s63, s15, 10
	s_add_u32 s62, s62, s63
	s_add_u32 s62, s62, 73728
	s_add_u32 s63, s63, 90112
	s_mov_b32 m0, s63
	s_nop 0
	buffer_load_dwordx4 v0, s[8:11], s62 offen lds
	s_add_u32 s62, s62, 4096
	s_add_u32 s63, s63, 4096
	s_mov_b32 m0, s63
	s_nop 0
	buffer_load_dwordx4 v0, s[8:11], s62 offen lds
	s_add_u32 s62, s62, 4096
	s_add_u32 s63, s63, 4096
	s_mov_b32 m0, s63
	s_nop 0
	buffer_load_dwordx4 v0, s[8:11], s62 offen lds
	s_add_u32 s62, s62, 4096
	s_add_u32 s63, s63, 4096
	s_mov_b32 m0, s63
	s_nop 0
	buffer_load_dwordx4 v0, s[8:11], s62 offen lds
	s_add_u32 s62, s62, 4096
	s_add_u32 s63, s63, 4096
	s_mov_b32 m0, s63
	s_nop 0
	buffer_load_dwordx4 v0, s[8:11], s62 offen lds
	s_add_u32 s62, s62, 4096
	s_add_u32 s63, s63, 4096
	s_mov_b32 m0, s63
	s_nop 0
	buffer_load_dwordx4 v0, s[8:11], s62 offen lds
	s_add_u32 s62, s62, 4096
	s_add_u32 s63, s63, 4096
	s_mov_b32 m0, s63
	s_nop 0
	buffer_load_dwordx4 v0, s[8:11], s62 offen lds
	s_add_u32 s62, s62, 4096
	s_add_u32 s63, s63, 4096
	s_mov_b32 m0, s63
	s_nop 0
	buffer_load_dwordx4 v0, s[8:11], s62 offen lds
	s_add_u32 s62, s62, 4096
	s_add_u32 s63, s63, 4096
	s_mov_b32 m0, s63
	s_nop 0
	buffer_load_dwordx4 v0, s[8:11], s62 offen lds
	s_load_dwordx2 s[22:23], s[0:1], 64
	s_waitcnt lgkmcnt(0)
	s_mov_b32 s8, s22
	s_and_b32 s9, s23, 0xffff
	s_mov_b32 s10, 0x480000
	s_mov_b32 s11, 0x00020000
	s_mul_i32 s62, s26, 147456
	s_lshl_b32 s63, s15, 10
	s_add_u32 s62, s62, s63
	s_add_u32 s62, s62, 110592
	s_add_u32 s63, s63, 126976
	s_mov_b32 m0, s63
	s_nop 0
	buffer_load_dwordx4 v0, s[8:11], s62 offen lds
	s_add_u32 s62, s62, 4096
	s_add_u32 s63, s63, 4096
	s_mov_b32 m0, s63
	s_nop 0
	buffer_load_dwordx4 v0, s[8:11], s62 offen lds
	s_add_u32 s62, s62, 4096
	s_add_u32 s63, s63, 4096
	s_mov_b32 m0, s63
	s_nop 0
	buffer_load_dwordx4 v0, s[8:11], s62 offen lds
	s_add_u32 s62, s62, 4096
	s_add_u32 s63, s63, 4096
	s_mov_b32 m0, s63
	s_nop 0
	buffer_load_dwordx4 v0, s[8:11], s62 offen lds
	s_add_u32 s62, s62, 4096
	s_add_u32 s63, s63, 4096
	s_mov_b32 m0, s63
	s_nop 0
	buffer_load_dwordx4 v0, s[8:11], s62 offen lds
	s_add_u32 s62, s62, 4096
	s_add_u32 s63, s63, 4096
	s_mov_b32 m0, s63
	s_nop 0
	buffer_load_dwordx4 v0, s[8:11], s62 offen lds
	s_add_u32 s62, s62, 4096
	s_add_u32 s63, s63, 4096
	s_mov_b32 m0, s63
	s_nop 0
	buffer_load_dwordx4 v0, s[8:11], s62 offen lds
	s_add_u32 s62, s62, 4096
	s_add_u32 s63, s63, 4096
	s_mov_b32 m0, s63
	s_nop 0
	buffer_load_dwordx4 v0, s[8:11], s62 offen lds
	s_add_u32 s62, s62, 4096
	s_add_u32 s63, s63, 4096
	s_mov_b32 m0, s63
	s_nop 0
	buffer_load_dwordx4 v0, s[8:11], s62 offen lds
	v_lshrrev_b32 v10, 2, v61
	v_and_b32 v11, 3, v61
	v_lshlrev_b32 v12, 2, v60
	v_add_u32 v12, v12, v10
	v_mul_u32_u24 v12, 1152, v12
	v_lshlrev_b32 v11, 3, v11
	v_add_u32 v12, v12, v11
	s_mul_i32 s17, s15, 288
	s_add_u32 s17, s17, 126976
	v_add_u32 v12, s17, v12
	s_lshl_b32 s67, s15, 13
	s_add_u32 s67, s67, 31744
	s_add_u32 s17, s67, 98304
	v_add_u32 v13, s17, v0
	s_waitcnt vmcnt(0)
	s_barrier
	s_or_b32 s17, s15, s27
	s_cmp_lg_u32 s17, 0
	s_cbranch_scc1 .isig_26
	v_mov_b32 v20, 0
	v_mov_b32 v21, 1
	s_mov_b64 exec, 1
	global_atomic_add v20, v21, s[12:13] offset:176
	s_mov_b64 exec, -1
.isig_26:
	ds_read_b64_tr_b16 v[252:253], v12 offset:0
	ds_read_b64_tr_b16 v[254:255], v12 offset:18432
	ds_read_b64_tr_b16 v[24:25], v12 offset:32
	ds_read_b64_tr_b16 v[26:27], v12 offset:18464
	ds_read_b64_tr_b16 v[28:29], v12 offset:64
	ds_read_b64_tr_b16 v[30:31], v12 offset:18496
	ds_read_b64_tr_b16 v[32:33], v12 offset:96
	ds_read_b64_tr_b16 v[34:35], v12 offset:18528
	ds_read_b64_tr_b16 v[36:37], v12 offset:128
	ds_read_b64_tr_b16 v[38:39], v12 offset:18560
	ds_read_b64_tr_b16 v[40:41], v12 offset:160
	ds_read_b64_tr_b16 v[42:43], v12 offset:18592
	ds_read_b64_tr_b16 v[44:45], v12 offset:192
	ds_read_b64_tr_b16 v[46:47], v12 offset:18624
	ds_read_b64_tr_b16 v[48:49], v12 offset:224
	ds_read_b64_tr_b16 v[50:51], v12 offset:18656
	ds_read_b64_tr_b16 v[52:53], v12 offset:256
	ds_read_b64_tr_b16 v[54:55], v12 offset:18688
	s_waitcnt lgkmcnt(0)
	s_barrier
	ds_write_b128 v13, v[24:27] offset:0
	ds_write_b128 v13, v[28:31] offset:1024
	ds_write_b128 v13, v[32:35] offset:2048
	ds_write_b128 v13, v[36:39] offset:3072
	ds_write_b128 v13, v[40:43] offset:4096
	ds_write_b128 v13, v[44:47] offset:5120
	ds_write_b128 v13, v[48:51] offset:6144
	ds_write_b128 v13, v[52:55] offset:7168
	v_subrev_u32 v12, 36864, v12
	v_subrev_u32 v13, 32768, v13
	s_waitcnt lgkmcnt(0)
	ds_read_b64_tr_b16 v[248:249], v12 offset:0
	ds_read_b64_tr_b16 v[250:251], v12 offset:18432
	ds_read_b64_tr_b16 v[24:25], v12 offset:32
	ds_read_b64_tr_b16 v[26:27], v12 offset:18464
	ds_read_b64_tr_b16 v[28:29], v12 offset:64
	ds_read_b64_tr_b16 v[30:31], v12 offset:18496
	ds_read_b64_tr_b16 v[32:33], v12 offset:96
	ds_read_b64_tr_b16 v[34:35], v12 offset:18528
	ds_read_b64_tr_b16 v[36:37], v12 offset:128
	ds_read_b64_tr_b16 v[38:39], v12 offset:18560
	ds_read_b64_tr_b16 v[40:41], v12 offset:160
	ds_read_b64_tr_b16 v[42:43], v12 offset:18592
	ds_read_b64_tr_b16 v[44:45], v12 offset:192
	ds_read_b64_tr_b16 v[46:47], v12 offset:18624
	ds_read_b64_tr_b16 v[48:49], v12 offset:224
	ds_read_b64_tr_b16 v[50:51], v12 offset:18656
	ds_read_b64_tr_b16 v[52:53], v12 offset:256
	ds_read_b64_tr_b16 v[54:55], v12 offset:18688
	s_waitcnt lgkmcnt(0)
	s_barrier
	ds_write_b128 v13, v[24:27] offset:0
	ds_write_b128 v13, v[28:31] offset:1024
	ds_write_b128 v13, v[32:35] offset:2048
	ds_write_b128 v13, v[36:39] offset:3072
	ds_write_b128 v13, v[40:43] offset:4096
	ds_write_b128 v13, v[44:47] offset:5120
	ds_write_b128 v13, v[48:51] offset:6144
	ds_write_b128 v13, v[52:55] offset:7168
	v_subrev_u32 v12, 36864, v12
	v_subrev_u32 v13, 32768, v13
	s_waitcnt lgkmcnt(0)
	ds_read_b64_tr_b16 v[244:245], v12 offset:0
	ds_read_b64_tr_b16 v[246:247], v12 offset:18432
	ds_read_b64_tr_b16 v[24:25], v12 offset:32
	ds_read_b64_tr_b16 v[26:27], v12 offset:18464
	ds_read_b64_tr_b16 v[28:29], v12 offset:64
	ds_read_b64_tr_b16 v[30:31], v12 offset:18496
	ds_read_b64_tr_b16 v[32:33], v12 offset:96
	ds_read_b64_tr_b16 v[34:35], v12 offset:18528
	ds_read_b64_tr_b16 v[36:37], v12 offset:128
	ds_read_b64_tr_b16 v[38:39], v12 offset:18560
	ds_read_b64_tr_b16 v[40:41], v12 offset:160
	ds_read_b64_tr_b16 v[42:43], v12 offset:18592
	ds_read_b64_tr_b16 v[44:45], v12 offset:192
	ds_read_b64_tr_b16 v[46:47], v12 offset:18624
	ds_read_b64_tr_b16 v[48:49], v12 offset:224
	ds_read_b64_tr_b16 v[50:51], v12 offset:18656
	ds_read_b64_tr_b16 v[52:53], v12 offset:256
	ds_read_b64_tr_b16 v[54:55], v12 offset:18688
	s_waitcnt lgkmcnt(0)
	s_barrier
	ds_write_b128 v13, v[24:27] offset:0
	ds_write_b128 v13, v[28:31] offset:1024
	ds_write_b128 v13, v[32:35] offset:2048
	ds_write_b128 v13, v[36:39] offset:3072
	ds_write_b128 v13, v[40:43] offset:4096
	ds_write_b128 v13, v[44:47] offset:5120
	ds_write_b128 v13, v[48:51] offset:6144
	ds_write_b128 v13, v[52:55] offset:7168
	v_subrev_u32 v12, 36864, v12
	v_subrev_u32 v13, 32768, v13
	s_waitcnt lgkmcnt(0)
	ds_read_b64_tr_b16 v[240:241], v12 offset:0
	ds_read_b64_tr_b16 v[242:243], v12 offset:18432
	ds_read_b64_tr_b16 v[24:25], v12 offset:32
	ds_read_b64_tr_b16 v[26:27], v12 offset:18464
	ds_read_b64_tr_b16 v[28:29], v12 offset:64
	ds_read_b64_tr_b16 v[30:31], v12 offset:18496
	ds_read_b64_tr_b16 v[32:33], v12 offset:96
	ds_read_b64_tr_b16 v[34:35], v12 offset:18528
	ds_read_b64_tr_b16 v[36:37], v12 offset:128
	ds_read_b64_tr_b16 v[38:39], v12 offset:18560
	ds_read_b64_tr_b16 v[40:41], v12 offset:160
	ds_read_b64_tr_b16 v[42:43], v12 offset:18592
	ds_read_b64_tr_b16 v[44:45], v12 offset:192
	ds_read_b64_tr_b16 v[46:47], v12 offset:18624
	ds_read_b64_tr_b16 v[48:49], v12 offset:224
	ds_read_b64_tr_b16 v[50:51], v12 offset:18656
	ds_read_b64_tr_b16 v[52:53], v12 offset:256
	ds_read_b64_tr_b16 v[54:55], v12 offset:18688
	s_waitcnt lgkmcnt(0)
	s_barrier
	ds_write_b128 v13, v[24:27] offset:0
	ds_write_b128 v13, v[28:31] offset:1024
	ds_write_b128 v13, v[32:35] offset:2048
	ds_write_b128 v13, v[36:39] offset:3072
	ds_write_b128 v13, v[40:43] offset:4096
	ds_write_b128 v13, v[44:47] offset:5120
	ds_write_b128 v13, v[48:51] offset:6144
	ds_write_b128 v13, v[52:55] offset:7168
	s_waitcnt lgkmcnt(0)
	v_and_b32 v10, 2, v62
	v_cmp_eq_u32 vcc, 0, v10
	v_mov_b32 v11, 0xeeeeeeee
	v_mov_b32 v12, 0x44444444
	v_cndmask_b32 v2, v11, v12, vcc
	s_lshl_b32 s64, s15, 10
	s_lshl_b32 s65, s15, 8
	v_lshlrev_b32 v10, 5, v61
	v_lshlrev_b32 v11, 3, v60
	v_add_u32 v10, v10, v11
	s_add_u32 s17, s64, 9216
	v_add_u32 v5, s17, v10
	v_lshrrev_b32 v10, 1, v60
	v_lshlrev_b32 v10, 8, v10
	v_and_b32 v11, 1, v60
	v_lshlrev_b32 v11, 3, v11
	v_add_u32 v10, v10, v11
	v_lshlrev_b32 v11, 4, v61
	v_add_u32 v10, v10, v11
	s_lshl_b32 s17, s15, 9
	s_add_u32 s17, s17, 13280
	v_add_u32 v6, s17, v10
	v_lshrrev_b32 v10, 3, v62
	v_mul_u32_u24 v10, 9216, v10
	v_and_b32 v11, 7, v62
	v_lshlrev_b32 v12, 4, v11
	v_add_u32 v3, v10, v12
	v_bfe_u32 v12, v11, 1, 1
	v_lshlrev_b32 v10, 9, v12
	v_bfe_u32 v12, v62, 3, 1
	v_lshlrev_b32 v12, 5, v12
	v_add_u32 v10, v10, v12
	v_bfe_u32 v12, v62, 4, 1
	v_lshlrev_b32 v12, 4, v12
	v_add_u32 v10, v10, v12
	v_and_b32 v12, 1, v11
	v_lshlrev_b32 v12, 2, v12
	v_add_u32 v10, v10, v12
	v_lshrrev_b32 v12, 5, v62
	v_lshlrev_b32 v12, 14, v12
	v_add_u32 v10, v10, v12
	v_lshrrev_b32 v12, 2, v11
	s_cmp_eq_u32 s15, 1
	s_cselect_b32 s17, 6, 3
	v_lshlrev_b32 v12, s17, v12
	v_add_u32 v10, v10, v12
	s_lshr_b32 s17, s26, 3
	s_lshl_b32 s17, s17, 1
	s_and_b32 s18, s15, 1
	s_add_u32 s17, s17, s18
	s_lshl_b32 s17, s17, 10
	s_and_b32 s18, s26, 1
	s_lshl_b32 s18, s18, 8
	s_add_u32 s17, s17, s18
	s_bfe_u32 s18, s26, 0x20001
	s_lshl_b32 s18, s18, 6
	s_add_u32 s17, s17, s18
	s_bfe_u32 s18, s26, 0x10002
	s_lshl_b32 s18, s18, 8
	s_and_b32 s19, s26, 1
	s_lshl_b32 s19, s19, 7
	s_add_u32 s18, s18, s19
	s_bfe_u32 s19, s26, 0x10001
	s_lshl_b32 s19, s19, 3
	s_add_u32 s18, s18, s19
	s_add_u32 s18, s18, 8192
	s_cmp_eq_u32 s15, 1
	s_cselect_b32 s17, s18, s17
	v_add_u32 v4, s17, v10
	s_mul_i32 s17, s27, 589824
	s_add_u32 s17, s17, 65536
	s_lshr_b32 s18, s26, 3
	s_mul_i32 s18, s18, 2304
	s_and_b32 s19, s15, 1
	s_lshl_b32 s19, s19, 10
	s_add_u32 s18, s18, s19
	s_and_b32 s19, s26, 7
	s_lshl_b32 s19, s19, 7
	s_add_u32 s18, s18, s19
	s_add_u32 s18, s18, 256
	s_bfe_u32 s30, s26, 0x20001
	s_mul_i32 s30, s30, 2304
	s_and_b32 s19, s26, 1
	s_lshl_b32 s19, s19, 7
	s_add_u32 s30, s30, s19
	s_cmp_eq_u32 s15, 1
	s_cselect_b32 s18, s30, s18
	s_add_u32 s18, s18, s17
	s_add_u32 s30, s18, 0
	s_add_u32 s31, s18, 73728
	s_add_u32 s32, s18, 147456
	s_add_u32 s33, s18, 221184
	s_mul_i32 s18, s26, 9216
	s_add_u32 s38, s17, s18
	s_mul_i32 s18, s15, 2304
	s_add_u32 s38, s38, s18
	s_cmp_lt_u32 s26, 8
	s_cselect_b32 s61, 1, 2
	s_cmp_ge_u32 s15, s61
	s_cselect_b32 s61, 1, 0
	s_mul_i32 s17, s27, 32768
	s_add_u32 s40, s17, 2031616
	s_add_u32 s44, s40, s64
	s_add_u32 s45, s44, 4096
	s_add_u32 s46, s40, s65
	s_add_u32 s46, s46, 8192
	s_add_u32 s47, s40, s64
	s_add_u32 s47, s47, 0x4000
	s_add_u32 s48, s47, 4096
	s_add_u32 s49, s40, s65
	s_add_u32 s49, s49, 24576
	v_xor_b32 v4, 0x4000, v4
	s_mul_i32 s17, s27, 50331648
	s_mul_i32 s18, s26, 24576
	s_add_u32 s52, s17, s18
	s_lshl_b32 s18, s15, 12
	s_add_u32 s52, s52, s18
	s_add_u32 s52, s52, 2105344
	s_add_u32 s68, s18, 15360
	s_lshl_b32 s66, s15, 11
	s_mul_i32 s17, s27, 16777216
	s_lshl_b32 s18, s26, 13
	s_add_u32 s17, s17, s18
	s_add_u32 s17, s17, 102760448
	s_add_u32 s53, s17, s64
	s_lshl_b32 s18, s15, 9
	s_add_u32 s69, s17, s18
	s_add_u32 s69, s69, 4096
	s_lshl_b32 s17, s14, 7
	s_lshl_b32 s18, s15, 2
	s_add_u32 s51, s17, s18
	s_mul_i32 s17, s27, 32
	s_add_u32 s17, s17, s26
	s_add_u32 s17, s17, 64
	s_lshl_b32 s17, s17, 7
	s_mov_b32 s50, s17
	s_mov_b32 s54, 0xcccccccc
	s_mov_b32 s55, 0xcccccccc
	s_mov_b32 s56, 0xff
	s_mov_b32 s57, 0xff
	s_mov_b32 s76, 0x11111111
	s_mov_b32 s77, 0x11111111
	s_mov_b32 s78, 0x3f80
	s_mov_b32 s58, 0x3e0293ee
	s_mov_b32 s59, 0x3e0293ee
	s_mov_b32 s60, 0xbe0293ee
	s_load_dwordx2 s[22:23], s[0:1], 32
	s_waitcnt lgkmcnt(0)
	s_mov_b32 s8, s22
	s_and_b32 s9, s23, 0xffff
	s_mov_b32 s10, 0x2400
	s_mov_b32 s11, 0x00020000
	v_lshrrev_b32 v10, 2, v63
	v_and_b32 v11, 15, v10
	v_lshrrev_b32 v12, 4, v10
	v_lshrrev_b32 v13, 2, v11
	v_lshlrev_b32 v13, 1, v13
	v_and_b32 v14, 1, v11
	v_add_u32 v13, v13, v14
	v_mul_u32_u24 v13, 1152, v13
	v_bfe_u32 v15, v11, 1, 1
	v_and_b32 v16, 1, v63
	v_lshrrev_b32 v17, 1, v12
	v_bfe_u32 v18, v63, 1, 1
	v_and_b32 v19, 1, v12
	v_lshlrev_b32 v29, 5, v15
	v_lshlrev_b32 v30, 0, v16
	v_add_u32 v29, v29, v30
	v_lshlrev_b32 v30, 1, v17
	v_add_u32 v29, v29, v30
	v_lshlrev_b32 v30, 2, v18
	v_add_u32 v29, v29, v30
	v_lshlrev_b32 v30, 3, v19
	v_add_u32 v29, v29, v30
	v_lshlrev_b32 v29, 1, v29
	v_add_u32 v29, v29, v13
	v_lshlrev_b32 v30, 1, v19
	v_add_u32 v30, v30, v18
	v_mul_u32_u24 v30, 144, v30
	v_lshlrev_b32 v31, 1, v15
	v_add_u32 v30, v30, v31
	v_lshlrev_b32 v31, 2, v16
	v_add_u32 v30, v30, v31
	v_lshlrev_b32 v31, 3, v17
	v_add_u32 v30, v30, v31
	v_lshlrev_b32 v30, 1, v30
	v_add_u32 v30, v30, v13
	buffer_load_ushort v32, v29, s[8:11], 0 offen offset:32
	buffer_load_ushort v40, v29, s[8:11], 0 offen offset:64
	buffer_load_ushort v33, v29, s[8:11], 0 offen offset:160
	buffer_load_ushort v41, v29, s[8:11], 0 offen offset:192
	buffer_load_ushort v34, v29, s[8:11], 0 offen offset:320
	buffer_load_ushort v42, v29, s[8:11], 0 offen offset:352
	buffer_load_ushort v35, v29, s[8:11], 0 offen offset:448
	buffer_load_ushort v43, v29, s[8:11], 0 offen offset:480
	buffer_load_ushort v36, v29, s[8:11], 0 offen offset:608
	buffer_load_ushort v44, v29, s[8:11], 0 offen offset:640
	buffer_load_ushort v37, v29, s[8:11], 0 offen offset:736
	buffer_load_ushort v45, v29, s[8:11], 0 offen offset:768
	buffer_load_ushort v38, v29, s[8:11], 0 offen offset:896
	buffer_load_ushort v46, v29, s[8:11], 0 offen offset:928
	buffer_load_ushort v39, v29, s[8:11], 0 offen offset:1024
	buffer_load_ushort v47, v29, s[8:11], 0 offen offset:1056
	buffer_load_dword v48, v30, s[8:11], 0 offen
	v_lshlrev_b32 v14, 2, v63
	s_waitcnt vmcnt(0)
	v_lshl_or_b32 v32, v40, 16, v32
	ds_write_b32 v14, v32 offset:0
	v_lshl_or_b32 v33, v41, 16, v33
	ds_write_b32 v14, v33 offset:1024
	v_lshl_or_b32 v34, v42, 16, v34
	ds_write_b32 v14, v34 offset:2048
	v_lshl_or_b32 v35, v43, 16, v35
	ds_write_b32 v14, v35 offset:3072
	v_lshl_or_b32 v36, v44, 16, v36
	ds_write_b32 v14, v36 offset:4096
	v_lshl_or_b32 v37, v45, 16, v37
	ds_write_b32 v14, v37 offset:5120
	v_lshl_or_b32 v38, v46, 16, v38
	ds_write_b32 v14, v38 offset:6144
	v_lshl_or_b32 v39, v47, 16, v39
	ds_write_b32 v14, v39 offset:7168
	ds_write_b32 v14, v48 offset:8192
	s_waitcnt lgkmcnt(0)
	v_mov_b32 v10, 0
	s_mov_b32 s20, 400000
	v_lshrrev_b32 v8, 4, v0
	v_and_b32 v8, 7, v8
	v_lshrrev_b32 v9, 2, v8
	v_mul_u32_u24 v9, 112, v9
	v_lshlrev_b32 v8, 2, v8
	v_add_u32 v8, v8, v9
	s_getpc_b64 s[18:19]
.ct_30:
	s_sub_u32 s18, s18, .ct_30-L_CHAIN
	s_subb_u32 s19, s19, 0
	v_lshrrev_b32 v10, 4, v0
	v_lshlrev_b32 v10, 7, v10
	s_lshl_b32 s17, s15, 13
	v_add_u32 v10, s17, v10
	s_mov_b32 s17, L_CHAIN_CE-L_CHAIN-4
	v_min_u32 v10, s17, v10
	global_load_dword v9, v10, s[18:19]
	v_mov_b32 v10, 0
.gbre_27:
	global_load_dword v9, v8, s[12:13] offset:16 sc1
	s_waitcnt vmcnt(0)
	v_readlane_b32 s17, v9, 0
	v_readlane_b32 s18, v9, 1
	s_nop 0
	s_add_u32 s17, s17, s18
	v_readlane_b32 s18, v9, 2
	s_nop 0
	s_add_u32 s17, s17, s18
	v_readlane_b32 s18, v9, 3
	s_nop 0
	s_add_u32 s17, s17, s18
	v_readlane_b32 s18, v9, 4
	s_nop 0
	s_add_u32 s17, s17, s18
	v_readlane_b32 s18, v9, 5
	s_nop 0
	s_add_u32 s17, s17, s18
	v_readlane_b32 s18, v9, 6
	s_nop 0
	s_add_u32 s17, s17, s18
	v_readlane_b32 s18, v9, 7
	s_nop 0
	s_add_u32 s17, s17, s18
	s_cmp_ge_u32 s17, 256
	s_cbranch_scc1 .gbok_28
	s_sub_u32 s20, s20, 1
	s_cmp_lg_u32 s20, 0
	s_cbranch_scc1 .gbre_27
	s_branch L_FAIL
.gbok_28:
	v_cmp_ne_u32 vcc, 32, v9
	s_cbranch_vccnz L_CHAIN_DEV
	s_mov_b32 s20, 400000
	s_mov_b64 exec, 15
.b1first_31:
	v_lshrrev_b32 v7, 2, v0
	buffer_load_dword v7, v7, s[4:7], s50 offen sc1
	s_waitcnt vmcnt(0)
	v_cmp_gt_u32 vcc, 1, v7
	s_cbranch_vccz .b1fok_32
	s_sub_u32 s20, s20, 1
	s_cmp_lg_u32 s20, 0
	s_cbranch_scc1 .b1first_31
	s_branch L_FAIL
.b1fok_32:
	s_mov_b64 exec, -1
	s_mov_b32 m0, s68
	s_nop 0
	buffer_load_dwordx4 v0, s[4:7], s52 offen offset:0 lds
	buffer_load_dwordx4 v0, s[4:7], s52 offen offset:1024 lds
	buffer_load_dwordx4 v0, s[4:7], s52 offen offset:2048 lds
	buffer_load_dwordx4 v0, s[4:7], s52 offen offset:3072 lds
	s_add_u32 s52, s52, 786432
	v_mov_b64 v[44:45], 0
	v_mov_b64 v[46:47], 0
	v_mov_b64 v[48:49], 0
	v_mov_b64 v[50:51], 0
	v_mov_b64 v[52:53], 0
	v_mov_b64 v[54:55], 0
	v_mov_b64 v[56:57], 0
	v_mov_b64 v[58:59], 0
	v_mov_b64 v[60:61], 0
	v_mov_b64 v[62:63], 0
	s_mov_b32 s28, 0
	s_waitcnt vmcnt(0)
	s_barrier
.chainloop_33:
	ds_read_b128 v[8:11], v0 offset:0
	ds_read_b128 v[12:15], v0 offset:1024
	ds_read_b128 v[16:19], v0 offset:2048
	ds_read_b128 v[20:23], v0 offset:3072
	ds_read_b128 v[24:27], v0 offset:4096
	ds_read_b128 v[28:31], v0 offset:5120
	ds_read_b128 v[32:35], v0 offset:6144
	ds_read_b128 v[36:39], v0 offset:7168
	ds_read_b128 v[40:43], v0 offset:8192
	s_mov_b64 exec, 15
	v_lshrrev_b32 v7, 2, v0
	buffer_load_dword v7, v7, s[4:7], s50 offen sc1
	s_mov_b64 exec, -1
	s_waitcnt lgkmcnt(8)
	v_smfmac_f32_16x16x64_bf16 v[44:47], v[8:11], a[0:7], v2
	v_smfmac_f32_16x16x64_bf16 v[52:55], v[8:11], a[144:151], v2
	v_smfmac_f32_16x16x64_bf16 v[48:51], v[8:11], a[72:79], v2
	v_smfmac_f32_16x16x64_bf16 v[56:59], v[8:11], a[216:223], v2
	s_waitcnt lgkmcnt(7)
	v_smfmac_f32_16x16x64_bf16 v[44:47], v[12:15], a[8:15], v2
	v_smfmac_f32_16x16x64_bf16 v[52:55], v[12:15], a[152:159], v2
	v_smfmac_f32_16x16x64_bf16 v[48:51], v[12:15], a[80:87], v2
	v_smfmac_f32_16x16x64_bf16 v[56:59], v[12:15], a[224:231], v2
	s_waitcnt lgkmcnt(6)
	v_smfmac_f32_16x16x64_bf16 v[44:47], v[16:19], a[16:23], v2
	v_smfmac_f32_16x16x64_bf16 v[52:55], v[16:19], a[160:167], v2
	v_smfmac_f32_16x16x64_bf16 v[48:51], v[16:19], a[88:95], v2
	v_smfmac_f32_16x16x64_bf16 v[56:59], v[16:19], a[232:239], v2
	s_waitcnt lgkmcnt(5)
	v_smfmac_f32_16x16x64_bf16 v[44:47], v[20:23], a[24:31], v2
	v_smfmac_f32_16x16x64_bf16 v[52:55], v[20:23], a[168:175], v2
	v_smfmac_f32_16x16x64_bf16 v[48:51], v[20:23], a[96:103], v2
	v_smfmac_f32_16x16x64_bf16 v[56:59], v[20:23], a[240:247], v2
	s_waitcnt lgkmcnt(4)
	v_smfmac_f32_16x16x64_bf16 v[44:47], v[24:27], a[32:39], v2
	v_smfmac_f32_16x16x64_bf16 v[52:55], v[24:27], a[176:183], v2
	v_smfmac_f32_16x16x64_bf16 v[48:51], v[24:27], a[104:111], v2
	v_smfmac_f32_16x16x64_bf16 v[56:59], v[24:27], a[248:255], v2
	s_waitcnt lgkmcnt(3)
	v_smfmac_f32_16x16x64_bf16 v[44:47], v[28:31], a[40:47], v2
	v_smfmac_f32_16x16x64_bf16 v[52:55], v[28:31], a[184:191], v2
	v_smfmac_f32_16x16x64_bf16 v[48:51], v[28:31], a[112:119], v2
	v_smfmac_f32_16x16x64_bf16 v[56:59], v[28:31], v[64:71], v2
	s_waitcnt lgkmcnt(2)
	v_smfmac_f32_16x16x64_bf16 v[44:47], v[32:35], a[48:55], v2
	v_smfmac_f32_16x16x64_bf16 v[52:55], v[32:35], a[192:199], v2
	v_smfmac_f32_16x16x64_bf16 v[48:51], v[32:35], a[120:127], v2
	v_smfmac_f32_16x16x64_bf16 v[56:59], v[32:35], v[72:79], v2
	s_waitcnt lgkmcnt(0)
	v_smfmac_f32_16x16x64_bf16 v[44:47], v[36:39], a[56:63], v2
	v_smfmac_f32_16x16x64_bf16 v[52:55], v[36:39], a[200:207], v2
	v_smfmac_f32_16x16x64_bf16 v[44:47], v[40:43], a[64:71], v2
	v_smfmac_f32_16x16x64_bf16 v[52:55], v[40:43], a[208:215], v2
	v_smfmac_f32_16x16x64_bf16 v[48:51], v[36:39], a[128:135], v2
	v_smfmac_f32_16x16x64_bf16 v[56:59], v[36:39], v[80:87], v2
	v_smfmac_f32_16x16x64_bf16 v[48:51], v[40:43], a[136:143], v2
	v_add_f32 v52, v52, v54
	v_add_f32 v53, v53, v55
	v_add_f32 v44, v44, v46
	v_add_f32 v45, v45, v47
	v_cvt_pk_bf16_f32 v54, v52, v53
	v_cvt_pk_bf16_f32 v55, v44, v45
	ds_write_b64 v5, v[54:55] offset:0
	v_smfmac_f32_16x16x64_bf16 v[56:59], v[40:43], v[88:95], v2
	v_mov_b64 v[44:45], 0
	v_mov_b64 v[46:47], 0
	v_smfmac_f32_16x16x64_bf16 v[60:63], v[8:11], v[96:103], v2
	v_smfmac_f32_16x16x64_bf16 v[60:63], v[12:15], v[104:111], v2
	v_add_f32 v56, v56, v58
	v_add_f32 v57, v57, v59
	v_add_f32 v48, v48, v50
	v_add_f32 v49, v49, v51
	v_cvt_pk_bf16_f32 v58, v56, v57
	v_cvt_pk_bf16_f32 v59, v48, v49
	ds_write_b64 v5, v[58:59] offset:512
	v_smfmac_f32_16x16x64_bf16 v[44:47], v[8:11], v[168:175], v2
	v_smfmac_f32_16x16x64_bf16 v[44:47], v[12:15], v[176:183], v2
	v_smfmac_f32_16x16x64_bf16 v[60:63], v[16:19], v[112:119], v2
	v_smfmac_f32_16x16x64_bf16 v[44:47], v[16:19], v[184:191], v2
	s_waitcnt lgkmcnt(0)
	s_barrier
	ds_read_b64_tr_b16 v[48:49], v1 offset:9216
	ds_read_b64_tr_b16 v[50:51], v1 offset:9728
	ds_read_b128 v[12:15], v0 offset:15360
	ds_read_b128 v[16:19], v0 offset:19456
	v_smfmac_f32_16x16x64_bf16 v[60:63], v[20:23], v[120:127], v2
	ds_read_b64_tr_b16 v[52:53], v1 offset:10240
	ds_read_b64_tr_b16 v[54:55], v1 offset:10752
	v_smfmac_f32_16x16x64_bf16 v[44:47], v[20:23], v[192:199], v2
	ds_read_b128 v[20:23], v0 offset:16384
	v_smfmac_f32_16x16x64_bf16 v[60:63], v[24:27], v[128:135], v2
	ds_read_b64_tr_b16 v[56:57], v1 offset:11264
	ds_read_b64_tr_b16 v[58:59], v1 offset:11776
	v_smfmac_f32_16x16x64_bf16 v[44:47], v[24:27], v[200:207], v2
	ds_read_b128 v[24:27], v0 offset:20480
	v_smfmac_f32_16x16x64_bf16 v[60:63], v[28:31], v[136:143], v2
	ds_read_b64_tr_b16 v[8:9], v1 offset:12288
	ds_read_b64_tr_b16 v[10:11], v1 offset:12800
	v_smfmac_f32_16x16x64_bf16 v[44:47], v[28:31], v[208:215], v2
	ds_read_b128 v[28:31], v0 offset:17408
	v_smfmac_f32_16x16x64_bf16 v[60:63], v[32:35], v[144:151], v2
	v_smfmac_f32_16x16x64_bf16 v[44:47], v[32:35], v[216:223], v2
	v_smfmac_f32_16x16x64_bf16 v[60:63], v[36:39], v[152:159], v2
	v_smfmac_f32_16x16x64_bf16 v[44:47], v[36:39], v[224:231], v2
	v_smfmac_f32_16x16x64_bf16 v[60:63], v[40:43], v[160:167], v2
	v_smfmac_f32_16x16x64_bf16 v[44:47], v[40:43], v[232:239], v2
	s_waitcnt lgkmcnt(10)
	v_mfma_f32_16x16x32_bf16 v[32:35], v[12:15], v[48:51], 0
	s_waitcnt lgkmcnt(9)
	v_mfma_f32_16x16x32_bf16 v[36:39], v[16:19], v[48:51], 0
	ds_read_b128 v[12:15], v0 offset:21504
	v_mfma_f32_16x16x32_bf16 v[40:43], v[48:51], v[48:51], 0
	ds_read_b128 v[16:19], v0 offset:18432
	ds_read_b128 v[48:51], v0 offset:22528
	s_waitcnt lgkmcnt(9)
	v_mfma_f32_16x16x32_bf16 v[32:35], v[20:23], v[52:55], v[32:35]
	s_waitcnt lgkmcnt(6)
	v_mfma_f32_16x16x32_bf16 v[36:39], v[24:27], v[52:55], v[36:39]
	v_mfma_f32_16x16x32_bf16 v[40:43], v[52:55], v[52:55], v[40:43]
	v_add_f32 v60, v60, v62
	v_add_f32 v61, v61, v63
	v_add_f32 v44, v44, v46
	v_add_f32 v45, v45, v47
	s_waitcnt lgkmcnt(3)
	v_mfma_f32_16x16x32_bf16 v[32:35], v[28:31], v[56:59], v[32:35]
	v_cvt_pk_bf16_f32 v62, v60, v61
	v_cvt_pk_bf16_f32 v63, v44, v45
	v_mfma_f32_16x16x32_bf16 v[40:43], v[56:59], v[56:59], v[40:43]
	buffer_store_dwordx2 v[62:63], v1, s[4:7], s69 offen sc1
	s_waitcnt lgkmcnt(2)
	v_mfma_f32_16x16x32_bf16 v[36:39], v[12:15], v[56:59], v[36:39]
	v_add_u32 v44, s66, v0
	v_add_u32 v45, s64, v1
	v_mfma_f32_16x16x32_bf16 v[40:43], v[8:11], v[8:11], v[40:43]
	s_waitcnt lgkmcnt(1)
	v_mfma_f32_16x16x32_bf16 v[32:35], v[16:19], v[8:11], v[32:35]
	s_waitcnt lgkmcnt(0)
	v_mfma_f32_16x16x32_bf16 v[36:39], v[48:51], v[8:11], v[36:39]
	ds_read_b128 v[8:11], v44 offset:23552
	ds_read_b128 v[12:15], v44 offset:24576
	ds_read_b64_tr_b16 v[52:53], v45 offset:9216
	ds_read_b64_tr_b16 v[54:55], v45 offset:9728
	v_mov_b32 v16, 0x3f803f80
	v_mov_b32 v17, 0x3f803f80
	v_mov_b32 v18, 0x3f803f80
	v_mov_b32 v19, 0x3f803f80
	v_mov_b32 v25, 0
	v_mov_b32 v26, 0
	v_max3_f32 v28, v40, v41, v32
	v_max3_f32 v29, v33, v34, v35
	v_max3_f32 v28, v28, v36, v37
	v_max3_f32 v29, v29, v38, v39
	v_max_f32 v28, v28, v29
	v_mov_b32 v29, v28
	s_waitcnt lgkmcnt(0)
	buffer_store_dwordx4 v[52:55], v0, s[4:7], s53 offen sc1
	v_permlane16_swap_b32 v28, v29
	v_max_f32 v28, v28, v29
	v_mov_b32 v29, v28
	s_add_u32 s53, s53, 262144
	s_add_u32 s69, s69, 262144
	v_permlane32_swap_b32 v28, v29
	v_max_f32 v28, v28, v29
	v_mul_f32 v28, s60, v28
	v_pk_fma_f32 v[40:41], v[40:41], s[58:59], v[28:29] op_sel_hi:[1,1,0]
	v_pk_fma_f32 v[32:33], v[32:33], s[58:59], v[28:29] op_sel_hi:[1,1,0]
	v_pk_fma_f32 v[34:35], v[34:35], s[58:59], v[28:29] op_sel_hi:[1,1,0]
	v_pk_fma_f32 v[36:37], v[36:37], s[58:59], v[28:29] op_sel_hi:[1,1,0]
	v_pk_fma_f32 v[38:39], v[38:39], s[58:59], v[28:29] op_sel_hi:[1,1,0]
	v_exp_f32 v40, v40
	v_exp_f32 v41, v41
	v_exp_f32 v32, v32
	v_cvt_pk_bf16_f32 v24, v40, v41
	v_exp_f32 v33, v33
	v_mov_b32 v27, v24
	v_exp_f32 v34, v34
	v_mfma_f32_16x16x16_bf16 v[56:59], v[16:17], v[24:25], 0
	v_exp_f32 v35, v35
	v_mfma_f32_16x16x16_bf16 v[48:51], v[62:63], v[24:25], 0
	v_exp_f32 v36, v36
	v_cvt_pk_bf16_f32 v20, v32, v33
	v_mfma_f32_16x16x16_bf16 v[52:55], v[62:63], v[26:27], 0
	v_exp_f32 v37, v37
	v_cvt_pk_bf16_f32 v21, v34, v35
	v_exp_f32 v38, v38
	v_exp_f32 v39, v39
	v_cvt_pk_bf16_f32 v22, v36, v37
	v_cvt_pk_bf16_f32 v23, v38, v39
	s_nop 1
	v_mfma_f32_16x16x32_bf16 v[56:59], v[16:19], v[20:23], v[56:59]
	v_mfma_f32_16x16x32_bf16 v[48:51], v[8:11], v[20:23], v[48:51]
	v_mfma_f32_16x16x32_bf16 v[52:55], v[12:15], v[20:23], v[52:55]
	v_add_u32 v46, s67, v0
	v_add_u32 v47, 0x10000, v46
	v_rcp_f32 v56, v56
	s_nop 0
	v_pk_mul_f32 v[48:49], v[48:49], v[56:57] op_sel_hi:[1,0]
	v_pk_mul_f32 v[50:51], v[50:51], v[56:57] op_sel_hi:[1,0]
	s_nop 1
	v_pk_mul_f32 v[52:53], v[52:53], v[56:57] op_sel_hi:[1,0]
	v_pk_mul_f32 v[54:55], v[54:55], v[56:57] op_sel_hi:[1,0]
	v_cvt_pk_bf16_f32 v60, v48, v49
	v_cvt_pk_bf16_f32 v61, v52, v53
	v_cvt_pk_bf16_f32 v62, v50, v51
	v_cvt_pk_bf16_f32 v63, v54, v55
	s_mov_b64 exec, s[54:55]
	ds_write_b64 v6, v[60:61]
	ds_write_b64 v6, v[62:63] offset:32
	s_mov_b64 exec, -1
	ds_read_b128 v[8:11], v46 offset:0
	ds_read_b128 v[12:15], v46 offset:32768
	ds_read_b128 v[16:19], v47 offset:0
	ds_read_b128 v[20:23], v47 offset:32768
	ds_read_b128 v[24:27], v46 offset:1024
	ds_read_b128 v[28:31], v46 offset:33792
	ds_read_b128 v[32:35], v47 offset:1024
	ds_read_b128 v[36:39], v47 offset:33792
	v_mov_b64 v[48:49], 0
	v_mov_b64 v[50:51], 0
	v_mov_b64 v[52:53], 0
	v_mov_b64 v[54:55], 0
	s_waitcnt lgkmcnt(8)
	s_barrier
	ds_read_b128 v[40:43], v0 offset:13312
	ds_read_b128 v[56:59], v0 offset:14336
	s_cmp_eq_u32 s28, 63
	s_cbranch_scc1 .skipk_35
	s_add_u32 s17, s28, 2
	s_mov_b64 exec, 15
	s_waitcnt vmcnt(2)
	v_cmp_gt_u32 vcc, s17, v7
	s_cbranch_vccz .b1ok_36
	s_mov_b32 s20, 400000
.b1re_37:
	v_lshrrev_b32 v7, 2, v0
	buffer_load_dword v7, v7, s[4:7], s50 offen sc1
	s_waitcnt vmcnt(0)
	v_cmp_gt_u32 vcc, s17, v7
	s_cbranch_vccz .b1ok_36
	s_sub_u32 s20, s20, 1
	s_cmp_lg_u32 s20, 0
	s_cbranch_scc1 .b1re_37
	s_branch L_FAIL
.b1ok_36:
	s_mov_b64 exec, -1
	s_mov_b32 m0, s68
	s_nop 0
	buffer_load_dwordx4 v0, s[4:7], s52 offen offset:0 lds
	buffer_load_dwordx4 v0, s[4:7], s52 offen offset:1024 lds
	buffer_load_dwordx4 v0, s[4:7], s52 offen offset:2048 lds
	buffer_load_dwordx4 v0, s[4:7], s52 offen offset:3072 lds
	s_add_u32 s52, s52, 786432
.skipk_35:
	s_waitcnt lgkmcnt(1)
	v_smfmac_f32_16x16x64_bf16 v[48:51], v[40:43], v[240:247], v2
	s_waitcnt lgkmcnt(0)
	v_smfmac_f32_16x16x64_bf16 v[48:51], v[56:59], v[248:255], v2
	v_smfmac_f32_16x16x64_bf16 v[52:55], v[40:43], v[8:15], v2
	ds_read_b128 v[8:11], v46 offset:2048
	ds_read_b128 v[12:15], v46 offset:34816
	v_smfmac_f32_16x16x64_bf16 v[52:55], v[56:59], v[16:23], v2
	ds_read_b128 v[16:19], v47 offset:2048
	ds_read_b128 v[20:23], v47 offset:34816
	v_add_f32 v44, v48, v50
	v_add_f32 v45, v49, v51
	v_mov_b64 v[48:49], 0
	v_mov_b64 v[50:51], 0
	v_lshrrev_b32 v61, 2, v0
	v_cvt_pk_bf16_f32 v60, v44, v45
	s_mov_b64 exec, s[76:77]
	v_or_b32_sdwa v60, v44, 1 dst_sel:WORD_0 dst_unused:UNUSED_PRESERVE src0_sel:WORD_1 src1_sel:DWORD
	s_mov_b64 exec, -1
	buffer_store_dword v60, v61, s[4:7], s38 offen
	v_smfmac_f32_16x16x64_bf16 v[48:51], v[40:43], v[24:31], v2
	ds_read_b128 v[24:27], v46 offset:3072
	ds_read_b128 v[28:31], v46 offset:35840
	v_smfmac_f32_16x16x64_bf16 v[48:51], v[56:59], v[32:39], v2
	ds_read_b128 v[32:35], v47 offset:3072
	ds_read_b128 v[36:39], v47 offset:35840
	v_add_f32 v44, v52, v54
	v_add_f32 v45, v53, v55
	v_mov_b64 v[52:53], 0
	v_mov_b64 v[54:55], 0
	v_cvt_pk_bf16_f32 v60, v44, v45
	s_nop 0
	v_or_b32_sdwa v60, v44, 1 dst_sel:WORD_0 dst_unused:UNUSED_PRESERVE src0_sel:WORD_1 src1_sel:DWORD
	s_waitcnt lgkmcnt(6)
	v_smfmac_f32_16x16x64_bf16 v[52:55], v[40:43], v[8:15], v2
	ds_read_b128 v[8:11], v46 offset:4096
	ds_read_b128 v[12:15], v46 offset:36864
	s_waitcnt lgkmcnt(6)
	v_smfmac_f32_16x16x64_bf16 v[52:55], v[56:59], v[16:23], v2
	ds_read_b128 v[16:19], v47 offset:4096
	ds_read_b128 v[20:23], v47 offset:36864
	v_add_f32 v44, v48, v50
	v_add_f32 v45, v49, v51
	v_mov_b64 v[48:49], 0
	v_mov_b64 v[50:51], 0
	v_cvt_pk_bf16_f32 v61, v44, v45
	s_waitcnt lgkmcnt(6)
	v_smfmac_f32_16x16x64_bf16 v[48:51], v[40:43], v[24:31], v2
	ds_read_b128 v[24:27], v46 offset:5120
	ds_read_b128 v[28:31], v46 offset:37888
	s_waitcnt lgkmcnt(6)
	v_smfmac_f32_16x16x64_bf16 v[48:51], v[56:59], v[32:39], v2
	ds_read_b128 v[32:35], v47 offset:5120
	ds_read_b128 v[36:39], v47 offset:37888
	v_add_f32 v44, v52, v54
	v_add_f32 v45, v53, v55
	v_mov_b64 v[52:53], 0
	v_mov_b64 v[54:55], 0
	v_cvt_pk_bf16_f32 v62, v44, v45
	s_waitcnt lgkmcnt(6)
	v_smfmac_f32_16x16x64_bf16 v[52:55], v[40:43], v[8:15], v2
	ds_read_b128 v[8:11], v46 offset:6144
	ds_read_b128 v[12:15], v46 offset:38912
	s_waitcnt lgkmcnt(6)
	v_smfmac_f32_16x16x64_bf16 v[52:55], v[56:59], v[16:23], v2
	ds_read_b128 v[16:19], v47 offset:6144
	ds_read_b128 v[20:23], v47 offset:38912
	v_add_f32 v44, v48, v50
	v_add_f32 v45, v49, v51
	v_mov_b64 v[48:49], 0
	v_mov_b64 v[50:51], 0
	v_cvt_pk_bf16_f32 v63, v44, v45
	buffer_store_dwordx4 v[60:63], v0, s[4:7], s38 offen offset:256
	s_waitcnt lgkmcnt(6)
	v_smfmac_f32_16x16x64_bf16 v[48:51], v[40:43], v[24:31], v2
	ds_read_b128 v[24:27], v46 offset:7168
	ds_read_b128 v[28:31], v46 offset:39936
	s_waitcnt lgkmcnt(6)
	v_smfmac_f32_16x16x64_bf16 v[48:51], v[56:59], v[32:39], v2
	ds_read_b128 v[32:35], v47 offset:7168
	ds_read_b128 v[36:39], v47 offset:39936
	v_add_f32 v44, v52, v54
	v_add_f32 v45, v53, v55
	v_mov_b64 v[52:53], 0
	v_mov_b64 v[54:55], 0
	v_cvt_pk_bf16_f32 v60, v44, v45
	s_nop 0
	v_or_b32_sdwa v60, v44, 1 dst_sel:WORD_0 dst_unused:UNUSED_PRESERVE src0_sel:WORD_1 src1_sel:DWORD
	s_waitcnt lgkmcnt(6)
	v_smfmac_f32_16x16x64_bf16 v[52:55], v[40:43], v[8:15], v2
	s_waitcnt lgkmcnt(4)
	v_smfmac_f32_16x16x64_bf16 v[52:55], v[56:59], v[16:23], v2
	v_add_f32 v44, v48, v50
	v_add_f32 v45, v49, v51
	v_mov_b64 v[48:49], 0
	v_mov_b64 v[50:51], 0
	v_cvt_pk_bf16_f32 v61, v44, v45
	s_waitcnt lgkmcnt(2)
	v_smfmac_f32_16x16x64_bf16 v[48:51], v[40:43], v[24:31], v2
	s_waitcnt lgkmcnt(0)
	v_smfmac_f32_16x16x64_bf16 v[48:51], v[56:59], v[32:39], v2
	v_add_f32 v44, v52, v54
	v_add_f32 v45, v53, v55
	v_cvt_pk_bf16_f32 v62, v44, v45
	s_nop 4
	v_add_f32 v44, v48, v50
	v_add_f32 v45, v49, v51
	v_cvt_pk_bf16_f32 v63, v44, v45
	buffer_store_dwordx4 v[60:63], v0, s[4:7], s38 offen offset:1280
	s_waitcnt vmcnt(0)
	s_mov_b32 s20, 400000
	s_cmp_eq_u32 s61, 0
	s_cbranch_scc1 .h1none_38
	buffer_load_dwordx4 v[8:11], v3, s[4:7], s30 offen sc1
	buffer_load_dwordx4 v[12:15], v3, s[4:7], s31 offen sc1
	buffer_load_dwordx4 v[16:19], v3, s[4:7], s32 offen sc1
	buffer_load_dwordx4 v[20:23], v3, s[4:7], s33 offen sc1
	v_mov_b64 v[44:45], 0
	v_mov_b64 v[46:47], 0
	v_mov_b64 v[48:49], 0
	v_mov_b64 v[50:51], 0
	v_mov_b64 v[52:53], 0
	v_mov_b64 v[54:55], 0
	v_mov_b64 v[56:57], 0
	v_mov_b64 v[58:59], 0
	v_mov_b64 v[60:61], 0
	v_mov_b64 v[62:63], 0
	v_lshrrev_b32 v35, 2, v0
	v_and_b32 v35, 16, v35
	v_lshlrev_b32 v35, v35, s78
	s_mov_b64 vcc, s[76:77]
	v_cndmask_b32 v24, 0, v35, vcc
	s_lshl_b64 vcc, vcc, 1
	v_cndmask_b32 v25, 0, v35, vcc
	s_lshl_b64 vcc, vcc, 1
	v_cndmask_b32 v26, 0, v35, vcc
	s_lshl_b64 vcc, vcc, 1
	v_cndmask_b32 v27, 0, v35, vcc
	v_bfe_i32 v34, v0, 9, 1
	s_branch .h1w_41
.hop1_40:
	s_mov_b64 exec, vcc
	s_sub_u32 s20, s20, 1
	s_cbranch_scc1 L_FAIL
	buffer_load_dwordx4 v[8:11], v3, s[4:7], s30 offen sc1
	buffer_load_dwordx4 v[12:15], v3, s[4:7], s31 offen sc1
	buffer_load_dwordx4 v[16:19], v3, s[4:7], s32 offen sc1
	buffer_load_dwordx4 v[20:23], v3, s[4:7], s33 offen sc1
.h1w_41:
	s_waitcnt vmcnt(0)
	v_mfma_f32_16x16x32_bf16 v[28:31], v[24:27], v[8:11], 0
	v_bitop3_b32 v35, v8, v12, v16 bitop3:0x80
	v_mfma_f32_16x16x32_bf16 v[28:31], v[24:27], v[12:15], v[28:31]
	v_bitop3_b32 v35, v35, v20, 1 bitop3:0x80
	v_mfma_f32_16x16x32_bf16 v[28:31], v[24:27], v[16:19], v[28:31]
	v_cmp_ne_u32 vcc, 1, v35
	v_mfma_f32_16x16x32_bf16 v[28:31], v[24:27], v[20:23], v[28:31]
	s_cbranch_vccnz .hop1_40
	s_mov_b64 exec, -1
	s_nop 5
	v_add_f32_dpp v32, v28, v28 row_ror:8 row_mask:0xf bank_mask:0x3
	v_add_f32_dpp v33, v29, v29 row_ror:8 row_mask:0xf bank_mask:0x3
	s_nop 0
	v_add_f32_dpp v32, v30, v30 row_ror:8 row_mask:0xf bank_mask:0xc
	v_add_f32_dpp v33, v31, v31 row_ror:8 row_mask:0xf bank_mask:0xc
	v_cvt_pk_bf16_f32 v32, v32, v33
	v_or_b32 v32, v32, v34
	buffer_store_dword v32, v4, s[4:7], s40 offen
	v_xor_b32 v4, 0x4000, v4
	s_branch .h1join_39
.h1none_38:
	v_mov_b64 v[44:45], 0
	v_mov_b64 v[46:47], 0
	v_mov_b64 v[48:49], 0
	v_mov_b64 v[50:51], 0
	v_mov_b64 v[52:53], 0
	v_mov_b64 v[54:55], 0
	v_mov_b64 v[56:57], 0
	v_mov_b64 v[58:59], 0
	v_mov_b64 v[60:61], 0
	v_mov_b64 v[62:63], 0
.h1join_39:
	s_barrier
	s_waitcnt vmcnt(0)
	v_add_u32 v20, s64, v0
	v_add_u32 v21, s65, v0
	v_mov_b64 v[16:17], 0
	v_mov_b64 v[18:19], 0
	s_mov_b32 s20, 400000
	buffer_load_dwordx4 v[8:11], v0, s[4:7], s47 offen sc1
	buffer_load_dwordx4 v[12:15], v0, s[4:7], s48 offen sc1
	s_mov_b64 exec, 0xffff
	buffer_load_dwordx4 v[16:19], v0, s[4:7], s49 offen sc1
	s_mov_b64 exec, -1
	s_branch .h2w_43
.hop2_42:
	s_mov_b64 exec, vcc
	s_mov_b64 s[74:75], vcc
	s_sub_u32 s20, s20, 1
	s_cbranch_scc1 L_FAIL
	buffer_load_dwordx4 v[8:11], v0, s[4:7], s47 offen sc1
	buffer_load_dwordx4 v[12:15], v0, s[4:7], s48 offen sc1
	s_and_b64 exec, exec, 0xffff
	buffer_load_dwordx4 v[16:19], v0, s[4:7], s49 offen sc1
	s_mov_b64 exec, s[74:75]
.h2w_43:
	s_waitcnt vmcnt(0)
	v_max3_u32 v22, v8, v9, v10
	v_max3_u32 v23, v11, v12, v13
	v_max3_u32 v22, v22, v14, v15
	v_max3_u32 v23, v23, v16, v17
	v_max3_u32 v22, v22, v18, v19
	v_max_u32 v22, v22, v23
	v_cmp_eq_u32 vcc, -1, v22
	s_cbranch_vccnz .hop2_42
	s_mov_b64 exec, -1
	s_add_u32 s17, s28, 1
	v_mov_b32 v36, s17
	s_mov_b64 exec, 1
	buffer_store_dword v36, v0, s[4:7], s51 offen sc1
	s_mov_b64 exec, -1
	ds_write_b128 v20, v[8:11] offset:0
	ds_write_b128 v20, v[12:15] offset:4096
	s_mov_b64 exec, 0xffff
	ds_write_b128 v21, v[16:19] offset:8192
	s_mov_b64 exec, -1
	s_add_u32 s28, s28, 1
	s_waitcnt lgkmcnt(0)
	s_barrier
	ds_read_b128 v[8:11], v0 offset:0
	ds_read_b128 v[12:15], v0 offset:1024
	ds_read_b128 v[16:19], v0 offset:2048
	ds_read_b128 v[20:23], v0 offset:3072
	ds_read_b128 v[24:27], v0 offset:4096
	ds_read_b128 v[28:31], v0 offset:5120
	ds_read_b128 v[32:35], v0 offset:6144
	ds_read_b128 v[36:39], v0 offset:7168
	ds_read_b128 v[40:43], v0 offset:8192
	s_mov_b64 exec, 15
	v_lshrrev_b32 v7, 2, v0
	buffer_load_dword v7, v7, s[4:7], s50 offen sc1
	s_mov_b64 exec, -1
	s_waitcnt lgkmcnt(8)
	v_smfmac_f32_16x16x64_bf16 v[44:47], v[8:11], a[0:7], v2
	v_smfmac_f32_16x16x64_bf16 v[52:55], v[8:11], a[144:151], v2
	v_smfmac_f32_16x16x64_bf16 v[48:51], v[8:11], a[72:79], v2
	v_smfmac_f32_16x16x64_bf16 v[56:59], v[8:11], a[216:223], v2
	s_waitcnt lgkmcnt(7)
	v_smfmac_f32_16x16x64_bf16 v[44:47], v[12:15], a[8:15], v2
	v_smfmac_f32_16x16x64_bf16 v[52:55], v[12:15], a[152:159], v2
	v_smfmac_f32_16x16x64_bf16 v[48:51], v[12:15], a[80:87], v2
	v_smfmac_f32_16x16x64_bf16 v[56:59], v[12:15], a[224:231], v2
	s_waitcnt lgkmcnt(6)
	v_smfmac_f32_16x16x64_bf16 v[44:47], v[16:19], a[16:23], v2
	v_smfmac_f32_16x16x64_bf16 v[52:55], v[16:19], a[160:167], v2
	v_smfmac_f32_16x16x64_bf16 v[48:51], v[16:19], a[88:95], v2
	v_smfmac_f32_16x16x64_bf16 v[56:59], v[16:19], a[232:239], v2
	s_waitcnt lgkmcnt(5)
	v_smfmac_f32_16x16x64_bf16 v[44:47], v[20:23], a[24:31], v2
	v_smfmac_f32_16x16x64_bf16 v[52:55], v[20:23], a[168:175], v2
	v_smfmac_f32_16x16x64_bf16 v[48:51], v[20:23], a[96:103], v2
	v_smfmac_f32_16x16x64_bf16 v[56:59], v[20:23], a[240:247], v2
	s_waitcnt lgkmcnt(4)
	v_smfmac_f32_16x16x64_bf16 v[44:47], v[24:27], a[32:39], v2
	v_smfmac_f32_16x16x64_bf16 v[52:55], v[24:27], a[176:183], v2
	v_smfmac_f32_16x16x64_bf16 v[48:51], v[24:27], a[104:111], v2
	v_smfmac_f32_16x16x64_bf16 v[56:59], v[24:27], a[248:255], v2
	s_waitcnt lgkmcnt(3)
	v_smfmac_f32_16x16x64_bf16 v[44:47], v[28:31], a[40:47], v2
	v_smfmac_f32_16x16x64_bf16 v[52:55], v[28:31], a[184:191], v2
	v_smfmac_f32_16x16x64_bf16 v[48:51], v[28:31], a[112:119], v2
	v_smfmac_f32_16x16x64_bf16 v[56:59], v[28:31], v[64:71], v2
	s_waitcnt lgkmcnt(2)
	v_smfmac_f32_16x16x64_bf16 v[44:47], v[32:35], a[48:55], v2
	v_smfmac_f32_16x16x64_bf16 v[52:55], v[32:35], a[192:199], v2
	v_smfmac_f32_16x16x64_bf16 v[48:51], v[32:35], a[120:127], v2
	v_smfmac_f32_16x16x64_bf16 v[56:59], v[32:35], v[72:79], v2
	s_waitcnt lgkmcnt(0)
	v_smfmac_f32_16x16x64_bf16 v[44:47], v[36:39], a[56:63], v2
	v_smfmac_f32_16x16x64_bf16 v[52:55], v[36:39], a[200:207], v2
	v_smfmac_f32_16x16x64_bf16 v[44:47], v[40:43], a[64:71], v2
	v_smfmac_f32_16x16x64_bf16 v[52:55], v[40:43], a[208:215], v2
	v_smfmac_f32_16x16x64_bf16 v[48:51], v[36:39], a[128:135], v2
	v_smfmac_f32_16x16x64_bf16 v[56:59], v[36:39], v[80:87], v2
	v_smfmac_f32_16x16x64_bf16 v[48:51], v[40:43], a[136:143], v2
	v_add_f32 v52, v52, v54
	v_add_f32 v53, v53, v55
	v_add_f32 v44, v44, v46
	v_add_f32 v45, v45, v47
	v_cvt_pk_bf16_f32 v54, v52, v53
	v_cvt_pk_bf16_f32 v55, v44, v45
	ds_write_b64 v5, v[54:55] offset:0
	v_smfmac_f32_16x16x64_bf16 v[56:59], v[40:43], v[88:95], v2
	v_mov_b64 v[44:45], 0
	v_mov_b64 v[46:47], 0
	v_smfmac_f32_16x16x64_bf16 v[60:63], v[8:11], v[96:103], v2
	v_smfmac_f32_16x16x64_bf16 v[60:63], v[12:15], v[104:111], v2
	v_add_f32 v56, v56, v58
	v_add_f32 v57, v57, v59
	v_add_f32 v48, v48, v50
	v_add_f32 v49, v49, v51
	v_cvt_pk_bf16_f32 v58, v56, v57
	v_cvt_pk_bf16_f32 v59, v48, v49
	ds_write_b64 v5, v[58:59] offset:512
	v_smfmac_f32_16x16x64_bf16 v[44:47], v[8:11], v[168:175], v2
	v_smfmac_f32_16x16x64_bf16 v[44:47], v[12:15], v[176:183], v2
	v_smfmac_f32_16x16x64_bf16 v[60:63], v[16:19], v[112:119], v2
	v_smfmac_f32_16x16x64_bf16 v[44:47], v[16:19], v[184:191], v2
	s_waitcnt lgkmcnt(0)
	s_barrier
	ds_read_b64_tr_b16 v[48:49], v1 offset:9216
	ds_read_b64_tr_b16 v[50:51], v1 offset:9728
	ds_read_b128 v[12:15], v0 offset:15360
	ds_read_b128 v[16:19], v0 offset:19456
	v_smfmac_f32_16x16x64_bf16 v[60:63], v[20:23], v[120:127], v2
	ds_read_b64_tr_b16 v[52:53], v1 offset:10240
	ds_read_b64_tr_b16 v[54:55], v1 offset:10752
	v_smfmac_f32_16x16x64_bf16 v[44:47], v[20:23], v[192:199], v2
	ds_read_b128 v[20:23], v0 offset:16384
	v_smfmac_f32_16x16x64_bf16 v[60:63], v[24:27], v[128:135], v2
	ds_read_b64_tr_b16 v[56:57], v1 offset:11264
	ds_read_b64_tr_b16 v[58:59], v1 offset:11776
	v_smfmac_f32_16x16x64_bf16 v[44:47], v[24:27], v[200:207], v2
	ds_read_b128 v[24:27], v0 offset:20480
	v_smfmac_f32_16x16x64_bf16 v[60:63], v[28:31], v[136:143], v2
	ds_read_b64_tr_b16 v[8:9], v1 offset:12288
	ds_read_b64_tr_b16 v[10:11], v1 offset:12800
	v_smfmac_f32_16x16x64_bf16 v[44:47], v[28:31], v[208:215], v2
	ds_read_b128 v[28:31], v0 offset:17408
	v_smfmac_f32_16x16x64_bf16 v[60:63], v[32:35], v[144:151], v2
	v_smfmac_f32_16x16x64_bf16 v[44:47], v[32:35], v[216:223], v2
	v_smfmac_f32_16x16x64_bf16 v[60:63], v[36:39], v[152:159], v2
	v_smfmac_f32_16x16x64_bf16 v[44:47], v[36:39], v[224:231], v2
	v_smfmac_f32_16x16x64_bf16 v[60:63], v[40:43], v[160:167], v2
	v_smfmac_f32_16x16x64_bf16 v[44:47], v[40:43], v[232:239], v2
	s_waitcnt lgkmcnt(10)
	v_mfma_f32_16x16x32_bf16 v[32:35], v[12:15], v[48:51], 0
	s_waitcnt lgkmcnt(9)
	v_mfma_f32_16x16x32_bf16 v[36:39], v[16:19], v[48:51], 0
	ds_read_b128 v[12:15], v0 offset:21504
	v_mfma_f32_16x16x32_bf16 v[40:43], v[48:51], v[48:51], 0
	ds_read_b128 v[16:19], v0 offset:18432
	ds_read_b128 v[48:51], v0 offset:22528
	s_waitcnt lgkmcnt(9)
	v_mfma_f32_16x16x32_bf16 v[32:35], v[20:23], v[52:55], v[32:35]
	s_waitcnt lgkmcnt(6)
	v_mfma_f32_16x16x32_bf16 v[36:39], v[24:27], v[52:55], v[36:39]
	v_mfma_f32_16x16x32_bf16 v[40:43], v[52:55], v[52:55], v[40:43]
	v_add_f32 v60, v60, v62
	v_add_f32 v61, v61, v63
	v_add_f32 v44, v44, v46
	v_add_f32 v45, v45, v47
	s_waitcnt lgkmcnt(3)
	v_mfma_f32_16x16x32_bf16 v[32:35], v[28:31], v[56:59], v[32:35]
	v_cvt_pk_bf16_f32 v62, v60, v61
	v_cvt_pk_bf16_f32 v63, v44, v45
	v_mfma_f32_16x16x32_bf16 v[40:43], v[56:59], v[56:59], v[40:43]
	buffer_store_dwordx2 v[62:63], v1, s[4:7], s69 offen sc1
	s_waitcnt lgkmcnt(2)
	v_mfma_f32_16x16x32_bf16 v[36:39], v[12:15], v[56:59], v[36:39]
	v_add_u32 v44, s66, v0
	v_add_u32 v45, s64, v1
	v_mfma_f32_16x16x32_bf16 v[40:43], v[8:11], v[8:11], v[40:43]
	s_waitcnt lgkmcnt(1)
	v_mfma_f32_16x16x32_bf16 v[32:35], v[16:19], v[8:11], v[32:35]
	s_waitcnt lgkmcnt(0)
	v_mfma_f32_16x16x32_bf16 v[36:39], v[48:51], v[8:11], v[36:39]
	ds_read_b128 v[8:11], v44 offset:23552
	ds_read_b128 v[12:15], v44 offset:24576
	ds_read_b64_tr_b16 v[52:53], v45 offset:9216
	ds_read_b64_tr_b16 v[54:55], v45 offset:9728
	v_mov_b32 v16, 0x3f803f80
	v_mov_b32 v17, 0x3f803f80
	v_mov_b32 v18, 0x3f803f80
	v_mov_b32 v19, 0x3f803f80
	v_mov_b32 v25, 0
	v_mov_b32 v26, 0
	v_max3_f32 v28, v40, v41, v32
	v_max3_f32 v29, v33, v34, v35
	v_max3_f32 v28, v28, v36, v37
	v_max3_f32 v29, v29, v38, v39
	v_max_f32 v28, v28, v29
	v_mov_b32 v29, v28
	s_waitcnt lgkmcnt(0)
	buffer_store_dwordx4 v[52:55], v0, s[4:7], s53 offen sc1
	s_cmp_eq_u32 s28, 63
	s_cbranch_scc1 .chainlast_34
	v_permlane16_swap_b32 v28, v29
	v_max_f32 v28, v28, v29
	v_mov_b32 v29, v28
	s_add_u32 s53, s53, 262144
	s_add_u32 s69, s69, 262144
	v_permlane32_swap_b32 v28, v29
	v_max_f32 v28, v28, v29
	v_mul_f32 v28, s60, v28
	v_pk_fma_f32 v[40:41], v[40:41], s[58:59], v[28:29] op_sel_hi:[1,1,0]
	v_pk_fma_f32 v[32:33], v[32:33], s[58:59], v[28:29] op_sel_hi:[1,1,0]
	v_pk_fma_f32 v[34:35], v[34:35], s[58:59], v[28:29] op_sel_hi:[1,1,0]
	v_pk_fma_f32 v[36:37], v[36:37], s[58:59], v[28:29] op_sel_hi:[1,1,0]
	v_pk_fma_f32 v[38:39], v[38:39], s[58:59], v[28:29] op_sel_hi:[1,1,0]
	v_exp_f32 v40, v40
	v_exp_f32 v41, v41
	v_exp_f32 v32, v32
	v_cvt_pk_bf16_f32 v24, v40, v41
	v_exp_f32 v33, v33
	v_mov_b32 v27, v24
	v_exp_f32 v34, v34
	v_mfma_f32_16x16x16_bf16 v[56:59], v[16:17], v[24:25], 0
	v_exp_f32 v35, v35
	v_mfma_f32_16x16x16_bf16 v[48:51], v[62:63], v[24:25], 0
	v_exp_f32 v36, v36
	v_cvt_pk_bf16_f32 v20, v32, v33
	v_mfma_f32_16x16x16_bf16 v[52:55], v[62:63], v[26:27], 0
	v_exp_f32 v37, v37
	v_cvt_pk_bf16_f32 v21, v34, v35
	v_exp_f32 v38, v38
	v_exp_f32 v39, v39
	v_cvt_pk_bf16_f32 v22, v36, v37
	v_cvt_pk_bf16_f32 v23, v38, v39
	s_nop 1
	v_mfma_f32_16x16x32_bf16 v[56:59], v[16:19], v[20:23], v[56:59]
	v_mfma_f32_16x16x32_bf16 v[48:51], v[8:11], v[20:23], v[48:51]
	v_mfma_f32_16x16x32_bf16 v[52:55], v[12:15], v[20:23], v[52:55]
	v_add_u32 v46, s67, v0
	v_add_u32 v47, 0x10000, v46
	v_rcp_f32 v56, v56
	s_nop 0
	v_pk_mul_f32 v[48:49], v[48:49], v[56:57] op_sel_hi:[1,0]
	v_pk_mul_f32 v[50:51], v[50:51], v[56:57] op_sel_hi:[1,0]
	s_nop 1
	v_pk_mul_f32 v[52:53], v[52:53], v[56:57] op_sel_hi:[1,0]
	v_pk_mul_f32 v[54:55], v[54:55], v[56:57] op_sel_hi:[1,0]
	v_cvt_pk_bf16_f32 v60, v48, v49
	v_cvt_pk_bf16_f32 v61, v52, v53
	v_cvt_pk_bf16_f32 v62, v50, v51
	v_cvt_pk_bf16_f32 v63, v54, v55
	s_mov_b64 exec, s[54:55]
	ds_write_b64 v6, v[60:61]
	ds_write_b64 v6, v[62:63] offset:32
	s_mov_b64 exec, -1
	ds_read_b128 v[8:11], v46 offset:0
	ds_read_b128 v[12:15], v46 offset:32768
	ds_read_b128 v[16:19], v47 offset:0
	ds_read_b128 v[20:23], v47 offset:32768
	ds_read_b128 v[24:27], v46 offset:1024
	ds_read_b128 v[28:31], v46 offset:33792
	ds_read_b128 v[32:35], v47 offset:1024
	ds_read_b128 v[36:39], v47 offset:33792
	v_mov_b64 v[48:49], 0
	v_mov_b64 v[50:51], 0
	v_mov_b64 v[52:53], 0
	v_mov_b64 v[54:55], 0
	s_waitcnt lgkmcnt(8)
	s_barrier
	ds_read_b128 v[40:43], v0 offset:13312
	ds_read_b128 v[56:59], v0 offset:14336
	s_cmp_eq_u32 s28, 63
	s_cbranch_scc1 .skipk_44
	s_add_u32 s17, s28, 2
	s_mov_b64 exec, 15
	s_waitcnt vmcnt(2)
	v_cmp_gt_u32 vcc, s17, v7
	s_cbranch_vccz .b1ok_45
	s_mov_b32 s20, 400000
.b1re_46:
	v_lshrrev_b32 v7, 2, v0
	buffer_load_dword v7, v7, s[4:7], s50 offen sc1
	s_waitcnt vmcnt(0)
	v_cmp_gt_u32 vcc, s17, v7
	s_cbranch_vccz .b1ok_45
	s_sub_u32 s20, s20, 1
	s_cmp_lg_u32 s20, 0
	s_cbranch_scc1 .b1re_46
	s_branch L_FAIL
.b1ok_45:
	s_mov_b64 exec, -1
	s_mov_b32 m0, s68
	s_nop 0
	buffer_load_dwordx4 v0, s[4:7], s52 offen offset:0 lds
	buffer_load_dwordx4 v0, s[4:7], s52 offen offset:1024 lds
	buffer_load_dwordx4 v0, s[4:7], s52 offen offset:2048 lds
	buffer_load_dwordx4 v0, s[4:7], s52 offen offset:3072 lds
	s_add_u32 s52, s52, 786432
.skipk_44:
	s_waitcnt lgkmcnt(1)
	v_smfmac_f32_16x16x64_bf16 v[48:51], v[40:43], v[240:247], v2
	s_waitcnt lgkmcnt(0)
	v_smfmac_f32_16x16x64_bf16 v[48:51], v[56:59], v[248:255], v2
	v_smfmac_f32_16x16x64_bf16 v[52:55], v[40:43], v[8:15], v2
	ds_read_b128 v[8:11], v46 offset:2048
	ds_read_b128 v[12:15], v46 offset:34816
	v_smfmac_f32_16x16x64_bf16 v[52:55], v[56:59], v[16:23], v2
	ds_read_b128 v[16:19], v47 offset:2048
	ds_read_b128 v[20:23], v47 offset:34816
	v_add_f32 v44, v48, v50
	v_add_f32 v45, v49, v51
	v_mov_b64 v[48:49], 0
	v_mov_b64 v[50:51], 0
	v_lshrrev_b32 v61, 2, v0
	v_cvt_pk_bf16_f32 v60, v44, v45
	v_add_u32 v44, 0x10000, v44
	s_mov_b64 exec, s[76:77]
	v_and_b32_sdwa v60, v44, -2 dst_sel:WORD_0 dst_unused:UNUSED_PRESERVE src0_sel:WORD_1 src1_sel:DWORD
	s_mov_b64 exec, -1
	buffer_store_dword v60, v61, s[4:7], s38 offen
	v_smfmac_f32_16x16x64_bf16 v[48:51], v[40:43], v[24:31], v2
	ds_read_b128 v[24:27], v46 offset:3072
	ds_read_b128 v[28:31], v46 offset:35840
	v_smfmac_f32_16x16x64_bf16 v[48:51], v[56:59], v[32:39], v2
	ds_read_b128 v[32:35], v47 offset:3072
	ds_read_b128 v[36:39], v47 offset:35840
	v_add_f32 v44, v52, v54
	v_add_f32 v45, v53, v55
	v_mov_b64 v[52:53], 0
	v_mov_b64 v[54:55], 0
	v_cvt_pk_bf16_f32 v60, v44, v45
	v_add_u32 v44, 0x10000, v44
	s_nop 0
	v_and_b32_sdwa v60, v44, -2 dst_sel:WORD_0 dst_unused:UNUSED_PRESERVE src0_sel:WORD_1 src1_sel:DWORD
	s_waitcnt lgkmcnt(6)
	v_smfmac_f32_16x16x64_bf16 v[52:55], v[40:43], v[8:15], v2
	ds_read_b128 v[8:11], v46 offset:4096
	ds_read_b128 v[12:15], v46 offset:36864
	s_waitcnt lgkmcnt(6)
	v_smfmac_f32_16x16x64_bf16 v[52:55], v[56:59], v[16:23], v2
	ds_read_b128 v[16:19], v47 offset:4096
	ds_read_b128 v[20:23], v47 offset:36864
	v_add_f32 v44, v48, v50
	v_add_f32 v45, v49, v51
	v_mov_b64 v[48:49], 0
	v_mov_b64 v[50:51], 0
	v_cvt_pk_bf16_f32 v61, v44, v45
	s_waitcnt lgkmcnt(6)
	v_smfmac_f32_16x16x64_bf16 v[48:51], v[40:43], v[24:31], v2
	ds_read_b128 v[24:27], v46 offset:5120
	ds_read_b128 v[28:31], v46 offset:37888
	s_waitcnt lgkmcnt(6)
	v_smfmac_f32_16x16x64_bf16 v[48:51], v[56:59], v[32:39], v2
	ds_read_b128 v[32:35], v47 offset:5120
	ds_read_b128 v[36:39], v47 offset:37888
	v_add_f32 v44, v52, v54
	v_add_f32 v45, v53, v55
	v_mov_b64 v[52:53], 0
	v_mov_b64 v[54:55], 0
	v_cvt_pk_bf16_f32 v62, v44, v45
	s_waitcnt lgkmcnt(6)
	v_smfmac_f32_16x16x64_bf16 v[52:55], v[40:43], v[8:15], v2
	ds_read_b128 v[8:11], v46 offset:6144
	ds_read_b128 v[12:15], v46 offset:38912
	s_waitcnt lgkmcnt(6)
	v_smfmac_f32_16x16x64_bf16 v[52:55], v[56:59], v[16:23], v2
	ds_read_b128 v[16:19], v47 offset:6144
	ds_read_b128 v[20:23], v47 offset:38912
	v_add_f32 v44, v48, v50
	v_add_f32 v45, v49, v51
	v_mov_b64 v[48:49], 0
	v_mov_b64 v[50:51], 0
	v_cvt_pk_bf16_f32 v63, v44, v45
	buffer_store_dwordx4 v[60:63], v0, s[4:7], s38 offen offset:256
	s_waitcnt lgkmcnt(6)
	v_smfmac_f32_16x16x64_bf16 v[48:51], v[40:43], v[24:31], v2
	ds_read_b128 v[24:27], v46 offset:7168
	ds_read_b128 v[28:31], v46 offset:39936
	s_waitcnt lgkmcnt(6)
	v_smfmac_f32_16x16x64_bf16 v[48:51], v[56:59], v[32:39], v2
	ds_read_b128 v[32:35], v47 offset:7168
	ds_read_b128 v[36:39], v47 offset:39936
	v_add_f32 v44, v52, v54
	v_add_f32 v45, v53, v55
	v_mov_b64 v[52:53], 0
	v_mov_b64 v[54:55], 0
	v_cvt_pk_bf16_f32 v60, v44, v45
	v_add_u32 v44, 0x10000, v44
	s_nop 0
	v_and_b32_sdwa v60, v44, -2 dst_sel:WORD_0 dst_unused:UNUSED_PRESERVE src0_sel:WORD_1 src1_sel:DWORD
	s_waitcnt lgkmcnt(6)
	v_smfmac_f32_16x16x64_bf16 v[52:55], v[40:43], v[8:15], v2
	s_waitcnt lgkmcnt(4)
	v_smfmac_f32_16x16x64_bf16 v[52:55], v[56:59], v[16:23], v2
	v_add_f32 v44, v48, v50
	v_add_f32 v45, v49, v51
	v_mov_b64 v[48:49], 0
	v_mov_b64 v[50:51], 0
	v_cvt_pk_bf16_f32 v61, v44, v45
	s_waitcnt lgkmcnt(2)
	v_smfmac_f32_16x16x64_bf16 v[48:51], v[40:43], v[24:31], v2
	s_waitcnt lgkmcnt(0)
	v_smfmac_f32_16x16x64_bf16 v[48:51], v[56:59], v[32:39], v2
	v_add_f32 v44, v52, v54
	v_add_f32 v45, v53, v55
	v_cvt_pk_bf16_f32 v62, v44, v45
	s_nop 4
	v_add_f32 v44, v48, v50
	v_add_f32 v45, v49, v51
	v_cvt_pk_bf16_f32 v63, v44, v45
	buffer_store_dwordx4 v[60:63], v0, s[4:7], s38 offen offset:1280
	s_waitcnt vmcnt(0)
	s_mov_b32 s20, 400000
	s_cmp_eq_u32 s61, 0
	s_cbranch_scc1 .h1none_47
	buffer_load_dwordx4 v[8:11], v3, s[4:7], s30 offen sc1
	buffer_load_dwordx4 v[12:15], v3, s[4:7], s31 offen sc1
	buffer_load_dwordx4 v[16:19], v3, s[4:7], s32 offen sc1
	buffer_load_dwordx4 v[20:23], v3, s[4:7], s33 offen sc1
	v_mov_b64 v[44:45], 0
	v_mov_b64 v[46:47], 0
	v_mov_b64 v[48:49], 0
	v_mov_b64 v[50:51], 0
	v_mov_b64 v[52:53], 0
	v_mov_b64 v[54:55], 0
	v_mov_b64 v[56:57], 0
	v_mov_b64 v[58:59], 0
	v_mov_b64 v[60:61], 0
	v_mov_b64 v[62:63], 0
	v_lshrrev_b32 v35, 2, v0
	v_and_b32 v35, 16, v35
	v_lshlrev_b32 v35, v35, s78
	s_mov_b64 vcc, s[76:77]
	v_cndmask_b32 v24, 0, v35, vcc
	s_lshl_b64 vcc, vcc, 1
	v_cndmask_b32 v25, 0, v35, vcc
	s_lshl_b64 vcc, vcc, 1
	v_cndmask_b32 v26, 0, v35, vcc
	s_lshl_b64 vcc, vcc, 1
	v_cndmask_b32 v27, 0, v35, vcc
	v_bfe_i32 v34, v0, 9, 1
	s_branch .h1w_50
.hop1_49:
	s_mov_b64 exec, vcc
	s_sub_u32 s20, s20, 1
	s_cbranch_scc1 L_FAIL
	buffer_load_dwordx4 v[8:11], v3, s[4:7], s30 offen sc1
	buffer_load_dwordx4 v[12:15], v3, s[4:7], s31 offen sc1
	buffer_load_dwordx4 v[16:19], v3, s[4:7], s32 offen sc1
	buffer_load_dwordx4 v[20:23], v3, s[4:7], s33 offen sc1
.h1w_50:
	s_waitcnt vmcnt(0)
	v_mfma_f32_16x16x32_bf16 v[28:31], v[24:27], v[8:11], 0
	v_or3_b32 v35, v8, v12, v16
	v_mfma_f32_16x16x32_bf16 v[28:31], v[24:27], v[12:15], v[28:31]
	v_bitop3_b32 v35, v35, v20, 1 bitop3:0xa8
	v_mfma_f32_16x16x32_bf16 v[28:31], v[24:27], v[16:19], v[28:31]
	v_cmp_ne_u32 vcc, 0, v35
	v_mfma_f32_16x16x32_bf16 v[28:31], v[24:27], v[20:23], v[28:31]
	s_cbranch_vccnz .hop1_49
	s_mov_b64 exec, -1
	s_nop 5
	v_add_f32_dpp v32, v28, v28 row_ror:8 row_mask:0xf bank_mask:0x3
	v_add_f32_dpp v33, v29, v29 row_ror:8 row_mask:0xf bank_mask:0x3
	s_nop 0
	v_add_f32_dpp v32, v30, v30 row_ror:8 row_mask:0xf bank_mask:0xc
	v_add_f32_dpp v33, v31, v31 row_ror:8 row_mask:0xf bank_mask:0xc
	v_cvt_pk_bf16_f32 v32, v32, v33
	v_or_b32 v32, v32, v34
	buffer_store_dword v32, v4, s[4:7], s40 offen
	v_xor_b32 v4, 0x4000, v4
	s_branch .h1join_48
.h1none_47:
	v_mov_b64 v[44:45], 0
	v_mov_b64 v[46:47], 0
	v_mov_b64 v[48:49], 0
	v_mov_b64 v[50:51], 0
	v_mov_b64 v[52:53], 0
	v_mov_b64 v[54:55], 0
	v_mov_b64 v[56:57], 0
	v_mov_b64 v[58:59], 0
	v_mov_b64 v[60:61], 0
	v_mov_b64 v[62:63], 0
.h1join_48:
	s_barrier
	s_waitcnt vmcnt(0)
	v_add_u32 v20, s64, v0
	v_add_u32 v21, s65, v0
	v_mov_b64 v[16:17], 0
	v_mov_b64 v[18:19], 0
	s_mov_b32 s20, 400000
	buffer_load_dwordx4 v[8:11], v0, s[4:7], s44 offen sc1
	buffer_load_dwordx4 v[12:15], v0, s[4:7], s45 offen sc1
	s_mov_b64 exec, 0xffff
	buffer_load_dwordx4 v[16:19], v0, s[4:7], s46 offen sc1
	s_mov_b64 exec, -1
	s_branch .h2w_52
.hop2_51:
	s_mov_b64 exec, vcc
	s_mov_b64 s[74:75], vcc
	s_sub_u32 s20, s20, 1
	s_cbranch_scc1 L_FAIL
	buffer_load_dwordx4 v[8:11], v0, s[4:7], s44 offen sc1
	buffer_load_dwordx4 v[12:15], v0, s[4:7], s45 offen sc1
	s_and_b64 exec, exec, 0xffff
	buffer_load_dwordx4 v[16:19], v0, s[4:7], s46 offen sc1
	s_mov_b64 exec, s[74:75]
.h2w_52:
	s_waitcnt vmcnt(0)
	v_max3_u32 v22, v8, v9, v10
	v_max3_u32 v23, v11, v12, v13
	v_max3_u32 v22, v22, v14, v15
	v_max3_u32 v23, v23, v16, v17
	v_max3_u32 v22, v22, v18, v19
	v_max_u32 v22, v22, v23
	v_cmp_eq_u32 vcc, -1, v22
	s_cbranch_vccnz .hop2_51
	s_mov_b64 exec, -1
	s_add_u32 s17, s28, 1
	v_mov_b32 v36, s17
	s_mov_b64 exec, 1
	buffer_store_dword v36, v0, s[4:7], s51 offen sc1
	s_mov_b64 exec, -1
	ds_write_b128 v20, v[8:11] offset:0
	ds_write_b128 v20, v[12:15] offset:4096
	s_mov_b64 exec, 0xffff
	ds_write_b128 v21, v[16:19] offset:8192
	s_mov_b64 exec, -1
	s_add_u32 s28, s28, 1
	s_waitcnt lgkmcnt(0)
	s_barrier
	s_cmp_lt_u32 s28, 64
	s_cbranch_scc1 .chainloop_33
.chainlast_34:
	s_waitcnt vmcnt(0)
	v_mov_b32 v14, 64
	s_mov_b64 exec, 1
	buffer_store_dword v14, v0, s[4:7], s51 offen sc1
	s_mov_b64 exec, -1
	s_branch L_END
L_CHAIN_CE:
L_CHAIN_DEV:
	s_mov_b32 s20, 400000
	s_mov_b64 exec, 15
.b1first_61:
	v_lshrrev_b32 v7, 2, v0
	buffer_load_dword v7, v7, s[4:7], s50 offen sc1
	s_waitcnt vmcnt(0)
	v_cmp_gt_u32 vcc, 1, v7
	s_cbranch_vccz .b1fok_62
	s_sub_u32 s20, s20, 1
	s_cmp_lg_u32 s20, 0
	s_cbranch_scc1 .b1first_61
	s_branch L_FAIL
.b1fok_62:
	s_mov_b64 exec, -1
	s_mov_b32 m0, s68
	s_nop 0
	buffer_load_dwordx4 v0, s[4:7], s52 offen offset:0 lds
	buffer_load_dwordx4 v0, s[4:7], s52 offen offset:1024 lds
	buffer_load_dwordx4 v0, s[4:7], s52 offen offset:2048 lds
	buffer_load_dwordx4 v0, s[4:7], s52 offen offset:3072 lds
	s_add_u32 s52, s52, 786432
	v_mov_b64 v[44:45], 0
	v_mov_b64 v[46:47], 0
	v_mov_b64 v[48:49], 0
	v_mov_b64 v[50:51], 0
	v_mov_b64 v[52:53], 0
	v_mov_b64 v[54:55], 0
	v_mov_b64 v[56:57], 0
	v_mov_b64 v[58:59], 0
	v_mov_b64 v[60:61], 0
	v_mov_b64 v[62:63], 0
	s_mov_b32 s28, 0
	s_waitcnt vmcnt(0)
	s_barrier
.chainloop_63:
	ds_read_b128 v[8:11], v0 offset:0
	ds_read_b128 v[12:15], v0 offset:1024
	ds_read_b128 v[16:19], v0 offset:2048
	ds_read_b128 v[20:23], v0 offset:3072
	ds_read_b128 v[24:27], v0 offset:4096
	ds_read_b128 v[28:31], v0 offset:5120
	ds_read_b128 v[32:35], v0 offset:6144
	ds_read_b128 v[36:39], v0 offset:7168
	ds_read_b128 v[40:43], v0 offset:8192
	s_mov_b64 exec, 15
	v_lshrrev_b32 v7, 2, v0
	buffer_load_dword v7, v7, s[4:7], s50 offen sc1
	s_mov_b64 exec, -1
	s_waitcnt lgkmcnt(8)
	v_smfmac_f32_16x16x64_bf16 v[44:47], v[8:11], a[0:7], v2
	v_smfmac_f32_16x16x64_bf16 v[52:55], v[8:11], a[144:151], v2
	v_smfmac_f32_16x16x64_bf16 v[48:51], v[8:11], a[72:79], v2
	v_smfmac_f32_16x16x64_bf16 v[56:59], v[8:11], a[216:223], v2
	s_waitcnt lgkmcnt(7)
	v_smfmac_f32_16x16x64_bf16 v[44:47], v[12:15], a[8:15], v2
	v_smfmac_f32_16x16x64_bf16 v[52:55], v[12:15], a[152:159], v2
	v_smfmac_f32_16x16x64_bf16 v[48:51], v[12:15], a[80:87], v2
	v_smfmac_f32_16x16x64_bf16 v[56:59], v[12:15], a[224:231], v2
	s_waitcnt lgkmcnt(6)
	v_smfmac_f32_16x16x64_bf16 v[44:47], v[16:19], a[16:23], v2
	v_smfmac_f32_16x16x64_bf16 v[52:55], v[16:19], a[160:167], v2
	v_smfmac_f32_16x16x64_bf16 v[48:51], v[16:19], a[88:95], v2
	v_smfmac_f32_16x16x64_bf16 v[56:59], v[16:19], a[232:239], v2
	s_waitcnt lgkmcnt(5)
	v_smfmac_f32_16x16x64_bf16 v[44:47], v[20:23], a[24:31], v2
	v_smfmac_f32_16x16x64_bf16 v[52:55], v[20:23], a[168:175], v2
	v_smfmac_f32_16x16x64_bf16 v[48:51], v[20:23], a[96:103], v2
	v_smfmac_f32_16x16x64_bf16 v[56:59], v[20:23], a[240:247], v2
	s_waitcnt lgkmcnt(4)
	v_smfmac_f32_16x16x64_bf16 v[44:47], v[24:27], a[32:39], v2
	v_smfmac_f32_16x16x64_bf16 v[52:55], v[24:27], a[176:183], v2
	v_smfmac_f32_16x16x64_bf16 v[48:51], v[24:27], a[104:111], v2
	v_smfmac_f32_16x16x64_bf16 v[56:59], v[24:27], a[248:255], v2
	s_waitcnt lgkmcnt(3)
	v_smfmac_f32_16x16x64_bf16 v[44:47], v[28:31], a[40:47], v2
	v_smfmac_f32_16x16x64_bf16 v[52:55], v[28:31], a[184:191], v2
	v_smfmac_f32_16x16x64_bf16 v[48:51], v[28:31], a[112:119], v2
	v_smfmac_f32_16x16x64_bf16 v[56:59], v[28:31], v[64:71], v2
	s_waitcnt lgkmcnt(2)
	v_smfmac_f32_16x16x64_bf16 v[44:47], v[32:35], a[48:55], v2
	v_smfmac_f32_16x16x64_bf16 v[52:55], v[32:35], a[192:199], v2
	v_smfmac_f32_16x16x64_bf16 v[48:51], v[32:35], a[120:127], v2
	v_smfmac_f32_16x16x64_bf16 v[56:59], v[32:35], v[72:79], v2
	s_waitcnt lgkmcnt(0)
	v_smfmac_f32_16x16x64_bf16 v[44:47], v[36:39], a[56:63], v2
	v_smfmac_f32_16x16x64_bf16 v[52:55], v[36:39], a[200:207], v2
	v_smfmac_f32_16x16x64_bf16 v[44:47], v[40:43], a[64:71], v2
	v_smfmac_f32_16x16x64_bf16 v[52:55], v[40:43], a[208:215], v2
	v_smfmac_f32_16x16x64_bf16 v[48:51], v[36:39], a[128:135], v2
	v_smfmac_f32_16x16x64_bf16 v[56:59], v[36:39], v[80:87], v2
	v_smfmac_f32_16x16x64_bf16 v[48:51], v[40:43], a[136:143], v2
	v_add_f32 v52, v52, v54
	v_add_f32 v53, v53, v55
	v_add_f32 v44, v44, v46
	v_add_f32 v45, v45, v47
	v_cvt_pk_bf16_f32 v54, v52, v53
	v_cvt_pk_bf16_f32 v55, v44, v45
	ds_write_b64 v5, v[54:55] offset:0
	v_smfmac_f32_16x16x64_bf16 v[56:59], v[40:43], v[88:95], v2
	v_mov_b64 v[44:45], 0
	v_mov_b64 v[46:47], 0
	v_smfmac_f32_16x16x64_bf16 v[60:63], v[8:11], v[96:103], v2
	v_smfmac_f32_16x16x64_bf16 v[60:63], v[12:15], v[104:111], v2
	v_add_f32 v56, v56, v58
	v_add_f32 v57, v57, v59
	v_add_f32 v48, v48, v50
	v_add_f32 v49, v49, v51
	v_cvt_pk_bf16_f32 v58, v56, v57
	v_cvt_pk_bf16_f32 v59, v48, v49
	ds_write_b64 v5, v[58:59] offset:512
	v_smfmac_f32_16x16x64_bf16 v[44:47], v[8:11], v[168:175], v2
	v_smfmac_f32_16x16x64_bf16 v[44:47], v[12:15], v[176:183], v2
	v_smfmac_f32_16x16x64_bf16 v[60:63], v[16:19], v[112:119], v2
	v_smfmac_f32_16x16x64_bf16 v[44:47], v[16:19], v[184:191], v2
	s_waitcnt lgkmcnt(0)
	s_barrier
	ds_read_b64_tr_b16 v[48:49], v1 offset:9216
	ds_read_b64_tr_b16 v[50:51], v1 offset:9728
	ds_read_b128 v[12:15], v0 offset:15360
	ds_read_b128 v[16:19], v0 offset:19456
	v_smfmac_f32_16x16x64_bf16 v[60:63], v[20:23], v[120:127], v2
	ds_read_b64_tr_b16 v[52:53], v1 offset:10240
	ds_read_b64_tr_b16 v[54:55], v1 offset:10752
	v_smfmac_f32_16x16x64_bf16 v[44:47], v[20:23], v[192:199], v2
	ds_read_b128 v[20:23], v0 offset:16384
	v_smfmac_f32_16x16x64_bf16 v[60:63], v[24:27], v[128:135], v2
	ds_read_b64_tr_b16 v[56:57], v1 offset:11264
	ds_read_b64_tr_b16 v[58:59], v1 offset:11776
	v_smfmac_f32_16x16x64_bf16 v[44:47], v[24:27], v[200:207], v2
	ds_read_b128 v[24:27], v0 offset:20480
	v_smfmac_f32_16x16x64_bf16 v[60:63], v[28:31], v[136:143], v2
	ds_read_b64_tr_b16 v[8:9], v1 offset:12288
	ds_read_b64_tr_b16 v[10:11], v1 offset:12800
	v_smfmac_f32_16x16x64_bf16 v[44:47], v[28:31], v[208:215], v2
	ds_read_b128 v[28:31], v0 offset:17408
	v_smfmac_f32_16x16x64_bf16 v[60:63], v[32:35], v[144:151], v2
	v_smfmac_f32_16x16x64_bf16 v[44:47], v[32:35], v[216:223], v2
	v_smfmac_f32_16x16x64_bf16 v[60:63], v[36:39], v[152:159], v2
	v_smfmac_f32_16x16x64_bf16 v[44:47], v[36:39], v[224:231], v2
	v_smfmac_f32_16x16x64_bf16 v[60:63], v[40:43], v[160:167], v2
	v_smfmac_f32_16x16x64_bf16 v[44:47], v[40:43], v[232:239], v2
	s_waitcnt lgkmcnt(10)
	v_mfma_f32_16x16x32_bf16 v[32:35], v[12:15], v[48:51], 0
	s_waitcnt lgkmcnt(9)
	v_mfma_f32_16x16x32_bf16 v[36:39], v[16:19], v[48:51], 0
	ds_read_b128 v[12:15], v0 offset:21504
	v_mfma_f32_16x16x32_bf16 v[40:43], v[48:51], v[48:51], 0
	ds_read_b128 v[16:19], v0 offset:18432
	ds_read_b128 v[48:51], v0 offset:22528
	s_waitcnt lgkmcnt(9)
	v_mfma_f32_16x16x32_bf16 v[32:35], v[20:23], v[52:55], v[32:35]
	s_waitcnt lgkmcnt(6)
	v_mfma_f32_16x16x32_bf16 v[36:39], v[24:27], v[52:55], v[36:39]
	v_mfma_f32_16x16x32_bf16 v[40:43], v[52:55], v[52:55], v[40:43]
	v_add_f32 v60, v60, v62
	v_add_f32 v61, v61, v63
	v_add_f32 v44, v44, v46
	v_add_f32 v45, v45, v47
	s_waitcnt lgkmcnt(3)
	v_mfma_f32_16x16x32_bf16 v[32:35], v[28:31], v[56:59], v[32:35]
	v_cvt_pk_bf16_f32 v62, v60, v61
	v_cvt_pk_bf16_f32 v63, v44, v45
	v_mfma_f32_16x16x32_bf16 v[40:43], v[56:59], v[56:59], v[40:43]
	buffer_store_dwordx2 v[62:63], v1, s[4:7], s69 offen sc1
	s_waitcnt lgkmcnt(2)
	v_mfma_f32_16x16x32_bf16 v[36:39], v[12:15], v[56:59], v[36:39]
	v_add_u32 v44, s66, v0
	v_add_u32 v45, s64, v1
	v_mfma_f32_16x16x32_bf16 v[40:43], v[8:11], v[8:11], v[40:43]
	s_waitcnt lgkmcnt(1)
	v_mfma_f32_16x16x32_bf16 v[32:35], v[16:19], v[8:11], v[32:35]
	s_waitcnt lgkmcnt(0)
	v_mfma_f32_16x16x32_bf16 v[36:39], v[48:51], v[8:11], v[36:39]
	ds_read_b128 v[8:11], v44 offset:23552
	ds_read_b128 v[12:15], v44 offset:24576
	ds_read_b64_tr_b16 v[52:53], v45 offset:9216
	ds_read_b64_tr_b16 v[54:55], v45 offset:9728
	v_mov_b32 v16, 0x3f803f80
	v_mov_b32 v17, 0x3f803f80
	v_mov_b32 v18, 0x3f803f80
	v_mov_b32 v19, 0x3f803f80
	v_mov_b32 v25, 0
	v_mov_b32 v26, 0
	v_max3_f32 v28, v40, v41, v32
	v_max3_f32 v29, v33, v34, v35
	v_max3_f32 v28, v28, v36, v37
	v_max3_f32 v29, v29, v38, v39
	v_max_f32 v28, v28, v29
	v_mov_b32 v29, v28
	s_waitcnt lgkmcnt(0)
	buffer_store_dwordx4 v[52:55], v0, s[4:7], s53 offen sc1
	v_permlane16_swap_b32 v28, v29
	v_max_f32 v28, v28, v29
	v_mov_b32 v29, v28
	s_add_u32 s53, s53, 262144
	s_add_u32 s69, s69, 262144
	v_permlane32_swap_b32 v28, v29
	v_max_f32 v28, v28, v29
	v_mul_f32 v28, s60, v28
	v_pk_fma_f32 v[40:41], v[40:41], s[58:59], v[28:29] op_sel_hi:[1,1,0]
	v_pk_fma_f32 v[32:33], v[32:33], s[58:59], v[28:29] op_sel_hi:[1,1,0]
	v_pk_fma_f32 v[34:35], v[34:35], s[58:59], v[28:29] op_sel_hi:[1,1,0]
	v_pk_fma_f32 v[36:37], v[36:37], s[58:59], v[28:29] op_sel_hi:[1,1,0]
	v_pk_fma_f32 v[38:39], v[38:39], s[58:59], v[28:29] op_sel_hi:[1,1,0]
	v_exp_f32 v40, v40
	v_exp_f32 v41, v41
	v_exp_f32 v32, v32
	v_cvt_pk_bf16_f32 v24, v40, v41
	v_exp_f32 v33, v33
	v_mov_b32 v27, v24
	v_exp_f32 v34, v34
	v_mfma_f32_16x16x16_bf16 v[56:59], v[16:17], v[24:25], 0
	v_exp_f32 v35, v35
	v_mfma_f32_16x16x16_bf16 v[48:51], v[62:63], v[24:25], 0
	v_exp_f32 v36, v36
	v_cvt_pk_bf16_f32 v20, v32, v33
	v_mfma_f32_16x16x16_bf16 v[52:55], v[62:63], v[26:27], 0
	v_exp_f32 v37, v37
	v_cvt_pk_bf16_f32 v21, v34, v35
	v_exp_f32 v38, v38
	v_exp_f32 v39, v39
	v_cvt_pk_bf16_f32 v22, v36, v37
	v_cvt_pk_bf16_f32 v23, v38, v39
	s_nop 1
	v_mfma_f32_16x16x32_bf16 v[56:59], v[16:19], v[20:23], v[56:59]
	v_mfma_f32_16x16x32_bf16 v[48:51], v[8:11], v[20:23], v[48:51]
	v_mfma_f32_16x16x32_bf16 v[52:55], v[12:15], v[20:23], v[52:55]
	v_add_u32 v46, s67, v0
	v_add_u32 v47, 0x10000, v46
	v_rcp_f32 v56, v56
	s_nop 0
	v_pk_mul_f32 v[48:49], v[48:49], v[56:57] op_sel_hi:[1,0]
	v_pk_mul_f32 v[50:51], v[50:51], v[56:57] op_sel_hi:[1,0]
	s_nop 1
	v_pk_mul_f32 v[52:53], v[52:53], v[56:57] op_sel_hi:[1,0]
	v_pk_mul_f32 v[54:55], v[54:55], v[56:57] op_sel_hi:[1,0]
	v_cvt_pk_bf16_f32 v60, v48, v49
	v_cvt_pk_bf16_f32 v61, v52, v53
	v_cvt_pk_bf16_f32 v62, v50, v51
	v_cvt_pk_bf16_f32 v63, v54, v55
	s_mov_b64 exec, s[54:55]
	ds_write_b64 v6, v[60:61]
	ds_write_b64 v6, v[62:63] offset:32
	s_mov_b64 exec, -1
	ds_read_b128 v[8:11], v46 offset:0
	ds_read_b128 v[12:15], v46 offset:32768
	ds_read_b128 v[16:19], v47 offset:0
	ds_read_b128 v[20:23], v47 offset:32768
	ds_read_b128 v[24:27], v46 offset:1024
	ds_read_b128 v[28:31], v46 offset:33792
	ds_read_b128 v[32:35], v47 offset:1024
	ds_read_b128 v[36:39], v47 offset:33792
	v_mov_b64 v[48:49], 0
	v_mov_b64 v[50:51], 0
	v_mov_b64 v[52:53], 0
	v_mov_b64 v[54:55], 0
	s_waitcnt lgkmcnt(8)
	s_barrier
	ds_read_b128 v[40:43], v0 offset:13312
	ds_read_b128 v[56:59], v0 offset:14336
	s_cmp_eq_u32 s28, 63
	s_cbranch_scc1 .skipk_65
	s_add_u32 s17, s28, 2
	s_mov_b64 exec, 15
	s_waitcnt vmcnt(2)
	v_cmp_gt_u32 vcc, s17, v7
	s_cbranch_vccz .b1ok_66
	s_mov_b32 s20, 400000
.b1re_67:
	v_lshrrev_b32 v7, 2, v0
	buffer_load_dword v7, v7, s[4:7], s50 offen sc1
	s_waitcnt vmcnt(0)
	v_cmp_gt_u32 vcc, s17, v7
	s_cbranch_vccz .b1ok_66
	s_sub_u32 s20, s20, 1
	s_cmp_lg_u32 s20, 0
	s_cbranch_scc1 .b1re_67
	s_branch L_FAIL
.b1ok_66:
	s_mov_b64 exec, -1
	s_mov_b32 m0, s68
	s_nop 0
	buffer_load_dwordx4 v0, s[4:7], s52 offen offset:0 lds
	buffer_load_dwordx4 v0, s[4:7], s52 offen offset:1024 lds
	buffer_load_dwordx4 v0, s[4:7], s52 offen offset:2048 lds
	buffer_load_dwordx4 v0, s[4:7], s52 offen offset:3072 lds
	s_add_u32 s52, s52, 786432
.skipk_65:
	s_waitcnt lgkmcnt(1)
	v_smfmac_f32_16x16x64_bf16 v[48:51], v[40:43], v[240:247], v2
	s_waitcnt lgkmcnt(0)
	v_smfmac_f32_16x16x64_bf16 v[48:51], v[56:59], v[248:255], v2
	v_smfmac_f32_16x16x64_bf16 v[52:55], v[40:43], v[8:15], v2
	ds_read_b128 v[8:11], v46 offset:2048
	ds_read_b128 v[12:15], v46 offset:34816
	v_smfmac_f32_16x16x64_bf16 v[52:55], v[56:59], v[16:23], v2
	ds_read_b128 v[16:19], v47 offset:2048
	ds_read_b128 v[20:23], v47 offset:34816
	v_add_f32 v44, v48, v50
	v_add_f32 v45, v49, v51
	v_mov_b64 v[48:49], 0
	v_mov_b64 v[50:51], 0
	v_lshrrev_b32 v61, 2, v0
	v_cvt_pk_bf16_f32 v60, v44, v45
	s_mov_b64 exec, s[76:77]
	v_or_b32_sdwa v60, v44, 1 dst_sel:WORD_0 dst_unused:UNUSED_PRESERVE src0_sel:WORD_1 src1_sel:DWORD
	s_mov_b64 exec, -1
	buffer_store_dword v60, v61, s[4:7], s38 offen sc1
	v_smfmac_f32_16x16x64_bf16 v[48:51], v[40:43], v[24:31], v2
	ds_read_b128 v[24:27], v46 offset:3072
	ds_read_b128 v[28:31], v46 offset:35840
	v_smfmac_f32_16x16x64_bf16 v[48:51], v[56:59], v[32:39], v2
	ds_read_b128 v[32:35], v47 offset:3072
	ds_read_b128 v[36:39], v47 offset:35840
	v_add_f32 v44, v52, v54
	v_add_f32 v45, v53, v55
	v_mov_b64 v[52:53], 0
	v_mov_b64 v[54:55], 0
	v_cvt_pk_bf16_f32 v60, v44, v45
	s_nop 0
	v_or_b32_sdwa v60, v44, 1 dst_sel:WORD_0 dst_unused:UNUSED_PRESERVE src0_sel:WORD_1 src1_sel:DWORD
	s_waitcnt lgkmcnt(6)
	v_smfmac_f32_16x16x64_bf16 v[52:55], v[40:43], v[8:15], v2
	ds_read_b128 v[8:11], v46 offset:4096
	ds_read_b128 v[12:15], v46 offset:36864
	s_waitcnt lgkmcnt(6)
	v_smfmac_f32_16x16x64_bf16 v[52:55], v[56:59], v[16:23], v2
	ds_read_b128 v[16:19], v47 offset:4096
	ds_read_b128 v[20:23], v47 offset:36864
	v_add_f32 v44, v48, v50
	v_add_f32 v45, v49, v51
	v_mov_b64 v[48:49], 0
	v_mov_b64 v[50:51], 0
	v_cvt_pk_bf16_f32 v61, v44, v45
	s_waitcnt lgkmcnt(6)
	v_smfmac_f32_16x16x64_bf16 v[48:51], v[40:43], v[24:31], v2
	ds_read_b128 v[24:27], v46 offset:5120
	ds_read_b128 v[28:31], v46 offset:37888
	s_waitcnt lgkmcnt(6)
	v_smfmac_f32_16x16x64_bf16 v[48:51], v[56:59], v[32:39], v2
	ds_read_b128 v[32:35], v47 offset:5120
	ds_read_b128 v[36:39], v47 offset:37888
	v_add_f32 v44, v52, v54
	v_add_f32 v45, v53, v55
	v_mov_b64 v[52:53], 0
	v_mov_b64 v[54:55], 0
	v_cvt_pk_bf16_f32 v62, v44, v45
	s_waitcnt lgkmcnt(6)
	v_smfmac_f32_16x16x64_bf16 v[52:55], v[40:43], v[8:15], v2
	ds_read_b128 v[8:11], v46 offset:6144
	ds_read_b128 v[12:15], v46 offset:38912
	s_waitcnt lgkmcnt(6)
	v_smfmac_f32_16x16x64_bf16 v[52:55], v[56:59], v[16:23], v2
	ds_read_b128 v[16:19], v47 offset:6144
	ds_read_b128 v[20:23], v47 offset:38912
	v_add_f32 v44, v48, v50
	v_add_f32 v45, v49, v51
	v_mov_b64 v[48:49], 0
	v_mov_b64 v[50:51], 0
	v_cvt_pk_bf16_f32 v63, v44, v45
	buffer_store_dwordx4 v[60:63], v0, s[4:7], s38 offen offset:256 sc1
	s_waitcnt lgkmcnt(6)
	v_smfmac_f32_16x16x64_bf16 v[48:51], v[40:43], v[24:31], v2
	ds_read_b128 v[24:27], v46 offset:7168
	ds_read_b128 v[28:31], v46 offset:39936
	s_waitcnt lgkmcnt(6)
	v_smfmac_f32_16x16x64_bf16 v[48:51], v[56:59], v[32:39], v2
	ds_read_b128 v[32:35], v47 offset:7168
	ds_read_b128 v[36:39], v47 offset:39936
	v_add_f32 v44, v52, v54
	v_add_f32 v45, v53, v55
	v_mov_b64 v[52:53], 0
	v_mov_b64 v[54:55], 0
	v_cvt_pk_bf16_f32 v60, v44, v45
	s_nop 0
	v_or_b32_sdwa v60, v44, 1 dst_sel:WORD_0 dst_unused:UNUSED_PRESERVE src0_sel:WORD_1 src1_sel:DWORD
	s_waitcnt lgkmcnt(6)
	v_smfmac_f32_16x16x64_bf16 v[52:55], v[40:43], v[8:15], v2
	s_waitcnt lgkmcnt(4)
	v_smfmac_f32_16x16x64_bf16 v[52:55], v[56:59], v[16:23], v2
	v_add_f32 v44, v48, v50
	v_add_f32 v45, v49, v51
	v_mov_b64 v[48:49], 0
	v_mov_b64 v[50:51], 0
	v_cvt_pk_bf16_f32 v61, v44, v45
	s_waitcnt lgkmcnt(2)
	v_smfmac_f32_16x16x64_bf16 v[48:51], v[40:43], v[24:31], v2
	s_waitcnt lgkmcnt(0)
	v_smfmac_f32_16x16x64_bf16 v[48:51], v[56:59], v[32:39], v2
	v_add_f32 v44, v52, v54
	v_add_f32 v45, v53, v55
	v_cvt_pk_bf16_f32 v62, v44, v45
	s_nop 4
	v_add_f32 v44, v48, v50
	v_add_f32 v45, v49, v51
	v_cvt_pk_bf16_f32 v63, v44, v45
	buffer_store_dwordx4 v[60:63], v0, s[4:7], s38 offen offset:1280 sc1
	s_waitcnt vmcnt(0)
	s_mov_b32 s20, 400000
	s_cmp_eq_u32 s61, 0
	s_cbranch_scc1 .h1none_68
	buffer_load_dwordx4 v[8:11], v3, s[4:7], s30 offen sc1
	buffer_load_dwordx4 v[12:15], v3, s[4:7], s31 offen sc1
	buffer_load_dwordx4 v[16:19], v3, s[4:7], s32 offen sc1
	buffer_load_dwordx4 v[20:23], v3, s[4:7], s33 offen sc1
	v_mov_b64 v[44:45], 0
	v_mov_b64 v[46:47], 0
	v_mov_b64 v[48:49], 0
	v_mov_b64 v[50:51], 0
	v_mov_b64 v[52:53], 0
	v_mov_b64 v[54:55], 0
	v_mov_b64 v[56:57], 0
	v_mov_b64 v[58:59], 0
	v_mov_b64 v[60:61], 0
	v_mov_b64 v[62:63], 0
	v_lshrrev_b32 v35, 2, v0
	v_and_b32 v35, 16, v35
	v_lshlrev_b32 v35, v35, s78
	s_mov_b64 vcc, s[76:77]
	v_cndmask_b32 v24, 0, v35, vcc
	s_lshl_b64 vcc, vcc, 1
	v_cndmask_b32 v25, 0, v35, vcc
	s_lshl_b64 vcc, vcc, 1
	v_cndmask_b32 v26, 0, v35, vcc
	s_lshl_b64 vcc, vcc, 1
	v_cndmask_b32 v27, 0, v35, vcc
	v_bfe_i32 v34, v0, 9, 1
	s_branch .h1w_71
.hop1_70:
	s_mov_b64 exec, vcc
	s_sub_u32 s20, s20, 1
	s_cbranch_scc1 L_FAIL
	buffer_load_dwordx4 v[8:11], v3, s[4:7], s30 offen sc1
	buffer_load_dwordx4 v[12:15], v3, s[4:7], s31 offen sc1
	buffer_load_dwordx4 v[16:19], v3, s[4:7], s32 offen sc1
	buffer_load_dwordx4 v[20:23], v3, s[4:7], s33 offen sc1
.h1w_71:
	s_waitcnt vmcnt(0)
	v_mfma_f32_16x16x32_bf16 v[28:31], v[24:27], v[8:11], 0
	v_bitop3_b32 v35, v8, v12, v16 bitop3:0x80
	v_mfma_f32_16x16x32_bf16 v[28:31], v[24:27], v[12:15], v[28:31]
	v_bitop3_b32 v35, v35, v20, 1 bitop3:0x80
	v_mfma_f32_16x16x32_bf16 v[28:31], v[24:27], v[16:19], v[28:31]
	v_cmp_ne_u32 vcc, 1, v35
	v_mfma_f32_16x16x32_bf16 v[28:31], v[24:27], v[20:23], v[28:31]
	s_cbranch_vccnz .hop1_70
	s_mov_b64 exec, -1
	s_nop 5
	v_add_f32_dpp v32, v28, v28 row_ror:8 row_mask:0xf bank_mask:0x3
	v_add_f32_dpp v33, v29, v29 row_ror:8 row_mask:0xf bank_mask:0x3
	s_nop 0
	v_add_f32_dpp v32, v30, v30 row_ror:8 row_mask:0xf bank_mask:0xc
	v_add_f32_dpp v33, v31, v31 row_ror:8 row_mask:0xf bank_mask:0xc
	v_cvt_pk_bf16_f32 v32, v32, v33
	v_or_b32 v32, v32, v34
	buffer_store_dword v32, v4, s[4:7], s40 offen sc1
	v_xor_b32 v4, 0x4000, v4
	s_branch .h1join_69
.h1none_68:
	v_mov_b64 v[44:45], 0
	v_mov_b64 v[46:47], 0
	v_mov_b64 v[48:49], 0
	v_mov_b64 v[50:51], 0
	v_mov_b64 v[52:53], 0
	v_mov_b64 v[54:55], 0
	v_mov_b64 v[56:57], 0
	v_mov_b64 v[58:59], 0
	v_mov_b64 v[60:61], 0
	v_mov_b64 v[62:63], 0
.h1join_69:
	s_barrier
	s_waitcnt vmcnt(0)
	v_add_u32 v20, s64, v0
	v_add_u32 v21, s65, v0
	v_mov_b64 v[16:17], 0
	v_mov_b64 v[18:19], 0
	s_mov_b32 s20, 400000
	buffer_load_dwordx4 v[8:11], v0, s[4:7], s47 offen sc1
	buffer_load_dwordx4 v[12:15], v0, s[4:7], s48 offen sc1
	s_mov_b64 exec, 0xffff
	buffer_load_dwordx4 v[16:19], v0, s[4:7], s49 offen sc1
	s_mov_b64 exec, -1
	s_branch .h2w_73
.hop2_72:
	s_mov_b64 exec, vcc
	s_mov_b64 s[74:75], vcc
	s_sub_u32 s20, s20, 1
	s_cbranch_scc1 L_FAIL
	buffer_load_dwordx4 v[8:11], v0, s[4:7], s47 offen sc1
	buffer_load_dwordx4 v[12:15], v0, s[4:7], s48 offen sc1
	s_and_b64 exec, exec, 0xffff
	buffer_load_dwordx4 v[16:19], v0, s[4:7], s49 offen sc1
	s_mov_b64 exec, s[74:75]
.h2w_73:
	s_waitcnt vmcnt(0)
	v_max3_u32 v22, v8, v9, v10
	v_max3_u32 v23, v11, v12, v13
	v_max3_u32 v22, v22, v14, v15
	v_max3_u32 v23, v23, v16, v17
	v_max3_u32 v22, v22, v18, v19
	v_max_u32 v22, v22, v23
	v_cmp_eq_u32 vcc, -1, v22
	s_cbranch_vccnz .hop2_72
	s_mov_b64 exec, -1
	s_add_u32 s17, s28, 1
	v_mov_b32 v36, s17
	s_mov_b64 exec, 1
	buffer_store_dword v36, v0, s[4:7], s51 offen sc1
	s_mov_b64 exec, -1
	ds_write_b128 v20, v[8:11] offset:0
	ds_write_b128 v20, v[12:15] offset:4096
	s_mov_b64 exec, 0xffff
	ds_write_b128 v21, v[16:19] offset:8192
	s_mov_b64 exec, -1
	s_add_u32 s28, s28, 1
	s_waitcnt lgkmcnt(0)
	s_barrier
	ds_read_b128 v[8:11], v0 offset:0
	ds_read_b128 v[12:15], v0 offset:1024
	ds_read_b128 v[16:19], v0 offset:2048
	ds_read_b128 v[20:23], v0 offset:3072
	ds_read_b128 v[24:27], v0 offset:4096
	ds_read_b128 v[28:31], v0 offset:5120
	ds_read_b128 v[32:35], v0 offset:6144
	ds_read_b128 v[36:39], v0 offset:7168
	ds_read_b128 v[40:43], v0 offset:8192
	s_mov_b64 exec, 15
	v_lshrrev_b32 v7, 2, v0
	buffer_load_dword v7, v7, s[4:7], s50 offen sc1
	s_mov_b64 exec, -1
	s_waitcnt lgkmcnt(8)
	v_smfmac_f32_16x16x64_bf16 v[44:47], v[8:11], a[0:7], v2
	v_smfmac_f32_16x16x64_bf16 v[52:55], v[8:11], a[144:151], v2
	v_smfmac_f32_16x16x64_bf16 v[48:51], v[8:11], a[72:79], v2
	v_smfmac_f32_16x16x64_bf16 v[56:59], v[8:11], a[216:223], v2
	s_waitcnt lgkmcnt(7)
	v_smfmac_f32_16x16x64_bf16 v[44:47], v[12:15], a[8:15], v2
	v_smfmac_f32_16x16x64_bf16 v[52:55], v[12:15], a[152:159], v2
	v_smfmac_f32_16x16x64_bf16 v[48:51], v[12:15], a[80:87], v2
	v_smfmac_f32_16x16x64_bf16 v[56:59], v[12:15], a[224:231], v2
	s_waitcnt lgkmcnt(6)
	v_smfmac_f32_16x16x64_bf16 v[44:47], v[16:19], a[16:23], v2
	v_smfmac_f32_16x16x64_bf16 v[52:55], v[16:19], a[160:167], v2
	v_smfmac_f32_16x16x64_bf16 v[48:51], v[16:19], a[88:95], v2
	v_smfmac_f32_16x16x64_bf16 v[56:59], v[16:19], a[232:239], v2
	s_waitcnt lgkmcnt(5)
	v_smfmac_f32_16x16x64_bf16 v[44:47], v[20:23], a[24:31], v2
	v_smfmac_f32_16x16x64_bf16 v[52:55], v[20:23], a[168:175], v2
	v_smfmac_f32_16x16x64_bf16 v[48:51], v[20:23], a[96:103], v2
	v_smfmac_f32_16x16x64_bf16 v[56:59], v[20:23], a[240:247], v2
	s_waitcnt lgkmcnt(4)
	v_smfmac_f32_16x16x64_bf16 v[44:47], v[24:27], a[32:39], v2
	v_smfmac_f32_16x16x64_bf16 v[52:55], v[24:27], a[176:183], v2
	v_smfmac_f32_16x16x64_bf16 v[48:51], v[24:27], a[104:111], v2
	v_smfmac_f32_16x16x64_bf16 v[56:59], v[24:27], a[248:255], v2
	s_waitcnt lgkmcnt(3)
	v_smfmac_f32_16x16x64_bf16 v[44:47], v[28:31], a[40:47], v2
	v_smfmac_f32_16x16x64_bf16 v[52:55], v[28:31], a[184:191], v2
	v_smfmac_f32_16x16x64_bf16 v[48:51], v[28:31], a[112:119], v2
	v_smfmac_f32_16x16x64_bf16 v[56:59], v[28:31], v[64:71], v2
	s_waitcnt lgkmcnt(2)
	v_smfmac_f32_16x16x64_bf16 v[44:47], v[32:35], a[48:55], v2
	v_smfmac_f32_16x16x64_bf16 v[52:55], v[32:35], a[192:199], v2
	v_smfmac_f32_16x16x64_bf16 v[48:51], v[32:35], a[120:127], v2
	v_smfmac_f32_16x16x64_bf16 v[56:59], v[32:35], v[72:79], v2
	s_waitcnt lgkmcnt(0)
	v_smfmac_f32_16x16x64_bf16 v[44:47], v[36:39], a[56:63], v2
	v_smfmac_f32_16x16x64_bf16 v[52:55], v[36:39], a[200:207], v2
	v_smfmac_f32_16x16x64_bf16 v[44:47], v[40:43], a[64:71], v2
	v_smfmac_f32_16x16x64_bf16 v[52:55], v[40:43], a[208:215], v2
	v_smfmac_f32_16x16x64_bf16 v[48:51], v[36:39], a[128:135], v2
	v_smfmac_f32_16x16x64_bf16 v[56:59], v[36:39], v[80:87], v2
	v_smfmac_f32_16x16x64_bf16 v[48:51], v[40:43], a[136:143], v2
	v_add_f32 v52, v52, v54
	v_add_f32 v53, v53, v55
	v_add_f32 v44, v44, v46
	v_add_f32 v45, v45, v47
	v_cvt_pk_bf16_f32 v54, v52, v53
	v_cvt_pk_bf16_f32 v55, v44, v45
	ds_write_b64 v5, v[54:55] offset:0
	v_smfmac_f32_16x16x64_bf16 v[56:59], v[40:43], v[88:95], v2
	v_mov_b64 v[44:45], 0
	v_mov_b64 v[46:47], 0
	v_smfmac_f32_16x16x64_bf16 v[60:63], v[8:11], v[96:103], v2
	v_smfmac_f32_16x16x64_bf16 v[60:63], v[12:15], v[104:111], v2
	v_add_f32 v56, v56, v58
	v_add_f32 v57, v57, v59
	v_add_f32 v48, v48, v50
	v_add_f32 v49, v49, v51
	v_cvt_pk_bf16_f32 v58, v56, v57
	v_cvt_pk_bf16_f32 v59, v48, v49
	ds_write_b64 v5, v[58:59] offset:512
	v_smfmac_f32_16x16x64_bf16 v[44:47], v[8:11], v[168:175], v2
	v_smfmac_f32_16x16x64_bf16 v[44:47], v[12:15], v[176:183], v2
	v_smfmac_f32_16x16x64_bf16 v[60:63], v[16:19], v[112:119], v2
	v_smfmac_f32_16x16x64_bf16 v[44:47], v[16:19], v[184:191], v2
	s_waitcnt lgkmcnt(0)
	s_barrier
	ds_read_b64_tr_b16 v[48:49], v1 offset:9216
	ds_read_b64_tr_b16 v[50:51], v1 offset:9728
	ds_read_b128 v[12:15], v0 offset:15360
	ds_read_b128 v[16:19], v0 offset:19456
	v_smfmac_f32_16x16x64_bf16 v[60:63], v[20:23], v[120:127], v2
	ds_read_b64_tr_b16 v[52:53], v1 offset:10240
	ds_read_b64_tr_b16 v[54:55], v1 offset:10752
	v_smfmac_f32_16x16x64_bf16 v[44:47], v[20:23], v[192:199], v2
	ds_read_b128 v[20:23], v0 offset:16384
	v_smfmac_f32_16x16x64_bf16 v[60:63], v[24:27], v[128:135], v2
	ds_read_b64_tr_b16 v[56:57], v1 offset:11264
	ds_read_b64_tr_b16 v[58:59], v1 offset:11776
	v_smfmac_f32_16x16x64_bf16 v[44:47], v[24:27], v[200:207], v2
	ds_read_b128 v[24:27], v0 offset:20480
	v_smfmac_f32_16x16x64_bf16 v[60:63], v[28:31], v[136:143], v2
	ds_read_b64_tr_b16 v[8:9], v1 offset:12288
	ds_read_b64_tr_b16 v[10:11], v1 offset:12800
	v_smfmac_f32_16x16x64_bf16 v[44:47], v[28:31], v[208:215], v2
	ds_read_b128 v[28:31], v0 offset:17408
	v_smfmac_f32_16x16x64_bf16 v[60:63], v[32:35], v[144:151], v2
	v_smfmac_f32_16x16x64_bf16 v[44:47], v[32:35], v[216:223], v2
	v_smfmac_f32_16x16x64_bf16 v[60:63], v[36:39], v[152:159], v2
	v_smfmac_f32_16x16x64_bf16 v[44:47], v[36:39], v[224:231], v2
	v_smfmac_f32_16x16x64_bf16 v[60:63], v[40:43], v[160:167], v2
	v_smfmac_f32_16x16x64_bf16 v[44:47], v[40:43], v[232:239], v2
	s_waitcnt lgkmcnt(10)
	v_mfma_f32_16x16x32_bf16 v[32:35], v[12:15], v[48:51], 0
	s_waitcnt lgkmcnt(9)
	v_mfma_f32_16x16x32_bf16 v[36:39], v[16:19], v[48:51], 0
	ds_read_b128 v[12:15], v0 offset:21504
	v_mfma_f32_16x16x32_bf16 v[40:43], v[48:51], v[48:51], 0
	ds_read_b128 v[16:19], v0 offset:18432
	ds_read_b128 v[48:51], v0 offset:22528
	s_waitcnt lgkmcnt(9)
	v_mfma_f32_16x16x32_bf16 v[32:35], v[20:23], v[52:55], v[32:35]
	s_waitcnt lgkmcnt(6)
	v_mfma_f32_16x16x32_bf16 v[36:39], v[24:27], v[52:55], v[36:39]
	v_mfma_f32_16x16x32_bf16 v[40:43], v[52:55], v[52:55], v[40:43]
	v_add_f32 v60, v60, v62
	v_add_f32 v61, v61, v63
	v_add_f32 v44, v44, v46
	v_add_f32 v45, v45, v47
	s_waitcnt lgkmcnt(3)
	v_mfma_f32_16x16x32_bf16 v[32:35], v[28:31], v[56:59], v[32:35]
	v_cvt_pk_bf16_f32 v62, v60, v61
	v_cvt_pk_bf16_f32 v63, v44, v45
	v_mfma_f32_16x16x32_bf16 v[40:43], v[56:59], v[56:59], v[40:43]
	buffer_store_dwordx2 v[62:63], v1, s[4:7], s69 offen sc1
	s_waitcnt lgkmcnt(2)
	v_mfma_f32_16x16x32_bf16 v[36:39], v[12:15], v[56:59], v[36:39]
	v_add_u32 v44, s66, v0
	v_add_u32 v45, s64, v1
	v_mfma_f32_16x16x32_bf16 v[40:43], v[8:11], v[8:11], v[40:43]
	s_waitcnt lgkmcnt(1)
	v_mfma_f32_16x16x32_bf16 v[32:35], v[16:19], v[8:11], v[32:35]
	s_waitcnt lgkmcnt(0)
	v_mfma_f32_16x16x32_bf16 v[36:39], v[48:51], v[8:11], v[36:39]
	ds_read_b128 v[8:11], v44 offset:23552
	ds_read_b128 v[12:15], v44 offset:24576
	ds_read_b64_tr_b16 v[52:53], v45 offset:9216
	ds_read_b64_tr_b16 v[54:55], v45 offset:9728
	v_mov_b32 v16, 0x3f803f80
	v_mov_b32 v17, 0x3f803f80
	v_mov_b32 v18, 0x3f803f80
	v_mov_b32 v19, 0x3f803f80
	v_mov_b32 v25, 0
	v_mov_b32 v26, 0
	v_max3_f32 v28, v40, v41, v32
	v_max3_f32 v29, v33, v34, v35
	v_max3_f32 v28, v28, v36, v37
	v_max3_f32 v29, v29, v38, v39
	v_max_f32 v28, v28, v29
	v_mov_b32 v29, v28
	s_waitcnt lgkmcnt(0)
	buffer_store_dwordx4 v[52:55], v0, s[4:7], s53 offen sc1
	s_cmp_eq_u32 s28, 63
	s_cbranch_scc1 .chainlast_64
	v_permlane16_swap_b32 v28, v29
	v_max_f32 v28, v28, v29
	v_mov_b32 v29, v28
	s_add_u32 s53, s53, 262144
	s_add_u32 s69, s69, 262144
	v_permlane32_swap_b32 v28, v29
	v_max_f32 v28, v28, v29
	v_mul_f32 v28, s60, v28
	v_pk_fma_f32 v[40:41], v[40:41], s[58:59], v[28:29] op_sel_hi:[1,1,0]
	v_pk_fma_f32 v[32:33], v[32:33], s[58:59], v[28:29] op_sel_hi:[1,1,0]
	v_pk_fma_f32 v[34:35], v[34:35], s[58:59], v[28:29] op_sel_hi:[1,1,0]
	v_pk_fma_f32 v[36:37], v[36:37], s[58:59], v[28:29] op_sel_hi:[1,1,0]
	v_pk_fma_f32 v[38:39], v[38:39], s[58:59], v[28:29] op_sel_hi:[1,1,0]
	v_exp_f32 v40, v40
	v_exp_f32 v41, v41
	v_exp_f32 v32, v32
	v_cvt_pk_bf16_f32 v24, v40, v41
	v_exp_f32 v33, v33
	v_mov_b32 v27, v24
	v_exp_f32 v34, v34
	v_mfma_f32_16x16x16_bf16 v[56:59], v[16:17], v[24:25], 0
	v_exp_f32 v35, v35
	v_mfma_f32_16x16x16_bf16 v[48:51], v[62:63], v[24:25], 0
	v_exp_f32 v36, v36
	v_cvt_pk_bf16_f32 v20, v32, v33
	v_mfma_f32_16x16x16_bf16 v[52:55], v[62:63], v[26:27], 0
	v_exp_f32 v37, v37
	v_cvt_pk_bf16_f32 v21, v34, v35
	v_exp_f32 v38, v38
	v_exp_f32 v39, v39
	v_cvt_pk_bf16_f32 v22, v36, v37
	v_cvt_pk_bf16_f32 v23, v38, v39
	s_nop 1
	v_mfma_f32_16x16x32_bf16 v[56:59], v[16:19], v[20:23], v[56:59]
	v_mfma_f32_16x16x32_bf16 v[48:51], v[8:11], v[20:23], v[48:51]
	v_mfma_f32_16x16x32_bf16 v[52:55], v[12:15], v[20:23], v[52:55]
	v_add_u32 v46, s67, v0
	v_add_u32 v47, 0x10000, v46
	v_rcp_f32 v56, v56
	s_nop 0
	v_pk_mul_f32 v[48:49], v[48:49], v[56:57] op_sel_hi:[1,0]
	v_pk_mul_f32 v[50:51], v[50:51], v[56:57] op_sel_hi:[1,0]
	s_nop 1
	v_pk_mul_f32 v[52:53], v[52:53], v[56:57] op_sel_hi:[1,0]
	v_pk_mul_f32 v[54:55], v[54:55], v[56:57] op_sel_hi:[1,0]
	v_cvt_pk_bf16_f32 v60, v48, v49
	v_cvt_pk_bf16_f32 v61, v52, v53
	v_cvt_pk_bf16_f32 v62, v50, v51
	v_cvt_pk_bf16_f32 v63, v54, v55
	s_mov_b64 exec, s[54:55]
	ds_write_b64 v6, v[60:61]
	ds_write_b64 v6, v[62:63] offset:32
	s_mov_b64 exec, -1
	ds_read_b128 v[8:11], v46 offset:0
	ds_read_b128 v[12:15], v46 offset:32768
	ds_read_b128 v[16:19], v47 offset:0
	ds_read_b128 v[20:23], v47 offset:32768
	ds_read_b128 v[24:27], v46 offset:1024
	ds_read_b128 v[28:31], v46 offset:33792
	ds_read_b128 v[32:35], v47 offset:1024
	ds_read_b128 v[36:39], v47 offset:33792
	v_mov_b64 v[48:49], 0
	v_mov_b64 v[50:51], 0
	v_mov_b64 v[52:53], 0
	v_mov_b64 v[54:55], 0
	s_waitcnt lgkmcnt(8)
	s_barrier
	ds_read_b128 v[40:43], v0 offset:13312
	ds_read_b128 v[56:59], v0 offset:14336
	s_cmp_eq_u32 s28, 63
	s_cbranch_scc1 .skipk_74
	s_add_u32 s17, s28, 2
	s_mov_b64 exec, 15
	s_waitcnt vmcnt(2)
	v_cmp_gt_u32 vcc, s17, v7
	s_cbranch_vccz .b1ok_75
	s_mov_b32 s20, 400000
.b1re_76:
	v_lshrrev_b32 v7, 2, v0
	buffer_load_dword v7, v7, s[4:7], s50 offen sc1
	s_waitcnt vmcnt(0)
	v_cmp_gt_u32 vcc, s17, v7
	s_cbranch_vccz .b1ok_75
	s_sub_u32 s20, s20, 1
	s_cmp_lg_u32 s20, 0
	s_cbranch_scc1 .b1re_76
	s_branch L_FAIL
.b1ok_75:
	s_mov_b64 exec, -1
	s_mov_b32 m0, s68
	s_nop 0
	buffer_load_dwordx4 v0, s[4:7], s52 offen offset:0 lds
	buffer_load_dwordx4 v0, s[4:7], s52 offen offset:1024 lds
	buffer_load_dwordx4 v0, s[4:7], s52 offen offset:2048 lds
	buffer_load_dwordx4 v0, s[4:7], s52 offen offset:3072 lds
	s_add_u32 s52, s52, 786432
.skipk_74:
	s_waitcnt lgkmcnt(1)
	v_smfmac_f32_16x16x64_bf16 v[48:51], v[40:43], v[240:247], v2
	s_waitcnt lgkmcnt(0)
	v_smfmac_f32_16x16x64_bf16 v[48:51], v[56:59], v[248:255], v2
	v_smfmac_f32_16x16x64_bf16 v[52:55], v[40:43], v[8:15], v2
	ds_read_b128 v[8:11], v46 offset:2048
	ds_read_b128 v[12:15], v46 offset:34816
	v_smfmac_f32_16x16x64_bf16 v[52:55], v[56:59], v[16:23], v2
	ds_read_b128 v[16:19], v47 offset:2048
	ds_read_b128 v[20:23], v47 offset:34816
	v_add_f32 v44, v48, v50
	v_add_f32 v45, v49, v51
	v_mov_b64 v[48:49], 0
	v_mov_b64 v[50:51], 0
	v_lshrrev_b32 v61, 2, v0
	v_cvt_pk_bf16_f32 v60, v44, v45
	v_add_u32 v44, 0x10000, v44
	s_mov_b64 exec, s[76:77]
	v_and_b32_sdwa v60, v44, -2 dst_sel:WORD_0 dst_unused:UNUSED_PRESERVE src0_sel:WORD_1 src1_sel:DWORD
	s_mov_b64 exec, -1
	buffer_store_dword v60, v61, s[4:7], s38 offen sc1
	v_smfmac_f32_16x16x64_bf16 v[48:51], v[40:43], v[24:31], v2
	ds_read_b128 v[24:27], v46 offset:3072
	ds_read_b128 v[28:31], v46 offset:35840
	v_smfmac_f32_16x16x64_bf16 v[48:51], v[56:59], v[32:39], v2
	ds_read_b128 v[32:35], v47 offset:3072
	ds_read_b128 v[36:39], v47 offset:35840
	v_add_f32 v44, v52, v54
	v_add_f32 v45, v53, v55
	v_mov_b64 v[52:53], 0
	v_mov_b64 v[54:55], 0
	v_cvt_pk_bf16_f32 v60, v44, v45
	v_add_u32 v44, 0x10000, v44
	s_nop 0
	v_and_b32_sdwa v60, v44, -2 dst_sel:WORD_0 dst_unused:UNUSED_PRESERVE src0_sel:WORD_1 src1_sel:DWORD
	s_waitcnt lgkmcnt(6)
	v_smfmac_f32_16x16x64_bf16 v[52:55], v[40:43], v[8:15], v2
	ds_read_b128 v[8:11], v46 offset:4096
	ds_read_b128 v[12:15], v46 offset:36864
	s_waitcnt lgkmcnt(6)
	v_smfmac_f32_16x16x64_bf16 v[52:55], v[56:59], v[16:23], v2
	ds_read_b128 v[16:19], v47 offset:4096
	ds_read_b128 v[20:23], v47 offset:36864
	v_add_f32 v44, v48, v50
	v_add_f32 v45, v49, v51
	v_mov_b64 v[48:49], 0
	v_mov_b64 v[50:51], 0
	v_cvt_pk_bf16_f32 v61, v44, v45
	s_waitcnt lgkmcnt(6)
	v_smfmac_f32_16x16x64_bf16 v[48:51], v[40:43], v[24:31], v2
	ds_read_b128 v[24:27], v46 offset:5120
	ds_read_b128 v[28:31], v46 offset:37888
	s_waitcnt lgkmcnt(6)
	v_smfmac_f32_16x16x64_bf16 v[48:51], v[56:59], v[32:39], v2
	ds_read_b128 v[32:35], v47 offset:5120
	ds_read_b128 v[36:39], v47 offset:37888
	v_add_f32 v44, v52, v54
	v_add_f32 v45, v53, v55
	v_mov_b64 v[52:53], 0
	v_mov_b64 v[54:55], 0
	v_cvt_pk_bf16_f32 v62, v44, v45
	s_waitcnt lgkmcnt(6)
	v_smfmac_f32_16x16x64_bf16 v[52:55], v[40:43], v[8:15], v2
	ds_read_b128 v[8:11], v46 offset:6144
	ds_read_b128 v[12:15], v46 offset:38912
	s_waitcnt lgkmcnt(6)
	v_smfmac_f32_16x16x64_bf16 v[52:55], v[56:59], v[16:23], v2
	ds_read_b128 v[16:19], v47 offset:6144
	ds_read_b128 v[20:23], v47 offset:38912
	v_add_f32 v44, v48, v50
	v_add_f32 v45, v49, v51
	v_mov_b64 v[48:49], 0
	v_mov_b64 v[50:51], 0
	v_cvt_pk_bf16_f32 v63, v44, v45
	buffer_store_dwordx4 v[60:63], v0, s[4:7], s38 offen offset:256 sc1
	s_waitcnt lgkmcnt(6)
	v_smfmac_f32_16x16x64_bf16 v[48:51], v[40:43], v[24:31], v2
	ds_read_b128 v[24:27], v46 offset:7168
	ds_read_b128 v[28:31], v46 offset:39936
	s_waitcnt lgkmcnt(6)
	v_smfmac_f32_16x16x64_bf16 v[48:51], v[56:59], v[32:39], v2
	ds_read_b128 v[32:35], v47 offset:7168
	ds_read_b128 v[36:39], v47 offset:39936
	v_add_f32 v44, v52, v54
	v_add_f32 v45, v53, v55
	v_mov_b64 v[52:53], 0
	v_mov_b64 v[54:55], 0
	v_cvt_pk_bf16_f32 v60, v44, v45
	v_add_u32 v44, 0x10000, v44
	s_nop 0
	v_and_b32_sdwa v60, v44, -2 dst_sel:WORD_0 dst_unused:UNUSED_PRESERVE src0_sel:WORD_1 src1_sel:DWORD
	s_waitcnt lgkmcnt(6)
	v_smfmac_f32_16x16x64_bf16 v[52:55], v[40:43], v[8:15], v2
	s_waitcnt lgkmcnt(4)
	v_smfmac_f32_16x16x64_bf16 v[52:55], v[56:59], v[16:23], v2
	v_add_f32 v44, v48, v50
	v_add_f32 v45, v49, v51
	v_mov_b64 v[48:49], 0
	v_mov_b64 v[50:51], 0
	v_cvt_pk_bf16_f32 v61, v44, v45
	s_waitcnt lgkmcnt(2)
	v_smfmac_f32_16x16x64_bf16 v[48:51], v[40:43], v[24:31], v2
	s_waitcnt lgkmcnt(0)
	v_smfmac_f32_16x16x64_bf16 v[48:51], v[56:59], v[32:39], v2
	v_add_f32 v44, v52, v54
	v_add_f32 v45, v53, v55
	v_cvt_pk_bf16_f32 v62, v44, v45
	s_nop 4
	v_add_f32 v44, v48, v50
	v_add_f32 v45, v49, v51
	v_cvt_pk_bf16_f32 v63, v44, v45
	buffer_store_dwordx4 v[60:63], v0, s[4:7], s38 offen offset:1280 sc1
	s_waitcnt vmcnt(0)
	s_mov_b32 s20, 400000
	s_cmp_eq_u32 s61, 0
	s_cbranch_scc1 .h1none_77
	buffer_load_dwordx4 v[8:11], v3, s[4:7], s30 offen sc1
	buffer_load_dwordx4 v[12:15], v3, s[4:7], s31 offen sc1
	buffer_load_dwordx4 v[16:19], v3, s[4:7], s32 offen sc1
	buffer_load_dwordx4 v[20:23], v3, s[4:7], s33 offen sc1
	v_mov_b64 v[44:45], 0
	v_mov_b64 v[46:47], 0
	v_mov_b64 v[48:49], 0
	v_mov_b64 v[50:51], 0
	v_mov_b64 v[52:53], 0
	v_mov_b64 v[54:55], 0
	v_mov_b64 v[56:57], 0
	v_mov_b64 v[58:59], 0
	v_mov_b64 v[60:61], 0
	v_mov_b64 v[62:63], 0
	v_lshrrev_b32 v35, 2, v0
	v_and_b32 v35, 16, v35
	v_lshlrev_b32 v35, v35, s78
	s_mov_b64 vcc, s[76:77]
	v_cndmask_b32 v24, 0, v35, vcc
	s_lshl_b64 vcc, vcc, 1
	v_cndmask_b32 v25, 0, v35, vcc
	s_lshl_b64 vcc, vcc, 1
	v_cndmask_b32 v26, 0, v35, vcc
	s_lshl_b64 vcc, vcc, 1
	v_cndmask_b32 v27, 0, v35, vcc
	v_bfe_i32 v34, v0, 9, 1
	s_branch .h1w_80
.hop1_79:
	s_mov_b64 exec, vcc
	s_sub_u32 s20, s20, 1
	s_cbranch_scc1 L_FAIL
	buffer_load_dwordx4 v[8:11], v3, s[4:7], s30 offen sc1
	buffer_load_dwordx4 v[12:15], v3, s[4:7], s31 offen sc1
	buffer_load_dwordx4 v[16:19], v3, s[4:7], s32 offen sc1
	buffer_load_dwordx4 v[20:23], v3, s[4:7], s33 offen sc1
.h1w_80:
	s_waitcnt vmcnt(0)
	v_mfma_f32_16x16x32_bf16 v[28:31], v[24:27], v[8:11], 0
	v_or3_b32 v35, v8, v12, v16
	v_mfma_f32_16x16x32_bf16 v[28:31], v[24:27], v[12:15], v[28:31]
	v_bitop3_b32 v35, v35, v20, 1 bitop3:0xa8
	v_mfma_f32_16x16x32_bf16 v[28:31], v[24:27], v[16:19], v[28:31]
	v_cmp_ne_u32 vcc, 0, v35
	v_mfma_f32_16x16x32_bf16 v[28:31], v[24:27], v[20:23], v[28:31]
	s_cbranch_vccnz .hop1_79
	s_mov_b64 exec, -1
	s_nop 5
	v_add_f32_dpp v32, v28, v28 row_ror:8 row_mask:0xf bank_mask:0x3
	v_add_f32_dpp v33, v29, v29 row_ror:8 row_mask:0xf bank_mask:0x3
	s_nop 0
	v_add_f32_dpp v32, v30, v30 row_ror:8 row_mask:0xf bank_mask:0xc
	v_add_f32_dpp v33, v31, v31 row_ror:8 row_mask:0xf bank_mask:0xc
	v_cvt_pk_bf16_f32 v32, v32, v33
	v_or_b32 v32, v32, v34
	buffer_store_dword v32, v4, s[4:7], s40 offen sc1
	v_xor_b32 v4, 0x4000, v4
	s_branch .h1join_78
.h1none_77:
	v_mov_b64 v[44:45], 0
	v_mov_b64 v[46:47], 0
	v_mov_b64 v[48:49], 0
	v_mov_b64 v[50:51], 0
	v_mov_b64 v[52:53], 0
	v_mov_b64 v[54:55], 0
	v_mov_b64 v[56:57], 0
	v_mov_b64 v[58:59], 0
	v_mov_b64 v[60:61], 0
	v_mov_b64 v[62:63], 0
.h1join_78:
	s_barrier
	s_waitcnt vmcnt(0)
	v_add_u32 v20, s64, v0
	v_add_u32 v21, s65, v0
	v_mov_b64 v[16:17], 0
	v_mov_b64 v[18:19], 0
	s_mov_b32 s20, 400000
	buffer_load_dwordx4 v[8:11], v0, s[4:7], s44 offen sc1
	buffer_load_dwordx4 v[12:15], v0, s[4:7], s45 offen sc1
	s_mov_b64 exec, 0xffff
	buffer_load_dwordx4 v[16:19], v0, s[4:7], s46 offen sc1
	s_mov_b64 exec, -1
	s_branch .h2w_82
.hop2_81:
	s_mov_b64 exec, vcc
	s_mov_b64 s[74:75], vcc
	s_sub_u32 s20, s20, 1
	s_cbranch_scc1 L_FAIL
	buffer_load_dwordx4 v[8:11], v0, s[4:7], s44 offen sc1
	buffer_load_dwordx4 v[12:15], v0, s[4:7], s45 offen sc1
	s_and_b64 exec, exec, 0xffff
	buffer_load_dwordx4 v[16:19], v0, s[4:7], s46 offen sc1
	s_mov_b64 exec, s[74:75]
.h2w_82:
	s_waitcnt vmcnt(0)
	v_max3_u32 v22, v8, v9, v10
	v_max3_u32 v23, v11, v12, v13
	v_max3_u32 v22, v22, v14, v15
	v_max3_u32 v23, v23, v16, v17
	v_max3_u32 v22, v22, v18, v19
	v_max_u32 v22, v22, v23
	v_cmp_eq_u32 vcc, -1, v22
	s_cbranch_vccnz .hop2_81
	s_mov_b64 exec, -1
	s_add_u32 s17, s28, 1
	v_mov_b32 v36, s17
	s_mov_b64 exec, 1
	buffer_store_dword v36, v0, s[4:7], s51 offen sc1
	s_mov_b64 exec, -1
	ds_write_b128 v20, v[8:11] offset:0
	ds_write_b128 v20, v[12:15] offset:4096
	s_mov_b64 exec, 0xffff
	ds_write_b128 v21, v[16:19] offset:8192
	s_mov_b64 exec, -1
	s_add_u32 s28, s28, 1
	s_waitcnt lgkmcnt(0)
	s_barrier
	s_cmp_lt_u32 s28, 64
	s_cbranch_scc1 .chainloop_63
.chainlast_64:
	s_waitcnt vmcnt(0)
	v_mov_b32 v14, 64
	s_mov_b64 exec, 1
	buffer_store_dword v14, v0, s[4:7], s51 offen sc1
	s_mov_b64 exec, -1
	s_branch L_END
.p2align 6
L_B1:
	v_and_b32 v79, 63, v0
	v_mov_b32 v75, v0
	v_and_b32 v78, 15, v79
	v_lshrrev_b32 v77, 4, v79
	v_and_b32 v76, 7, v79
	s_cmp_eq_u32 s27, 0
	s_cbranch_scc1 .idef_83
	s_cmp_lg_u32 s15, 0
	s_cbranch_scc1 .idok_85
	s_mov_b32 s20, 400000
	v_mov_b32 v10, 0
.idre_84:
	global_load_dword v11, v10, s[12:13] offset:176 sc1
	s_waitcnt vmcnt(0)
	v_readfirstlane_b32 s17, v11
	s_nop 0
	s_cmp_ge_u32 s17, 64
	s_cbranch_scc1 .idok_85
	s_sleep 8
	s_sub_u32 s20, s20, 1
	s_cmp_lg_u32 s20, 0
	s_cbranch_scc1 .idre_84
	s_branch L_FAIL
.idok_85:
	s_barrier
.idef_83:
	v_lshlrev_b32 v16, 1, v77
	v_xor_b32 v16, v16, v78
	v_xor_b32 v17, 8, v16
	v_lshlrev_b32 v16, 4, v16
	v_lshlrev_b32 v17, 4, v17
	v_lshlrev_b32 v18, 13, v77
	v_add_u32 v14, v16, v18
	v_add_u32 v15, v17, v18
	v_lshrrev_b32 v16, 2, v78
	v_and_b32 v17, 3, v78
	v_lshrrev_b32 v18, 1, v77
	v_lshlrev_b32 v18, 2, v18
	v_or_b32 v18, v18, v16
	v_lshlrev_b32 v18, 1, v18
	v_lshrrev_b32 v19, 1, v17
	s_lshl_b32 s17, s15, 2
	v_add_u32 v19, s17, v19
	v_and_b32 v17, 1, v17
	v_lshlrev_b32 v17, 3, v17
	v_lshlrev_b32 v20, 2, v77
	v_add_u32 v20, v20, v16
	v_lshlrev_b32 v20, 8, v20
	v_add_u32 v20, v20, v17
	v_xor_b32 v21, v19, v18
	v_add_u32 v19, 2, v19
	v_xor_b32 v22, v19, v18
	v_lshlrev_b32 v21, 4, v21
	v_lshlrev_b32 v22, 4, v22
	v_add_u32 v21, v21, v20
	v_add_u32 v22, v22, v20
	v_add_u32 v23, 0x10000, v21
	v_add_u32 v24, 0x10000, v22
	v_add_u32 v25, 73728, v21
	v_add_u32 v26, 73728, v22
	v_add_u32 v27, 73728, v23
	v_add_u32 v28, 73728, v24
	s_and_b32 s17, s15, 2
	s_cmp_eq_u32 s17, 0
	s_cselect_b64 vcc, -1, 0
	v_cndmask_b32 v29, v15, v14, vcc
	s_load_dwordx2 s[22:23], s[0:1], 40
	s_waitcnt lgkmcnt(0)
	s_mov_b32 s8, s22
	s_and_b32 s9, s23, 0xffff
	s_mov_b32 s10, 0x480000
	s_mov_b32 s11, 0x00020000
	s_lshl_b32 s62, s26, 8
	s_lshl_b32 s17, s15, 15
	s_add_u32 s62, s62, s17
	s_lshl_b32 s63, s15, 10
	s_mov_b32 m0, s63
	s_nop 0
	buffer_load_dwordx4 v29, s[8:11], s62 offen lds
	s_add_u32 s62, s62, 131072
	s_add_u32 s63, s63, 4096
	s_mov_b32 m0, s63
	s_nop 0
	buffer_load_dwordx4 v29, s[8:11], s62 offen lds
	s_add_u32 s62, s62, 131072
	s_add_u32 s63, s63, 4096
	s_mov_b32 m0, s63
	s_nop 0
	buffer_load_dwordx4 v29, s[8:11], s62 offen lds
	s_add_u32 s62, s62, 131072
	s_add_u32 s63, s63, 4096
	s_mov_b32 m0, s63
	s_nop 0
	buffer_load_dwordx4 v29, s[8:11], s62 offen lds
	s_add_u32 s62, s62, 131072
	s_add_u32 s63, s63, 4096
	s_mov_b32 m0, s63
	s_nop 0
	buffer_load_dwordx4 v29, s[8:11], s62 offen lds
	s_add_u32 s62, s62, 131072
	s_add_u32 s63, s63, 4096
	s_mov_b32 m0, s63
	s_nop 0
	buffer_load_dwordx4 v29, s[8:11], s62 offen lds
	s_add_u32 s62, s62, 131072
	s_add_u32 s63, s63, 4096
	s_mov_b32 m0, s63
	s_nop 0
	buffer_load_dwordx4 v29, s[8:11], s62 offen lds
	s_add_u32 s62, s62, 131072
	s_add_u32 s63, s63, 4096
	s_mov_b32 m0, s63
	s_nop 0
	buffer_load_dwordx4 v29, s[8:11], s62 offen lds
	s_add_u32 s62, s62, 131072
	s_add_u32 s63, s63, 4096
	s_mov_b32 m0, s63
	s_nop 0
	buffer_load_dwordx4 v29, s[8:11], s62 offen lds
	s_add_u32 s62, s62, 131072
	s_add_u32 s63, s63, 4096
	s_mov_b32 m0, s63
	s_nop 0
	buffer_load_dwordx4 v29, s[8:11], s62 offen lds
	s_add_u32 s62, s62, 131072
	s_add_u32 s63, s63, 4096
	s_mov_b32 m0, s63
	s_nop 0
	buffer_load_dwordx4 v29, s[8:11], s62 offen lds
	s_add_u32 s62, s62, 131072
	s_add_u32 s63, s63, 4096
	s_mov_b32 m0, s63
	s_nop 0
	buffer_load_dwordx4 v29, s[8:11], s62 offen lds
	s_add_u32 s62, s62, 131072
	s_add_u32 s63, s63, 4096
	s_mov_b32 m0, s63
	s_nop 0
	buffer_load_dwordx4 v29, s[8:11], s62 offen lds
	s_add_u32 s62, s62, 131072
	s_add_u32 s63, s63, 4096
	s_mov_b32 m0, s63
	s_nop 0
	buffer_load_dwordx4 v29, s[8:11], s62 offen lds
	s_add_u32 s62, s62, 131072
	s_add_u32 s63, s63, 4096
	s_mov_b32 m0, s63
	s_nop 0
	buffer_load_dwordx4 v29, s[8:11], s62 offen lds
	s_add_u32 s62, s62, 131072
	s_add_u32 s63, s63, 4096
	s_mov_b32 m0, s63
	s_nop 0
	buffer_load_dwordx4 v29, s[8:11], s62 offen lds
	s_add_u32 s62, s62, 131072
	s_add_u32 s63, s63, 4096
	s_mov_b32 m0, s63
	s_nop 0
	buffer_load_dwordx4 v29, s[8:11], s62 offen lds
	s_add_u32 s62, s62, 131072
	s_add_u32 s63, s63, 4096
	s_mov_b32 m0, s63
	s_nop 0
	buffer_load_dwordx4 v29, s[8:11], s62 offen lds
	s_load_dwordx2 s[22:23], s[0:1], 40
	s_waitcnt lgkmcnt(0)
	s_mov_b32 s8, s22
	s_and_b32 s9, s23, 0xffff
	s_mov_b32 s10, 0x480000
	s_mov_b32 s11, 0x00020000
	s_lshl_b32 s62, s26, 8
	s_lshl_b32 s17, s15, 15
	s_add_u32 s62, s62, s17
	s_add_u32 s62, s62, 2359296
	s_lshl_b32 s63, s15, 10
	s_add_u32 s63, s63, 73728
	s_mov_b32 m0, s63
	s_nop 0
	buffer_load_dwordx4 v29, s[8:11], s62 offen lds
	s_add_u32 s62, s62, 131072
	s_add_u32 s63, s63, 4096
	s_mov_b32 m0, s63
	s_nop 0
	buffer_load_dwordx4 v29, s[8:11], s62 offen lds
	s_add_u32 s62, s62, 131072
	s_add_u32 s63, s63, 4096
	s_mov_b32 m0, s63
	s_nop 0
	buffer_load_dwordx4 v29, s[8:11], s62 offen lds
	s_add_u32 s62, s62, 131072
	s_add_u32 s63, s63, 4096
	s_mov_b32 m0, s63
	s_nop 0
	buffer_load_dwordx4 v29, s[8:11], s62 offen lds
	s_add_u32 s62, s62, 131072
	s_add_u32 s63, s63, 4096
	s_mov_b32 m0, s63
	s_nop 0
	buffer_load_dwordx4 v29, s[8:11], s62 offen lds
	s_add_u32 s62, s62, 131072
	s_add_u32 s63, s63, 4096
	s_mov_b32 m0, s63
	s_nop 0
	buffer_load_dwordx4 v29, s[8:11], s62 offen lds
	s_add_u32 s62, s62, 131072
	s_add_u32 s63, s63, 4096
	s_mov_b32 m0, s63
	s_nop 0
	buffer_load_dwordx4 v29, s[8:11], s62 offen lds
	s_add_u32 s62, s62, 131072
	s_add_u32 s63, s63, 4096
	s_mov_b32 m0, s63
	s_nop 0
	buffer_load_dwordx4 v29, s[8:11], s62 offen lds
	s_add_u32 s62, s62, 131072
	s_add_u32 s63, s63, 4096
	s_mov_b32 m0, s63
	s_nop 0
	buffer_load_dwordx4 v29, s[8:11], s62 offen lds
	s_add_u32 s62, s62, 131072
	s_add_u32 s63, s63, 4096
	s_mov_b32 m0, s63
	s_nop 0
	buffer_load_dwordx4 v29, s[8:11], s62 offen lds
	s_add_u32 s62, s62, 131072
	s_add_u32 s63, s63, 4096
	s_mov_b32 m0, s63
	s_nop 0
	buffer_load_dwordx4 v29, s[8:11], s62 offen lds
	s_add_u32 s62, s62, 131072
	s_add_u32 s63, s63, 4096
	s_mov_b32 m0, s63
	s_nop 0
	buffer_load_dwordx4 v29, s[8:11], s62 offen lds
	s_add_u32 s62, s62, 131072
	s_add_u32 s63, s63, 4096
	s_mov_b32 m0, s63
	s_nop 0
	buffer_load_dwordx4 v29, s[8:11], s62 offen lds
	s_add_u32 s62, s62, 131072
	s_add_u32 s63, s63, 4096
	s_mov_b32 m0, s63
	s_nop 0
	buffer_load_dwordx4 v29, s[8:11], s62 offen lds
	s_add_u32 s62, s62, 131072
	s_add_u32 s63, s63, 4096
	s_mov_b32 m0, s63
	s_nop 0
	buffer_load_dwordx4 v29, s[8:11], s62 offen lds
	s_add_u32 s62, s62, 131072
	s_add_u32 s63, s63, 4096
	s_mov_b32 m0, s63
	s_nop 0
	buffer_load_dwordx4 v29, s[8:11], s62 offen lds
	s_add_u32 s62, s62, 131072
	s_add_u32 s63, s63, 4096
	s_mov_b32 m0, s63
	s_nop 0
	buffer_load_dwordx4 v29, s[8:11], s62 offen lds
	s_add_u32 s62, s62, 131072
	s_add_u32 s63, s63, 4096
	s_mov_b32 m0, s63
	s_nop 0
	buffer_load_dwordx4 v29, s[8:11], s62 offen lds
	s_waitcnt vmcnt(18)
	s_barrier
	ds_read_b64_tr_b16 a[0:1], v21 offset:0
	ds_read_b64_tr_b16 a[2:3], v21 offset:4096
	ds_read_b64_tr_b16 a[4:5], v21 offset:8192
	ds_read_b64_tr_b16 a[6:7], v21 offset:12288
	ds_read_b64_tr_b16 a[8:9], v21 offset:16384
	ds_read_b64_tr_b16 a[10:11], v21 offset:20480
	ds_read_b64_tr_b16 a[12:13], v21 offset:24576
	ds_read_b64_tr_b16 a[14:15], v21 offset:28672
	s_waitcnt lgkmcnt(8)
	ds_read_b64_tr_b16 a[16:17], v21 offset:32768
	ds_read_b64_tr_b16 a[18:19], v21 offset:36864
	ds_read_b64_tr_b16 a[20:21], v21 offset:40960
	ds_read_b64_tr_b16 a[22:23], v21 offset:45056
	ds_read_b64_tr_b16 a[24:25], v21 offset:49152
	ds_read_b64_tr_b16 a[26:27], v21 offset:53248
	ds_read_b64_tr_b16 a[28:29], v21 offset:57344
	ds_read_b64_tr_b16 a[30:31], v21 offset:61440
	s_waitcnt lgkmcnt(8)
	ds_read_b64_tr_b16 a[32:33], v23 offset:0
	ds_read_b64_tr_b16 a[34:35], v23 offset:4096
	ds_read_b64_tr_b16 a[72:73], v22 offset:0
	ds_read_b64_tr_b16 a[74:75], v22 offset:4096
	ds_read_b64_tr_b16 a[76:77], v22 offset:8192
	ds_read_b64_tr_b16 a[78:79], v22 offset:12288
	ds_read_b64_tr_b16 a[80:81], v22 offset:16384
	ds_read_b64_tr_b16 a[82:83], v22 offset:20480
	ds_read_b64_tr_b16 a[84:85], v22 offset:24576
	ds_read_b64_tr_b16 a[86:87], v22 offset:28672
	s_waitcnt lgkmcnt(8)
	ds_read_b64_tr_b16 a[88:89], v22 offset:32768
	ds_read_b64_tr_b16 a[90:91], v22 offset:36864
	ds_read_b64_tr_b16 a[92:93], v22 offset:40960
	ds_read_b64_tr_b16 a[94:95], v22 offset:45056
	ds_read_b64_tr_b16 a[96:97], v22 offset:49152
	ds_read_b64_tr_b16 a[98:99], v22 offset:53248
	ds_read_b64_tr_b16 a[100:101], v22 offset:57344
	ds_read_b64_tr_b16 a[102:103], v22 offset:61440
	s_waitcnt lgkmcnt(8)
	ds_read_b64_tr_b16 a[104:105], v24 offset:0
	ds_read_b64_tr_b16 a[106:107], v24 offset:4096
	s_waitcnt lgkmcnt(0)
	s_barrier
	s_load_dwordx2 s[22:23], s[0:1], 48
	s_waitcnt lgkmcnt(0)
	s_mov_b32 s8, s22
	s_and_b32 s9, s23, 0xffff
	s_mov_b32 s10, 0x480000
	s_mov_b32 s11, 0x00020000
	s_lshl_b32 s62, s26, 8
	s_lshl_b32 s17, s15, 15
	s_add_u32 s62, s62, s17
	s_lshl_b32 s63, s15, 10
	s_mov_b32 m0, s63
	s_nop 0
	buffer_load_dwordx4 v29, s[8:11], s62 offen lds
	s_add_u32 s62, s62, 131072
	s_add_u32 s63, s63, 4096
	s_mov_b32 m0, s63
	s_nop 0
	buffer_load_dwordx4 v29, s[8:11], s62 offen lds
	s_add_u32 s62, s62, 131072
	s_add_u32 s63, s63, 4096
	s_mov_b32 m0, s63
	s_nop 0
	buffer_load_dwordx4 v29, s[8:11], s62 offen lds
	s_add_u32 s62, s62, 131072
	s_add_u32 s63, s63, 4096
	s_mov_b32 m0, s63
	s_nop 0
	buffer_load_dwordx4 v29, s[8:11], s62 offen lds
	s_add_u32 s62, s62, 131072
	s_add_u32 s63, s63, 4096
	s_mov_b32 m0, s63
	s_nop 0
	buffer_load_dwordx4 v29, s[8:11], s62 offen lds
	s_add_u32 s62, s62, 131072
	s_add_u32 s63, s63, 4096
	s_mov_b32 m0, s63
	s_nop 0
	buffer_load_dwordx4 v29, s[8:11], s62 offen lds
	s_add_u32 s62, s62, 131072
	s_add_u32 s63, s63, 4096
	s_mov_b32 m0, s63
	s_nop 0
	buffer_load_dwordx4 v29, s[8:11], s62 offen lds
	s_add_u32 s62, s62, 131072
	s_add_u32 s63, s63, 4096
	s_mov_b32 m0, s63
	s_nop 0
	buffer_load_dwordx4 v29, s[8:11], s62 offen lds
	s_add_u32 s62, s62, 131072
	s_add_u32 s63, s63, 4096
	s_mov_b32 m0, s63
	s_nop 0
	buffer_load_dwordx4 v29, s[8:11], s62 offen lds
	s_add_u32 s62, s62, 131072
	s_add_u32 s63, s63, 4096
	s_mov_b32 m0, s63
	s_nop 0
	buffer_load_dwordx4 v29, s[8:11], s62 offen lds
	s_add_u32 s62, s62, 131072
	s_add_u32 s63, s63, 4096
	s_mov_b32 m0, s63
	s_nop 0
	buffer_load_dwordx4 v29, s[8:11], s62 offen lds
	s_add_u32 s62, s62, 131072
	s_add_u32 s63, s63, 4096
	s_mov_b32 m0, s63
	s_nop 0
	buffer_load_dwordx4 v29, s[8:11], s62 offen lds
	s_add_u32 s62, s62, 131072
	s_add_u32 s63, s63, 4096
	s_mov_b32 m0, s63
	s_nop 0
	buffer_load_dwordx4 v29, s[8:11], s62 offen lds
	s_add_u32 s62, s62, 131072
	s_add_u32 s63, s63, 4096
	s_mov_b32 m0, s63
	s_nop 0
	buffer_load_dwordx4 v29, s[8:11], s62 offen lds
	s_add_u32 s62, s62, 131072
	s_add_u32 s63, s63, 4096
	s_mov_b32 m0, s63
	s_nop 0
	buffer_load_dwordx4 v29, s[8:11], s62 offen lds
	s_add_u32 s62, s62, 131072
	s_add_u32 s63, s63, 4096
	s_mov_b32 m0, s63
	s_nop 0
	buffer_load_dwordx4 v29, s[8:11], s62 offen lds
	s_add_u32 s62, s62, 131072
	s_add_u32 s63, s63, 4096
	s_mov_b32 m0, s63
	s_nop 0
	buffer_load_dwordx4 v29, s[8:11], s62 offen lds
	s_add_u32 s62, s62, 131072
	s_add_u32 s63, s63, 4096
	s_mov_b32 m0, s63
	s_nop 0
	buffer_load_dwordx4 v29, s[8:11], s62 offen lds
	s_waitcnt vmcnt(18)
	s_barrier
	ds_read_b64_tr_b16 a[36:37], v25 offset:0
	ds_read_b64_tr_b16 a[38:39], v25 offset:4096
	ds_read_b64_tr_b16 a[40:41], v25 offset:8192
	ds_read_b64_tr_b16 a[42:43], v25 offset:12288
	ds_read_b64_tr_b16 a[44:45], v25 offset:16384
	ds_read_b64_tr_b16 a[46:47], v25 offset:20480
	ds_read_b64_tr_b16 a[48:49], v25 offset:24576
	ds_read_b64_tr_b16 a[50:51], v25 offset:28672
	s_waitcnt lgkmcnt(8)
	ds_read_b64_tr_b16 a[52:53], v25 offset:32768
	ds_read_b64_tr_b16 a[54:55], v25 offset:36864
	ds_read_b64_tr_b16 a[56:57], v25 offset:40960
	ds_read_b64_tr_b16 a[58:59], v25 offset:45056
	ds_read_b64_tr_b16 a[60:61], v25 offset:49152
	ds_read_b64_tr_b16 a[62:63], v25 offset:53248
	ds_read_b64_tr_b16 a[64:65], v25 offset:57344
	ds_read_b64_tr_b16 a[66:67], v25 offset:61440
	s_waitcnt lgkmcnt(8)
	ds_read_b64_tr_b16 a[68:69], v27 offset:0
	ds_read_b64_tr_b16 a[70:71], v27 offset:4096
	ds_read_b64_tr_b16 a[108:109], v26 offset:0
	ds_read_b64_tr_b16 a[110:111], v26 offset:4096
	ds_read_b64_tr_b16 a[112:113], v26 offset:8192
	ds_read_b64_tr_b16 a[114:115], v26 offset:12288
	ds_read_b64_tr_b16 a[116:117], v26 offset:16384
	ds_read_b64_tr_b16 a[118:119], v26 offset:20480
	ds_read_b64_tr_b16 a[120:121], v26 offset:24576
	ds_read_b64_tr_b16 a[122:123], v26 offset:28672
	s_waitcnt lgkmcnt(8)
	ds_read_b64_tr_b16 a[124:125], v26 offset:32768
	ds_read_b64_tr_b16 a[126:127], v26 offset:36864
	ds_read_b64_tr_b16 a[128:129], v26 offset:40960
	ds_read_b64_tr_b16 a[130:131], v26 offset:45056
	ds_read_b64_tr_b16 a[132:133], v26 offset:49152
	ds_read_b64_tr_b16 a[134:135], v26 offset:53248
	ds_read_b64_tr_b16 a[136:137], v26 offset:57344
	ds_read_b64_tr_b16 a[138:139], v26 offset:61440
	s_waitcnt lgkmcnt(8)
	ds_read_b64_tr_b16 a[140:141], v28 offset:0
	ds_read_b64_tr_b16 a[142:143], v28 offset:4096
	s_waitcnt lgkmcnt(0)
	s_barrier
	s_load_dwordx2 s[22:23], s[0:1], 48
	s_waitcnt lgkmcnt(0)
	s_mov_b32 s8, s22
	s_and_b32 s9, s23, 0xffff
	s_mov_b32 s10, 0x480000
	s_mov_b32 s11, 0x00020000
	s_lshl_b32 s62, s26, 8
	s_lshl_b32 s17, s15, 15
	s_add_u32 s62, s62, s17
	s_add_u32 s62, s62, 2359296
	s_lshl_b32 s63, s15, 10
	s_add_u32 s63, s63, 73728
	s_mov_b32 m0, s63
	s_nop 0
	buffer_load_dwordx4 v29, s[8:11], s62 offen lds
	s_add_u32 s62, s62, 131072
	s_add_u32 s63, s63, 4096
	s_mov_b32 m0, s63
	s_nop 0
	buffer_load_dwordx4 v29, s[8:11], s62 offen lds
	s_add_u32 s62, s62, 131072
	s_add_u32 s63, s63, 4096
	s_mov_b32 m0, s63
	s_nop 0
	buffer_load_dwordx4 v29, s[8:11], s62 offen lds
	s_add_u32 s62, s62, 131072
	s_add_u32 s63, s63, 4096
	s_mov_b32 m0, s63
	s_nop 0
	buffer_load_dwordx4 v29, s[8:11], s62 offen lds
	s_add_u32 s62, s62, 131072
	s_add_u32 s63, s63, 4096
	s_mov_b32 m0, s63
	s_nop 0
	buffer_load_dwordx4 v29, s[8:11], s62 offen lds
	s_add_u32 s62, s62, 131072
	s_add_u32 s63, s63, 4096
	s_mov_b32 m0, s63
	s_nop 0
	buffer_load_dwordx4 v29, s[8:11], s62 offen lds
	s_add_u32 s62, s62, 131072
	s_add_u32 s63, s63, 4096
	s_mov_b32 m0, s63
	s_nop 0
	buffer_load_dwordx4 v29, s[8:11], s62 offen lds
	s_add_u32 s62, s62, 131072
	s_add_u32 s63, s63, 4096
	s_mov_b32 m0, s63
	s_nop 0
	buffer_load_dwordx4 v29, s[8:11], s62 offen lds
	s_add_u32 s62, s62, 131072
	s_add_u32 s63, s63, 4096
	s_mov_b32 m0, s63
	s_nop 0
	buffer_load_dwordx4 v29, s[8:11], s62 offen lds
	s_add_u32 s62, s62, 131072
	s_add_u32 s63, s63, 4096
	s_mov_b32 m0, s63
	s_nop 0
	buffer_load_dwordx4 v29, s[8:11], s62 offen lds
	s_add_u32 s62, s62, 131072
	s_add_u32 s63, s63, 4096
	s_mov_b32 m0, s63
	s_nop 0
	buffer_load_dwordx4 v29, s[8:11], s62 offen lds
	s_add_u32 s62, s62, 131072
	s_add_u32 s63, s63, 4096
	s_mov_b32 m0, s63
	s_nop 0
	buffer_load_dwordx4 v29, s[8:11], s62 offen lds
	s_add_u32 s62, s62, 131072
	s_add_u32 s63, s63, 4096
	s_mov_b32 m0, s63
	s_nop 0
	buffer_load_dwordx4 v29, s[8:11], s62 offen lds
	s_add_u32 s62, s62, 131072
	s_add_u32 s63, s63, 4096
	s_mov_b32 m0, s63
	s_nop 0
	buffer_load_dwordx4 v29, s[8:11], s62 offen lds
	s_add_u32 s62, s62, 131072
	s_add_u32 s63, s63, 4096
	s_mov_b32 m0, s63
	s_nop 0
	buffer_load_dwordx4 v29, s[8:11], s62 offen lds
	s_add_u32 s62, s62, 131072
	s_add_u32 s63, s63, 4096
	s_mov_b32 m0, s63
	s_nop 0
	buffer_load_dwordx4 v29, s[8:11], s62 offen lds
	s_add_u32 s62, s62, 131072
	s_add_u32 s63, s63, 4096
	s_mov_b32 m0, s63
	s_nop 0
	buffer_load_dwordx4 v29, s[8:11], s62 offen lds
	s_add_u32 s62, s62, 131072
	s_add_u32 s63, s63, 4096
	s_mov_b32 m0, s63
	s_nop 0
	buffer_load_dwordx4 v29, s[8:11], s62 offen lds
	s_waitcnt vmcnt(18)
	s_barrier
	ds_read_b64_tr_b16 a[144:145], v21 offset:0
	ds_read_b64_tr_b16 a[146:147], v21 offset:4096
	ds_read_b64_tr_b16 a[148:149], v21 offset:8192
	ds_read_b64_tr_b16 a[150:151], v21 offset:12288
	ds_read_b64_tr_b16 a[152:153], v21 offset:16384
	ds_read_b64_tr_b16 a[154:155], v21 offset:20480
	ds_read_b64_tr_b16 a[156:157], v21 offset:24576
	ds_read_b64_tr_b16 a[158:159], v21 offset:28672
	s_waitcnt lgkmcnt(8)
	ds_read_b64_tr_b16 a[160:161], v21 offset:32768
	ds_read_b64_tr_b16 a[162:163], v21 offset:36864
	ds_read_b64_tr_b16 a[164:165], v21 offset:40960
	ds_read_b64_tr_b16 a[166:167], v21 offset:45056
	ds_read_b64_tr_b16 a[168:169], v21 offset:49152
	ds_read_b64_tr_b16 a[170:171], v21 offset:53248
	ds_read_b64_tr_b16 a[172:173], v21 offset:57344
	ds_read_b64_tr_b16 a[174:175], v21 offset:61440
	s_waitcnt lgkmcnt(8)
	ds_read_b64_tr_b16 a[176:177], v23 offset:0
	ds_read_b64_tr_b16 a[178:179], v23 offset:4096
	ds_read_b64_tr_b16 a[216:217], v22 offset:0
	ds_read_b64_tr_b16 a[218:219], v22 offset:4096
	ds_read_b64_tr_b16 a[220:221], v22 offset:8192
	ds_read_b64_tr_b16 a[222:223], v22 offset:12288
	ds_read_b64_tr_b16 a[224:225], v22 offset:16384
	ds_read_b64_tr_b16 a[226:227], v22 offset:20480
	ds_read_b64_tr_b16 a[228:229], v22 offset:24576
	ds_read_b64_tr_b16 a[230:231], v22 offset:28672
	s_waitcnt lgkmcnt(8)
	ds_read_b64_tr_b16 a[232:233], v22 offset:32768
	ds_read_b64_tr_b16 a[234:235], v22 offset:36864
	ds_read_b64_tr_b16 a[236:237], v22 offset:40960
	ds_read_b64_tr_b16 a[238:239], v22 offset:45056
	ds_read_b64_tr_b16 a[240:241], v22 offset:49152
	ds_read_b64_tr_b16 a[242:243], v22 offset:53248
	ds_read_b64_tr_b16 a[244:245], v22 offset:57344
	ds_read_b64_tr_b16 a[246:247], v22 offset:61440
	s_waitcnt lgkmcnt(8)
	ds_read_b64_tr_b16 a[248:249], v24 offset:0
	ds_read_b64_tr_b16 a[250:251], v24 offset:4096
	s_waitcnt lgkmcnt(0)
	s_barrier
	s_load_dwordx2 s[22:23], s[0:1], 56
	s_waitcnt lgkmcnt(0)
	s_mov_b32 s8, s22
	s_and_b32 s9, s23, 0xffff
	s_mov_b32 s10, 0x480000
	s_mov_b32 s11, 0x00020000
	s_lshl_b32 s62, s26, 8
	s_lshl_b32 s17, s15, 15
	s_add_u32 s62, s62, s17
	s_lshl_b32 s63, s15, 10
	s_mov_b32 m0, s63
	s_nop 0
	buffer_load_dwordx4 v29, s[8:11], s62 offen lds
	s_add_u32 s62, s62, 131072
	s_add_u32 s63, s63, 4096
	s_mov_b32 m0, s63
	s_nop 0
	buffer_load_dwordx4 v29, s[8:11], s62 offen lds
	s_add_u32 s62, s62, 131072
	s_add_u32 s63, s63, 4096
	s_mov_b32 m0, s63
	s_nop 0
	buffer_load_dwordx4 v29, s[8:11], s62 offen lds
	s_add_u32 s62, s62, 131072
	s_add_u32 s63, s63, 4096
	s_mov_b32 m0, s63
	s_nop 0
	buffer_load_dwordx4 v29, s[8:11], s62 offen lds
	s_add_u32 s62, s62, 131072
	s_add_u32 s63, s63, 4096
	s_mov_b32 m0, s63
	s_nop 0
	buffer_load_dwordx4 v29, s[8:11], s62 offen lds
	s_add_u32 s62, s62, 131072
	s_add_u32 s63, s63, 4096
	s_mov_b32 m0, s63
	s_nop 0
	buffer_load_dwordx4 v29, s[8:11], s62 offen lds
	s_add_u32 s62, s62, 131072
	s_add_u32 s63, s63, 4096
	s_mov_b32 m0, s63
	s_nop 0
	buffer_load_dwordx4 v29, s[8:11], s62 offen lds
	s_add_u32 s62, s62, 131072
	s_add_u32 s63, s63, 4096
	s_mov_b32 m0, s63
	s_nop 0
	buffer_load_dwordx4 v29, s[8:11], s62 offen lds
	s_add_u32 s62, s62, 131072
	s_add_u32 s63, s63, 4096
	s_mov_b32 m0, s63
	s_nop 0
	buffer_load_dwordx4 v29, s[8:11], s62 offen lds
	s_add_u32 s62, s62, 131072
	s_add_u32 s63, s63, 4096
	s_mov_b32 m0, s63
	s_nop 0
	buffer_load_dwordx4 v29, s[8:11], s62 offen lds
	s_add_u32 s62, s62, 131072
	s_add_u32 s63, s63, 4096
	s_mov_b32 m0, s63
	s_nop 0
	buffer_load_dwordx4 v29, s[8:11], s62 offen lds
	s_add_u32 s62, s62, 131072
	s_add_u32 s63, s63, 4096
	s_mov_b32 m0, s63
	s_nop 0
	buffer_load_dwordx4 v29, s[8:11], s62 offen lds
	s_add_u32 s62, s62, 131072
	s_add_u32 s63, s63, 4096
	s_mov_b32 m0, s63
	s_nop 0
	buffer_load_dwordx4 v29, s[8:11], s62 offen lds
	s_add_u32 s62, s62, 131072
	s_add_u32 s63, s63, 4096
	s_mov_b32 m0, s63
	s_nop 0
	buffer_load_dwordx4 v29, s[8:11], s62 offen lds
	s_add_u32 s62, s62, 131072
	s_add_u32 s63, s63, 4096
	s_mov_b32 m0, s63
	s_nop 0
	buffer_load_dwordx4 v29, s[8:11], s62 offen lds
	s_add_u32 s62, s62, 131072
	s_add_u32 s63, s63, 4096
	s_mov_b32 m0, s63
	s_nop 0
	buffer_load_dwordx4 v29, s[8:11], s62 offen lds
	s_add_u32 s62, s62, 131072
	s_add_u32 s63, s63, 4096
	s_mov_b32 m0, s63
	s_nop 0
	buffer_load_dwordx4 v29, s[8:11], s62 offen lds
	s_add_u32 s62, s62, 131072
	s_add_u32 s63, s63, 4096
	s_mov_b32 m0, s63
	s_nop 0
	buffer_load_dwordx4 v29, s[8:11], s62 offen lds
	s_waitcnt vmcnt(18)
	s_barrier
	ds_read_b64_tr_b16 a[180:181], v25 offset:0
	ds_read_b64_tr_b16 a[182:183], v25 offset:4096
	ds_read_b64_tr_b16 a[184:185], v25 offset:8192
	ds_read_b64_tr_b16 a[186:187], v25 offset:12288
	ds_read_b64_tr_b16 a[188:189], v25 offset:16384
	ds_read_b64_tr_b16 a[190:191], v25 offset:20480
	ds_read_b64_tr_b16 a[192:193], v25 offset:24576
	ds_read_b64_tr_b16 a[194:195], v25 offset:28672
	s_waitcnt lgkmcnt(8)
	ds_read_b64_tr_b16 a[196:197], v25 offset:32768
	ds_read_b64_tr_b16 a[198:199], v25 offset:36864
	ds_read_b64_tr_b16 a[200:201], v25 offset:40960
	ds_read_b64_tr_b16 a[202:203], v25 offset:45056
	ds_read_b64_tr_b16 a[204:205], v25 offset:49152
	ds_read_b64_tr_b16 a[206:207], v25 offset:53248
	ds_read_b64_tr_b16 a[208:209], v25 offset:57344
	ds_read_b64_tr_b16 a[210:211], v25 offset:61440
	s_waitcnt lgkmcnt(8)
	ds_read_b64_tr_b16 a[212:213], v27 offset:0
	ds_read_b64_tr_b16 a[214:215], v27 offset:4096
	ds_read_b64_tr_b16 a[252:253], v26 offset:0
	ds_read_b64_tr_b16 a[254:255], v26 offset:4096
	ds_read_b64_tr_b16 v[80:81], v26 offset:8192
	ds_read_b64_tr_b16 v[82:83], v26 offset:12288
	ds_read_b64_tr_b16 v[84:85], v26 offset:16384
	ds_read_b64_tr_b16 v[86:87], v26 offset:20480
	ds_read_b64_tr_b16 v[88:89], v26 offset:24576
	ds_read_b64_tr_b16 v[90:91], v26 offset:28672
	s_waitcnt lgkmcnt(8)
	ds_read_b64_tr_b16 v[92:93], v26 offset:32768
	ds_read_b64_tr_b16 v[94:95], v26 offset:36864
	ds_read_b64_tr_b16 v[96:97], v26 offset:40960
	ds_read_b64_tr_b16 v[98:99], v26 offset:45056
	ds_read_b64_tr_b16 v[100:101], v26 offset:49152
	ds_read_b64_tr_b16 v[102:103], v26 offset:53248
	ds_read_b64_tr_b16 v[104:105], v26 offset:57344
	ds_read_b64_tr_b16 v[106:107], v26 offset:61440
	s_waitcnt lgkmcnt(8)
	ds_read_b64_tr_b16 v[108:109], v28 offset:0
	ds_read_b64_tr_b16 v[110:111], v28 offset:4096
	s_waitcnt lgkmcnt(0)
	s_barrier
	s_load_dwordx2 s[22:23], s[0:1], 56
	s_waitcnt lgkmcnt(0)
	s_mov_b32 s8, s22
	s_and_b32 s9, s23, 0xffff
	s_mov_b32 s10, 0x480000
	s_mov_b32 s11, 0x00020000
	s_lshl_b32 s62, s26, 8
	s_lshl_b32 s17, s15, 15
	s_add_u32 s62, s62, s17
	s_add_u32 s62, s62, 2359296
	s_lshl_b32 s63, s15, 10
	s_add_u32 s63, s63, 73728
	s_mov_b32 m0, s63
	s_nop 0
	buffer_load_dwordx4 v29, s[8:11], s62 offen lds
	s_add_u32 s62, s62, 131072
	s_add_u32 s63, s63, 4096
	s_mov_b32 m0, s63
	s_nop 0
	buffer_load_dwordx4 v29, s[8:11], s62 offen lds
	s_add_u32 s62, s62, 131072
	s_add_u32 s63, s63, 4096
	s_mov_b32 m0, s63
	s_nop 0
	buffer_load_dwordx4 v29, s[8:11], s62 offen lds
	s_add_u32 s62, s62, 131072
	s_add_u32 s63, s63, 4096
	s_mov_b32 m0, s63
	s_nop 0
	buffer_load_dwordx4 v29, s[8:11], s62 offen lds
	s_add_u32 s62, s62, 131072
	s_add_u32 s63, s63, 4096
	s_mov_b32 m0, s63
	s_nop 0
	buffer_load_dwordx4 v29, s[8:11], s62 offen lds
	s_add_u32 s62, s62, 131072
	s_add_u32 s63, s63, 4096
	s_mov_b32 m0, s63
	s_nop 0
	buffer_load_dwordx4 v29, s[8:11], s62 offen lds
	s_add_u32 s62, s62, 131072
	s_add_u32 s63, s63, 4096
	s_mov_b32 m0, s63
	s_nop 0
	buffer_load_dwordx4 v29, s[8:11], s62 offen lds
	s_add_u32 s62, s62, 131072
	s_add_u32 s63, s63, 4096
	s_mov_b32 m0, s63
	s_nop 0
	buffer_load_dwordx4 v29, s[8:11], s62 offen lds
	s_add_u32 s62, s62, 131072
	s_add_u32 s63, s63, 4096
	s_mov_b32 m0, s63
	s_nop 0
	buffer_load_dwordx4 v29, s[8:11], s62 offen lds
	s_add_u32 s62, s62, 131072
	s_add_u32 s63, s63, 4096
	s_mov_b32 m0, s63
	s_nop 0
	buffer_load_dwordx4 v29, s[8:11], s62 offen lds
	s_add_u32 s62, s62, 131072
	s_add_u32 s63, s63, 4096
	s_mov_b32 m0, s63
	s_nop 0
	buffer_load_dwordx4 v29, s[8:11], s62 offen lds
	s_add_u32 s62, s62, 131072
	s_add_u32 s63, s63, 4096
	s_mov_b32 m0, s63
	s_nop 0
	buffer_load_dwordx4 v29, s[8:11], s62 offen lds
	s_add_u32 s62, s62, 131072
	s_add_u32 s63, s63, 4096
	s_mov_b32 m0, s63
	s_nop 0
	buffer_load_dwordx4 v29, s[8:11], s62 offen lds
	s_add_u32 s62, s62, 131072
	s_add_u32 s63, s63, 4096
	s_mov_b32 m0, s63
	s_nop 0
	buffer_load_dwordx4 v29, s[8:11], s62 offen lds
	s_add_u32 s62, s62, 131072
	s_add_u32 s63, s63, 4096
	s_mov_b32 m0, s63
	s_nop 0
	buffer_load_dwordx4 v29, s[8:11], s62 offen lds
	s_add_u32 s62, s62, 131072
	s_add_u32 s63, s63, 4096
	s_mov_b32 m0, s63
	s_nop 0
	buffer_load_dwordx4 v29, s[8:11], s62 offen lds
	s_add_u32 s62, s62, 131072
	s_add_u32 s63, s63, 4096
	s_mov_b32 m0, s63
	s_nop 0
	buffer_load_dwordx4 v29, s[8:11], s62 offen lds
	s_add_u32 s62, s62, 131072
	s_add_u32 s63, s63, 4096
	s_mov_b32 m0, s63
	s_nop 0
	buffer_load_dwordx4 v29, s[8:11], s62 offen lds
	s_waitcnt vmcnt(18)
	s_barrier
	ds_read_b64_tr_b16 v[112:113], v21 offset:0
	ds_read_b64_tr_b16 v[114:115], v21 offset:4096
	ds_read_b64_tr_b16 v[116:117], v21 offset:8192
	ds_read_b64_tr_b16 v[118:119], v21 offset:12288
	ds_read_b64_tr_b16 v[120:121], v21 offset:16384
	ds_read_b64_tr_b16 v[122:123], v21 offset:20480
	ds_read_b64_tr_b16 v[124:125], v21 offset:24576
	ds_read_b64_tr_b16 v[126:127], v21 offset:28672
	s_waitcnt lgkmcnt(8)
	ds_read_b64_tr_b16 v[128:129], v21 offset:32768
	ds_read_b64_tr_b16 v[130:131], v21 offset:36864
	ds_read_b64_tr_b16 v[132:133], v21 offset:40960
	ds_read_b64_tr_b16 v[134:135], v21 offset:45056
	ds_read_b64_tr_b16 v[136:137], v21 offset:49152
	ds_read_b64_tr_b16 v[138:139], v21 offset:53248
	ds_read_b64_tr_b16 v[140:141], v21 offset:57344
	ds_read_b64_tr_b16 v[142:143], v21 offset:61440
	s_waitcnt lgkmcnt(8)
	ds_read_b64_tr_b16 v[144:145], v23 offset:0
	ds_read_b64_tr_b16 v[146:147], v23 offset:4096
	ds_read_b64_tr_b16 v[184:185], v22 offset:0
	ds_read_b64_tr_b16 v[186:187], v22 offset:4096
	ds_read_b64_tr_b16 v[188:189], v22 offset:8192
	ds_read_b64_tr_b16 v[190:191], v22 offset:12288
	ds_read_b64_tr_b16 v[192:193], v22 offset:16384
	ds_read_b64_tr_b16 v[194:195], v22 offset:20480
	ds_read_b64_tr_b16 v[196:197], v22 offset:24576
	ds_read_b64_tr_b16 v[198:199], v22 offset:28672
	s_waitcnt lgkmcnt(8)
	ds_read_b64_tr_b16 v[200:201], v22 offset:32768
	ds_read_b64_tr_b16 v[202:203], v22 offset:36864
	ds_read_b64_tr_b16 v[204:205], v22 offset:40960
	ds_read_b64_tr_b16 v[206:207], v22 offset:45056
	ds_read_b64_tr_b16 v[208:209], v22 offset:49152
	ds_read_b64_tr_b16 v[210:211], v22 offset:53248
	ds_read_b64_tr_b16 v[212:213], v22 offset:57344
	ds_read_b64_tr_b16 v[214:215], v22 offset:61440
	s_waitcnt lgkmcnt(8)
	ds_read_b64_tr_b16 v[216:217], v24 offset:0
	ds_read_b64_tr_b16 v[218:219], v24 offset:4096
	s_waitcnt lgkmcnt(0)
	s_barrier
	s_waitcnt vmcnt(0)
	s_barrier
	ds_read_b64_tr_b16 v[148:149], v25 offset:0
	ds_read_b64_tr_b16 v[150:151], v25 offset:4096
	ds_read_b64_tr_b16 v[152:153], v25 offset:8192
	ds_read_b64_tr_b16 v[154:155], v25 offset:12288
	ds_read_b64_tr_b16 v[156:157], v25 offset:16384
	ds_read_b64_tr_b16 v[158:159], v25 offset:20480
	ds_read_b64_tr_b16 v[160:161], v25 offset:24576
	ds_read_b64_tr_b16 v[162:163], v25 offset:28672
	s_waitcnt lgkmcnt(8)
	ds_read_b64_tr_b16 v[164:165], v25 offset:32768
	ds_read_b64_tr_b16 v[166:167], v25 offset:36864
	ds_read_b64_tr_b16 v[168:169], v25 offset:40960
	ds_read_b64_tr_b16 v[170:171], v25 offset:45056
	ds_read_b64_tr_b16 v[172:173], v25 offset:49152
	ds_read_b64_tr_b16 v[174:175], v25 offset:53248
	ds_read_b64_tr_b16 v[176:177], v25 offset:57344
	ds_read_b64_tr_b16 v[178:179], v25 offset:61440
	s_waitcnt lgkmcnt(8)
	ds_read_b64_tr_b16 v[180:181], v27 offset:0
	ds_read_b64_tr_b16 v[182:183], v27 offset:4096
	ds_read_b64_tr_b16 v[220:221], v26 offset:0
	ds_read_b64_tr_b16 v[222:223], v26 offset:4096
	ds_read_b64_tr_b16 v[224:225], v26 offset:8192
	ds_read_b64_tr_b16 v[226:227], v26 offset:12288
	ds_read_b64_tr_b16 v[228:229], v26 offset:16384
	ds_read_b64_tr_b16 v[230:231], v26 offset:20480
	ds_read_b64_tr_b16 v[232:233], v26 offset:24576
	ds_read_b64_tr_b16 v[234:235], v26 offset:28672
	s_waitcnt lgkmcnt(8)
	ds_read_b64_tr_b16 v[236:237], v26 offset:32768
	ds_read_b64_tr_b16 v[238:239], v26 offset:36864
	ds_read_b64_tr_b16 v[240:241], v26 offset:40960
	ds_read_b64_tr_b16 v[242:243], v26 offset:45056
	ds_read_b64_tr_b16 v[244:245], v26 offset:49152
	ds_read_b64_tr_b16 v[246:247], v26 offset:53248
	ds_read_b64_tr_b16 v[248:249], v26 offset:57344
	ds_read_b64_tr_b16 v[250:251], v26 offset:61440
	s_waitcnt lgkmcnt(8)
	ds_read_b64_tr_b16 v[252:253], v28 offset:0
	ds_read_b64_tr_b16 v[254:255], v28 offset:4096
	s_waitcnt lgkmcnt(0)
	s_barrier
	s_or_b32 s17, s15, s27
	s_cmp_lg_u32 s17, 0
	s_cbranch_scc1 .isig_86
	v_mov_b32 v64, 0
	v_mov_b32 v65, 1
	s_mov_b64 exec, 1
	global_atomic_add v64, v65, s[12:13] offset:176
	s_mov_b64 exec, -1
.isig_86:
	v_lshlrev_b32 v64, 4, v79
	v_mov_b32 v68, 0
	s_mul_i32 s19, s27, 0x40
	s_add_u32 s19, s19, 0x80
	v_min_u32 v66, 15, v79
	v_lshrrev_b32 v74, 2, v66
	v_add_u32 v74, s19, v74
	v_lshlrev_b32 v74, 7, v74
	v_and_b32 v66, 3, v66
	v_lshlrev_b32 v66, 2, v66
	v_add_u32 v66, v66, v74
	s_lshl_b32 s30, s14, 7
	s_lshl_b32 s17, s15, 2
	s_add_u32 s30, s30, s17
	s_mul_i32 s31, s27, 0x240000
	s_add_u32 s31, s31, 0xa600000
	s_mul_i32 s34, s27, 50331648
	s_mul_i32 s17, s26, 24576
	s_add_u32 s34, s34, s17
	s_lshl_b32 s17, s15, 10
	s_add_u32 s34, s34, s17
	s_add_u32 s34, s34, 2097152
	v_mov_b32 v74, 0
	s_mov_b32 s20, 400000
	v_and_b32 v72, 7, v79
	v_lshrrev_b32 v73, 2, v72
	v_mul_u32_u24 v73, 112, v73
	v_lshlrev_b32 v72, 2, v72
	v_add_u32 v72, v72, v73
	s_getpc_b64 s[18:19]
.ct_90:
	s_sub_u32 s18, s18, .ct_90-L_B1
	s_subb_u32 s19, s19, 0
	v_lshlrev_b32 v74, 7, v79
	s_lshl_b32 s17, s15, 13
	v_add_u32 v74, s17, v74
	s_mov_b32 s17, L_B1_CE-L_B1-4
	v_min_u32 v74, s17, v74
	global_load_dword v73, v74, s[18:19]
	v_mov_b32 v74, 0
.gbre_87:
	global_load_dword v73, v72, s[12:13] offset:16 sc1
	s_waitcnt vmcnt(0)
	v_readlane_b32 s17, v73, 0
	v_readlane_b32 s18, v73, 1
	s_nop 0
	s_add_u32 s17, s17, s18
	v_readlane_b32 s18, v73, 2
	s_nop 0
	s_add_u32 s17, s17, s18
	v_readlane_b32 s18, v73, 3
	s_nop 0
	s_add_u32 s17, s17, s18
	v_readlane_b32 s18, v73, 4
	s_nop 0
	s_add_u32 s17, s17, s18
	v_readlane_b32 s18, v73, 5
	s_nop 0
	s_add_u32 s17, s17, s18
	v_readlane_b32 s18, v73, 6
	s_nop 0
	s_add_u32 s17, s17, s18
	v_readlane_b32 s18, v73, 7
	s_nop 0
	s_add_u32 s17, s17, s18
	s_cmp_ge_u32 s17, 256
	s_cbranch_scc1 .gbok_88
	s_sub_u32 s20, s20, 1
	s_cmp_lg_u32 s20, 0
	s_cbranch_scc1 .gbre_87
	s_branch L_FAIL
.gbok_88:
	s_mul_i32 s17, s15, 9216
	s_add_u32 s31, s31, s17
	s_mov_b32 s32, s17
	s_lshl_b32 s44, s17, 1
	s_add_u32 s44, s44, 36864
	s_mov_b32 s33, 0
	s_mov_b32 s28, 0
	s_mov_b32 s29, 0
.gloop_91:
	s_cmp_lg_u32 s29, 0
	s_cbranch_scc1 .gpref_92
	s_add_u32 s37, s28, 1
	s_mov_b32 s20, 400000
.pre_94:
	buffer_load_dword v67, v66, s[4:7], 0 offen sc1
	s_waitcnt vmcnt(0)
	v_cmp_gt_u32 vcc, s37, v67
	s_cbranch_vccz .pok_95
	s_sub_u32 s20, s20, 1
	s_cmp_lg_u32 s20, 0
	s_cbranch_scc1 .pre_94
	s_branch L_FAIL
.pok_95:
	s_add_u32 s17, s32, 0
	s_mov_b32 m0, s17
	s_add_u32 s18, s31, 0
	buffer_load_dwordx4 v64, s[4:7], s18 offen offset:0 lds
	buffer_load_dwordx4 v64, s[4:7], s18 offen offset:1024 lds
	buffer_load_dwordx4 v64, s[4:7], s18 offen offset:2048 lds
	buffer_load_dwordx4 v64, s[4:7], s18 offen offset:3072 lds
	s_add_u32 s17, s32, 4096
	s_mov_b32 m0, s17
	s_add_u32 s18, s31, 4096
	buffer_load_dwordx4 v64, s[4:7], s18 offen offset:0 lds
	buffer_load_dwordx4 v64, s[4:7], s18 offen offset:1024 lds
	buffer_load_dwordx4 v64, s[4:7], s18 offen offset:2048 lds
	buffer_load_dwordx4 v64, s[4:7], s18 offen offset:3072 lds
	s_add_u32 s17, s32, 8192
	s_mov_b32 m0, s17
	s_add_u32 s18, s31, 8192
	buffer_load_dwordx4 v64, s[4:7], s18 offen offset:0 lds
	s_add_u32 s31, s31, 36864
	s_sub_u32 s32, s44, s32
	s_waitcnt vmcnt(0)
	s_branch .ggo_93
.gpref_92:
	s_waitcnt vmcnt(6)
.ggo_93:
	s_barrier
	s_mov_b32 s29, 0
	v_add_u32 v65, s33, v64
	s_sub_u32 s33, 36864, s33
	buffer_load_dword v67, v66, s[4:7], 0 offen sc1
	ds_read_b128 v[48:51], v65 offset:0
	ds_read_b128 v[52:55], v65 offset:18432
	ds_read_b128 v[56:59], v65 offset:1024
	ds_read_b128 v[60:63], v65 offset:19456
	s_waitcnt lgkmcnt(2)
	v_mfma_f32_16x16x32_bf16 v[0:3], a[0:3], v[48:51], 0
	v_mfma_f32_16x16x32_bf16 v[8:11], a[0:3], v[52:55], 0
	v_mfma_f32_16x16x32_bf16 v[4:7], a[72:75], v[48:51], 0
	v_mfma_f32_16x16x32_bf16 v[12:15], a[72:75], v[52:55], 0
	v_mfma_f32_16x16x32_bf16 v[16:19], a[144:147], v[48:51], 0
	v_mfma_f32_16x16x32_bf16 v[24:27], a[144:147], v[52:55], 0
	v_mfma_f32_16x16x32_bf16 v[20:23], a[216:219], v[48:51], 0
	v_mfma_f32_16x16x32_bf16 v[28:31], a[216:219], v[52:55], 0
	v_mfma_f32_16x16x32_bf16 v[32:35], v[48:51], v[112:115], 0
	v_mfma_f32_16x16x32_bf16 v[36:39], v[52:55], v[112:115], 0
	v_mfma_f32_16x16x32_bf16 v[40:43], v[48:51], v[184:187], 0
	v_mfma_f32_16x16x32_bf16 v[44:47], v[52:55], v[184:187], 0
	ds_read_b128 v[48:51], v65 offset:2048
	ds_read_b128 v[52:55], v65 offset:20480
	s_waitcnt lgkmcnt(2)
	v_mfma_f32_16x16x32_bf16 v[0:3], a[4:7], v[56:59], v[0:3]
	v_mfma_f32_16x16x32_bf16 v[8:11], a[4:7], v[60:63], v[8:11]
	v_mfma_f32_16x16x32_bf16 v[4:7], a[76:79], v[56:59], v[4:7]
	v_mfma_f32_16x16x32_bf16 v[12:15], a[76:79], v[60:63], v[12:15]
	v_mfma_f32_16x16x32_bf16 v[16:19], a[148:151], v[56:59], v[16:19]
	v_mfma_f32_16x16x32_bf16 v[24:27], a[148:151], v[60:63], v[24:27]
	v_mfma_f32_16x16x32_bf16 v[20:23], a[220:223], v[56:59], v[20:23]
	v_mfma_f32_16x16x32_bf16 v[28:31], a[220:223], v[60:63], v[28:31]
	v_mfma_f32_16x16x32_bf16 v[32:35], v[56:59], v[116:119], v[32:35]
	v_mfma_f32_16x16x32_bf16 v[36:39], v[60:63], v[116:119], v[36:39]
	v_mfma_f32_16x16x32_bf16 v[40:43], v[56:59], v[188:191], v[40:43]
	v_mfma_f32_16x16x32_bf16 v[44:47], v[60:63], v[188:191], v[44:47]
	ds_read_b128 v[56:59], v65 offset:3072
	ds_read_b128 v[60:63], v65 offset:21504
	s_waitcnt lgkmcnt(2)
	v_mfma_f32_16x16x32_bf16 v[0:3], a[8:11], v[48:51], v[0:3]
	v_mfma_f32_16x16x32_bf16 v[8:11], a[8:11], v[52:55], v[8:11]
	v_mfma_f32_16x16x32_bf16 v[4:7], a[80:83], v[48:51], v[4:7]
	v_mfma_f32_16x16x32_bf16 v[12:15], a[80:83], v[52:55], v[12:15]
	v_mfma_f32_16x16x32_bf16 v[16:19], a[152:155], v[48:51], v[16:19]
	v_mfma_f32_16x16x32_bf16 v[24:27], a[152:155], v[52:55], v[24:27]
	v_mfma_f32_16x16x32_bf16 v[20:23], a[224:227], v[48:51], v[20:23]
	v_mfma_f32_16x16x32_bf16 v[28:31], a[224:227], v[52:55], v[28:31]
	v_mfma_f32_16x16x32_bf16 v[32:35], v[48:51], v[120:123], v[32:35]
	v_mfma_f32_16x16x32_bf16 v[36:39], v[52:55], v[120:123], v[36:39]
	v_mfma_f32_16x16x32_bf16 v[40:43], v[48:51], v[192:195], v[40:43]
	v_mfma_f32_16x16x32_bf16 v[44:47], v[52:55], v[192:195], v[44:47]
	ds_read_b128 v[48:51], v65 offset:4096
	ds_read_b128 v[52:55], v65 offset:22528
	s_waitcnt lgkmcnt(2)
	v_mfma_f32_16x16x32_bf16 v[0:3], a[12:15], v[56:59], v[0:3]
	v_mfma_f32_16x16x32_bf16 v[8:11], a[12:15], v[60:63], v[8:11]
	v_mfma_f32_16x16x32_bf16 v[4:7], a[84:87], v[56:59], v[4:7]
	v_mfma_f32_16x16x32_bf16 v[12:15], a[84:87], v[60:63], v[12:15]
	v_mfma_f32_16x16x32_bf16 v[16:19], a[156:159], v[56:59], v[16:19]
	v_mfma_f32_16x16x32_bf16 v[24:27], a[156:159], v[60:63], v[24:27]
	v_mfma_f32_16x16x32_bf16 v[20:23], a[228:231], v[56:59], v[20:23]
	v_mfma_f32_16x16x32_bf16 v[28:31], a[228:231], v[60:63], v[28:31]
	v_mfma_f32_16x16x32_bf16 v[32:35], v[56:59], v[124:127], v[32:35]
	v_mfma_f32_16x16x32_bf16 v[36:39], v[60:63], v[124:127], v[36:39]
	v_mfma_f32_16x16x32_bf16 v[40:43], v[56:59], v[196:199], v[40:43]
	v_mfma_f32_16x16x32_bf16 v[44:47], v[60:63], v[196:199], v[44:47]
	ds_read_b128 v[56:59], v65 offset:5120
	ds_read_b128 v[60:63], v65 offset:23552
	s_waitcnt lgkmcnt(2)
	v_mfma_f32_16x16x32_bf16 v[0:3], a[16:19], v[48:51], v[0:3]
	v_mfma_f32_16x16x32_bf16 v[8:11], a[16:19], v[52:55], v[8:11]
	v_mfma_f32_16x16x32_bf16 v[4:7], a[88:91], v[48:51], v[4:7]
	v_mfma_f32_16x16x32_bf16 v[12:15], a[88:91], v[52:55], v[12:15]
	v_mfma_f32_16x16x32_bf16 v[16:19], a[160:163], v[48:51], v[16:19]
	v_mfma_f32_16x16x32_bf16 v[24:27], a[160:163], v[52:55], v[24:27]
	v_mfma_f32_16x16x32_bf16 v[20:23], a[232:235], v[48:51], v[20:23]
	v_mfma_f32_16x16x32_bf16 v[28:31], a[232:235], v[52:55], v[28:31]
	v_mfma_f32_16x16x32_bf16 v[32:35], v[48:51], v[128:131], v[32:35]
	v_mfma_f32_16x16x32_bf16 v[36:39], v[52:55], v[128:131], v[36:39]
	v_mfma_f32_16x16x32_bf16 v[40:43], v[48:51], v[200:203], v[40:43]
	v_mfma_f32_16x16x32_bf16 v[44:47], v[52:55], v[200:203], v[44:47]
	ds_read_b128 v[48:51], v65 offset:6144
	ds_read_b128 v[52:55], v65 offset:24576
	s_waitcnt lgkmcnt(2)
	v_mfma_f32_16x16x32_bf16 v[0:3], a[20:23], v[56:59], v[0:3]
	v_mfma_f32_16x16x32_bf16 v[8:11], a[20:23], v[60:63], v[8:11]
	v_mfma_f32_16x16x32_bf16 v[4:7], a[92:95], v[56:59], v[4:7]
	v_mfma_f32_16x16x32_bf16 v[12:15], a[92:95], v[60:63], v[12:15]
	v_mfma_f32_16x16x32_bf16 v[16:19], a[164:167], v[56:59], v[16:19]
	v_mfma_f32_16x16x32_bf16 v[24:27], a[164:167], v[60:63], v[24:27]
	v_mfma_f32_16x16x32_bf16 v[20:23], a[236:239], v[56:59], v[20:23]
	v_mfma_f32_16x16x32_bf16 v[28:31], a[236:239], v[60:63], v[28:31]
	v_mfma_f32_16x16x32_bf16 v[32:35], v[56:59], v[132:135], v[32:35]
	v_mfma_f32_16x16x32_bf16 v[36:39], v[60:63], v[132:135], v[36:39]
	v_mfma_f32_16x16x32_bf16 v[40:43], v[56:59], v[204:207], v[40:43]
	v_mfma_f32_16x16x32_bf16 v[44:47], v[60:63], v[204:207], v[44:47]
	ds_read_b128 v[56:59], v65 offset:7168
	ds_read_b128 v[60:63], v65 offset:25600
	s_waitcnt vmcnt(0)
	v_mov_b32 v69, s28
	s_mov_b64 exec, 1
	buffer_store_dword v69, v68, s[4:7], s30 offen sc1
	s_mov_b64 exec, -1
	s_cmp_ge_u32 s28, 63
	s_cbranch_scc1 .gnopf_96
	s_add_u32 s37, s28, 2
	v_cmp_gt_u32 vcc, s37, v67
	s_cbranch_vccnz .gnopf2_97
	s_mov_b32 s29, 1
	s_waitcnt lgkmcnt(2)
	v_mfma_f32_16x16x32_bf16 v[0:3], a[24:27], v[48:51], v[0:3]
	s_add_u32 s17, s32, 0
	s_mov_b32 m0, s17
	s_add_u32 s18, s31, 0
	buffer_load_dwordx4 v64, s[4:7], s18 offen offset:0 lds
	v_mfma_f32_16x16x32_bf16 v[8:11], a[24:27], v[52:55], v[8:11]
	buffer_load_dwordx4 v64, s[4:7], s18 offen offset:1024 lds
	v_mfma_f32_16x16x32_bf16 v[4:7], a[96:99], v[48:51], v[4:7]
	buffer_load_dwordx4 v64, s[4:7], s18 offen offset:2048 lds
	v_mfma_f32_16x16x32_bf16 v[12:15], a[96:99], v[52:55], v[12:15]
	buffer_load_dwordx4 v64, s[4:7], s18 offen offset:3072 lds
	v_mfma_f32_16x16x32_bf16 v[16:19], a[168:171], v[48:51], v[16:19]
	s_add_u32 s17, s32, 4096
	s_mov_b32 m0, s17
	s_add_u32 s18, s31, 4096
	buffer_load_dwordx4 v64, s[4:7], s18 offen offset:0 lds
	v_mfma_f32_16x16x32_bf16 v[24:27], a[168:171], v[52:55], v[24:27]
	buffer_load_dwordx4 v64, s[4:7], s18 offen offset:1024 lds
	v_mfma_f32_16x16x32_bf16 v[20:23], a[240:243], v[48:51], v[20:23]
	buffer_load_dwordx4 v64, s[4:7], s18 offen offset:2048 lds
	v_mfma_f32_16x16x32_bf16 v[28:31], a[240:243], v[52:55], v[28:31]
	buffer_load_dwordx4 v64, s[4:7], s18 offen offset:3072 lds
	v_mfma_f32_16x16x32_bf16 v[32:35], v[48:51], v[136:139], v[32:35]
	s_add_u32 s17, s32, 8192
	s_mov_b32 m0, s17
	s_add_u32 s18, s31, 8192
	buffer_load_dwordx4 v64, s[4:7], s18 offen offset:0 lds
	s_add_u32 s31, s31, 36864
	s_sub_u32 s32, s44, s32
	v_mfma_f32_16x16x32_bf16 v[36:39], v[52:55], v[136:139], v[36:39]
	v_mfma_f32_16x16x32_bf16 v[40:43], v[48:51], v[208:211], v[40:43]
	v_mfma_f32_16x16x32_bf16 v[44:47], v[52:55], v[208:211], v[44:47]
	ds_read_b128 v[48:51], v65 offset:8192
	ds_read_b128 v[52:55], v65 offset:26624
	s_branch .gaft_98
.gnopf2_97:
	buffer_load_dword v67, v66, s[4:7], 0 offen sc1
.gnopf_96:
	s_waitcnt lgkmcnt(2)
	v_mfma_f32_16x16x32_bf16 v[0:3], a[24:27], v[48:51], v[0:3]
	v_mfma_f32_16x16x32_bf16 v[8:11], a[24:27], v[52:55], v[8:11]
	v_mfma_f32_16x16x32_bf16 v[4:7], a[96:99], v[48:51], v[4:7]
	v_mfma_f32_16x16x32_bf16 v[12:15], a[96:99], v[52:55], v[12:15]
	v_mfma_f32_16x16x32_bf16 v[16:19], a[168:171], v[48:51], v[16:19]
	v_mfma_f32_16x16x32_bf16 v[24:27], a[168:171], v[52:55], v[24:27]
	v_mfma_f32_16x16x32_bf16 v[20:23], a[240:243], v[48:51], v[20:23]
	v_mfma_f32_16x16x32_bf16 v[28:31], a[240:243], v[52:55], v[28:31]
	v_mfma_f32_16x16x32_bf16 v[32:35], v[48:51], v[136:139], v[32:35]
	v_mfma_f32_16x16x32_bf16 v[36:39], v[52:55], v[136:139], v[36:39]
	v_mfma_f32_16x16x32_bf16 v[40:43], v[48:51], v[208:211], v[40:43]
	v_mfma_f32_16x16x32_bf16 v[44:47], v[52:55], v[208:211], v[44:47]
	ds_read_b128 v[48:51], v65 offset:8192
	ds_read_b128 v[52:55], v65 offset:26624
.gaft_98:
	s_waitcnt lgkmcnt(2)
	v_mfma_f32_16x16x32_bf16 v[0:3], a[28:31], v[56:59], v[0:3]
	v_mfma_f32_16x16x32_bf16 v[8:11], a[28:31], v[60:63], v[8:11]
	v_mfma_f32_16x16x32_bf16 v[4:7], a[100:103], v[56:59], v[4:7]
	v_mfma_f32_16x16x32_bf16 v[12:15], a[100:103], v[60:63], v[12:15]
	v_mfma_f32_16x16x32_bf16 v[16:19], a[172:175], v[56:59], v[16:19]
	v_mfma_f32_16x16x32_bf16 v[24:27], a[172:175], v[60:63], v[24:27]
	v_mfma_f32_16x16x32_bf16 v[20:23], a[244:247], v[56:59], v[20:23]
	v_mfma_f32_16x16x32_bf16 v[28:31], a[244:247], v[60:63], v[28:31]
	v_mfma_f32_16x16x32_bf16 v[32:35], v[56:59], v[140:143], v[32:35]
	v_mfma_f32_16x16x32_bf16 v[36:39], v[60:63], v[140:143], v[36:39]
	v_mfma_f32_16x16x32_bf16 v[40:43], v[56:59], v[212:215], v[40:43]
	v_mfma_f32_16x16x32_bf16 v[44:47], v[60:63], v[212:215], v[44:47]
	ds_read_b128 v[56:59], v65 offset:9216
	ds_read_b128 v[60:63], v65 offset:27648
	s_waitcnt lgkmcnt(2)
	v_mfma_f32_16x16x32_bf16 v[0:3], a[32:35], v[48:51], v[0:3]
	v_mfma_f32_16x16x32_bf16 v[8:11], a[32:35], v[52:55], v[8:11]
	v_mfma_f32_16x16x32_bf16 v[4:7], a[104:107], v[48:51], v[4:7]
	v_mfma_f32_16x16x32_bf16 v[12:15], a[104:107], v[52:55], v[12:15]
	v_mfma_f32_16x16x32_bf16 v[16:19], a[176:179], v[48:51], v[16:19]
	v_mfma_f32_16x16x32_bf16 v[24:27], a[176:179], v[52:55], v[24:27]
	v_mfma_f32_16x16x32_bf16 v[20:23], a[248:251], v[48:51], v[20:23]
	v_mfma_f32_16x16x32_bf16 v[28:31], a[248:251], v[52:55], v[28:31]
	v_mfma_f32_16x16x32_bf16 v[32:35], v[48:51], v[144:147], v[32:35]
	v_mfma_f32_16x16x32_bf16 v[36:39], v[52:55], v[144:147], v[36:39]
	v_mfma_f32_16x16x32_bf16 v[40:43], v[48:51], v[216:219], v[40:43]
	v_mfma_f32_16x16x32_bf16 v[44:47], v[52:55], v[216:219], v[44:47]
	ds_read_b128 v[48:51], v65 offset:10240
	ds_read_b128 v[52:55], v65 offset:28672
	s_cmp_lg_u32 s29, 0
	s_cbranch_scc1 .gnopf_99
	s_cmp_ge_u32 s28, 63
	s_cbranch_scc1 .gnopf_99
	s_waitcnt vmcnt(0)
	s_add_u32 s37, s28, 2
	v_cmp_gt_u32 vcc, s37, v67
	s_cbranch_vccnz .gnopf2_100
	s_mov_b32 s29, 1
	s_waitcnt lgkmcnt(2)
	v_mfma_f32_16x16x32_bf16 v[0:3], a[36:39], v[56:59], v[0:3]
	s_add_u32 s17, s32, 0
	s_mov_b32 m0, s17
	s_add_u32 s18, s31, 0
	buffer_load_dwordx4 v64, s[4:7], s18 offen offset:0 lds
	v_mfma_f32_16x16x32_bf16 v[8:11], a[36:39], v[60:63], v[8:11]
	buffer_load_dwordx4 v64, s[4:7], s18 offen offset:1024 lds
	v_mfma_f32_16x16x32_bf16 v[4:7], a[108:111], v[56:59], v[4:7]
	buffer_load_dwordx4 v64, s[4:7], s18 offen offset:2048 lds
	v_mfma_f32_16x16x32_bf16 v[12:15], a[108:111], v[60:63], v[12:15]
	buffer_load_dwordx4 v64, s[4:7], s18 offen offset:3072 lds
	v_mfma_f32_16x16x32_bf16 v[16:19], a[180:183], v[56:59], v[16:19]
	s_add_u32 s17, s32, 4096
	s_mov_b32 m0, s17
	s_add_u32 s18, s31, 4096
	buffer_load_dwordx4 v64, s[4:7], s18 offen offset:0 lds
	v_mfma_f32_16x16x32_bf16 v[24:27], a[180:183], v[60:63], v[24:27]
	buffer_load_dwordx4 v64, s[4:7], s18 offen offset:1024 lds
	v_mfma_f32_16x16x32_bf16 v[20:23], a[252:255], v[56:59], v[20:23]
	buffer_load_dwordx4 v64, s[4:7], s18 offen offset:2048 lds
	v_mfma_f32_16x16x32_bf16 v[28:31], a[252:255], v[60:63], v[28:31]
	buffer_load_dwordx4 v64, s[4:7], s18 offen offset:3072 lds
	v_mfma_f32_16x16x32_bf16 v[32:35], v[56:59], v[148:151], v[32:35]
	s_add_u32 s17, s32, 8192
	s_mov_b32 m0, s17
	s_add_u32 s18, s31, 8192
	buffer_load_dwordx4 v64, s[4:7], s18 offen offset:0 lds
	s_add_u32 s31, s31, 36864
	s_sub_u32 s32, s44, s32
	v_mfma_f32_16x16x32_bf16 v[36:39], v[60:63], v[148:151], v[36:39]
	v_mfma_f32_16x16x32_bf16 v[40:43], v[56:59], v[220:223], v[40:43]
	v_mfma_f32_16x16x32_bf16 v[44:47], v[60:63], v[220:223], v[44:47]
	ds_read_b128 v[56:59], v65 offset:11264
	ds_read_b128 v[60:63], v65 offset:29696
	s_branch .gaft_101
.gnopf2_100:
	buffer_load_dword v67, v66, s[4:7], 0 offen sc1
.gnopf_99:
	s_waitcnt lgkmcnt(2)
	v_mfma_f32_16x16x32_bf16 v[0:3], a[36:39], v[56:59], v[0:3]
	v_mfma_f32_16x16x32_bf16 v[8:11], a[36:39], v[60:63], v[8:11]
	v_mfma_f32_16x16x32_bf16 v[4:7], a[108:111], v[56:59], v[4:7]
	v_mfma_f32_16x16x32_bf16 v[12:15], a[108:111], v[60:63], v[12:15]
	v_mfma_f32_16x16x32_bf16 v[16:19], a[180:183], v[56:59], v[16:19]
	v_mfma_f32_16x16x32_bf16 v[24:27], a[180:183], v[60:63], v[24:27]
	v_mfma_f32_16x16x32_bf16 v[20:23], a[252:255], v[56:59], v[20:23]
	v_mfma_f32_16x16x32_bf16 v[28:31], a[252:255], v[60:63], v[28:31]
	v_mfma_f32_16x16x32_bf16 v[32:35], v[56:59], v[148:151], v[32:35]
	v_mfma_f32_16x16x32_bf16 v[36:39], v[60:63], v[148:151], v[36:39]
	v_mfma_f32_16x16x32_bf16 v[40:43], v[56:59], v[220:223], v[40:43]
	v_mfma_f32_16x16x32_bf16 v[44:47], v[60:63], v[220:223], v[44:47]
	ds_read_b128 v[56:59], v65 offset:11264
	ds_read_b128 v[60:63], v65 offset:29696
.gaft_101:
	s_waitcnt lgkmcnt(2)
	v_mfma_f32_16x16x32_bf16 v[0:3], a[40:43], v[48:51], v[0:3]
	v_mfma_f32_16x16x32_bf16 v[8:11], a[40:43], v[52:55], v[8:11]
	v_mfma_f32_16x16x32_bf16 v[4:7], a[112:115], v[48:51], v[4:7]
	v_mfma_f32_16x16x32_bf16 v[12:15], a[112:115], v[52:55], v[12:15]
	v_mfma_f32_16x16x32_bf16 v[16:19], a[184:187], v[48:51], v[16:19]
	v_mfma_f32_16x16x32_bf16 v[24:27], a[184:187], v[52:55], v[24:27]
	v_mfma_f32_16x16x32_bf16 v[20:23], v[80:83], v[48:51], v[20:23]
	v_mfma_f32_16x16x32_bf16 v[28:31], v[80:83], v[52:55], v[28:31]
	v_mfma_f32_16x16x32_bf16 v[32:35], v[48:51], v[152:155], v[32:35]
	v_mfma_f32_16x16x32_bf16 v[36:39], v[52:55], v[152:155], v[36:39]
	v_mfma_f32_16x16x32_bf16 v[40:43], v[48:51], v[224:227], v[40:43]
	v_mfma_f32_16x16x32_bf16 v[44:47], v[52:55], v[224:227], v[44:47]
	ds_read_b128 v[48:51], v65 offset:12288
	ds_read_b128 v[52:55], v65 offset:30720
	s_waitcnt lgkmcnt(2)
	v_mfma_f32_16x16x32_bf16 v[0:3], a[44:47], v[56:59], v[0:3]
	v_mfma_f32_16x16x32_bf16 v[8:11], a[44:47], v[60:63], v[8:11]
	v_mfma_f32_16x16x32_bf16 v[4:7], a[116:119], v[56:59], v[4:7]
	v_mfma_f32_16x16x32_bf16 v[12:15], a[116:119], v[60:63], v[12:15]
	v_mfma_f32_16x16x32_bf16 v[16:19], a[188:191], v[56:59], v[16:19]
	v_mfma_f32_16x16x32_bf16 v[24:27], a[188:191], v[60:63], v[24:27]
	v_mfma_f32_16x16x32_bf16 v[20:23], v[84:87], v[56:59], v[20:23]
	v_mfma_f32_16x16x32_bf16 v[28:31], v[84:87], v[60:63], v[28:31]
	v_mfma_f32_16x16x32_bf16 v[32:35], v[56:59], v[156:159], v[32:35]
	v_mfma_f32_16x16x32_bf16 v[36:39], v[60:63], v[156:159], v[36:39]
	v_mfma_f32_16x16x32_bf16 v[40:43], v[56:59], v[228:231], v[40:43]
	v_mfma_f32_16x16x32_bf16 v[44:47], v[60:63], v[228:231], v[44:47]
	ds_read_b128 v[56:59], v65 offset:13312
	ds_read_b128 v[60:63], v65 offset:31744
	s_waitcnt lgkmcnt(2)
	v_mfma_f32_16x16x32_bf16 v[0:3], a[48:51], v[48:51], v[0:3]
	v_mfma_f32_16x16x32_bf16 v[8:11], a[48:51], v[52:55], v[8:11]
	v_mfma_f32_16x16x32_bf16 v[4:7], a[120:123], v[48:51], v[4:7]
	v_mfma_f32_16x16x32_bf16 v[12:15], a[120:123], v[52:55], v[12:15]
	v_mfma_f32_16x16x32_bf16 v[16:19], a[192:195], v[48:51], v[16:19]
	v_mfma_f32_16x16x32_bf16 v[24:27], a[192:195], v[52:55], v[24:27]
	v_mfma_f32_16x16x32_bf16 v[20:23], v[88:91], v[48:51], v[20:23]
	v_mfma_f32_16x16x32_bf16 v[28:31], v[88:91], v[52:55], v[28:31]
	v_mfma_f32_16x16x32_bf16 v[32:35], v[48:51], v[160:163], v[32:35]
	v_mfma_f32_16x16x32_bf16 v[36:39], v[52:55], v[160:163], v[36:39]
	v_mfma_f32_16x16x32_bf16 v[40:43], v[48:51], v[232:235], v[40:43]
	v_mfma_f32_16x16x32_bf16 v[44:47], v[52:55], v[232:235], v[44:47]
	ds_read_b128 v[48:51], v65 offset:14336
	ds_read_b128 v[52:55], v65 offset:32768
	s_cmp_lg_u32 s29, 0
	s_cbranch_scc1 .gnopf_102
	s_cmp_ge_u32 s28, 63
	s_cbranch_scc1 .gnopf_102
	s_waitcnt vmcnt(0)
	s_add_u32 s37, s28, 2
	v_cmp_gt_u32 vcc, s37, v67
	s_cbranch_vccnz .gnopf2_103
	s_mov_b32 s29, 1
	s_waitcnt lgkmcnt(2)
	v_mfma_f32_16x16x32_bf16 v[0:3], a[52:55], v[56:59], v[0:3]
	s_add_u32 s17, s32, 0
	s_mov_b32 m0, s17
	s_add_u32 s18, s31, 0
	buffer_load_dwordx4 v64, s[4:7], s18 offen offset:0 lds
	v_mfma_f32_16x16x32_bf16 v[8:11], a[52:55], v[60:63], v[8:11]
	buffer_load_dwordx4 v64, s[4:7], s18 offen offset:1024 lds
	v_mfma_f32_16x16x32_bf16 v[4:7], a[124:127], v[56:59], v[4:7]
	buffer_load_dwordx4 v64, s[4:7], s18 offen offset:2048 lds
	v_mfma_f32_16x16x32_bf16 v[12:15], a[124:127], v[60:63], v[12:15]
	buffer_load_dwordx4 v64, s[4:7], s18 offen offset:3072 lds
	v_mfma_f32_16x16x32_bf16 v[16:19], a[196:199], v[56:59], v[16:19]
	s_add_u32 s17, s32, 4096
	s_mov_b32 m0, s17
	s_add_u32 s18, s31, 4096
	buffer_load_dwordx4 v64, s[4:7], s18 offen offset:0 lds
	v_mfma_f32_16x16x32_bf16 v[24:27], a[196:199], v[60:63], v[24:27]
	buffer_load_dwordx4 v64, s[4:7], s18 offen offset:1024 lds
	v_mfma_f32_16x16x32_bf16 v[20:23], v[92:95], v[56:59], v[20:23]
	buffer_load_dwordx4 v64, s[4:7], s18 offen offset:2048 lds
	v_mfma_f32_16x16x32_bf16 v[28:31], v[92:95], v[60:63], v[28:31]
	buffer_load_dwordx4 v64, s[4:7], s18 offen offset:3072 lds
	v_mfma_f32_16x16x32_bf16 v[32:35], v[56:59], v[164:167], v[32:35]
	s_add_u32 s17, s32, 8192
	s_mov_b32 m0, s17
	s_add_u32 s18, s31, 8192
	buffer_load_dwordx4 v64, s[4:7], s18 offen offset:0 lds
	s_add_u32 s31, s31, 36864
	s_sub_u32 s32, s44, s32
	v_mfma_f32_16x16x32_bf16 v[36:39], v[60:63], v[164:167], v[36:39]
	v_mfma_f32_16x16x32_bf16 v[40:43], v[56:59], v[236:239], v[40:43]
	v_mfma_f32_16x16x32_bf16 v[44:47], v[60:63], v[236:239], v[44:47]
	ds_read_b128 v[56:59], v65 offset:15360
	ds_read_b128 v[60:63], v65 offset:33792
	s_branch .gaft_104
.gnopf2_103:
	buffer_load_dword v67, v66, s[4:7], 0 offen sc1
.gnopf_102:
	s_waitcnt lgkmcnt(2)
	v_mfma_f32_16x16x32_bf16 v[0:3], a[52:55], v[56:59], v[0:3]
	v_mfma_f32_16x16x32_bf16 v[8:11], a[52:55], v[60:63], v[8:11]
	v_mfma_f32_16x16x32_bf16 v[4:7], a[124:127], v[56:59], v[4:7]
	v_mfma_f32_16x16x32_bf16 v[12:15], a[124:127], v[60:63], v[12:15]
	v_mfma_f32_16x16x32_bf16 v[16:19], a[196:199], v[56:59], v[16:19]
	v_mfma_f32_16x16x32_bf16 v[24:27], a[196:199], v[60:63], v[24:27]
	v_mfma_f32_16x16x32_bf16 v[20:23], v[92:95], v[56:59], v[20:23]
	v_mfma_f32_16x16x32_bf16 v[28:31], v[92:95], v[60:63], v[28:31]
	v_mfma_f32_16x16x32_bf16 v[32:35], v[56:59], v[164:167], v[32:35]
	v_mfma_f32_16x16x32_bf16 v[36:39], v[60:63], v[164:167], v[36:39]
	v_mfma_f32_16x16x32_bf16 v[40:43], v[56:59], v[236:239], v[40:43]
	v_mfma_f32_16x16x32_bf16 v[44:47], v[60:63], v[236:239], v[44:47]
	ds_read_b128 v[56:59], v65 offset:15360
	ds_read_b128 v[60:63], v65 offset:33792
.gaft_104:
	s_waitcnt lgkmcnt(2)
	v_mfma_f32_16x16x32_bf16 v[0:3], a[56:59], v[48:51], v[0:3]
	v_mfma_f32_16x16x32_bf16 v[8:11], a[56:59], v[52:55], v[8:11]
	v_mfma_f32_16x16x32_bf16 v[4:7], a[128:131], v[48:51], v[4:7]
	v_mfma_f32_16x16x32_bf16 v[12:15], a[128:131], v[52:55], v[12:15]
	v_mfma_f32_16x16x32_bf16 v[16:19], a[200:203], v[48:51], v[16:19]
	v_mfma_f32_16x16x32_bf16 v[24:27], a[200:203], v[52:55], v[24:27]
	v_mfma_f32_16x16x32_bf16 v[20:23], v[96:99], v[48:51], v[20:23]
	v_mfma_f32_16x16x32_bf16 v[28:31], v[96:99], v[52:55], v[28:31]
	v_mfma_f32_16x16x32_bf16 v[32:35], v[48:51], v[168:171], v[32:35]
	v_mfma_f32_16x16x32_bf16 v[36:39], v[52:55], v[168:171], v[36:39]
	v_mfma_f32_16x16x32_bf16 v[40:43], v[48:51], v[240:243], v[40:43]
	v_mfma_f32_16x16x32_bf16 v[44:47], v[52:55], v[240:243], v[44:47]
	ds_read_b128 v[48:51], v65 offset:16384
	ds_read_b128 v[52:55], v65 offset:34816
	s_waitcnt lgkmcnt(2)
	v_mfma_f32_16x16x32_bf16 v[0:3], a[60:63], v[56:59], v[0:3]
	v_mfma_f32_16x16x32_bf16 v[8:11], a[60:63], v[60:63], v[8:11]
	v_mfma_f32_16x16x32_bf16 v[4:7], a[132:135], v[56:59], v[4:7]
	v_mfma_f32_16x16x32_bf16 v[12:15], a[132:135], v[60:63], v[12:15]
	v_mfma_f32_16x16x32_bf16 v[16:19], a[204:207], v[56:59], v[16:19]
	v_mfma_f32_16x16x32_bf16 v[24:27], a[204:207], v[60:63], v[24:27]
	v_mfma_f32_16x16x32_bf16 v[20:23], v[100:103], v[56:59], v[20:23]
	v_mfma_f32_16x16x32_bf16 v[28:31], v[100:103], v[60:63], v[28:31]
	v_mfma_f32_16x16x32_bf16 v[32:35], v[56:59], v[172:175], v[32:35]
	v_mfma_f32_16x16x32_bf16 v[36:39], v[60:63], v[172:175], v[36:39]
	v_mfma_f32_16x16x32_bf16 v[40:43], v[56:59], v[244:247], v[40:43]
	v_mfma_f32_16x16x32_bf16 v[44:47], v[60:63], v[244:247], v[44:47]
	ds_read_b128 v[56:59], v65 offset:17408
	ds_read_b128 v[60:63], v65 offset:35840
	s_waitcnt lgkmcnt(2)
	v_mfma_f32_16x16x32_bf16 v[0:3], a[64:67], v[48:51], v[0:3]
	v_mfma_f32_16x16x32_bf16 v[4:7], a[136:139], v[48:51], v[4:7]
	v_mfma_f32_16x16x32_bf16 v[8:11], a[64:67], v[52:55], v[8:11]
	v_mfma_f32_16x16x32_bf16 v[12:15], a[136:139], v[52:55], v[12:15]
	v_mfma_f32_16x16x32_bf16 v[16:19], a[208:211], v[48:51], v[16:19]
	v_mfma_f32_16x16x32_bf16 v[20:23], v[104:107], v[48:51], v[20:23]
	v_mfma_f32_16x16x32_bf16 v[24:27], a[208:211], v[52:55], v[24:27]
	v_mfma_f32_16x16x32_bf16 v[28:31], v[104:107], v[52:55], v[28:31]
	s_waitcnt lgkmcnt(0)
	v_mfma_f32_16x16x32_bf16 v[0:3], a[68:71], v[56:59], v[0:3]
	v_mfma_f32_16x16x32_bf16 v[4:7], a[140:143], v[56:59], v[4:7]
	v_mfma_f32_16x16x32_bf16 v[32:35], v[48:51], v[176:179], v[32:35]
	s_nop 5
	v_cvt_pk_bf16_f32 v0, v0, v1
	v_cvt_pk_bf16_f32 v1, v2, v3
	v_cvt_pk_bf16_f32 v2, v4, v5
	v_mfma_f32_16x16x32_bf16 v[36:39], v[52:55], v[176:179], v[36:39]
	v_cvt_pk_bf16_f32 v3, v6, v7
	s_add_u32 s35, s34, 0
	buffer_store_dwordx4 v[0:3], v64, s[4:7], s35 offen sc1
	v_mfma_f32_16x16x32_bf16 v[8:11], a[68:71], v[60:63], v[8:11]
	v_mfma_f32_16x16x32_bf16 v[12:15], a[140:143], v[60:63], v[12:15]
	v_mfma_f32_16x16x32_bf16 v[40:43], v[48:51], v[248:251], v[40:43]
	s_nop 5
	v_cvt_pk_bf16_f32 v8, v8, v9
	v_cvt_pk_bf16_f32 v9, v10, v11
	v_cvt_pk_bf16_f32 v10, v12, v13
	v_mfma_f32_16x16x32_bf16 v[44:47], v[52:55], v[248:251], v[44:47]
	v_cvt_pk_bf16_f32 v11, v14, v15
	s_add_u32 s35, s34, 4096
	buffer_store_dwordx4 v[8:11], v64, s[4:7], s35 offen sc1
	v_mfma_f32_16x16x32_bf16 v[16:19], a[212:215], v[56:59], v[16:19]
	v_mfma_f32_16x16x32_bf16 v[20:23], v[108:111], v[56:59], v[20:23]
	v_mfma_f32_16x16x32_bf16 v[24:27], a[212:215], v[60:63], v[24:27]
	s_nop 5
	v_cvt_pk_bf16_f32 v16, v16, v17
	v_cvt_pk_bf16_f32 v17, v18, v19
	v_cvt_pk_bf16_f32 v18, v20, v21
	v_mfma_f32_16x16x32_bf16 v[28:31], v[108:111], v[60:63], v[28:31]
	v_cvt_pk_bf16_f32 v19, v22, v23
	s_add_u32 s35, s34, 8192
	buffer_store_dwordx4 v[16:19], v64, s[4:7], s35 offen sc1
	v_mfma_f32_16x16x32_bf16 v[32:35], v[56:59], v[180:183], v[32:35]
	v_cvt_pk_bf16_f32 v24, v24, v25
	v_cvt_pk_bf16_f32 v25, v26, v27
	s_nop 1
	v_cvt_pk_bf16_f32 v26, v28, v29
	v_mfma_f32_16x16x32_bf16 v[36:39], v[60:63], v[180:183], v[36:39]
	v_cvt_pk_bf16_f32 v27, v30, v31
	s_add_u32 s35, s34, 12288
	buffer_store_dwordx4 v[24:27], v64, s[4:7], s35 offen sc1
	v_mfma_f32_16x16x32_bf16 v[40:43], v[56:59], v[252:255], v[40:43]
	v_cvt_pk_bf16_f32 v32, v32, v33
	v_cvt_pk_bf16_f32 v33, v34, v35
	s_nop 1
	v_cvt_pk_bf16_f32 v34, v36, v37
	v_mfma_f32_16x16x32_bf16 v[44:47], v[60:63], v[252:255], v[44:47]
	v_cvt_pk_bf16_f32 v35, v38, v39
	s_lshl_b32 s17, s15, 10
	s_add_u32 s35, s34, s17
	s_add_u32 s35, s35, 16384
	buffer_store_dwordx4 v[32:35], v64, s[4:7], s35 offen offset:0 sc1
	v_cvt_pk_bf16_f32 v40, v40, v41
	v_cvt_pk_bf16_f32 v41, v42, v43
	s_nop 0
	v_cvt_pk_bf16_f32 v42, v44, v45
	v_cvt_pk_bf16_f32 v43, v46, v47
	buffer_store_dwordx4 v[40:43], v64, s[4:7], s35 offen offset:1024 sc1
	s_add_u32 s34, s34, 786432
	s_add_u32 s28, s28, 1
	s_cmp_lg_u32 s29, 0
	s_cbranch_scc1 .gloop_91
	s_cmp_ge_u32 s28, 64
	s_cbranch_scc1 .gnofin_106
	s_waitcnt vmcnt(6)
	s_add_u32 s37, s28, 1
	v_cmp_gt_u32 vcc, s37, v67
	s_cbranch_vccnz .gnofin_106
	s_add_u32 s17, s32, 0
	s_mov_b32 m0, s17
	s_add_u32 s18, s31, 0
	buffer_load_dwordx4 v64, s[4:7], s18 offen offset:0 lds
	buffer_load_dwordx4 v64, s[4:7], s18 offen offset:1024 lds
	buffer_load_dwordx4 v64, s[4:7], s18 offen offset:2048 lds
	buffer_load_dwordx4 v64, s[4:7], s18 offen offset:3072 lds
	s_add_u32 s17, s32, 4096
	s_mov_b32 m0, s17
	s_add_u32 s18, s31, 4096
	buffer_load_dwordx4 v64, s[4:7], s18 offen offset:0 lds
	buffer_load_dwordx4 v64, s[4:7], s18 offen offset:1024 lds
	buffer_load_dwordx4 v64, s[4:7], s18 offen offset:2048 lds
	buffer_load_dwordx4 v64, s[4:7], s18 offen offset:3072 lds
	s_add_u32 s17, s32, 8192
	s_mov_b32 m0, s17
	s_add_u32 s18, s31, 8192
	buffer_load_dwordx4 v64, s[4:7], s18 offen offset:0 lds
	s_add_u32 s31, s31, 36864
	s_sub_u32 s32, s44, s32
	s_waitcnt vmcnt(9)
	v_mov_b32 v69, s28
	s_mov_b64 exec, 1
	buffer_store_dword v69, v68, s[4:7], s30 offen sc1
	s_mov_b64 exec, -1
	s_waitcnt vmcnt(1)
	s_branch .ggo_93
.gnofin_106:
	s_waitcnt vmcnt(0)
	v_mov_b32 v69, s28
	s_mov_b64 exec, 1
	buffer_store_dword v69, v68, s[4:7], s30 offen sc1
	s_mov_b64 exec, -1
	s_cmp_lt_u32 s28, 64
	s_cbranch_scc1 .gloop_91
	s_branch L_END
L_B1_CE:
.p2align 6
L_A1:
	v_and_b32 v1, 63, v0
	s_getpc_b64 s[18:19]
.ct_107:
	s_sub_u32 s18, s18, .ct_107-L_A1
	s_subb_u32 s19, s19, 0
	v_lshlrev_b32 v2, 7, v1
	s_lshl_b32 s17, s15, 13
	v_add_u32 v2, s17, v2
	s_mov_b32 s17, L_A1_CE-L_A1-4
	v_min_u32 v2, s17, v2
	global_load_dword v100, v2, s[18:19]
	v_and_b32 v79, 63, v0
	v_mov_b32 v75, v0
	v_and_b32 v78, 15, v79
	v_lshrrev_b32 v77, 4, v79
	v_and_b32 v76, 7, v79
	s_mul_i32 s38, s26, 43
	s_lshr_b32 s38, s38, 7
	s_mul_i32 s17, s38, 3
	s_sub_u32 s17, s26, s17
	s_mul_i32 s39, s17, 12
	s_mul_i32 s17, s15, 3
	s_add_u32 s39, s39, s17
	v_lshrrev_b32 v68, 1, v79
	v_mul_u32_u24 v68, 3456, v68
	v_and_b32 v72, 1, v79
	v_lshlrev_b32 v72, 4, v72
	v_add_u32 v68, v68, v72
	v_lshrrev_b32 v69, 3, v79
	v_mul_u32_u24 v69, 3456, v69
	v_mul_u32_u24 v72, 36, v76
	v_add_u32 v69, v69, v72
	s_add_u32 s50, s39, 0
	s_mul_i32 s47, s38, 1152
	s_mul_i32 s17, s50, 36
	s_sub_u32 s18, s50, 32
	s_mul_i32 s18, s18, 288
	s_add_u32 s18, s18, 32
	s_cmp_ge_u32 s50, 32
	s_cselect_b32 s17, s18, s17
	s_add_u32 s47, s47, s17
	s_add_u32 s51, s39, 1
	s_mul_i32 s48, s38, 1152
	s_mul_i32 s17, s51, 36
	s_sub_u32 s18, s51, 32
	s_mul_i32 s18, s18, 288
	s_add_u32 s18, s18, 32
	s_cmp_ge_u32 s51, 32
	s_cselect_b32 s17, s18, s17
	s_add_u32 s48, s48, s17
	s_add_u32 s52, s39, 2
	s_mul_i32 s49, s38, 1152
	s_mul_i32 s17, s52, 36
	s_sub_u32 s18, s52, 32
	s_mul_i32 s18, s18, 288
	s_add_u32 s18, s18, 32
	s_cmp_ge_u32 s52, 32
	s_cselect_b32 s17, s18, s17
	s_add_u32 s49, s49, s17
	s_load_dwordx2 s[22:23], s[0:1], 8
	s_waitcnt lgkmcnt(0)
	s_mov_b32 s8, s22
	s_and_b32 s9, s23, 0xffff
	s_mov_b32 s10, 0x1e6000
	s_mov_b32 s11, 0x00020000
	v_lshrrev_b32 v72, 2, v78
	v_lshlrev_b32 v73, 2, v77
	v_add_u32 v72, v72, v73
	v_lshlrev_b32 v72, 5, v72
	v_and_b32 v73, 3, v78
	v_lshlrev_b32 v73, 3, v73
	v_add_u32 v72, v72, v73
	s_mul_i32 s17, s15, 36864
	v_add_u32 v70, s17, v72
	s_mul_i32 s63, s15, 36864
	s_add_u32 s62, s47, 0
	s_cmp_ge_u32 s50, 32
	s_cbranch_scc1 .a1lo_108
	s_mov_b32 m0, s63
	s_nop 0
	buffer_load_dwordx4 v68, s[8:11], s62 offen lds
	s_branch .a1en_109
.a1lo_108:
	s_mov_b32 m0, s63
	s_nop 0
	buffer_load_dword v69, s[8:11], s62 offen lds
	s_add_u32 s62, s62, 27648
	s_add_u32 s63, s63, 256
	s_mov_b32 m0, s63
	s_nop 0
	buffer_load_dword v69, s[8:11], s62 offen lds
	s_add_u32 s62, s62, 27648
	s_add_u32 s63, s63, 256
	s_mov_b32 m0, s63
	s_nop 0
	buffer_load_dword v69, s[8:11], s62 offen lds
	s_add_u32 s62, s62, 27648
	s_add_u32 s63, s63, 256
	s_mov_b32 m0, s63
	s_nop 0
	buffer_load_dword v69, s[8:11], s62 offen lds
.a1en_109:
	s_mul_i32 s63, s15, 36864
	s_add_u32 s63, s63, 1024
	s_add_u32 s62, s48, 0
	s_cmp_ge_u32 s51, 32
	s_cbranch_scc1 .a1lo_110
	s_mov_b32 m0, s63
	s_nop 0
	buffer_load_dwordx4 v68, s[8:11], s62 offen lds
	s_branch .a1en_111
.a1lo_110:
	s_mov_b32 m0, s63
	s_nop 0
	buffer_load_dword v69, s[8:11], s62 offen lds
	s_add_u32 s62, s62, 27648
	s_add_u32 s63, s63, 256
	s_mov_b32 m0, s63
	s_nop 0
	buffer_load_dword v69, s[8:11], s62 offen lds
	s_add_u32 s62, s62, 27648
	s_add_u32 s63, s63, 256
	s_mov_b32 m0, s63
	s_nop 0
	buffer_load_dword v69, s[8:11], s62 offen lds
	s_add_u32 s62, s62, 27648
	s_add_u32 s63, s63, 256
	s_mov_b32 m0, s63
	s_nop 0
	buffer_load_dword v69, s[8:11], s62 offen lds
.a1en_111:
	s_mul_i32 s63, s15, 36864
	s_add_u32 s63, s63, 2048
	s_add_u32 s62, s49, 0
	s_cmp_ge_u32 s52, 32
	s_cbranch_scc1 .a1lo_112
	s_mov_b32 m0, s63
	s_nop 0
	buffer_load_dwordx4 v68, s[8:11], s62 offen lds
	s_branch .a1en_113
.a1lo_112:
	s_mov_b32 m0, s63
	s_nop 0
	buffer_load_dword v69, s[8:11], s62 offen lds
	s_add_u32 s62, s62, 27648
	s_add_u32 s63, s63, 256
	s_mov_b32 m0, s63
	s_nop 0
	buffer_load_dword v69, s[8:11], s62 offen lds
	s_add_u32 s62, s62, 27648
	s_add_u32 s63, s63, 256
	s_mov_b32 m0, s63
	s_nop 0
	buffer_load_dword v69, s[8:11], s62 offen lds
	s_add_u32 s62, s62, 27648
	s_add_u32 s63, s63, 256
	s_mov_b32 m0, s63
	s_nop 0
	buffer_load_dword v69, s[8:11], s62 offen lds
.a1en_113:
	s_mul_i32 s63, s15, 36864
	s_add_u32 s63, s63, 3072
	s_add_u32 s62, s47, 110592
	s_cmp_ge_u32 s50, 32
	s_cbranch_scc1 .a1lo_114
	s_mov_b32 m0, s63
	s_nop 0
	buffer_load_dwordx4 v68, s[8:11], s62 offen lds
	s_branch .a1en_115
.a1lo_114:
	s_mov_b32 m0, s63
	s_nop 0
	buffer_load_dword v69, s[8:11], s62 offen lds
	s_add_u32 s62, s62, 27648
	s_add_u32 s63, s63, 256
	s_mov_b32 m0, s63
	s_nop 0
	buffer_load_dword v69, s[8:11], s62 offen lds
	s_add_u32 s62, s62, 27648
	s_add_u32 s63, s63, 256
	s_mov_b32 m0, s63
	s_nop 0
	buffer_load_dword v69, s[8:11], s62 offen lds
	s_add_u32 s62, s62, 27648
	s_add_u32 s63, s63, 256
	s_mov_b32 m0, s63
	s_nop 0
	buffer_load_dword v69, s[8:11], s62 offen lds
.a1en_115:
	s_mul_i32 s63, s15, 36864
	s_add_u32 s63, s63, 4096
	s_add_u32 s62, s48, 110592
	s_cmp_ge_u32 s51, 32
	s_cbranch_scc1 .a1lo_116
	s_mov_b32 m0, s63
	s_nop 0
	buffer_load_dwordx4 v68, s[8:11], s62 offen lds
	s_branch .a1en_117
.a1lo_116:
	s_mov_b32 m0, s63
	s_nop 0
	buffer_load_dword v69, s[8:11], s62 offen lds
	s_add_u32 s62, s62, 27648
	s_add_u32 s63, s63, 256
	s_mov_b32 m0, s63
	s_nop 0
	buffer_load_dword v69, s[8:11], s62 offen lds
	s_add_u32 s62, s62, 27648
	s_add_u32 s63, s63, 256
	s_mov_b32 m0, s63
	s_nop 0
	buffer_load_dword v69, s[8:11], s62 offen lds
	s_add_u32 s62, s62, 27648
	s_add_u32 s63, s63, 256
	s_mov_b32 m0, s63
	s_nop 0
	buffer_load_dword v69, s[8:11], s62 offen lds
.a1en_117:
	s_mul_i32 s63, s15, 36864
	s_add_u32 s63, s63, 5120
	s_add_u32 s62, s49, 110592
	s_cmp_ge_u32 s52, 32
	s_cbranch_scc1 .a1lo_118
	s_mov_b32 m0, s63
	s_nop 0
	buffer_load_dwordx4 v68, s[8:11], s62 offen lds
	s_branch .a1en_119
.a1lo_118:
	s_mov_b32 m0, s63
	s_nop 0
	buffer_load_dword v69, s[8:11], s62 offen lds
	s_add_u32 s62, s62, 27648
	s_add_u32 s63, s63, 256
	s_mov_b32 m0, s63
	s_nop 0
	buffer_load_dword v69, s[8:11], s62 offen lds
	s_add_u32 s62, s62, 27648
	s_add_u32 s63, s63, 256
	s_mov_b32 m0, s63
	s_nop 0
	buffer_load_dword v69, s[8:11], s62 offen lds
	s_add_u32 s62, s62, 27648
	s_add_u32 s63, s63, 256
	s_mov_b32 m0, s63
	s_nop 0
	buffer_load_dword v69, s[8:11], s62 offen lds
.a1en_119:
	s_mul_i32 s63, s15, 36864
	s_add_u32 s63, s63, 6144
	s_add_u32 s62, s47, 221184
	s_cmp_ge_u32 s50, 32
	s_cbranch_scc1 .a1lo_120
	s_mov_b32 m0, s63
	s_nop 0
	buffer_load_dwordx4 v68, s[8:11], s62 offen lds
	s_branch .a1en_121
.a1lo_120:
	s_mov_b32 m0, s63
	s_nop 0
	buffer_load_dword v69, s[8:11], s62 offen lds
	s_add_u32 s62, s62, 27648
	s_add_u32 s63, s63, 256
	s_mov_b32 m0, s63
	s_nop 0
	buffer_load_dword v69, s[8:11], s62 offen lds
	s_add_u32 s62, s62, 27648
	s_add_u32 s63, s63, 256
	s_mov_b32 m0, s63
	s_nop 0
	buffer_load_dword v69, s[8:11], s62 offen lds
	s_add_u32 s62, s62, 27648
	s_add_u32 s63, s63, 256
	s_mov_b32 m0, s63
	s_nop 0
	buffer_load_dword v69, s[8:11], s62 offen lds
.a1en_121:
	s_mul_i32 s63, s15, 36864
	s_add_u32 s63, s63, 7168
	s_add_u32 s62, s48, 221184
	s_cmp_ge_u32 s51, 32
	s_cbranch_scc1 .a1lo_122
	s_mov_b32 m0, s63
	s_nop 0
	buffer_load_dwordx4 v68, s[8:11], s62 offen lds
	s_branch .a1en_123
.a1lo_122:
	s_mov_b32 m0, s63
	s_nop 0
	buffer_load_dword v69, s[8:11], s62 offen lds
	s_add_u32 s62, s62, 27648
	s_add_u32 s63, s63, 256
	s_mov_b32 m0, s63
	s_nop 0
	buffer_load_dword v69, s[8:11], s62 offen lds
	s_add_u32 s62, s62, 27648
	s_add_u32 s63, s63, 256
	s_mov_b32 m0, s63
	s_nop 0
	buffer_load_dword v69, s[8:11], s62 offen lds
	s_add_u32 s62, s62, 27648
	s_add_u32 s63, s63, 256
	s_mov_b32 m0, s63
	s_nop 0
	buffer_load_dword v69, s[8:11], s62 offen lds
.a1en_123:
	s_mul_i32 s63, s15, 36864
	s_add_u32 s63, s63, 8192
	s_add_u32 s62, s49, 221184
	s_cmp_ge_u32 s52, 32
	s_cbranch_scc1 .a1lo_124
	s_mov_b32 m0, s63
	s_nop 0
	buffer_load_dwordx4 v68, s[8:11], s62 offen lds
	s_branch .a1en_125
.a1lo_124:
	s_mov_b32 m0, s63
	s_nop 0
	buffer_load_dword v69, s[8:11], s62 offen lds
	s_add_u32 s62, s62, 27648
	s_add_u32 s63, s63, 256
	s_mov_b32 m0, s63
	s_nop 0
	buffer_load_dword v69, s[8:11], s62 offen lds
	s_add_u32 s62, s62, 27648
	s_add_u32 s63, s63, 256
	s_mov_b32 m0, s63
	s_nop 0
	buffer_load_dword v69, s[8:11], s62 offen lds
	s_add_u32 s62, s62, 27648
	s_add_u32 s63, s63, 256
	s_mov_b32 m0, s63
	s_nop 0
	buffer_load_dword v69, s[8:11], s62 offen lds
.a1en_125:
	s_mul_i32 s63, s15, 36864
	s_add_u32 s63, s63, 9216
	s_add_u32 s62, s47, 331776
	s_cmp_ge_u32 s50, 32
	s_cbranch_scc1 .a1lo_126
	s_mov_b32 m0, s63
	s_nop 0
	buffer_load_dwordx4 v68, s[8:11], s62 offen lds
	s_branch .a1en_127
.a1lo_126:
	s_mov_b32 m0, s63
	s_nop 0
	buffer_load_dword v69, s[8:11], s62 offen lds
	s_add_u32 s62, s62, 27648
	s_add_u32 s63, s63, 256
	s_mov_b32 m0, s63
	s_nop 0
	buffer_load_dword v69, s[8:11], s62 offen lds
	s_add_u32 s62, s62, 27648
	s_add_u32 s63, s63, 256
	s_mov_b32 m0, s63
	s_nop 0
	buffer_load_dword v69, s[8:11], s62 offen lds
	s_add_u32 s62, s62, 27648
	s_add_u32 s63, s63, 256
	s_mov_b32 m0, s63
	s_nop 0
	buffer_load_dword v69, s[8:11], s62 offen lds
.a1en_127:
	s_mul_i32 s63, s15, 36864
	s_add_u32 s63, s63, 10240
	s_add_u32 s62, s48, 331776
	s_cmp_ge_u32 s51, 32
	s_cbranch_scc1 .a1lo_128
	s_mov_b32 m0, s63
	s_nop 0
	buffer_load_dwordx4 v68, s[8:11], s62 offen lds
	s_branch .a1en_129
.a1lo_128:
	s_mov_b32 m0, s63
	s_nop 0
	buffer_load_dword v69, s[8:11], s62 offen lds
	s_add_u32 s62, s62, 27648
	s_add_u32 s63, s63, 256
	s_mov_b32 m0, s63
	s_nop 0
	buffer_load_dword v69, s[8:11], s62 offen lds
	s_add_u32 s62, s62, 27648
	s_add_u32 s63, s63, 256
	s_mov_b32 m0, s63
	s_nop 0
	buffer_load_dword v69, s[8:11], s62 offen lds
	s_add_u32 s62, s62, 27648
	s_add_u32 s63, s63, 256
	s_mov_b32 m0, s63
	s_nop 0
	buffer_load_dword v69, s[8:11], s62 offen lds
.a1en_129:
	s_mul_i32 s63, s15, 36864
	s_add_u32 s63, s63, 11264
	s_add_u32 s62, s49, 331776
	s_cmp_ge_u32 s52, 32
	s_cbranch_scc1 .a1lo_130
	s_mov_b32 m0, s63
	s_nop 0
	buffer_load_dwordx4 v68, s[8:11], s62 offen lds
	s_branch .a1en_131
.a1lo_130:
	s_mov_b32 m0, s63
	s_nop 0
	buffer_load_dword v69, s[8:11], s62 offen lds
	s_add_u32 s62, s62, 27648
	s_add_u32 s63, s63, 256
	s_mov_b32 m0, s63
	s_nop 0
	buffer_load_dword v69, s[8:11], s62 offen lds
	s_add_u32 s62, s62, 27648
	s_add_u32 s63, s63, 256
	s_mov_b32 m0, s63
	s_nop 0
	buffer_load_dword v69, s[8:11], s62 offen lds
	s_add_u32 s62, s62, 27648
	s_add_u32 s63, s63, 256
	s_mov_b32 m0, s63
	s_nop 0
	buffer_load_dword v69, s[8:11], s62 offen lds
.a1en_131:
	s_mul_i32 s63, s15, 36864
	s_add_u32 s63, s63, 12288
	s_add_u32 s62, s47, 442368
	s_cmp_ge_u32 s50, 32
	s_cbranch_scc1 .a1lo_132
	s_mov_b32 m0, s63
	s_nop 0
	buffer_load_dwordx4 v68, s[8:11], s62 offen lds
	s_branch .a1en_133
.a1lo_132:
	s_mov_b32 m0, s63
	s_nop 0
	buffer_load_dword v69, s[8:11], s62 offen lds
	s_add_u32 s62, s62, 27648
	s_add_u32 s63, s63, 256
	s_mov_b32 m0, s63
	s_nop 0
	buffer_load_dword v69, s[8:11], s62 offen lds
	s_add_u32 s62, s62, 27648
	s_add_u32 s63, s63, 256
	s_mov_b32 m0, s63
	s_nop 0
	buffer_load_dword v69, s[8:11], s62 offen lds
	s_add_u32 s62, s62, 27648
	s_add_u32 s63, s63, 256
	s_mov_b32 m0, s63
	s_nop 0
	buffer_load_dword v69, s[8:11], s62 offen lds
.a1en_133:
	s_mul_i32 s63, s15, 36864
	s_add_u32 s63, s63, 13312
	s_add_u32 s62, s48, 442368
	s_cmp_ge_u32 s51, 32
	s_cbranch_scc1 .a1lo_134
	s_mov_b32 m0, s63
	s_nop 0
	buffer_load_dwordx4 v68, s[8:11], s62 offen lds
	s_branch .a1en_135
.a1lo_134:
	s_mov_b32 m0, s63
	s_nop 0
	buffer_load_dword v69, s[8:11], s62 offen lds
	s_add_u32 s62, s62, 27648
	s_add_u32 s63, s63, 256
	s_mov_b32 m0, s63
	s_nop 0
	buffer_load_dword v69, s[8:11], s62 offen lds
	s_add_u32 s62, s62, 27648
	s_add_u32 s63, s63, 256
	s_mov_b32 m0, s63
	s_nop 0
	buffer_load_dword v69, s[8:11], s62 offen lds
	s_add_u32 s62, s62, 27648
	s_add_u32 s63, s63, 256
	s_mov_b32 m0, s63
	s_nop 0
	buffer_load_dword v69, s[8:11], s62 offen lds
.a1en_135:
	s_mul_i32 s63, s15, 36864
	s_add_u32 s63, s63, 14336
	s_add_u32 s62, s49, 442368
	s_cmp_ge_u32 s52, 32
	s_cbranch_scc1 .a1lo_136
	s_mov_b32 m0, s63
	s_nop 0
	buffer_load_dwordx4 v68, s[8:11], s62 offen lds
	s_branch .a1en_137
.a1lo_136:
	s_mov_b32 m0, s63
	s_nop 0
	buffer_load_dword v69, s[8:11], s62 offen lds
	s_add_u32 s62, s62, 27648
	s_add_u32 s63, s63, 256
	s_mov_b32 m0, s63
	s_nop 0
	buffer_load_dword v69, s[8:11], s62 offen lds
	s_add_u32 s62, s62, 27648
	s_add_u32 s63, s63, 256
	s_mov_b32 m0, s63
	s_nop 0
	buffer_load_dword v69, s[8:11], s62 offen lds
	s_add_u32 s62, s62, 27648
	s_add_u32 s63, s63, 256
	s_mov_b32 m0, s63
	s_nop 0
	buffer_load_dword v69, s[8:11], s62 offen lds
.a1en_137:
	s_mul_i32 s63, s15, 36864
	s_add_u32 s63, s63, 15360
	s_add_u32 s62, s47, 552960
	s_cmp_ge_u32 s50, 32
	s_cbranch_scc1 .a1lo_138
	s_mov_b32 m0, s63
	s_nop 0
	buffer_load_dwordx4 v68, s[8:11], s62 offen lds
	s_branch .a1en_139
.a1lo_138:
	s_mov_b32 m0, s63
	s_nop 0
	buffer_load_dword v69, s[8:11], s62 offen lds
	s_add_u32 s62, s62, 27648
	s_add_u32 s63, s63, 256
	s_mov_b32 m0, s63
	s_nop 0
	buffer_load_dword v69, s[8:11], s62 offen lds
	s_add_u32 s62, s62, 27648
	s_add_u32 s63, s63, 256
	s_mov_b32 m0, s63
	s_nop 0
	buffer_load_dword v69, s[8:11], s62 offen lds
	s_add_u32 s62, s62, 27648
	s_add_u32 s63, s63, 256
	s_mov_b32 m0, s63
	s_nop 0
	buffer_load_dword v69, s[8:11], s62 offen lds
.a1en_139:
	s_mul_i32 s63, s15, 36864
	s_add_u32 s63, s63, 16384
	s_add_u32 s62, s48, 552960
	s_cmp_ge_u32 s51, 32
	s_cbranch_scc1 .a1lo_140
	s_mov_b32 m0, s63
	s_nop 0
	buffer_load_dwordx4 v68, s[8:11], s62 offen lds
	s_branch .a1en_141
.a1lo_140:
	s_mov_b32 m0, s63
	s_nop 0
	buffer_load_dword v69, s[8:11], s62 offen lds
	s_add_u32 s62, s62, 27648
	s_add_u32 s63, s63, 256
	s_mov_b32 m0, s63
	s_nop 0
	buffer_load_dword v69, s[8:11], s62 offen lds
	s_add_u32 s62, s62, 27648
	s_add_u32 s63, s63, 256
	s_mov_b32 m0, s63
	s_nop 0
	buffer_load_dword v69, s[8:11], s62 offen lds
	s_add_u32 s62, s62, 27648
	s_add_u32 s63, s63, 256
	s_mov_b32 m0, s63
	s_nop 0
	buffer_load_dword v69, s[8:11], s62 offen lds
.a1en_141:
	s_mul_i32 s63, s15, 36864
	s_add_u32 s63, s63, 17408
	s_add_u32 s62, s49, 552960
	s_cmp_ge_u32 s52, 32
	s_cbranch_scc1 .a1lo_142
	s_mov_b32 m0, s63
	s_nop 0
	buffer_load_dwordx4 v68, s[8:11], s62 offen lds
	s_branch .a1en_143
.a1lo_142:
	s_mov_b32 m0, s63
	s_nop 0
	buffer_load_dword v69, s[8:11], s62 offen lds
	s_add_u32 s62, s62, 27648
	s_add_u32 s63, s63, 256
	s_mov_b32 m0, s63
	s_nop 0
	buffer_load_dword v69, s[8:11], s62 offen lds
	s_add_u32 s62, s62, 27648
	s_add_u32 s63, s63, 256
	s_mov_b32 m0, s63
	s_nop 0
	buffer_load_dword v69, s[8:11], s62 offen lds
	s_add_u32 s62, s62, 27648
	s_add_u32 s63, s63, 256
	s_mov_b32 m0, s63
	s_nop 0
	buffer_load_dword v69, s[8:11], s62 offen lds
.a1en_143:
	s_mul_i32 s63, s15, 36864
	s_add_u32 s63, s63, 18432
	s_add_u32 s62, s47, 663552
	s_cmp_ge_u32 s50, 32
	s_cbranch_scc1 .a1lo_144
	s_mov_b32 m0, s63
	s_nop 0
	buffer_load_dwordx4 v68, s[8:11], s62 offen lds
	s_branch .a1en_145
.a1lo_144:
	s_mov_b32 m0, s63
	s_nop 0
	buffer_load_dword v69, s[8:11], s62 offen lds
	s_add_u32 s62, s62, 27648
	s_add_u32 s63, s63, 256
	s_mov_b32 m0, s63
	s_nop 0
	buffer_load_dword v69, s[8:11], s62 offen lds
	s_add_u32 s62, s62, 27648
	s_add_u32 s63, s63, 256
	s_mov_b32 m0, s63
	s_nop 0
	buffer_load_dword v69, s[8:11], s62 offen lds
	s_add_u32 s62, s62, 27648
	s_add_u32 s63, s63, 256
	s_mov_b32 m0, s63
	s_nop 0
	buffer_load_dword v69, s[8:11], s62 offen lds
.a1en_145:
	s_mul_i32 s63, s15, 36864
	s_add_u32 s63, s63, 19456
	s_add_u32 s62, s48, 663552
	s_cmp_ge_u32 s51, 32
	s_cbranch_scc1 .a1lo_146
	s_mov_b32 m0, s63
	s_nop 0
	buffer_load_dwordx4 v68, s[8:11], s62 offen lds
	s_branch .a1en_147
.a1lo_146:
	s_mov_b32 m0, s63
	s_nop 0
	buffer_load_dword v69, s[8:11], s62 offen lds
	s_add_u32 s62, s62, 27648
	s_add_u32 s63, s63, 256
	s_mov_b32 m0, s63
	s_nop 0
	buffer_load_dword v69, s[8:11], s62 offen lds
	s_add_u32 s62, s62, 27648
	s_add_u32 s63, s63, 256
	s_mov_b32 m0, s63
	s_nop 0
	buffer_load_dword v69, s[8:11], s62 offen lds
	s_add_u32 s62, s62, 27648
	s_add_u32 s63, s63, 256
	s_mov_b32 m0, s63
	s_nop 0
	buffer_load_dword v69, s[8:11], s62 offen lds
.a1en_147:
	s_mul_i32 s63, s15, 36864
	s_add_u32 s63, s63, 20480
	s_add_u32 s62, s49, 663552
	s_cmp_ge_u32 s52, 32
	s_cbranch_scc1 .a1lo_148
	s_mov_b32 m0, s63
	s_nop 0
	buffer_load_dwordx4 v68, s[8:11], s62 offen lds
	s_branch .a1en_149
.a1lo_148:
	s_mov_b32 m0, s63
	s_nop 0
	buffer_load_dword v69, s[8:11], s62 offen lds
	s_add_u32 s62, s62, 27648
	s_add_u32 s63, s63, 256
	s_mov_b32 m0, s63
	s_nop 0
	buffer_load_dword v69, s[8:11], s62 offen lds
	s_add_u32 s62, s62, 27648
	s_add_u32 s63, s63, 256
	s_mov_b32 m0, s63
	s_nop 0
	buffer_load_dword v69, s[8:11], s62 offen lds
	s_add_u32 s62, s62, 27648
	s_add_u32 s63, s63, 256
	s_mov_b32 m0, s63
	s_nop 0
	buffer_load_dword v69, s[8:11], s62 offen lds
.a1en_149:
	s_mul_i32 s63, s15, 36864
	s_add_u32 s63, s63, 21504
	s_add_u32 s62, s47, 774144
	s_cmp_ge_u32 s50, 32
	s_cbranch_scc1 .a1lo_150
	s_mov_b32 m0, s63
	s_nop 0
	buffer_load_dwordx4 v68, s[8:11], s62 offen lds
	s_branch .a1en_151
.a1lo_150:
	s_mov_b32 m0, s63
	s_nop 0
	buffer_load_dword v69, s[8:11], s62 offen lds
	s_add_u32 s62, s62, 27648
	s_add_u32 s63, s63, 256
	s_mov_b32 m0, s63
	s_nop 0
	buffer_load_dword v69, s[8:11], s62 offen lds
	s_add_u32 s62, s62, 27648
	s_add_u32 s63, s63, 256
	s_mov_b32 m0, s63
	s_nop 0
	buffer_load_dword v69, s[8:11], s62 offen lds
	s_add_u32 s62, s62, 27648
	s_add_u32 s63, s63, 256
	s_mov_b32 m0, s63
	s_nop 0
	buffer_load_dword v69, s[8:11], s62 offen lds
.a1en_151:
	s_mul_i32 s63, s15, 36864
	s_add_u32 s63, s63, 22528
	s_add_u32 s62, s48, 774144
	s_cmp_ge_u32 s51, 32
	s_cbranch_scc1 .a1lo_152
	s_mov_b32 m0, s63
	s_nop 0
	buffer_load_dwordx4 v68, s[8:11], s62 offen lds
	s_branch .a1en_153
.a1lo_152:
	s_mov_b32 m0, s63
	s_nop 0
	buffer_load_dword v69, s[8:11], s62 offen lds
	s_add_u32 s62, s62, 27648
	s_add_u32 s63, s63, 256
	s_mov_b32 m0, s63
	s_nop 0
	buffer_load_dword v69, s[8:11], s62 offen lds
	s_add_u32 s62, s62, 27648
	s_add_u32 s63, s63, 256
	s_mov_b32 m0, s63
	s_nop 0
	buffer_load_dword v69, s[8:11], s62 offen lds
	s_add_u32 s62, s62, 27648
	s_add_u32 s63, s63, 256
	s_mov_b32 m0, s63
	s_nop 0
	buffer_load_dword v69, s[8:11], s62 offen lds
.a1en_153:
	s_mul_i32 s63, s15, 36864
	s_add_u32 s63, s63, 23552
	s_add_u32 s62, s49, 774144
	s_cmp_ge_u32 s52, 32
	s_cbranch_scc1 .a1lo_154
	s_mov_b32 m0, s63
	s_nop 0
	buffer_load_dwordx4 v68, s[8:11], s62 offen lds
	s_branch .a1en_155
.a1lo_154:
	s_mov_b32 m0, s63
	s_nop 0
	buffer_load_dword v69, s[8:11], s62 offen lds
	s_add_u32 s62, s62, 27648
	s_add_u32 s63, s63, 256
	s_mov_b32 m0, s63
	s_nop 0
	buffer_load_dword v69, s[8:11], s62 offen lds
	s_add_u32 s62, s62, 27648
	s_add_u32 s63, s63, 256
	s_mov_b32 m0, s63
	s_nop 0
	buffer_load_dword v69, s[8:11], s62 offen lds
	s_add_u32 s62, s62, 27648
	s_add_u32 s63, s63, 256
	s_mov_b32 m0, s63
	s_nop 0
	buffer_load_dword v69, s[8:11], s62 offen lds
.a1en_155:
	s_mul_i32 s63, s15, 36864
	s_add_u32 s63, s63, 24576
	s_add_u32 s62, s47, 884736
	s_cmp_ge_u32 s50, 32
	s_cbranch_scc1 .a1lo_156
	s_mov_b32 m0, s63
	s_nop 0
	buffer_load_dwordx4 v68, s[8:11], s62 offen lds
	s_branch .a1en_157
.a1lo_156:
	s_mov_b32 m0, s63
	s_nop 0
	buffer_load_dword v69, s[8:11], s62 offen lds
	s_add_u32 s62, s62, 27648
	s_add_u32 s63, s63, 256
	s_mov_b32 m0, s63
	s_nop 0
	buffer_load_dword v69, s[8:11], s62 offen lds
	s_add_u32 s62, s62, 27648
	s_add_u32 s63, s63, 256
	s_mov_b32 m0, s63
	s_nop 0
	buffer_load_dword v69, s[8:11], s62 offen lds
	s_add_u32 s62, s62, 27648
	s_add_u32 s63, s63, 256
	s_mov_b32 m0, s63
	s_nop 0
	buffer_load_dword v69, s[8:11], s62 offen lds
.a1en_157:
	s_mul_i32 s63, s15, 36864
	s_add_u32 s63, s63, 25600
	s_add_u32 s62, s48, 884736
	s_cmp_ge_u32 s51, 32
	s_cbranch_scc1 .a1lo_158
	s_mov_b32 m0, s63
	s_nop 0
	buffer_load_dwordx4 v68, s[8:11], s62 offen lds
	s_branch .a1en_159
.a1lo_158:
	s_mov_b32 m0, s63
	s_nop 0
	buffer_load_dword v69, s[8:11], s62 offen lds
	s_add_u32 s62, s62, 27648
	s_add_u32 s63, s63, 256
	s_mov_b32 m0, s63
	s_nop 0
	buffer_load_dword v69, s[8:11], s62 offen lds
	s_add_u32 s62, s62, 27648
	s_add_u32 s63, s63, 256
	s_mov_b32 m0, s63
	s_nop 0
	buffer_load_dword v69, s[8:11], s62 offen lds
	s_add_u32 s62, s62, 27648
	s_add_u32 s63, s63, 256
	s_mov_b32 m0, s63
	s_nop 0
	buffer_load_dword v69, s[8:11], s62 offen lds
.a1en_159:
	s_mul_i32 s63, s15, 36864
	s_add_u32 s63, s63, 26624
	s_add_u32 s62, s49, 884736
	s_cmp_ge_u32 s52, 32
	s_cbranch_scc1 .a1lo_160
	s_mov_b32 m0, s63
	s_nop 0
	buffer_load_dwordx4 v68, s[8:11], s62 offen lds
	s_branch .a1en_161
.a1lo_160:
	s_mov_b32 m0, s63
	s_nop 0
	buffer_load_dword v69, s[8:11], s62 offen lds
	s_add_u32 s62, s62, 27648
	s_add_u32 s63, s63, 256
	s_mov_b32 m0, s63
	s_nop 0
	buffer_load_dword v69, s[8:11], s62 offen lds
	s_add_u32 s62, s62, 27648
	s_add_u32 s63, s63, 256
	s_mov_b32 m0, s63
	s_nop 0
	buffer_load_dword v69, s[8:11], s62 offen lds
	s_add_u32 s62, s62, 27648
	s_add_u32 s63, s63, 256
	s_mov_b32 m0, s63
	s_nop 0
	buffer_load_dword v69, s[8:11], s62 offen lds
.a1en_161:
	s_waitcnt vmcnt(0)
	ds_read_b64_tr_b16 a[0:1], v70 offset:0
	ds_read_b64_tr_b16 a[2:3], v70 offset:512
	ds_read_b64_tr_b16 a[72:73], v70 offset:1024
	ds_read_b64_tr_b16 a[74:75], v70 offset:1536
	ds_read_b64_tr_b16 a[144:145], v70 offset:2048
	ds_read_b64_tr_b16 a[146:147], v70 offset:2560
	ds_read_b64_tr_b16 a[4:5], v70 offset:3072
	ds_read_b64_tr_b16 a[6:7], v70 offset:3584
	s_waitcnt lgkmcnt(8)
	ds_read_b64_tr_b16 a[76:77], v70 offset:4096
	ds_read_b64_tr_b16 a[78:79], v70 offset:4608
	ds_read_b64_tr_b16 a[148:149], v70 offset:5120
	ds_read_b64_tr_b16 a[150:151], v70 offset:5632
	ds_read_b64_tr_b16 a[8:9], v70 offset:6144
	ds_read_b64_tr_b16 a[10:11], v70 offset:6656
	ds_read_b64_tr_b16 a[80:81], v70 offset:7168
	ds_read_b64_tr_b16 a[82:83], v70 offset:7680
	s_waitcnt lgkmcnt(8)
	ds_read_b64_tr_b16 a[152:153], v70 offset:8192
	ds_read_b64_tr_b16 a[154:155], v70 offset:8704
	ds_read_b64_tr_b16 a[12:13], v70 offset:9216
	ds_read_b64_tr_b16 a[14:15], v70 offset:9728
	ds_read_b64_tr_b16 a[84:85], v70 offset:10240
	ds_read_b64_tr_b16 a[86:87], v70 offset:10752
	ds_read_b64_tr_b16 a[156:157], v70 offset:11264
	ds_read_b64_tr_b16 a[158:159], v70 offset:11776
	s_waitcnt lgkmcnt(8)
	ds_read_b64_tr_b16 a[16:17], v70 offset:12288
	ds_read_b64_tr_b16 a[18:19], v70 offset:12800
	ds_read_b64_tr_b16 a[88:89], v70 offset:13312
	ds_read_b64_tr_b16 a[90:91], v70 offset:13824
	ds_read_b64_tr_b16 a[160:161], v70 offset:14336
	ds_read_b64_tr_b16 a[162:163], v70 offset:14848
	ds_read_b64_tr_b16 a[20:21], v70 offset:15360
	ds_read_b64_tr_b16 a[22:23], v70 offset:15872
	s_waitcnt lgkmcnt(8)
	ds_read_b64_tr_b16 a[92:93], v70 offset:16384
	ds_read_b64_tr_b16 a[94:95], v70 offset:16896
	ds_read_b64_tr_b16 a[164:165], v70 offset:17408
	ds_read_b64_tr_b16 a[166:167], v70 offset:17920
	ds_read_b64_tr_b16 a[24:25], v70 offset:18432
	ds_read_b64_tr_b16 a[26:27], v70 offset:18944
	ds_read_b64_tr_b16 a[96:97], v70 offset:19456
	ds_read_b64_tr_b16 a[98:99], v70 offset:19968
	s_waitcnt lgkmcnt(8)
	ds_read_b64_tr_b16 a[168:169], v70 offset:20480
	ds_read_b64_tr_b16 a[170:171], v70 offset:20992
	ds_read_b64_tr_b16 a[28:29], v70 offset:21504
	ds_read_b64_tr_b16 a[30:31], v70 offset:22016
	ds_read_b64_tr_b16 a[100:101], v70 offset:22528
	ds_read_b64_tr_b16 a[102:103], v70 offset:23040
	ds_read_b64_tr_b16 a[172:173], v70 offset:23552
	ds_read_b64_tr_b16 a[174:175], v70 offset:24064
	s_waitcnt lgkmcnt(8)
	ds_read_b64_tr_b16 a[32:33], v70 offset:24576
	ds_read_b64_tr_b16 a[34:35], v70 offset:25088
	ds_read_b64_tr_b16 a[104:105], v70 offset:25600
	ds_read_b64_tr_b16 a[106:107], v70 offset:26112
	ds_read_b64_tr_b16 a[176:177], v70 offset:26624
	ds_read_b64_tr_b16 a[178:179], v70 offset:27136
	s_waitcnt lgkmcnt(0)
	s_mul_i32 s63, s15, 36864
	s_add_u32 s62, s47, 995328
	s_cmp_ge_u32 s50, 32
	s_cbranch_scc1 .a1lo_162
	s_mov_b32 m0, s63
	s_nop 0
	buffer_load_dwordx4 v68, s[8:11], s62 offen lds
	s_branch .a1en_163
.a1lo_162:
	s_mov_b32 m0, s63
	s_nop 0
	buffer_load_dword v69, s[8:11], s62 offen lds
	s_add_u32 s62, s62, 27648
	s_add_u32 s63, s63, 256
	s_mov_b32 m0, s63
	s_nop 0
	buffer_load_dword v69, s[8:11], s62 offen lds
	s_add_u32 s62, s62, 27648
	s_add_u32 s63, s63, 256
	s_mov_b32 m0, s63
	s_nop 0
	buffer_load_dword v69, s[8:11], s62 offen lds
	s_add_u32 s62, s62, 27648
	s_add_u32 s63, s63, 256
	s_mov_b32 m0, s63
	s_nop 0
	buffer_load_dword v69, s[8:11], s62 offen lds
.a1en_163:
	s_mul_i32 s63, s15, 36864
	s_add_u32 s63, s63, 1024
	s_add_u32 s62, s48, 995328
	s_cmp_ge_u32 s51, 32
	s_cbranch_scc1 .a1lo_164
	s_mov_b32 m0, s63
	s_nop 0
	buffer_load_dwordx4 v68, s[8:11], s62 offen lds
	s_branch .a1en_165
.a1lo_164:
	s_mov_b32 m0, s63
	s_nop 0
	buffer_load_dword v69, s[8:11], s62 offen lds
	s_add_u32 s62, s62, 27648
	s_add_u32 s63, s63, 256
	s_mov_b32 m0, s63
	s_nop 0
	buffer_load_dword v69, s[8:11], s62 offen lds
	s_add_u32 s62, s62, 27648
	s_add_u32 s63, s63, 256
	s_mov_b32 m0, s63
	s_nop 0
	buffer_load_dword v69, s[8:11], s62 offen lds
	s_add_u32 s62, s62, 27648
	s_add_u32 s63, s63, 256
	s_mov_b32 m0, s63
	s_nop 0
	buffer_load_dword v69, s[8:11], s62 offen lds
.a1en_165:
	s_mul_i32 s63, s15, 36864
	s_add_u32 s63, s63, 2048
	s_add_u32 s62, s49, 995328
	s_cmp_ge_u32 s52, 32
	s_cbranch_scc1 .a1lo_166
	s_mov_b32 m0, s63
	s_nop 0
	buffer_load_dwordx4 v68, s[8:11], s62 offen lds
	s_branch .a1en_167
.a1lo_166:
	s_mov_b32 m0, s63
	s_nop 0
	buffer_load_dword v69, s[8:11], s62 offen lds
	s_add_u32 s62, s62, 27648
	s_add_u32 s63, s63, 256
	s_mov_b32 m0, s63
	s_nop 0
	buffer_load_dword v69, s[8:11], s62 offen lds
	s_add_u32 s62, s62, 27648
	s_add_u32 s63, s63, 256
	s_mov_b32 m0, s63
	s_nop 0
	buffer_load_dword v69, s[8:11], s62 offen lds
	s_add_u32 s62, s62, 27648
	s_add_u32 s63, s63, 256
	s_mov_b32 m0, s63
	s_nop 0
	buffer_load_dword v69, s[8:11], s62 offen lds
.a1en_167:
	s_mul_i32 s63, s15, 36864
	s_add_u32 s63, s63, 3072
	s_add_u32 s62, s47, 1105920
	s_cmp_ge_u32 s50, 32
	s_cbranch_scc1 .a1lo_168
	s_mov_b32 m0, s63
	s_nop 0
	buffer_load_dwordx4 v68, s[8:11], s62 offen lds
	s_branch .a1en_169
.a1lo_168:
	s_mov_b32 m0, s63
	s_nop 0
	buffer_load_dword v69, s[8:11], s62 offen lds
	s_add_u32 s62, s62, 27648
	s_add_u32 s63, s63, 256
	s_mov_b32 m0, s63
	s_nop 0
	buffer_load_dword v69, s[8:11], s62 offen lds
	s_add_u32 s62, s62, 27648
	s_add_u32 s63, s63, 256
	s_mov_b32 m0, s63
	s_nop 0
	buffer_load_dword v69, s[8:11], s62 offen lds
	s_add_u32 s62, s62, 27648
	s_add_u32 s63, s63, 256
	s_mov_b32 m0, s63
	s_nop 0
	buffer_load_dword v69, s[8:11], s62 offen lds
.a1en_169:
	s_mul_i32 s63, s15, 36864
	s_add_u32 s63, s63, 4096
	s_add_u32 s62, s48, 1105920
	s_cmp_ge_u32 s51, 32
	s_cbranch_scc1 .a1lo_170
	s_mov_b32 m0, s63
	s_nop 0
	buffer_load_dwordx4 v68, s[8:11], s62 offen lds
	s_branch .a1en_171
.a1lo_170:
	s_mov_b32 m0, s63
	s_nop 0
	buffer_load_dword v69, s[8:11], s62 offen lds
	s_add_u32 s62, s62, 27648
	s_add_u32 s63, s63, 256
	s_mov_b32 m0, s63
	s_nop 0
	buffer_load_dword v69, s[8:11], s62 offen lds
	s_add_u32 s62, s62, 27648
	s_add_u32 s63, s63, 256
	s_mov_b32 m0, s63
	s_nop 0
	buffer_load_dword v69, s[8:11], s62 offen lds
	s_add_u32 s62, s62, 27648
	s_add_u32 s63, s63, 256
	s_mov_b32 m0, s63
	s_nop 0
	buffer_load_dword v69, s[8:11], s62 offen lds
.a1en_171:
	s_mul_i32 s63, s15, 36864
	s_add_u32 s63, s63, 5120
	s_add_u32 s62, s49, 1105920
	s_cmp_ge_u32 s52, 32
	s_cbranch_scc1 .a1lo_172
	s_mov_b32 m0, s63
	s_nop 0
	buffer_load_dwordx4 v68, s[8:11], s62 offen lds
	s_branch .a1en_173
.a1lo_172:
	s_mov_b32 m0, s63
	s_nop 0
	buffer_load_dword v69, s[8:11], s62 offen lds
	s_add_u32 s62, s62, 27648
	s_add_u32 s63, s63, 256
	s_mov_b32 m0, s63
	s_nop 0
	buffer_load_dword v69, s[8:11], s62 offen lds
	s_add_u32 s62, s62, 27648
	s_add_u32 s63, s63, 256
	s_mov_b32 m0, s63
	s_nop 0
	buffer_load_dword v69, s[8:11], s62 offen lds
	s_add_u32 s62, s62, 27648
	s_add_u32 s63, s63, 256
	s_mov_b32 m0, s63
	s_nop 0
	buffer_load_dword v69, s[8:11], s62 offen lds
.a1en_173:
	s_mul_i32 s63, s15, 36864
	s_add_u32 s63, s63, 6144
	s_add_u32 s62, s47, 1216512
	s_cmp_ge_u32 s50, 32
	s_cbranch_scc1 .a1lo_174
	s_mov_b32 m0, s63
	s_nop 0
	buffer_load_dwordx4 v68, s[8:11], s62 offen lds
	s_branch .a1en_175
.a1lo_174:
	s_mov_b32 m0, s63
	s_nop 0
	buffer_load_dword v69, s[8:11], s62 offen lds
	s_add_u32 s62, s62, 27648
	s_add_u32 s63, s63, 256
	s_mov_b32 m0, s63
	s_nop 0
	buffer_load_dword v69, s[8:11], s62 offen lds
	s_add_u32 s62, s62, 27648
	s_add_u32 s63, s63, 256
	s_mov_b32 m0, s63
	s_nop 0
	buffer_load_dword v69, s[8:11], s62 offen lds
	s_add_u32 s62, s62, 27648
	s_add_u32 s63, s63, 256
	s_mov_b32 m0, s63
	s_nop 0
	buffer_load_dword v69, s[8:11], s62 offen lds
.a1en_175:
	s_mul_i32 s63, s15, 36864
	s_add_u32 s63, s63, 7168
	s_add_u32 s62, s48, 1216512
	s_cmp_ge_u32 s51, 32
	s_cbranch_scc1 .a1lo_176
	s_mov_b32 m0, s63
	s_nop 0
	buffer_load_dwordx4 v68, s[8:11], s62 offen lds
	s_branch .a1en_177
.a1lo_176:
	s_mov_b32 m0, s63
	s_nop 0
	buffer_load_dword v69, s[8:11], s62 offen lds
	s_add_u32 s62, s62, 27648
	s_add_u32 s63, s63, 256
	s_mov_b32 m0, s63
	s_nop 0
	buffer_load_dword v69, s[8:11], s62 offen lds
	s_add_u32 s62, s62, 27648
	s_add_u32 s63, s63, 256
	s_mov_b32 m0, s63
	s_nop 0
	buffer_load_dword v69, s[8:11], s62 offen lds
	s_add_u32 s62, s62, 27648
	s_add_u32 s63, s63, 256
	s_mov_b32 m0, s63
	s_nop 0
	buffer_load_dword v69, s[8:11], s62 offen lds
.a1en_177:
	s_mul_i32 s63, s15, 36864
	s_add_u32 s63, s63, 8192
	s_add_u32 s62, s49, 1216512
	s_cmp_ge_u32 s52, 32
	s_cbranch_scc1 .a1lo_178
	s_mov_b32 m0, s63
	s_nop 0
	buffer_load_dwordx4 v68, s[8:11], s62 offen lds
	s_branch .a1en_179
.a1lo_178:
	s_mov_b32 m0, s63
	s_nop 0
	buffer_load_dword v69, s[8:11], s62 offen lds
	s_add_u32 s62, s62, 27648
	s_add_u32 s63, s63, 256
	s_mov_b32 m0, s63
	s_nop 0
	buffer_load_dword v69, s[8:11], s62 offen lds
	s_add_u32 s62, s62, 27648
	s_add_u32 s63, s63, 256
	s_mov_b32 m0, s63
	s_nop 0
	buffer_load_dword v69, s[8:11], s62 offen lds
	s_add_u32 s62, s62, 27648
	s_add_u32 s63, s63, 256
	s_mov_b32 m0, s63
	s_nop 0
	buffer_load_dword v69, s[8:11], s62 offen lds
.a1en_179:
	s_mul_i32 s63, s15, 36864
	s_add_u32 s63, s63, 9216
	s_add_u32 s62, s47, 1327104
	s_cmp_ge_u32 s50, 32
	s_cbranch_scc1 .a1lo_180
	s_mov_b32 m0, s63
	s_nop 0
	buffer_load_dwordx4 v68, s[8:11], s62 offen lds
	s_branch .a1en_181
.a1lo_180:
	s_mov_b32 m0, s63
	s_nop 0
	buffer_load_dword v69, s[8:11], s62 offen lds
	s_add_u32 s62, s62, 27648
	s_add_u32 s63, s63, 256
	s_mov_b32 m0, s63
	s_nop 0
	buffer_load_dword v69, s[8:11], s62 offen lds
	s_add_u32 s62, s62, 27648
	s_add_u32 s63, s63, 256
	s_mov_b32 m0, s63
	s_nop 0
	buffer_load_dword v69, s[8:11], s62 offen lds
	s_add_u32 s62, s62, 27648
	s_add_u32 s63, s63, 256
	s_mov_b32 m0, s63
	s_nop 0
	buffer_load_dword v69, s[8:11], s62 offen lds
.a1en_181:
	s_mul_i32 s63, s15, 36864
	s_add_u32 s63, s63, 10240
	s_add_u32 s62, s48, 1327104
	s_cmp_ge_u32 s51, 32
	s_cbranch_scc1 .a1lo_182
	s_mov_b32 m0, s63
	s_nop 0
	buffer_load_dwordx4 v68, s[8:11], s62 offen lds
	s_branch .a1en_183
.a1lo_182:
	s_mov_b32 m0, s63
	s_nop 0
	buffer_load_dword v69, s[8:11], s62 offen lds
	s_add_u32 s62, s62, 27648
	s_add_u32 s63, s63, 256
	s_mov_b32 m0, s63
	s_nop 0
	buffer_load_dword v69, s[8:11], s62 offen lds
	s_add_u32 s62, s62, 27648
	s_add_u32 s63, s63, 256
	s_mov_b32 m0, s63
	s_nop 0
	buffer_load_dword v69, s[8:11], s62 offen lds
	s_add_u32 s62, s62, 27648
	s_add_u32 s63, s63, 256
	s_mov_b32 m0, s63
	s_nop 0
	buffer_load_dword v69, s[8:11], s62 offen lds
.a1en_183:
	s_mul_i32 s63, s15, 36864
	s_add_u32 s63, s63, 11264
	s_add_u32 s62, s49, 1327104
	s_cmp_ge_u32 s52, 32
	s_cbranch_scc1 .a1lo_184
	s_mov_b32 m0, s63
	s_nop 0
	buffer_load_dwordx4 v68, s[8:11], s62 offen lds
	s_branch .a1en_185
.a1lo_184:
	s_mov_b32 m0, s63
	s_nop 0
	buffer_load_dword v69, s[8:11], s62 offen lds
	s_add_u32 s62, s62, 27648
	s_add_u32 s63, s63, 256
	s_mov_b32 m0, s63
	s_nop 0
	buffer_load_dword v69, s[8:11], s62 offen lds
	s_add_u32 s62, s62, 27648
	s_add_u32 s63, s63, 256
	s_mov_b32 m0, s63
	s_nop 0
	buffer_load_dword v69, s[8:11], s62 offen lds
	s_add_u32 s62, s62, 27648
	s_add_u32 s63, s63, 256
	s_mov_b32 m0, s63
	s_nop 0
	buffer_load_dword v69, s[8:11], s62 offen lds
.a1en_185:
	s_mul_i32 s63, s15, 36864
	s_add_u32 s63, s63, 12288
	s_add_u32 s62, s47, 1437696
	s_cmp_ge_u32 s50, 32
	s_cbranch_scc1 .a1lo_186
	s_mov_b32 m0, s63
	s_nop 0
	buffer_load_dwordx4 v68, s[8:11], s62 offen lds
	s_branch .a1en_187
.a1lo_186:
	s_mov_b32 m0, s63
	s_nop 0
	buffer_load_dword v69, s[8:11], s62 offen lds
	s_add_u32 s62, s62, 27648
	s_add_u32 s63, s63, 256
	s_mov_b32 m0, s63
	s_nop 0
	buffer_load_dword v69, s[8:11], s62 offen lds
	s_add_u32 s62, s62, 27648
	s_add_u32 s63, s63, 256
	s_mov_b32 m0, s63
	s_nop 0
	buffer_load_dword v69, s[8:11], s62 offen lds
	s_add_u32 s62, s62, 27648
	s_add_u32 s63, s63, 256
	s_mov_b32 m0, s63
	s_nop 0
	buffer_load_dword v69, s[8:11], s62 offen lds
.a1en_187:
	s_mul_i32 s63, s15, 36864
	s_add_u32 s63, s63, 13312
	s_add_u32 s62, s48, 1437696
	s_cmp_ge_u32 s51, 32
	s_cbranch_scc1 .a1lo_188
	s_mov_b32 m0, s63
	s_nop 0
	buffer_load_dwordx4 v68, s[8:11], s62 offen lds
	s_branch .a1en_189
.a1lo_188:
	s_mov_b32 m0, s63
	s_nop 0
	buffer_load_dword v69, s[8:11], s62 offen lds
	s_add_u32 s62, s62, 27648
	s_add_u32 s63, s63, 256
	s_mov_b32 m0, s63
	s_nop 0
	buffer_load_dword v69, s[8:11], s62 offen lds
	s_add_u32 s62, s62, 27648
	s_add_u32 s63, s63, 256
	s_mov_b32 m0, s63
	s_nop 0
	buffer_load_dword v69, s[8:11], s62 offen lds
	s_add_u32 s62, s62, 27648
	s_add_u32 s63, s63, 256
	s_mov_b32 m0, s63
	s_nop 0
	buffer_load_dword v69, s[8:11], s62 offen lds
.a1en_189:
	s_mul_i32 s63, s15, 36864
	s_add_u32 s63, s63, 14336
	s_add_u32 s62, s49, 1437696
	s_cmp_ge_u32 s52, 32
	s_cbranch_scc1 .a1lo_190
	s_mov_b32 m0, s63
	s_nop 0
	buffer_load_dwordx4 v68, s[8:11], s62 offen lds
	s_branch .a1en_191
.a1lo_190:
	s_mov_b32 m0, s63
	s_nop 0
	buffer_load_dword v69, s[8:11], s62 offen lds
	s_add_u32 s62, s62, 27648
	s_add_u32 s63, s63, 256
	s_mov_b32 m0, s63
	s_nop 0
	buffer_load_dword v69, s[8:11], s62 offen lds
	s_add_u32 s62, s62, 27648
	s_add_u32 s63, s63, 256
	s_mov_b32 m0, s63
	s_nop 0
	buffer_load_dword v69, s[8:11], s62 offen lds
	s_add_u32 s62, s62, 27648
	s_add_u32 s63, s63, 256
	s_mov_b32 m0, s63
	s_nop 0
	buffer_load_dword v69, s[8:11], s62 offen lds
.a1en_191:
	s_mul_i32 s63, s15, 36864
	s_add_u32 s63, s63, 15360
	s_add_u32 s62, s47, 1548288
	s_cmp_ge_u32 s50, 32
	s_cbranch_scc1 .a1lo_192
	s_mov_b32 m0, s63
	s_nop 0
	buffer_load_dwordx4 v68, s[8:11], s62 offen lds
	s_branch .a1en_193
.a1lo_192:
	s_mov_b32 m0, s63
	s_nop 0
	buffer_load_dword v69, s[8:11], s62 offen lds
	s_add_u32 s62, s62, 27648
	s_add_u32 s63, s63, 256
	s_mov_b32 m0, s63
	s_nop 0
	buffer_load_dword v69, s[8:11], s62 offen lds
	s_add_u32 s62, s62, 27648
	s_add_u32 s63, s63, 256
	s_mov_b32 m0, s63
	s_nop 0
	buffer_load_dword v69, s[8:11], s62 offen lds
	s_add_u32 s62, s62, 27648
	s_add_u32 s63, s63, 256
	s_mov_b32 m0, s63
	s_nop 0
	buffer_load_dword v69, s[8:11], s62 offen lds
.a1en_193:
	s_mul_i32 s63, s15, 36864
	s_add_u32 s63, s63, 16384
	s_add_u32 s62, s48, 1548288
	s_cmp_ge_u32 s51, 32
	s_cbranch_scc1 .a1lo_194
	s_mov_b32 m0, s63
	s_nop 0
	buffer_load_dwordx4 v68, s[8:11], s62 offen lds
	s_branch .a1en_195
.a1lo_194:
	s_mov_b32 m0, s63
	s_nop 0
	buffer_load_dword v69, s[8:11], s62 offen lds
	s_add_u32 s62, s62, 27648
	s_add_u32 s63, s63, 256
	s_mov_b32 m0, s63
	s_nop 0
	buffer_load_dword v69, s[8:11], s62 offen lds
	s_add_u32 s62, s62, 27648
	s_add_u32 s63, s63, 256
	s_mov_b32 m0, s63
	s_nop 0
	buffer_load_dword v69, s[8:11], s62 offen lds
	s_add_u32 s62, s62, 27648
	s_add_u32 s63, s63, 256
	s_mov_b32 m0, s63
	s_nop 0
	buffer_load_dword v69, s[8:11], s62 offen lds
.a1en_195:
	s_mul_i32 s63, s15, 36864
	s_add_u32 s63, s63, 17408
	s_add_u32 s62, s49, 1548288
	s_cmp_ge_u32 s52, 32
	s_cbranch_scc1 .a1lo_196
	s_mov_b32 m0, s63
	s_nop 0
	buffer_load_dwordx4 v68, s[8:11], s62 offen lds
	s_branch .a1en_197
.a1lo_196:
	s_mov_b32 m0, s63
	s_nop 0
	buffer_load_dword v69, s[8:11], s62 offen lds
	s_add_u32 s62, s62, 27648
	s_add_u32 s63, s63, 256
	s_mov_b32 m0, s63
	s_nop 0
	buffer_load_dword v69, s[8:11], s62 offen lds
	s_add_u32 s62, s62, 27648
	s_add_u32 s63, s63, 256
	s_mov_b32 m0, s63
	s_nop 0
	buffer_load_dword v69, s[8:11], s62 offen lds
	s_add_u32 s62, s62, 27648
	s_add_u32 s63, s63, 256
	s_mov_b32 m0, s63
	s_nop 0
	buffer_load_dword v69, s[8:11], s62 offen lds
.a1en_197:
	s_mul_i32 s63, s15, 36864
	s_add_u32 s63, s63, 18432
	s_add_u32 s62, s47, 1658880
	s_cmp_ge_u32 s50, 32
	s_cbranch_scc1 .a1lo_198
	s_mov_b32 m0, s63
	s_nop 0
	buffer_load_dwordx4 v68, s[8:11], s62 offen lds
	s_branch .a1en_199
.a1lo_198:
	s_mov_b32 m0, s63
	s_nop 0
	buffer_load_dword v69, s[8:11], s62 offen lds
	s_add_u32 s62, s62, 27648
	s_add_u32 s63, s63, 256
	s_mov_b32 m0, s63
	s_nop 0
	buffer_load_dword v69, s[8:11], s62 offen lds
	s_add_u32 s62, s62, 27648
	s_add_u32 s63, s63, 256
	s_mov_b32 m0, s63
	s_nop 0
	buffer_load_dword v69, s[8:11], s62 offen lds
	s_add_u32 s62, s62, 27648
	s_add_u32 s63, s63, 256
	s_mov_b32 m0, s63
	s_nop 0
	buffer_load_dword v69, s[8:11], s62 offen lds
.a1en_199:
	s_mul_i32 s63, s15, 36864
	s_add_u32 s63, s63, 19456
	s_add_u32 s62, s48, 1658880
	s_cmp_ge_u32 s51, 32
	s_cbranch_scc1 .a1lo_200
	s_mov_b32 m0, s63
	s_nop 0
	buffer_load_dwordx4 v68, s[8:11], s62 offen lds
	s_branch .a1en_201
.a1lo_200:
	s_mov_b32 m0, s63
	s_nop 0
	buffer_load_dword v69, s[8:11], s62 offen lds
	s_add_u32 s62, s62, 27648
	s_add_u32 s63, s63, 256
	s_mov_b32 m0, s63
	s_nop 0
	buffer_load_dword v69, s[8:11], s62 offen lds
	s_add_u32 s62, s62, 27648
	s_add_u32 s63, s63, 256
	s_mov_b32 m0, s63
	s_nop 0
	buffer_load_dword v69, s[8:11], s62 offen lds
	s_add_u32 s62, s62, 27648
	s_add_u32 s63, s63, 256
	s_mov_b32 m0, s63
	s_nop 0
	buffer_load_dword v69, s[8:11], s62 offen lds
.a1en_201:
	s_mul_i32 s63, s15, 36864
	s_add_u32 s63, s63, 20480
	s_add_u32 s62, s49, 1658880
	s_cmp_ge_u32 s52, 32
	s_cbranch_scc1 .a1lo_202
	s_mov_b32 m0, s63
	s_nop 0
	buffer_load_dwordx4 v68, s[8:11], s62 offen lds
	s_branch .a1en_203
.a1lo_202:
	s_mov_b32 m0, s63
	s_nop 0
	buffer_load_dword v69, s[8:11], s62 offen lds
	s_add_u32 s62, s62, 27648
	s_add_u32 s63, s63, 256
	s_mov_b32 m0, s63
	s_nop 0
	buffer_load_dword v69, s[8:11], s62 offen lds
	s_add_u32 s62, s62, 27648
	s_add_u32 s63, s63, 256
	s_mov_b32 m0, s63
	s_nop 0
	buffer_load_dword v69, s[8:11], s62 offen lds
	s_add_u32 s62, s62, 27648
	s_add_u32 s63, s63, 256
	s_mov_b32 m0, s63
	s_nop 0
	buffer_load_dword v69, s[8:11], s62 offen lds
.a1en_203:
	s_mul_i32 s63, s15, 36864
	s_add_u32 s63, s63, 21504
	s_add_u32 s62, s47, 1769472
	s_cmp_ge_u32 s50, 32
	s_cbranch_scc1 .a1lo_204
	s_mov_b32 m0, s63
	s_nop 0
	buffer_load_dwordx4 v68, s[8:11], s62 offen lds
	s_branch .a1en_205
.a1lo_204:
	s_mov_b32 m0, s63
	s_nop 0
	buffer_load_dword v69, s[8:11], s62 offen lds
	s_add_u32 s62, s62, 27648
	s_add_u32 s63, s63, 256
	s_mov_b32 m0, s63
	s_nop 0
	buffer_load_dword v69, s[8:11], s62 offen lds
	s_add_u32 s62, s62, 27648
	s_add_u32 s63, s63, 256
	s_mov_b32 m0, s63
	s_nop 0
	buffer_load_dword v69, s[8:11], s62 offen lds
	s_add_u32 s62, s62, 27648
	s_add_u32 s63, s63, 256
	s_mov_b32 m0, s63
	s_nop 0
	buffer_load_dword v69, s[8:11], s62 offen lds
.a1en_205:
	s_mul_i32 s63, s15, 36864
	s_add_u32 s63, s63, 22528
	s_add_u32 s62, s48, 1769472
	s_cmp_ge_u32 s51, 32
	s_cbranch_scc1 .a1lo_206
	s_mov_b32 m0, s63
	s_nop 0
	buffer_load_dwordx4 v68, s[8:11], s62 offen lds
	s_branch .a1en_207
.a1lo_206:
	s_mov_b32 m0, s63
	s_nop 0
	buffer_load_dword v69, s[8:11], s62 offen lds
	s_add_u32 s62, s62, 27648
	s_add_u32 s63, s63, 256
	s_mov_b32 m0, s63
	s_nop 0
	buffer_load_dword v69, s[8:11], s62 offen lds
	s_add_u32 s62, s62, 27648
	s_add_u32 s63, s63, 256
	s_mov_b32 m0, s63
	s_nop 0
	buffer_load_dword v69, s[8:11], s62 offen lds
	s_add_u32 s62, s62, 27648
	s_add_u32 s63, s63, 256
	s_mov_b32 m0, s63
	s_nop 0
	buffer_load_dword v69, s[8:11], s62 offen lds
.a1en_207:
	s_mul_i32 s63, s15, 36864
	s_add_u32 s63, s63, 23552
	s_add_u32 s62, s49, 1769472
	s_cmp_ge_u32 s52, 32
	s_cbranch_scc1 .a1lo_208
	s_mov_b32 m0, s63
	s_nop 0
	buffer_load_dwordx4 v68, s[8:11], s62 offen lds
	s_branch .a1en_209
.a1lo_208:
	s_mov_b32 m0, s63
	s_nop 0
	buffer_load_dword v69, s[8:11], s62 offen lds
	s_add_u32 s62, s62, 27648
	s_add_u32 s63, s63, 256
	s_mov_b32 m0, s63
	s_nop 0
	buffer_load_dword v69, s[8:11], s62 offen lds
	s_add_u32 s62, s62, 27648
	s_add_u32 s63, s63, 256
	s_mov_b32 m0, s63
	s_nop 0
	buffer_load_dword v69, s[8:11], s62 offen lds
	s_add_u32 s62, s62, 27648
	s_add_u32 s63, s63, 256
	s_mov_b32 m0, s63
	s_nop 0
	buffer_load_dword v69, s[8:11], s62 offen lds
.a1en_209:
	s_mul_i32 s63, s15, 36864
	s_add_u32 s63, s63, 24576
	s_add_u32 s62, s47, 1880064
	s_cmp_ge_u32 s50, 32
	s_cbranch_scc1 .a1lo_210
	s_mov_b32 m0, s63
	s_nop 0
	buffer_load_dwordx4 v68, s[8:11], s62 offen lds
	s_branch .a1en_211
.a1lo_210:
	s_mov_b32 m0, s63
	s_nop 0
	buffer_load_dword v69, s[8:11], s62 offen lds
	s_add_u32 s62, s62, 27648
	s_add_u32 s63, s63, 256
	s_mov_b32 m0, s63
	s_nop 0
	buffer_load_dword v69, s[8:11], s62 offen lds
	s_add_u32 s62, s62, 27648
	s_add_u32 s63, s63, 256
	s_mov_b32 m0, s63
	s_nop 0
	buffer_load_dword v69, s[8:11], s62 offen lds
	s_add_u32 s62, s62, 27648
	s_add_u32 s63, s63, 256
	s_mov_b32 m0, s63
	s_nop 0
	buffer_load_dword v69, s[8:11], s62 offen lds
.a1en_211:
	s_mul_i32 s63, s15, 36864
	s_add_u32 s63, s63, 25600
	s_add_u32 s62, s48, 1880064
	s_cmp_ge_u32 s51, 32
	s_cbranch_scc1 .a1lo_212
	s_mov_b32 m0, s63
	s_nop 0
	buffer_load_dwordx4 v68, s[8:11], s62 offen lds
	s_branch .a1en_213
.a1lo_212:
	s_mov_b32 m0, s63
	s_nop 0
	buffer_load_dword v69, s[8:11], s62 offen lds
	s_add_u32 s62, s62, 27648
	s_add_u32 s63, s63, 256
	s_mov_b32 m0, s63
	s_nop 0
	buffer_load_dword v69, s[8:11], s62 offen lds
	s_add_u32 s62, s62, 27648
	s_add_u32 s63, s63, 256
	s_mov_b32 m0, s63
	s_nop 0
	buffer_load_dword v69, s[8:11], s62 offen lds
	s_add_u32 s62, s62, 27648
	s_add_u32 s63, s63, 256
	s_mov_b32 m0, s63
	s_nop 0
	buffer_load_dword v69, s[8:11], s62 offen lds
.a1en_213:
	s_mul_i32 s63, s15, 36864
	s_add_u32 s63, s63, 26624
	s_add_u32 s62, s49, 1880064
	s_cmp_ge_u32 s52, 32
	s_cbranch_scc1 .a1lo_214
	s_mov_b32 m0, s63
	s_nop 0
	buffer_load_dwordx4 v68, s[8:11], s62 offen lds
	s_branch .a1en_215
.a1lo_214:
	s_mov_b32 m0, s63
	s_nop 0
	buffer_load_dword v69, s[8:11], s62 offen lds
	s_add_u32 s62, s62, 27648
	s_add_u32 s63, s63, 256
	s_mov_b32 m0, s63
	s_nop 0
	buffer_load_dword v69, s[8:11], s62 offen lds
	s_add_u32 s62, s62, 27648
	s_add_u32 s63, s63, 256
	s_mov_b32 m0, s63
	s_nop 0
	buffer_load_dword v69, s[8:11], s62 offen lds
	s_add_u32 s62, s62, 27648
	s_add_u32 s63, s63, 256
	s_mov_b32 m0, s63
	s_nop 0
	buffer_load_dword v69, s[8:11], s62 offen lds
.a1en_215:
	s_waitcnt vmcnt(0)
	ds_read_b64_tr_b16 a[36:37], v70 offset:0
	ds_read_b64_tr_b16 a[38:39], v70 offset:512
	ds_read_b64_tr_b16 a[108:109], v70 offset:1024
	ds_read_b64_tr_b16 a[110:111], v70 offset:1536
	ds_read_b64_tr_b16 a[180:181], v70 offset:2048
	ds_read_b64_tr_b16 a[182:183], v70 offset:2560
	ds_read_b64_tr_b16 a[40:41], v70 offset:3072
	ds_read_b64_tr_b16 a[42:43], v70 offset:3584
	s_waitcnt lgkmcnt(8)
	ds_read_b64_tr_b16 a[112:113], v70 offset:4096
	ds_read_b64_tr_b16 a[114:115], v70 offset:4608
	ds_read_b64_tr_b16 a[184:185], v70 offset:5120
	ds_read_b64_tr_b16 a[186:187], v70 offset:5632
	ds_read_b64_tr_b16 a[44:45], v70 offset:6144
	ds_read_b64_tr_b16 a[46:47], v70 offset:6656
	ds_read_b64_tr_b16 a[116:117], v70 offset:7168
	ds_read_b64_tr_b16 a[118:119], v70 offset:7680
	s_waitcnt lgkmcnt(8)
	ds_read_b64_tr_b16 a[188:189], v70 offset:8192
	ds_read_b64_tr_b16 a[190:191], v70 offset:8704
	ds_read_b64_tr_b16 a[48:49], v70 offset:9216
	ds_read_b64_tr_b16 a[50:51], v70 offset:9728
	ds_read_b64_tr_b16 a[120:121], v70 offset:10240
	ds_read_b64_tr_b16 a[122:123], v70 offset:10752
	ds_read_b64_tr_b16 a[192:193], v70 offset:11264
	ds_read_b64_tr_b16 a[194:195], v70 offset:11776
	s_waitcnt lgkmcnt(8)
	ds_read_b64_tr_b16 a[52:53], v70 offset:12288
	ds_read_b64_tr_b16 a[54:55], v70 offset:12800
	ds_read_b64_tr_b16 a[124:125], v70 offset:13312
	ds_read_b64_tr_b16 a[126:127], v70 offset:13824
	ds_read_b64_tr_b16 a[196:197], v70 offset:14336
	ds_read_b64_tr_b16 a[198:199], v70 offset:14848
	ds_read_b64_tr_b16 a[56:57], v70 offset:15360
	ds_read_b64_tr_b16 a[58:59], v70 offset:15872
	s_waitcnt lgkmcnt(8)
	ds_read_b64_tr_b16 a[128:129], v70 offset:16384
	ds_read_b64_tr_b16 a[130:131], v70 offset:16896
	ds_read_b64_tr_b16 a[200:201], v70 offset:17408
	ds_read_b64_tr_b16 a[202:203], v70 offset:17920
	ds_read_b64_tr_b16 a[60:61], v70 offset:18432
	ds_read_b64_tr_b16 a[62:63], v70 offset:18944
	ds_read_b64_tr_b16 a[132:133], v70 offset:19456
	ds_read_b64_tr_b16 a[134:135], v70 offset:19968
	s_waitcnt lgkmcnt(8)
	ds_read_b64_tr_b16 a[204:205], v70 offset:20480
	ds_read_b64_tr_b16 a[206:207], v70 offset:20992
	ds_read_b64_tr_b16 a[64:65], v70 offset:21504
	ds_read_b64_tr_b16 a[66:67], v70 offset:22016
	ds_read_b64_tr_b16 a[136:137], v70 offset:22528
	ds_read_b64_tr_b16 a[138:139], v70 offset:23040
	ds_read_b64_tr_b16 a[208:209], v70 offset:23552
	ds_read_b64_tr_b16 a[210:211], v70 offset:24064
	s_waitcnt lgkmcnt(8)
	ds_read_b64_tr_b16 a[68:69], v70 offset:24576
	ds_read_b64_tr_b16 a[70:71], v70 offset:25088
	ds_read_b64_tr_b16 a[140:141], v70 offset:25600
	ds_read_b64_tr_b16 a[142:143], v70 offset:26112
	ds_read_b64_tr_b16 a[212:213], v70 offset:26624
	ds_read_b64_tr_b16 a[214:215], v70 offset:27136
	s_waitcnt lgkmcnt(0)
	s_barrier
	v_lshlrev_b32 v60, 4, v79
	v_lshlrev_b32 v66, 3, v79
	v_mov_b32 v64, 0
	s_mul_i32 s19, s27, 0x18
	s_add_u32 s19, s19, 0xa0
	v_min_u32 v62, 15, v79
	v_lshrrev_b32 v74, 2, v62
	v_add_u32 v74, s19, v74
	v_lshlrev_b32 v74, 7, v74
	v_and_b32 v62, 3, v62
	v_lshlrev_b32 v62, 2, v62
	v_add_u32 v62, v62, v74
	s_lshl_b32 s46, s27, 9
	v_xor_b32 v67, s46, v62
	s_mul_i32 s19, s27, 0x40
	s_add_u32 s19, s19, 0x8d
	v_min_u32 v68, 63, v79
	v_lshrrev_b32 v74, 2, v68
	v_add_u32 v74, s19, v74
	v_lshlrev_b32 v74, 7, v74
	v_and_b32 v68, 3, v68
	v_lshlrev_b32 v68, 2, v68
	v_add_u32 v68, v68, v74
	s_lshl_b32 s30, s14, 7
	s_lshl_b32 s17, s15, 2
	s_add_u32 s30, s30, s17
	s_mul_i32 s31, s27, 0x240000
	s_add_u32 s31, s31, 0x8200000
	s_mul_i32 s34, s27, 0x6c0000
	s_add_u32 s34, s34, 0x8680000
	s_mul_i32 s17, s38, 36864
	s_add_u32 s34, s34, s17
	s_lshl_b32 s17, s39, 10
	s_add_u32 s34, s34, s17
	v_mov_b32 v74, 0
	s_mov_b32 s20, 400000
	v_and_b32 v72, 7, v79
	v_lshrrev_b32 v73, 2, v72
	v_mul_u32_u24 v73, 112, v73
	v_lshlrev_b32 v72, 2, v72
	v_add_u32 v72, v72, v73
	s_cmp_eq_u32 s27, 0
	s_cbranch_scc1 .ctsk_218
	s_getpc_b64 s[18:19]
.ct_219:
	s_sub_u32 s18, s18, .ct_219-L_A1
	s_subb_u32 s19, s19, 0
	v_lshlrev_b32 v74, 7, v79
	s_lshl_b32 s17, s15, 13
	v_add_u32 v74, s17, v74
	s_mov_b32 s17, L_A3_CE-L_A1-4
	v_min_u32 v74, s17, v74
	global_load_dword v73, v74, s[18:19]
	v_lshlrev_b32 v74, 7, v79
	s_lshl_b32 s17, s15, 13
	s_add_u32 s17, s17, 32768
	v_add_u32 v74, s17, v74
	s_mov_b32 s17, L_A3_CE-L_A1-4
	v_min_u32 v74, s17, v74
	global_load_dword v73, v74, s[18:19]
	v_mov_b32 v74, 0
.ctsk_218:
	s_cmp_eq_u32 s27, 0
	s_cbranch_scc1 .ctsk_220
	s_getpc_b64 s[18:19]
.ct_221:
	s_add_u32 s18, s18, L_RA1-.ct_221
	s_addc_u32 s19, s19, 0
	v_lshlrev_b32 v74, 7, v79
	s_lshl_b32 s17, s15, 13
	v_add_u32 v74, s17, v74
	s_mov_b32 s17, L_RA1_CE-L_RA1-4
	v_min_u32 v74, s17, v74
	global_load_dword v73, v74, s[18:19]
	v_mov_b32 v74, 0
.ctsk_220:
.gbre_216:
	global_load_dword v73, v72, s[12:13] offset:16 sc1
	s_waitcnt vmcnt(0)
	v_readlane_b32 s17, v73, 0
	v_readlane_b32 s18, v73, 1
	s_nop 0
	s_add_u32 s17, s17, s18
	v_readlane_b32 s18, v73, 2
	s_nop 0
	s_add_u32 s17, s17, s18
	v_readlane_b32 s18, v73, 3
	s_nop 0
	s_add_u32 s17, s17, s18
	v_readlane_b32 s18, v73, 4
	s_nop 0
	s_add_u32 s17, s17, s18
	v_readlane_b32 s18, v73, 5
	s_nop 0
	s_add_u32 s17, s17, s18
	v_readlane_b32 s18, v73, 6
	s_nop 0
	s_add_u32 s17, s17, s18
	v_readlane_b32 s18, v73, 7
	s_nop 0
	s_add_u32 s17, s17, s18
	s_cmp_ge_u32 s17, 256
	s_cbranch_scc1 .gbok_217
	s_sub_u32 s20, s20, 1
	s_cmp_lg_u32 s20, 0
	s_cbranch_scc1 .gbre_216
	s_branch L_FAIL
.gbok_217:
	v_cmp_ne_u32 vcc, 32, v73
	s_cbranch_vccnz L_A1_DEV
	s_cmp_eq_u32 s38, 2
	s_cbranch_scc1 .a1v_222
	s_mul_i32 s17, s15, 9216
	s_add_u32 s31, s31, s17
	s_mov_b32 s32, s17
	s_lshl_b32 s44, s17, 1
	s_add_u32 s44, s44, 36864
	s_mov_b32 s33, 0
	s_mov_b32 s28, 0
	s_mov_b32 s29, 0
	s_mov_b32 s55, s34
.gloop_223:
	s_cmp_lg_u32 s29, 0
	s_cbranch_scc1 .gpref_224
	s_add_u32 s37, s28, 1
	s_mov_b32 s20, 400000
.pre_226:
	buffer_load_dword v63, v62, s[4:7], 0 offen sc1
	s_waitcnt vmcnt(0)
	v_cmp_gt_u32 vcc, s37, v63
	s_cbranch_vccz .pok_227
	s_sub_u32 s20, s20, 1
	s_cmp_lg_u32 s20, 0
	s_cbranch_scc1 .pre_226
	s_branch L_FAIL
.pok_227:
	s_add_u32 s17, s32, 0
	s_mov_b32 m0, s17
	s_add_u32 s18, s31, 0
	buffer_load_dwordx4 v60, s[4:7], s18 offen offset:0 lds
	buffer_load_dwordx4 v60, s[4:7], s18 offen offset:1024 lds
	buffer_load_dwordx4 v60, s[4:7], s18 offen offset:2048 lds
	buffer_load_dwordx4 v60, s[4:7], s18 offen offset:3072 lds
	s_add_u32 s17, s32, 4096
	s_mov_b32 m0, s17
	s_add_u32 s18, s31, 4096
	buffer_load_dwordx4 v60, s[4:7], s18 offen offset:0 lds
	buffer_load_dwordx4 v60, s[4:7], s18 offen offset:1024 lds
	buffer_load_dwordx4 v60, s[4:7], s18 offen offset:2048 lds
	buffer_load_dwordx4 v60, s[4:7], s18 offen offset:3072 lds
	s_add_u32 s17, s32, 8192
	s_mov_b32 m0, s17
	s_add_u32 s18, s31, 8192
	buffer_load_dwordx4 v60, s[4:7], s18 offen offset:0 lds
	s_add_u32 s31, s31, 36864
	s_sub_u32 s32, s44, s32
	s_waitcnt vmcnt(0)
	s_branch .ggo_225
.gpref_224:
	s_waitcnt vmcnt(6)
.ggo_225:
	s_barrier
	s_mov_b32 s29, 0
	v_add_u32 v61, s33, v60
	s_sub_u32 s33, 36864, s33
	buffer_load_dword v63, v67, s[4:7], 0 offen sc1
	buffer_load_dword v69, v68, s[4:7], 0 offen sc1
	ds_read_b128 v[24:27], v61 offset:0
	ds_read_b128 v[28:31], v61 offset:18432
	ds_read_b128 v[32:35], v61 offset:1024
	ds_read_b128 v[36:39], v61 offset:19456
	ds_read_b128 v[40:43], v61 offset:2048
	ds_read_b128 v[44:47], v61 offset:20480
	s_waitcnt lgkmcnt(4)
	v_mfma_f32_16x16x32_bf16 v[0:3], a[0:3], v[24:27], 0
	v_mfma_f32_16x16x32_bf16 v[4:7], a[0:3], v[28:31], 0
	v_mfma_f32_16x16x32_bf16 v[8:11], a[72:75], v[24:27], 0
	v_mfma_f32_16x16x32_bf16 v[12:15], a[72:75], v[28:31], 0
	v_mfma_f32_16x16x32_bf16 v[16:19], a[144:147], v[24:27], 0
	v_mfma_f32_16x16x32_bf16 v[20:23], a[144:147], v[28:31], 0
	ds_read_b128 v[24:27], v61 offset:3072
	ds_read_b128 v[28:31], v61 offset:21504
	s_waitcnt lgkmcnt(4)
	v_mfma_f32_16x16x32_bf16 v[0:3], a[4:7], v[32:35], v[0:3]
	v_mfma_f32_16x16x32_bf16 v[4:7], a[4:7], v[36:39], v[4:7]
	v_mfma_f32_16x16x32_bf16 v[8:11], a[76:79], v[32:35], v[8:11]
	v_mfma_f32_16x16x32_bf16 v[12:15], a[76:79], v[36:39], v[12:15]
	v_mfma_f32_16x16x32_bf16 v[16:19], a[148:151], v[32:35], v[16:19]
	v_mfma_f32_16x16x32_bf16 v[20:23], a[148:151], v[36:39], v[20:23]
	ds_read_b128 v[32:35], v61 offset:4096
	ds_read_b128 v[36:39], v61 offset:22528
	s_waitcnt lgkmcnt(4)
	v_mfma_f32_16x16x32_bf16 v[0:3], a[8:11], v[40:43], v[0:3]
	v_mfma_f32_16x16x32_bf16 v[4:7], a[8:11], v[44:47], v[4:7]
	v_mfma_f32_16x16x32_bf16 v[8:11], a[80:83], v[40:43], v[8:11]
	v_mfma_f32_16x16x32_bf16 v[12:15], a[80:83], v[44:47], v[12:15]
	v_mfma_f32_16x16x32_bf16 v[16:19], a[152:155], v[40:43], v[16:19]
	v_mfma_f32_16x16x32_bf16 v[20:23], a[152:155], v[44:47], v[20:23]
	ds_read_b128 v[40:43], v61 offset:5120
	ds_read_b128 v[44:47], v61 offset:23552
	s_waitcnt lgkmcnt(4)
	v_mfma_f32_16x16x32_bf16 v[0:3], a[12:15], v[24:27], v[0:3]
	v_mfma_f32_16x16x32_bf16 v[4:7], a[12:15], v[28:31], v[4:7]
	v_mfma_f32_16x16x32_bf16 v[8:11], a[84:87], v[24:27], v[8:11]
	v_mfma_f32_16x16x32_bf16 v[12:15], a[84:87], v[28:31], v[12:15]
	v_mfma_f32_16x16x32_bf16 v[16:19], a[156:159], v[24:27], v[16:19]
	v_mfma_f32_16x16x32_bf16 v[20:23], a[156:159], v[28:31], v[20:23]
	ds_read_b128 v[24:27], v61 offset:6144
	ds_read_b128 v[28:31], v61 offset:24576
	s_waitcnt lgkmcnt(4)
	v_mfma_f32_16x16x32_bf16 v[0:3], a[16:19], v[32:35], v[0:3]
	v_mfma_f32_16x16x32_bf16 v[4:7], a[16:19], v[36:39], v[4:7]
	v_mfma_f32_16x16x32_bf16 v[8:11], a[88:91], v[32:35], v[8:11]
	v_mfma_f32_16x16x32_bf16 v[12:15], a[88:91], v[36:39], v[12:15]
	v_mfma_f32_16x16x32_bf16 v[16:19], a[160:163], v[32:35], v[16:19]
	v_mfma_f32_16x16x32_bf16 v[20:23], a[160:163], v[36:39], v[20:23]
	ds_read_b128 v[32:35], v61 offset:7168
	ds_read_b128 v[36:39], v61 offset:25600
	s_waitcnt lgkmcnt(4)
	v_mfma_f32_16x16x32_bf16 v[0:3], a[20:23], v[40:43], v[0:3]
	v_mfma_f32_16x16x32_bf16 v[4:7], a[20:23], v[44:47], v[4:7]
	v_mfma_f32_16x16x32_bf16 v[8:11], a[92:95], v[40:43], v[8:11]
	v_mfma_f32_16x16x32_bf16 v[12:15], a[92:95], v[44:47], v[12:15]
	v_mfma_f32_16x16x32_bf16 v[16:19], a[164:167], v[40:43], v[16:19]
	v_mfma_f32_16x16x32_bf16 v[20:23], a[164:167], v[44:47], v[20:23]
	ds_read_b128 v[40:43], v61 offset:8192
	ds_read_b128 v[44:47], v61 offset:26624
	s_waitcnt lgkmcnt(4)
	v_mfma_f32_16x16x32_bf16 v[0:3], a[24:27], v[24:27], v[0:3]
	v_mfma_f32_16x16x32_bf16 v[4:7], a[24:27], v[28:31], v[4:7]
	v_mfma_f32_16x16x32_bf16 v[8:11], a[96:99], v[24:27], v[8:11]
	v_mfma_f32_16x16x32_bf16 v[12:15], a[96:99], v[28:31], v[12:15]
	v_mfma_f32_16x16x32_bf16 v[16:19], a[168:171], v[24:27], v[16:19]
	v_mfma_f32_16x16x32_bf16 v[20:23], a[168:171], v[28:31], v[20:23]
	ds_read_b128 v[24:27], v61 offset:9216
	ds_read_b128 v[28:31], v61 offset:27648
	s_waitcnt lgkmcnt(4)
	v_mfma_f32_16x16x32_bf16 v[0:3], a[28:31], v[32:35], v[0:3]
	v_mfma_f32_16x16x32_bf16 v[4:7], a[28:31], v[36:39], v[4:7]
	v_mfma_f32_16x16x32_bf16 v[8:11], a[100:103], v[32:35], v[8:11]
	v_mfma_f32_16x16x32_bf16 v[12:15], a[100:103], v[36:39], v[12:15]
	v_mfma_f32_16x16x32_bf16 v[16:19], a[172:175], v[32:35], v[16:19]
	v_mfma_f32_16x16x32_bf16 v[20:23], a[172:175], v[36:39], v[20:23]
	ds_read_b128 v[32:35], v61 offset:10240
	ds_read_b128 v[36:39], v61 offset:28672
	s_waitcnt lgkmcnt(4)
	v_mfma_f32_16x16x32_bf16 v[0:3], a[32:35], v[40:43], v[0:3]
	v_mfma_f32_16x16x32_bf16 v[4:7], a[32:35], v[44:47], v[4:7]
	v_mfma_f32_16x16x32_bf16 v[8:11], a[104:107], v[40:43], v[8:11]
	v_mfma_f32_16x16x32_bf16 v[12:15], a[104:107], v[44:47], v[12:15]
	v_mfma_f32_16x16x32_bf16 v[16:19], a[176:179], v[40:43], v[16:19]
	v_mfma_f32_16x16x32_bf16 v[20:23], a[176:179], v[44:47], v[20:23]
	ds_read_b128 v[40:43], v61 offset:11264
	ds_read_b128 v[44:47], v61 offset:29696
	s_waitcnt vmcnt(0)
	v_mov_b32 v65, s28
	s_mov_b64 exec, 1
	buffer_store_dword v65, v64, s[4:7], s30 offen
	s_mov_b64 exec, -1
	s_cmp_ge_u32 s28, 63
	s_cbranch_scc1 .gnopf_228
	s_add_u32 s37, s28, 2
	v_cmp_gt_u32 vcc, s37, v63
	s_cbranch_vccnz .gnopf2_229
	s_mov_b32 s29, 1
	s_waitcnt lgkmcnt(4)
	v_mfma_f32_16x16x32_bf16 v[0:3], a[36:39], v[24:27], v[0:3]
	s_add_u32 s17, s32, 0
	s_mov_b32 m0, s17
	s_add_u32 s18, s31, 0
	buffer_load_dwordx4 v60, s[4:7], s18 offen offset:0 lds
	v_mfma_f32_16x16x32_bf16 v[4:7], a[36:39], v[28:31], v[4:7]
	buffer_load_dwordx4 v60, s[4:7], s18 offen offset:1024 lds
	v_mfma_f32_16x16x32_bf16 v[8:11], a[108:111], v[24:27], v[8:11]
	buffer_load_dwordx4 v60, s[4:7], s18 offen offset:2048 lds
	v_mfma_f32_16x16x32_bf16 v[12:15], a[108:111], v[28:31], v[12:15]
	buffer_load_dwordx4 v60, s[4:7], s18 offen offset:3072 lds
	v_mfma_f32_16x16x32_bf16 v[16:19], a[180:183], v[24:27], v[16:19]
	s_add_u32 s17, s32, 4096
	s_mov_b32 m0, s17
	s_add_u32 s18, s31, 4096
	buffer_load_dwordx4 v60, s[4:7], s18 offen offset:0 lds
	v_mfma_f32_16x16x32_bf16 v[20:23], a[180:183], v[28:31], v[20:23]
	buffer_load_dwordx4 v60, s[4:7], s18 offen offset:1024 lds
	ds_read_b128 v[24:27], v61 offset:12288
	ds_read_b128 v[28:31], v61 offset:30720
	s_waitcnt lgkmcnt(4)
	v_mfma_f32_16x16x32_bf16 v[0:3], a[40:43], v[32:35], v[0:3]
	buffer_load_dwordx4 v60, s[4:7], s18 offen offset:2048 lds
	v_mfma_f32_16x16x32_bf16 v[4:7], a[40:43], v[36:39], v[4:7]
	buffer_load_dwordx4 v60, s[4:7], s18 offen offset:3072 lds
	v_mfma_f32_16x16x32_bf16 v[8:11], a[112:115], v[32:35], v[8:11]
	s_add_u32 s17, s32, 8192
	s_mov_b32 m0, s17
	s_add_u32 s18, s31, 8192
	buffer_load_dwordx4 v60, s[4:7], s18 offen offset:0 lds
	s_add_u32 s31, s31, 36864
	s_sub_u32 s32, s44, s32
	v_mfma_f32_16x16x32_bf16 v[12:15], a[112:115], v[36:39], v[12:15]
	v_mfma_f32_16x16x32_bf16 v[16:19], a[184:187], v[32:35], v[16:19]
	v_mfma_f32_16x16x32_bf16 v[20:23], a[184:187], v[36:39], v[20:23]
	ds_read_b128 v[32:35], v61 offset:13312
	ds_read_b128 v[36:39], v61 offset:31744
	s_branch .gaft_230
.gnopf2_229:
	buffer_load_dword v63, v67, s[4:7], 0 offen sc1
.gnopf_228:
	s_waitcnt lgkmcnt(4)
	v_mfma_f32_16x16x32_bf16 v[0:3], a[36:39], v[24:27], v[0:3]
	v_mfma_f32_16x16x32_bf16 v[4:7], a[36:39], v[28:31], v[4:7]
	v_mfma_f32_16x16x32_bf16 v[8:11], a[108:111], v[24:27], v[8:11]
	v_mfma_f32_16x16x32_bf16 v[12:15], a[108:111], v[28:31], v[12:15]
	v_mfma_f32_16x16x32_bf16 v[16:19], a[180:183], v[24:27], v[16:19]
	v_mfma_f32_16x16x32_bf16 v[20:23], a[180:183], v[28:31], v[20:23]
	ds_read_b128 v[24:27], v61 offset:12288
	ds_read_b128 v[28:31], v61 offset:30720
	s_waitcnt lgkmcnt(4)
	v_mfma_f32_16x16x32_bf16 v[0:3], a[40:43], v[32:35], v[0:3]
	v_mfma_f32_16x16x32_bf16 v[4:7], a[40:43], v[36:39], v[4:7]
	v_mfma_f32_16x16x32_bf16 v[8:11], a[112:115], v[32:35], v[8:11]
	v_mfma_f32_16x16x32_bf16 v[12:15], a[112:115], v[36:39], v[12:15]
	v_mfma_f32_16x16x32_bf16 v[16:19], a[184:187], v[32:35], v[16:19]
	v_mfma_f32_16x16x32_bf16 v[20:23], a[184:187], v[36:39], v[20:23]
	ds_read_b128 v[32:35], v61 offset:13312
	ds_read_b128 v[36:39], v61 offset:31744
.gaft_230:
	s_waitcnt lgkmcnt(4)
	v_mfma_f32_16x16x32_bf16 v[0:3], a[44:47], v[40:43], v[0:3]
	v_mfma_f32_16x16x32_bf16 v[4:7], a[44:47], v[44:47], v[4:7]
	v_mfma_f32_16x16x32_bf16 v[8:11], a[116:119], v[40:43], v[8:11]
	v_mfma_f32_16x16x32_bf16 v[12:15], a[116:119], v[44:47], v[12:15]
	v_mfma_f32_16x16x32_bf16 v[16:19], a[188:191], v[40:43], v[16:19]
	v_mfma_f32_16x16x32_bf16 v[20:23], a[188:191], v[44:47], v[20:23]
	ds_read_b128 v[40:43], v61 offset:14336
	ds_read_b128 v[44:47], v61 offset:32768
	s_waitcnt lgkmcnt(4)
	v_mfma_f32_16x16x32_bf16 v[0:3], a[48:51], v[24:27], v[0:3]
	v_mfma_f32_16x16x32_bf16 v[4:7], a[48:51], v[28:31], v[4:7]
	v_mfma_f32_16x16x32_bf16 v[8:11], a[120:123], v[24:27], v[8:11]
	v_mfma_f32_16x16x32_bf16 v[12:15], a[120:123], v[28:31], v[12:15]
	v_mfma_f32_16x16x32_bf16 v[16:19], a[192:195], v[24:27], v[16:19]
	v_mfma_f32_16x16x32_bf16 v[20:23], a[192:195], v[28:31], v[20:23]
	ds_read_b128 v[24:27], v61 offset:15360
	ds_read_b128 v[28:31], v61 offset:33792
	s_waitcnt lgkmcnt(4)
	v_mfma_f32_16x16x32_bf16 v[0:3], a[52:55], v[32:35], v[0:3]
	v_mfma_f32_16x16x32_bf16 v[4:7], a[52:55], v[36:39], v[4:7]
	v_mfma_f32_16x16x32_bf16 v[8:11], a[124:127], v[32:35], v[8:11]
	v_mfma_f32_16x16x32_bf16 v[12:15], a[124:127], v[36:39], v[12:15]
	v_mfma_f32_16x16x32_bf16 v[16:19], a[196:199], v[32:35], v[16:19]
	v_mfma_f32_16x16x32_bf16 v[20:23], a[196:199], v[36:39], v[20:23]
	ds_read_b128 v[32:35], v61 offset:16384
	ds_read_b128 v[36:39], v61 offset:34816
	s_waitcnt lgkmcnt(4)
	v_mfma_f32_16x16x32_bf16 v[0:3], a[56:59], v[40:43], v[0:3]
	v_mfma_f32_16x16x32_bf16 v[4:7], a[56:59], v[44:47], v[4:7]
	v_mfma_f32_16x16x32_bf16 v[8:11], a[128:131], v[40:43], v[8:11]
	v_mfma_f32_16x16x32_bf16 v[12:15], a[128:131], v[44:47], v[12:15]
	v_mfma_f32_16x16x32_bf16 v[16:19], a[200:203], v[40:43], v[16:19]
	v_mfma_f32_16x16x32_bf16 v[20:23], a[200:203], v[44:47], v[20:23]
	ds_read_b128 v[40:43], v61 offset:17408
	ds_read_b128 v[44:47], v61 offset:35840
	s_waitcnt lgkmcnt(4)
	v_mfma_f32_16x16x32_bf16 v[0:3], a[60:63], v[24:27], v[0:3]
	v_mfma_f32_16x16x32_bf16 v[4:7], a[60:63], v[28:31], v[4:7]
	v_mfma_f32_16x16x32_bf16 v[8:11], a[132:135], v[24:27], v[8:11]
	v_mfma_f32_16x16x32_bf16 v[12:15], a[132:135], v[28:31], v[12:15]
	v_mfma_f32_16x16x32_bf16 v[16:19], a[204:207], v[24:27], v[16:19]
	v_mfma_f32_16x16x32_bf16 v[20:23], a[204:207], v[28:31], v[20:23]
	s_waitcnt lgkmcnt(2)
	v_mfma_f32_16x16x32_bf16 v[0:3], a[64:67], v[32:35], v[0:3]
	v_mfma_f32_16x16x32_bf16 v[4:7], a[64:67], v[36:39], v[4:7]
	v_mfma_f32_16x16x32_bf16 v[8:11], a[136:139], v[32:35], v[8:11]
	v_mfma_f32_16x16x32_bf16 v[12:15], a[136:139], v[36:39], v[12:15]
	v_mfma_f32_16x16x32_bf16 v[16:19], a[208:211], v[32:35], v[16:19]
	v_mfma_f32_16x16x32_bf16 v[20:23], a[208:211], v[36:39], v[20:23]
	s_waitcnt lgkmcnt(0)
	v_mfma_f32_16x16x32_bf16 v[0:3], a[68:71], v[40:43], v[0:3]
	v_mfma_f32_16x16x32_bf16 v[4:7], a[68:71], v[44:47], v[4:7]
	v_mfma_f32_16x16x32_bf16 v[8:11], a[140:143], v[40:43], v[8:11]
	v_mfma_f32_16x16x32_bf16 v[12:15], a[140:143], v[44:47], v[12:15]
	v_mfma_f32_16x16x32_bf16 v[16:19], a[212:215], v[40:43], v[16:19]
	v_mfma_f32_16x16x32_bf16 v[20:23], a[212:215], v[44:47], v[20:23]
	s_sub_i32 s57, s28, 3
	s_max_i32 s57, s57, 0
	v_cmp_gt_u32 vcc, s57, v69
	s_cbranch_vccz .pck_231
	s_mov_b32 s20, 400000
.pre_232:
	buffer_load_dword v69, v68, s[4:7], 0 offen sc1
	s_waitcnt vmcnt(0)
	v_cmp_gt_u32 vcc, s57, v69
	s_cbranch_vccz .pok_233
	s_sub_u32 s20, s20, 1
	s_cmp_lg_u32 s20, 0
	s_cbranch_scc1 .pre_232
	s_branch L_FAIL
.pok_233:
.pck_231:
	s_and_b32 s34, s28, 3
	s_mul_i32 s34, s34, 110592
	s_add_u32 s34, s34, s55
	v_cvt_pk_bf16_f32 v0, v0, v1
	v_cvt_pk_bf16_f32 v1, v2, v3
	v_cvt_pk_bf16_f32 v2, v4, v5
	v_cvt_pk_bf16_f32 v3, v6, v7
	buffer_store_dwordx2 v[0:1], v66, s[4:7], s34 offen offset:0
	buffer_store_dwordx2 v[2:3], v66, s[4:7], s34 offen offset:512
	v_cvt_pk_bf16_f32 v8, v8, v9
	v_cvt_pk_bf16_f32 v9, v10, v11
	v_cvt_pk_bf16_f32 v10, v12, v13
	v_cvt_pk_bf16_f32 v11, v14, v15
	buffer_store_dwordx2 v[8:9], v66, s[4:7], s34 offen offset:1024
	buffer_store_dwordx2 v[10:11], v66, s[4:7], s34 offen offset:1536
	v_cvt_pk_bf16_f32 v16, v16, v17
	v_cvt_pk_bf16_f32 v17, v18, v19
	v_cvt_pk_bf16_f32 v18, v20, v21
	v_cvt_pk_bf16_f32 v19, v22, v23
	buffer_store_dwordx2 v[16:17], v66, s[4:7], s34 offen offset:2048
	buffer_store_dwordx2 v[18:19], v66, s[4:7], s34 offen offset:2560
	s_add_u32 s34, s34, 110592
	v_xor_b32 v62, s46, v62
	v_xor_b32 v67, s46, v67
	s_add_u32 s28, s28, 1
	s_cmp_lg_u32 s29, 0
	s_cbranch_scc1 .gloop_223
	s_cmp_ge_u32 s28, 64
	s_cbranch_scc1 .gnofin_235
	s_waitcnt vmcnt(6)
	s_add_u32 s37, s28, 1
	v_cmp_gt_u32 vcc, s37, v63
	s_cbranch_vccnz .gnofin_235
	s_add_u32 s17, s32, 0
	s_mov_b32 m0, s17
	s_add_u32 s18, s31, 0
	buffer_load_dwordx4 v60, s[4:7], s18 offen offset:0 lds
	buffer_load_dwordx4 v60, s[4:7], s18 offen offset:1024 lds
	buffer_load_dwordx4 v60, s[4:7], s18 offen offset:2048 lds
	buffer_load_dwordx4 v60, s[4:7], s18 offen offset:3072 lds
	s_add_u32 s17, s32, 4096
	s_mov_b32 m0, s17
	s_add_u32 s18, s31, 4096
	buffer_load_dwordx4 v60, s[4:7], s18 offen offset:0 lds
	buffer_load_dwordx4 v60, s[4:7], s18 offen offset:1024 lds
	buffer_load_dwordx4 v60, s[4:7], s18 offen offset:2048 lds
	buffer_load_dwordx4 v60, s[4:7], s18 offen offset:3072 lds
	s_add_u32 s17, s32, 8192
	s_mov_b32 m0, s17
	s_add_u32 s18, s31, 8192
	buffer_load_dwordx4 v60, s[4:7], s18 offen offset:0 lds
	s_add_u32 s31, s31, 36864
	s_sub_u32 s32, s44, s32
	s_waitcnt vmcnt(9)
	v_mov_b32 v65, s28
	s_mov_b64 exec, 1
	buffer_store_dword v65, v64, s[4:7], s30 offen
	s_mov_b64 exec, -1
	s_waitcnt vmcnt(1)
	s_branch .ggo_225
.gnofin_235:
	s_waitcnt vmcnt(0)
	v_mov_b32 v65, s28
	s_mov_b64 exec, 1
	buffer_store_dword v65, v64, s[4:7], s30 offen
	s_mov_b64 exec, -1
	s_cmp_lt_u32 s28, 64
	s_cbranch_scc1 .gloop_223
	s_branch L_END
.a1v_222:
	s_mul_i32 s17, s15, 9216
	s_add_u32 s31, s31, s17
	s_mov_b32 s32, s17
	s_lshl_b32 s44, s17, 1
	s_add_u32 s44, s44, 36864
	s_mov_b32 s33, 0
	s_mov_b32 s28, 0
	s_mov_b32 s29, 0
	s_mov_b32 s55, s34
.gloop_236:
	s_cmp_lg_u32 s29, 0
	s_cbranch_scc1 .gpref_237
	s_add_u32 s37, s28, 1
	s_mov_b32 s20, 400000
.pre_239:
	buffer_load_dword v63, v62, s[4:7], 0 offen sc1
	s_waitcnt vmcnt(0)
	v_cmp_gt_u32 vcc, s37, v63
	s_cbranch_vccz .pok_240
	s_sub_u32 s20, s20, 1
	s_cmp_lg_u32 s20, 0
	s_cbranch_scc1 .pre_239
	s_branch L_FAIL
.pok_240:
	s_add_u32 s17, s32, 0
	s_mov_b32 m0, s17
	s_add_u32 s18, s31, 0
	buffer_load_dwordx4 v60, s[4:7], s18 offen offset:0 lds
	buffer_load_dwordx4 v60, s[4:7], s18 offen offset:1024 lds
	buffer_load_dwordx4 v60, s[4:7], s18 offen offset:2048 lds
	buffer_load_dwordx4 v60, s[4:7], s18 offen offset:3072 lds
	s_add_u32 s17, s32, 4096
	s_mov_b32 m0, s17
	s_add_u32 s18, s31, 4096
	buffer_load_dwordx4 v60, s[4:7], s18 offen offset:0 lds
	buffer_load_dwordx4 v60, s[4:7], s18 offen offset:1024 lds
	buffer_load_dwordx4 v60, s[4:7], s18 offen offset:2048 lds
	buffer_load_dwordx4 v60, s[4:7], s18 offen offset:3072 lds
	s_add_u32 s17, s32, 8192
	s_mov_b32 m0, s17
	s_add_u32 s18, s31, 8192
	buffer_load_dwordx4 v60, s[4:7], s18 offen offset:0 lds
	s_add_u32 s31, s31, 36864
	s_sub_u32 s32, s44, s32
	s_waitcnt vmcnt(0)
	s_branch .ggo_238
.gpref_237:
	s_waitcnt vmcnt(3)
.ggo_238:
	s_barrier
	s_mov_b32 s29, 0
	v_add_u32 v61, s33, v60
	s_sub_u32 s33, 36864, s33
	buffer_load_dword v63, v67, s[4:7], 0 offen sc1
	buffer_load_dword v69, v68, s[4:7], 0 offen sc1
	ds_read_b128 v[24:27], v61 offset:0
	ds_read_b128 v[28:31], v61 offset:18432
	ds_read_b128 v[32:35], v61 offset:1024
	ds_read_b128 v[36:39], v61 offset:19456
	ds_read_b128 v[40:43], v61 offset:2048
	ds_read_b128 v[44:47], v61 offset:20480
	s_waitcnt lgkmcnt(4)
	v_mfma_f32_16x16x32_bf16 v[0:3], v[24:27], a[0:3], 0
	v_mfma_f32_16x16x32_bf16 v[4:7], v[28:31], a[0:3], 0
	v_mfma_f32_16x16x32_bf16 v[8:11], v[24:27], a[72:75], 0
	v_mfma_f32_16x16x32_bf16 v[12:15], v[28:31], a[72:75], 0
	v_mfma_f32_16x16x32_bf16 v[16:19], v[24:27], a[144:147], 0
	v_mfma_f32_16x16x32_bf16 v[20:23], v[28:31], a[144:147], 0
	ds_read_b128 v[24:27], v61 offset:3072
	ds_read_b128 v[28:31], v61 offset:21504
	s_waitcnt lgkmcnt(4)
	v_mfma_f32_16x16x32_bf16 v[0:3], v[32:35], a[4:7], v[0:3]
	v_mfma_f32_16x16x32_bf16 v[4:7], v[36:39], a[4:7], v[4:7]
	v_mfma_f32_16x16x32_bf16 v[8:11], v[32:35], a[76:79], v[8:11]
	v_mfma_f32_16x16x32_bf16 v[12:15], v[36:39], a[76:79], v[12:15]
	v_mfma_f32_16x16x32_bf16 v[16:19], v[32:35], a[148:151], v[16:19]
	v_mfma_f32_16x16x32_bf16 v[20:23], v[36:39], a[148:151], v[20:23]
	ds_read_b128 v[32:35], v61 offset:4096
	ds_read_b128 v[36:39], v61 offset:22528
	s_waitcnt lgkmcnt(4)
	v_mfma_f32_16x16x32_bf16 v[0:3], v[40:43], a[8:11], v[0:3]
	v_mfma_f32_16x16x32_bf16 v[4:7], v[44:47], a[8:11], v[4:7]
	v_mfma_f32_16x16x32_bf16 v[8:11], v[40:43], a[80:83], v[8:11]
	v_mfma_f32_16x16x32_bf16 v[12:15], v[44:47], a[80:83], v[12:15]
	v_mfma_f32_16x16x32_bf16 v[16:19], v[40:43], a[152:155], v[16:19]
	v_mfma_f32_16x16x32_bf16 v[20:23], v[44:47], a[152:155], v[20:23]
	ds_read_b128 v[40:43], v61 offset:5120
	ds_read_b128 v[44:47], v61 offset:23552
	s_waitcnt lgkmcnt(4)
	v_mfma_f32_16x16x32_bf16 v[0:3], v[24:27], a[12:15], v[0:3]
	v_mfma_f32_16x16x32_bf16 v[4:7], v[28:31], a[12:15], v[4:7]
	v_mfma_f32_16x16x32_bf16 v[8:11], v[24:27], a[84:87], v[8:11]
	v_mfma_f32_16x16x32_bf16 v[12:15], v[28:31], a[84:87], v[12:15]
	v_mfma_f32_16x16x32_bf16 v[16:19], v[24:27], a[156:159], v[16:19]
	v_mfma_f32_16x16x32_bf16 v[20:23], v[28:31], a[156:159], v[20:23]
	ds_read_b128 v[24:27], v61 offset:6144
	ds_read_b128 v[28:31], v61 offset:24576
	s_waitcnt lgkmcnt(4)
	v_mfma_f32_16x16x32_bf16 v[0:3], v[32:35], a[16:19], v[0:3]
	v_mfma_f32_16x16x32_bf16 v[4:7], v[36:39], a[16:19], v[4:7]
	v_mfma_f32_16x16x32_bf16 v[8:11], v[32:35], a[88:91], v[8:11]
	v_mfma_f32_16x16x32_bf16 v[12:15], v[36:39], a[88:91], v[12:15]
	v_mfma_f32_16x16x32_bf16 v[16:19], v[32:35], a[160:163], v[16:19]
	v_mfma_f32_16x16x32_bf16 v[20:23], v[36:39], a[160:163], v[20:23]
	ds_read_b128 v[32:35], v61 offset:7168
	ds_read_b128 v[36:39], v61 offset:25600
	s_waitcnt lgkmcnt(4)
	v_mfma_f32_16x16x32_bf16 v[0:3], v[40:43], a[20:23], v[0:3]
	v_mfma_f32_16x16x32_bf16 v[4:7], v[44:47], a[20:23], v[4:7]
	v_mfma_f32_16x16x32_bf16 v[8:11], v[40:43], a[92:95], v[8:11]
	v_mfma_f32_16x16x32_bf16 v[12:15], v[44:47], a[92:95], v[12:15]
	v_mfma_f32_16x16x32_bf16 v[16:19], v[40:43], a[164:167], v[16:19]
	v_mfma_f32_16x16x32_bf16 v[20:23], v[44:47], a[164:167], v[20:23]
	ds_read_b128 v[40:43], v61 offset:8192
	ds_read_b128 v[44:47], v61 offset:26624
	s_waitcnt lgkmcnt(4)
	v_mfma_f32_16x16x32_bf16 v[0:3], v[24:27], a[24:27], v[0:3]
	v_mfma_f32_16x16x32_bf16 v[4:7], v[28:31], a[24:27], v[4:7]
	v_mfma_f32_16x16x32_bf16 v[8:11], v[24:27], a[96:99], v[8:11]
	v_mfma_f32_16x16x32_bf16 v[12:15], v[28:31], a[96:99], v[12:15]
	v_mfma_f32_16x16x32_bf16 v[16:19], v[24:27], a[168:171], v[16:19]
	v_mfma_f32_16x16x32_bf16 v[20:23], v[28:31], a[168:171], v[20:23]
	ds_read_b128 v[24:27], v61 offset:9216
	ds_read_b128 v[28:31], v61 offset:27648
	s_waitcnt lgkmcnt(4)
	v_mfma_f32_16x16x32_bf16 v[0:3], v[32:35], a[28:31], v[0:3]
	v_mfma_f32_16x16x32_bf16 v[4:7], v[36:39], a[28:31], v[4:7]
	v_mfma_f32_16x16x32_bf16 v[8:11], v[32:35], a[100:103], v[8:11]
	v_mfma_f32_16x16x32_bf16 v[12:15], v[36:39], a[100:103], v[12:15]
	v_mfma_f32_16x16x32_bf16 v[16:19], v[32:35], a[172:175], v[16:19]
	v_mfma_f32_16x16x32_bf16 v[20:23], v[36:39], a[172:175], v[20:23]
	ds_read_b128 v[32:35], v61 offset:10240
	ds_read_b128 v[36:39], v61 offset:28672
	s_waitcnt lgkmcnt(4)
	v_mfma_f32_16x16x32_bf16 v[0:3], v[40:43], a[32:35], v[0:3]
	v_mfma_f32_16x16x32_bf16 v[4:7], v[44:47], a[32:35], v[4:7]
	v_mfma_f32_16x16x32_bf16 v[8:11], v[40:43], a[104:107], v[8:11]
	v_mfma_f32_16x16x32_bf16 v[12:15], v[44:47], a[104:107], v[12:15]
	v_mfma_f32_16x16x32_bf16 v[16:19], v[40:43], a[176:179], v[16:19]
	v_mfma_f32_16x16x32_bf16 v[20:23], v[44:47], a[176:179], v[20:23]
	ds_read_b128 v[40:43], v61 offset:11264
	ds_read_b128 v[44:47], v61 offset:29696
	s_waitcnt vmcnt(0)
	v_mov_b32 v65, s28
	s_mov_b64 exec, 1
	buffer_store_dword v65, v64, s[4:7], s30 offen
	s_mov_b64 exec, -1
	s_cmp_ge_u32 s28, 63
	s_cbranch_scc1 .gnopf_241
	s_add_u32 s37, s28, 2
	v_cmp_gt_u32 vcc, s37, v63
	s_cbranch_vccnz .gnopf2_242
	s_mov_b32 s29, 1
	s_waitcnt lgkmcnt(4)
	v_mfma_f32_16x16x32_bf16 v[0:3], v[24:27], a[36:39], v[0:3]
	s_add_u32 s17, s32, 0
	s_mov_b32 m0, s17
	s_add_u32 s18, s31, 0
	buffer_load_dwordx4 v60, s[4:7], s18 offen offset:0 lds
	v_mfma_f32_16x16x32_bf16 v[4:7], v[28:31], a[36:39], v[4:7]
	buffer_load_dwordx4 v60, s[4:7], s18 offen offset:1024 lds
	v_mfma_f32_16x16x32_bf16 v[8:11], v[24:27], a[108:111], v[8:11]
	buffer_load_dwordx4 v60, s[4:7], s18 offen offset:2048 lds
	v_mfma_f32_16x16x32_bf16 v[12:15], v[28:31], a[108:111], v[12:15]
	buffer_load_dwordx4 v60, s[4:7], s18 offen offset:3072 lds
	v_mfma_f32_16x16x32_bf16 v[16:19], v[24:27], a[180:183], v[16:19]
	s_add_u32 s17, s32, 4096
	s_mov_b32 m0, s17
	s_add_u32 s18, s31, 4096
	buffer_load_dwordx4 v60, s[4:7], s18 offen offset:0 lds
	v_mfma_f32_16x16x32_bf16 v[20:23], v[28:31], a[180:183], v[20:23]
	buffer_load_dwordx4 v60, s[4:7], s18 offen offset:1024 lds
	ds_read_b128 v[24:27], v61 offset:12288
	ds_read_b128 v[28:31], v61 offset:30720
	s_waitcnt lgkmcnt(4)
	v_mfma_f32_16x16x32_bf16 v[0:3], v[32:35], a[40:43], v[0:3]
	buffer_load_dwordx4 v60, s[4:7], s18 offen offset:2048 lds
	v_mfma_f32_16x16x32_bf16 v[4:7], v[36:39], a[40:43], v[4:7]
	buffer_load_dwordx4 v60, s[4:7], s18 offen offset:3072 lds
	v_mfma_f32_16x16x32_bf16 v[8:11], v[32:35], a[112:115], v[8:11]
	s_add_u32 s17, s32, 8192
	s_mov_b32 m0, s17
	s_add_u32 s18, s31, 8192
	buffer_load_dwordx4 v60, s[4:7], s18 offen offset:0 lds
	s_add_u32 s31, s31, 36864
	s_sub_u32 s32, s44, s32
	v_mfma_f32_16x16x32_bf16 v[12:15], v[36:39], a[112:115], v[12:15]
	v_mfma_f32_16x16x32_bf16 v[16:19], v[32:35], a[184:187], v[16:19]
	v_mfma_f32_16x16x32_bf16 v[20:23], v[36:39], a[184:187], v[20:23]
	ds_read_b128 v[32:35], v61 offset:13312
	ds_read_b128 v[36:39], v61 offset:31744
	s_branch .gaft_243
.gnopf2_242:
	buffer_load_dword v63, v67, s[4:7], 0 offen sc1
.gnopf_241:
	s_waitcnt lgkmcnt(4)
	v_mfma_f32_16x16x32_bf16 v[0:3], v[24:27], a[36:39], v[0:3]
	v_mfma_f32_16x16x32_bf16 v[4:7], v[28:31], a[36:39], v[4:7]
	v_mfma_f32_16x16x32_bf16 v[8:11], v[24:27], a[108:111], v[8:11]
	v_mfma_f32_16x16x32_bf16 v[12:15], v[28:31], a[108:111], v[12:15]
	v_mfma_f32_16x16x32_bf16 v[16:19], v[24:27], a[180:183], v[16:19]
	v_mfma_f32_16x16x32_bf16 v[20:23], v[28:31], a[180:183], v[20:23]
	ds_read_b128 v[24:27], v61 offset:12288
	ds_read_b128 v[28:31], v61 offset:30720
	s_waitcnt lgkmcnt(4)
	v_mfma_f32_16x16x32_bf16 v[0:3], v[32:35], a[40:43], v[0:3]
	v_mfma_f32_16x16x32_bf16 v[4:7], v[36:39], a[40:43], v[4:7]
	v_mfma_f32_16x16x32_bf16 v[8:11], v[32:35], a[112:115], v[8:11]
	v_mfma_f32_16x16x32_bf16 v[12:15], v[36:39], a[112:115], v[12:15]
	v_mfma_f32_16x16x32_bf16 v[16:19], v[32:35], a[184:187], v[16:19]
	v_mfma_f32_16x16x32_bf16 v[20:23], v[36:39], a[184:187], v[20:23]
	ds_read_b128 v[32:35], v61 offset:13312
	ds_read_b128 v[36:39], v61 offset:31744
.gaft_243:
	s_waitcnt lgkmcnt(4)
	v_mfma_f32_16x16x32_bf16 v[0:3], v[40:43], a[44:47], v[0:3]
	v_mfma_f32_16x16x32_bf16 v[4:7], v[44:47], a[44:47], v[4:7]
	v_mfma_f32_16x16x32_bf16 v[8:11], v[40:43], a[116:119], v[8:11]
	v_mfma_f32_16x16x32_bf16 v[12:15], v[44:47], a[116:119], v[12:15]
	v_mfma_f32_16x16x32_bf16 v[16:19], v[40:43], a[188:191], v[16:19]
	v_mfma_f32_16x16x32_bf16 v[20:23], v[44:47], a[188:191], v[20:23]
	ds_read_b128 v[40:43], v61 offset:14336
	ds_read_b128 v[44:47], v61 offset:32768
	s_waitcnt lgkmcnt(4)
	v_mfma_f32_16x16x32_bf16 v[0:3], v[24:27], a[48:51], v[0:3]
	v_mfma_f32_16x16x32_bf16 v[4:7], v[28:31], a[48:51], v[4:7]
	v_mfma_f32_16x16x32_bf16 v[8:11], v[24:27], a[120:123], v[8:11]
	v_mfma_f32_16x16x32_bf16 v[12:15], v[28:31], a[120:123], v[12:15]
	v_mfma_f32_16x16x32_bf16 v[16:19], v[24:27], a[192:195], v[16:19]
	v_mfma_f32_16x16x32_bf16 v[20:23], v[28:31], a[192:195], v[20:23]
	ds_read_b128 v[24:27], v61 offset:15360
	ds_read_b128 v[28:31], v61 offset:33792
	s_waitcnt lgkmcnt(4)
	v_mfma_f32_16x16x32_bf16 v[0:3], v[32:35], a[52:55], v[0:3]
	v_mfma_f32_16x16x32_bf16 v[4:7], v[36:39], a[52:55], v[4:7]
	v_mfma_f32_16x16x32_bf16 v[8:11], v[32:35], a[124:127], v[8:11]
	v_mfma_f32_16x16x32_bf16 v[12:15], v[36:39], a[124:127], v[12:15]
	v_mfma_f32_16x16x32_bf16 v[16:19], v[32:35], a[196:199], v[16:19]
	v_mfma_f32_16x16x32_bf16 v[20:23], v[36:39], a[196:199], v[20:23]
	ds_read_b128 v[32:35], v61 offset:16384
	ds_read_b128 v[36:39], v61 offset:34816
	s_waitcnt lgkmcnt(4)
	v_mfma_f32_16x16x32_bf16 v[0:3], v[40:43], a[56:59], v[0:3]
	v_mfma_f32_16x16x32_bf16 v[4:7], v[44:47], a[56:59], v[4:7]
	v_mfma_f32_16x16x32_bf16 v[8:11], v[40:43], a[128:131], v[8:11]
	v_mfma_f32_16x16x32_bf16 v[12:15], v[44:47], a[128:131], v[12:15]
	v_mfma_f32_16x16x32_bf16 v[16:19], v[40:43], a[200:203], v[16:19]
	v_mfma_f32_16x16x32_bf16 v[20:23], v[44:47], a[200:203], v[20:23]
	ds_read_b128 v[40:43], v61 offset:17408
	ds_read_b128 v[44:47], v61 offset:35840
	s_waitcnt lgkmcnt(4)
	v_mfma_f32_16x16x32_bf16 v[0:3], v[24:27], a[60:63], v[0:3]
	v_mfma_f32_16x16x32_bf16 v[4:7], v[28:31], a[60:63], v[4:7]
	v_mfma_f32_16x16x32_bf16 v[8:11], v[24:27], a[132:135], v[8:11]
	v_mfma_f32_16x16x32_bf16 v[12:15], v[28:31], a[132:135], v[12:15]
	v_mfma_f32_16x16x32_bf16 v[16:19], v[24:27], a[204:207], v[16:19]
	v_mfma_f32_16x16x32_bf16 v[20:23], v[28:31], a[204:207], v[20:23]
	s_waitcnt lgkmcnt(2)
	v_mfma_f32_16x16x32_bf16 v[0:3], v[32:35], a[64:67], v[0:3]
	v_mfma_f32_16x16x32_bf16 v[4:7], v[36:39], a[64:67], v[4:7]
	v_mfma_f32_16x16x32_bf16 v[8:11], v[32:35], a[136:139], v[8:11]
	v_mfma_f32_16x16x32_bf16 v[12:15], v[36:39], a[136:139], v[12:15]
	v_mfma_f32_16x16x32_bf16 v[16:19], v[32:35], a[208:211], v[16:19]
	v_mfma_f32_16x16x32_bf16 v[20:23], v[36:39], a[208:211], v[20:23]
	s_waitcnt lgkmcnt(0)
	v_mfma_f32_16x16x32_bf16 v[0:3], v[40:43], a[68:71], v[0:3]
	v_mfma_f32_16x16x32_bf16 v[4:7], v[44:47], a[68:71], v[4:7]
	v_mfma_f32_16x16x32_bf16 v[8:11], v[40:43], a[140:143], v[8:11]
	v_mfma_f32_16x16x32_bf16 v[12:15], v[44:47], a[140:143], v[12:15]
	v_mfma_f32_16x16x32_bf16 v[16:19], v[40:43], a[212:215], v[16:19]
	v_mfma_f32_16x16x32_bf16 v[20:23], v[44:47], a[212:215], v[20:23]
	s_sub_i32 s57, s28, 3
	s_max_i32 s57, s57, 0
	v_cmp_gt_u32 vcc, s57, v69
	s_cbranch_vccz .pck_244
	s_mov_b32 s20, 400000
.pre_245:
	buffer_load_dword v69, v68, s[4:7], 0 offen sc1
	s_waitcnt vmcnt(0)
	v_cmp_gt_u32 vcc, s57, v69
	s_cbranch_vccz .pok_246
	s_sub_u32 s20, s20, 1
	s_cmp_lg_u32 s20, 0
	s_cbranch_scc1 .pre_245
	s_branch L_FAIL
.pok_246:
.pck_244:
	s_and_b32 s34, s28, 3
	s_mul_i32 s34, s34, 110592
	s_add_u32 s34, s34, s55
	v_cvt_pk_bf16_f32 v0, v0, v1
	v_cvt_pk_bf16_f32 v1, v2, v3
	v_cvt_pk_bf16_f32 v2, v4, v5
	v_cvt_pk_bf16_f32 v3, v6, v7
	buffer_store_dwordx4 v[0:3], v60, s[4:7], s34 offen offset:0
	v_cvt_pk_bf16_f32 v8, v8, v9
	v_cvt_pk_bf16_f32 v9, v10, v11
	v_cvt_pk_bf16_f32 v10, v12, v13
	v_cvt_pk_bf16_f32 v11, v14, v15
	buffer_store_dwordx4 v[8:11], v60, s[4:7], s34 offen offset:1024
	v_cvt_pk_bf16_f32 v16, v16, v17
	v_cvt_pk_bf16_f32 v17, v18, v19
	v_cvt_pk_bf16_f32 v18, v20, v21
	v_cvt_pk_bf16_f32 v19, v22, v23
	buffer_store_dwordx4 v[16:19], v60, s[4:7], s34 offen offset:2048
	s_add_u32 s34, s34, 110592
	v_xor_b32 v62, s46, v62
	v_xor_b32 v67, s46, v67
	s_add_u32 s28, s28, 1
	s_cmp_lg_u32 s29, 0
	s_cbranch_scc1 .gloop_236
	s_cmp_ge_u32 s28, 64
	s_cbranch_scc1 .gnofin_248
	s_waitcnt vmcnt(3)
	s_add_u32 s37, s28, 1
	v_cmp_gt_u32 vcc, s37, v63
	s_cbranch_vccnz .gnofin_248
	s_add_u32 s17, s32, 0
	s_mov_b32 m0, s17
	s_add_u32 s18, s31, 0
	buffer_load_dwordx4 v60, s[4:7], s18 offen offset:0 lds
	buffer_load_dwordx4 v60, s[4:7], s18 offen offset:1024 lds
	buffer_load_dwordx4 v60, s[4:7], s18 offen offset:2048 lds
	buffer_load_dwordx4 v60, s[4:7], s18 offen offset:3072 lds
	s_add_u32 s17, s32, 4096
	s_mov_b32 m0, s17
	s_add_u32 s18, s31, 4096
	buffer_load_dwordx4 v60, s[4:7], s18 offen offset:0 lds
	buffer_load_dwordx4 v60, s[4:7], s18 offen offset:1024 lds
	buffer_load_dwordx4 v60, s[4:7], s18 offen offset:2048 lds
	buffer_load_dwordx4 v60, s[4:7], s18 offen offset:3072 lds
	s_add_u32 s17, s32, 8192
	s_mov_b32 m0, s17
	s_add_u32 s18, s31, 8192
	buffer_load_dwordx4 v60, s[4:7], s18 offen offset:0 lds
	s_add_u32 s31, s31, 36864
	s_sub_u32 s32, s44, s32
	s_waitcnt vmcnt(9)
	v_mov_b32 v65, s28
	s_mov_b64 exec, 1
	buffer_store_dword v65, v64, s[4:7], s30 offen
	s_mov_b64 exec, -1
	s_waitcnt vmcnt(1)
	s_branch .ggo_238
.gnofin_248:
	s_waitcnt vmcnt(0)
	v_mov_b32 v65, s28
	s_mov_b64 exec, 1
	buffer_store_dword v65, v64, s[4:7], s30 offen
	s_mov_b64 exec, -1
	s_cmp_lt_u32 s28, 64
	s_cbranch_scc1 .gloop_236
	s_branch L_END
L_A1_CE:
L_A1_DEV:
	s_cmp_eq_u32 s38, 2
	s_cbranch_scc1 .a1v_363
	s_mul_i32 s17, s15, 9216
	s_add_u32 s31, s31, s17
	s_mov_b32 s32, s17
	s_lshl_b32 s44, s17, 1
	s_add_u32 s44, s44, 36864
	s_mov_b32 s33, 0
	s_mov_b32 s28, 0
	s_mov_b32 s29, 0
	s_mov_b32 s55, s34
.gloop_364:
	s_cmp_lg_u32 s29, 0
	s_cbranch_scc1 .gpref_365
	s_add_u32 s37, s28, 1
	s_mov_b32 s20, 400000
.pre_367:
	buffer_load_dword v63, v62, s[4:7], 0 offen sc1
	s_waitcnt vmcnt(0)
	v_cmp_gt_u32 vcc, s37, v63
	s_cbranch_vccz .pok_368
	s_sub_u32 s20, s20, 1
	s_cmp_lg_u32 s20, 0
	s_cbranch_scc1 .pre_367
	s_branch L_FAIL
.pok_368:
	s_add_u32 s17, s32, 0
	s_mov_b32 m0, s17
	s_add_u32 s18, s31, 0
	buffer_load_dwordx4 v60, s[4:7], s18 offen offset:0 lds
	buffer_load_dwordx4 v60, s[4:7], s18 offen offset:1024 lds
	buffer_load_dwordx4 v60, s[4:7], s18 offen offset:2048 lds
	buffer_load_dwordx4 v60, s[4:7], s18 offen offset:3072 lds
	s_add_u32 s17, s32, 4096
	s_mov_b32 m0, s17
	s_add_u32 s18, s31, 4096
	buffer_load_dwordx4 v60, s[4:7], s18 offen offset:0 lds
	buffer_load_dwordx4 v60, s[4:7], s18 offen offset:1024 lds
	buffer_load_dwordx4 v60, s[4:7], s18 offen offset:2048 lds
	buffer_load_dwordx4 v60, s[4:7], s18 offen offset:3072 lds
	s_add_u32 s17, s32, 8192
	s_mov_b32 m0, s17
	s_add_u32 s18, s31, 8192
	buffer_load_dwordx4 v60, s[4:7], s18 offen offset:0 lds
	s_add_u32 s31, s31, 36864
	s_sub_u32 s32, s44, s32
	s_waitcnt vmcnt(0)
	s_branch .ggo_366
.gpref_365:
	s_waitcnt vmcnt(6)
.ggo_366:
	s_barrier
	s_mov_b32 s29, 0
	v_add_u32 v61, s33, v60
	s_sub_u32 s33, 36864, s33
	buffer_load_dword v63, v67, s[4:7], 0 offen sc1
	buffer_load_dword v69, v68, s[4:7], 0 offen sc1
	ds_read_b128 v[24:27], v61 offset:0
	ds_read_b128 v[28:31], v61 offset:18432
	ds_read_b128 v[32:35], v61 offset:1024
	ds_read_b128 v[36:39], v61 offset:19456
	ds_read_b128 v[40:43], v61 offset:2048
	ds_read_b128 v[44:47], v61 offset:20480
	s_waitcnt lgkmcnt(4)
	v_mfma_f32_16x16x32_bf16 v[0:3], a[0:3], v[24:27], 0
	v_mfma_f32_16x16x32_bf16 v[4:7], a[0:3], v[28:31], 0
	v_mfma_f32_16x16x32_bf16 v[8:11], a[72:75], v[24:27], 0
	v_mfma_f32_16x16x32_bf16 v[12:15], a[72:75], v[28:31], 0
	v_mfma_f32_16x16x32_bf16 v[16:19], a[144:147], v[24:27], 0
	v_mfma_f32_16x16x32_bf16 v[20:23], a[144:147], v[28:31], 0
	ds_read_b128 v[24:27], v61 offset:3072
	ds_read_b128 v[28:31], v61 offset:21504
	s_waitcnt lgkmcnt(4)
	v_mfma_f32_16x16x32_bf16 v[0:3], a[4:7], v[32:35], v[0:3]
	v_mfma_f32_16x16x32_bf16 v[4:7], a[4:7], v[36:39], v[4:7]
	v_mfma_f32_16x16x32_bf16 v[8:11], a[76:79], v[32:35], v[8:11]
	v_mfma_f32_16x16x32_bf16 v[12:15], a[76:79], v[36:39], v[12:15]
	v_mfma_f32_16x16x32_bf16 v[16:19], a[148:151], v[32:35], v[16:19]
	v_mfma_f32_16x16x32_bf16 v[20:23], a[148:151], v[36:39], v[20:23]
	ds_read_b128 v[32:35], v61 offset:4096
	ds_read_b128 v[36:39], v61 offset:22528
	s_waitcnt lgkmcnt(4)
	v_mfma_f32_16x16x32_bf16 v[0:3], a[8:11], v[40:43], v[0:3]
	v_mfma_f32_16x16x32_bf16 v[4:7], a[8:11], v[44:47], v[4:7]
	v_mfma_f32_16x16x32_bf16 v[8:11], a[80:83], v[40:43], v[8:11]
	v_mfma_f32_16x16x32_bf16 v[12:15], a[80:83], v[44:47], v[12:15]
	v_mfma_f32_16x16x32_bf16 v[16:19], a[152:155], v[40:43], v[16:19]
	v_mfma_f32_16x16x32_bf16 v[20:23], a[152:155], v[44:47], v[20:23]
	ds_read_b128 v[40:43], v61 offset:5120
	ds_read_b128 v[44:47], v61 offset:23552
	s_waitcnt lgkmcnt(4)
	v_mfma_f32_16x16x32_bf16 v[0:3], a[12:15], v[24:27], v[0:3]
	v_mfma_f32_16x16x32_bf16 v[4:7], a[12:15], v[28:31], v[4:7]
	v_mfma_f32_16x16x32_bf16 v[8:11], a[84:87], v[24:27], v[8:11]
	v_mfma_f32_16x16x32_bf16 v[12:15], a[84:87], v[28:31], v[12:15]
	v_mfma_f32_16x16x32_bf16 v[16:19], a[156:159], v[24:27], v[16:19]
	v_mfma_f32_16x16x32_bf16 v[20:23], a[156:159], v[28:31], v[20:23]
	ds_read_b128 v[24:27], v61 offset:6144
	ds_read_b128 v[28:31], v61 offset:24576
	s_waitcnt lgkmcnt(4)
	v_mfma_f32_16x16x32_bf16 v[0:3], a[16:19], v[32:35], v[0:3]
	v_mfma_f32_16x16x32_bf16 v[4:7], a[16:19], v[36:39], v[4:7]
	v_mfma_f32_16x16x32_bf16 v[8:11], a[88:91], v[32:35], v[8:11]
	v_mfma_f32_16x16x32_bf16 v[12:15], a[88:91], v[36:39], v[12:15]
	v_mfma_f32_16x16x32_bf16 v[16:19], a[160:163], v[32:35], v[16:19]
	v_mfma_f32_16x16x32_bf16 v[20:23], a[160:163], v[36:39], v[20:23]
	ds_read_b128 v[32:35], v61 offset:7168
	ds_read_b128 v[36:39], v61 offset:25600
	s_waitcnt lgkmcnt(4)
	v_mfma_f32_16x16x32_bf16 v[0:3], a[20:23], v[40:43], v[0:3]
	v_mfma_f32_16x16x32_bf16 v[4:7], a[20:23], v[44:47], v[4:7]
	v_mfma_f32_16x16x32_bf16 v[8:11], a[92:95], v[40:43], v[8:11]
	v_mfma_f32_16x16x32_bf16 v[12:15], a[92:95], v[44:47], v[12:15]
	v_mfma_f32_16x16x32_bf16 v[16:19], a[164:167], v[40:43], v[16:19]
	v_mfma_f32_16x16x32_bf16 v[20:23], a[164:167], v[44:47], v[20:23]
	ds_read_b128 v[40:43], v61 offset:8192
	ds_read_b128 v[44:47], v61 offset:26624
	s_waitcnt lgkmcnt(4)
	v_mfma_f32_16x16x32_bf16 v[0:3], a[24:27], v[24:27], v[0:3]
	v_mfma_f32_16x16x32_bf16 v[4:7], a[24:27], v[28:31], v[4:7]
	v_mfma_f32_16x16x32_bf16 v[8:11], a[96:99], v[24:27], v[8:11]
	v_mfma_f32_16x16x32_bf16 v[12:15], a[96:99], v[28:31], v[12:15]
	v_mfma_f32_16x16x32_bf16 v[16:19], a[168:171], v[24:27], v[16:19]
	v_mfma_f32_16x16x32_bf16 v[20:23], a[168:171], v[28:31], v[20:23]
	ds_read_b128 v[24:27], v61 offset:9216
	ds_read_b128 v[28:31], v61 offset:27648
	s_waitcnt lgkmcnt(4)
	v_mfma_f32_16x16x32_bf16 v[0:3], a[28:31], v[32:35], v[0:3]
	v_mfma_f32_16x16x32_bf16 v[4:7], a[28:31], v[36:39], v[4:7]
	v_mfma_f32_16x16x32_bf16 v[8:11], a[100:103], v[32:35], v[8:11]
	v_mfma_f32_16x16x32_bf16 v[12:15], a[100:103], v[36:39], v[12:15]
	v_mfma_f32_16x16x32_bf16 v[16:19], a[172:175], v[32:35], v[16:19]
	v_mfma_f32_16x16x32_bf16 v[20:23], a[172:175], v[36:39], v[20:23]
	ds_read_b128 v[32:35], v61 offset:10240
	ds_read_b128 v[36:39], v61 offset:28672
	s_waitcnt lgkmcnt(4)
	v_mfma_f32_16x16x32_bf16 v[0:3], a[32:35], v[40:43], v[0:3]
	v_mfma_f32_16x16x32_bf16 v[4:7], a[32:35], v[44:47], v[4:7]
	v_mfma_f32_16x16x32_bf16 v[8:11], a[104:107], v[40:43], v[8:11]
	v_mfma_f32_16x16x32_bf16 v[12:15], a[104:107], v[44:47], v[12:15]
	v_mfma_f32_16x16x32_bf16 v[16:19], a[176:179], v[40:43], v[16:19]
	v_mfma_f32_16x16x32_bf16 v[20:23], a[176:179], v[44:47], v[20:23]
	ds_read_b128 v[40:43], v61 offset:11264
	ds_read_b128 v[44:47], v61 offset:29696
	s_waitcnt vmcnt(0)
	v_mov_b32 v65, s28
	s_mov_b64 exec, 1
	buffer_store_dword v65, v64, s[4:7], s30 offen sc1
	s_mov_b64 exec, -1
	s_cmp_ge_u32 s28, 63
	s_cbranch_scc1 .gnopf_369
	s_add_u32 s37, s28, 2
	v_cmp_gt_u32 vcc, s37, v63
	s_cbranch_vccnz .gnopf2_370
	s_mov_b32 s29, 1
	s_waitcnt lgkmcnt(4)
	v_mfma_f32_16x16x32_bf16 v[0:3], a[36:39], v[24:27], v[0:3]
	s_add_u32 s17, s32, 0
	s_mov_b32 m0, s17
	s_add_u32 s18, s31, 0
	buffer_load_dwordx4 v60, s[4:7], s18 offen offset:0 lds
	v_mfma_f32_16x16x32_bf16 v[4:7], a[36:39], v[28:31], v[4:7]
	buffer_load_dwordx4 v60, s[4:7], s18 offen offset:1024 lds
	v_mfma_f32_16x16x32_bf16 v[8:11], a[108:111], v[24:27], v[8:11]
	buffer_load_dwordx4 v60, s[4:7], s18 offen offset:2048 lds
	v_mfma_f32_16x16x32_bf16 v[12:15], a[108:111], v[28:31], v[12:15]
	buffer_load_dwordx4 v60, s[4:7], s18 offen offset:3072 lds
	v_mfma_f32_16x16x32_bf16 v[16:19], a[180:183], v[24:27], v[16:19]
	s_add_u32 s17, s32, 4096
	s_mov_b32 m0, s17
	s_add_u32 s18, s31, 4096
	buffer_load_dwordx4 v60, s[4:7], s18 offen offset:0 lds
	v_mfma_f32_16x16x32_bf16 v[20:23], a[180:183], v[28:31], v[20:23]
	buffer_load_dwordx4 v60, s[4:7], s18 offen offset:1024 lds
	ds_read_b128 v[24:27], v61 offset:12288
	ds_read_b128 v[28:31], v61 offset:30720
	s_waitcnt lgkmcnt(4)
	v_mfma_f32_16x16x32_bf16 v[0:3], a[40:43], v[32:35], v[0:3]
	buffer_load_dwordx4 v60, s[4:7], s18 offen offset:2048 lds
	v_mfma_f32_16x16x32_bf16 v[4:7], a[40:43], v[36:39], v[4:7]
	buffer_load_dwordx4 v60, s[4:7], s18 offen offset:3072 lds
	v_mfma_f32_16x16x32_bf16 v[8:11], a[112:115], v[32:35], v[8:11]
	s_add_u32 s17, s32, 8192
	s_mov_b32 m0, s17
	s_add_u32 s18, s31, 8192
	buffer_load_dwordx4 v60, s[4:7], s18 offen offset:0 lds
	s_add_u32 s31, s31, 36864
	s_sub_u32 s32, s44, s32
	v_mfma_f32_16x16x32_bf16 v[12:15], a[112:115], v[36:39], v[12:15]
	v_mfma_f32_16x16x32_bf16 v[16:19], a[184:187], v[32:35], v[16:19]
	v_mfma_f32_16x16x32_bf16 v[20:23], a[184:187], v[36:39], v[20:23]
	ds_read_b128 v[32:35], v61 offset:13312
	ds_read_b128 v[36:39], v61 offset:31744
	s_branch .gaft_371
.gnopf2_370:
	buffer_load_dword v63, v67, s[4:7], 0 offen sc1
.gnopf_369:
	s_waitcnt lgkmcnt(4)
	v_mfma_f32_16x16x32_bf16 v[0:3], a[36:39], v[24:27], v[0:3]
	v_mfma_f32_16x16x32_bf16 v[4:7], a[36:39], v[28:31], v[4:7]
	v_mfma_f32_16x16x32_bf16 v[8:11], a[108:111], v[24:27], v[8:11]
	v_mfma_f32_16x16x32_bf16 v[12:15], a[108:111], v[28:31], v[12:15]
	v_mfma_f32_16x16x32_bf16 v[16:19], a[180:183], v[24:27], v[16:19]
	v_mfma_f32_16x16x32_bf16 v[20:23], a[180:183], v[28:31], v[20:23]
	ds_read_b128 v[24:27], v61 offset:12288
	ds_read_b128 v[28:31], v61 offset:30720
	s_waitcnt lgkmcnt(4)
	v_mfma_f32_16x16x32_bf16 v[0:3], a[40:43], v[32:35], v[0:3]
	v_mfma_f32_16x16x32_bf16 v[4:7], a[40:43], v[36:39], v[4:7]
	v_mfma_f32_16x16x32_bf16 v[8:11], a[112:115], v[32:35], v[8:11]
	v_mfma_f32_16x16x32_bf16 v[12:15], a[112:115], v[36:39], v[12:15]
	v_mfma_f32_16x16x32_bf16 v[16:19], a[184:187], v[32:35], v[16:19]
	v_mfma_f32_16x16x32_bf16 v[20:23], a[184:187], v[36:39], v[20:23]
	ds_read_b128 v[32:35], v61 offset:13312
	ds_read_b128 v[36:39], v61 offset:31744
.gaft_371:
	s_waitcnt lgkmcnt(4)
	v_mfma_f32_16x16x32_bf16 v[0:3], a[44:47], v[40:43], v[0:3]
	v_mfma_f32_16x16x32_bf16 v[4:7], a[44:47], v[44:47], v[4:7]
	v_mfma_f32_16x16x32_bf16 v[8:11], a[116:119], v[40:43], v[8:11]
	v_mfma_f32_16x16x32_bf16 v[12:15], a[116:119], v[44:47], v[12:15]
	v_mfma_f32_16x16x32_bf16 v[16:19], a[188:191], v[40:43], v[16:19]
	v_mfma_f32_16x16x32_bf16 v[20:23], a[188:191], v[44:47], v[20:23]
	ds_read_b128 v[40:43], v61 offset:14336
	ds_read_b128 v[44:47], v61 offset:32768
	s_waitcnt lgkmcnt(4)
	v_mfma_f32_16x16x32_bf16 v[0:3], a[48:51], v[24:27], v[0:3]
	v_mfma_f32_16x16x32_bf16 v[4:7], a[48:51], v[28:31], v[4:7]
	v_mfma_f32_16x16x32_bf16 v[8:11], a[120:123], v[24:27], v[8:11]
	v_mfma_f32_16x16x32_bf16 v[12:15], a[120:123], v[28:31], v[12:15]
	v_mfma_f32_16x16x32_bf16 v[16:19], a[192:195], v[24:27], v[16:19]
	v_mfma_f32_16x16x32_bf16 v[20:23], a[192:195], v[28:31], v[20:23]
	ds_read_b128 v[24:27], v61 offset:15360
	ds_read_b128 v[28:31], v61 offset:33792
	s_waitcnt lgkmcnt(4)
	v_mfma_f32_16x16x32_bf16 v[0:3], a[52:55], v[32:35], v[0:3]
	v_mfma_f32_16x16x32_bf16 v[4:7], a[52:55], v[36:39], v[4:7]
	v_mfma_f32_16x16x32_bf16 v[8:11], a[124:127], v[32:35], v[8:11]
	v_mfma_f32_16x16x32_bf16 v[12:15], a[124:127], v[36:39], v[12:15]
	v_mfma_f32_16x16x32_bf16 v[16:19], a[196:199], v[32:35], v[16:19]
	v_mfma_f32_16x16x32_bf16 v[20:23], a[196:199], v[36:39], v[20:23]
	ds_read_b128 v[32:35], v61 offset:16384
	ds_read_b128 v[36:39], v61 offset:34816
	s_waitcnt lgkmcnt(4)
	v_mfma_f32_16x16x32_bf16 v[0:3], a[56:59], v[40:43], v[0:3]
	v_mfma_f32_16x16x32_bf16 v[4:7], a[56:59], v[44:47], v[4:7]
	v_mfma_f32_16x16x32_bf16 v[8:11], a[128:131], v[40:43], v[8:11]
	v_mfma_f32_16x16x32_bf16 v[12:15], a[128:131], v[44:47], v[12:15]
	v_mfma_f32_16x16x32_bf16 v[16:19], a[200:203], v[40:43], v[16:19]
	v_mfma_f32_16x16x32_bf16 v[20:23], a[200:203], v[44:47], v[20:23]
	ds_read_b128 v[40:43], v61 offset:17408
	ds_read_b128 v[44:47], v61 offset:35840
	s_waitcnt lgkmcnt(4)
	v_mfma_f32_16x16x32_bf16 v[0:3], a[60:63], v[24:27], v[0:3]
	v_mfma_f32_16x16x32_bf16 v[4:7], a[60:63], v[28:31], v[4:7]
	v_mfma_f32_16x16x32_bf16 v[8:11], a[132:135], v[24:27], v[8:11]
	v_mfma_f32_16x16x32_bf16 v[12:15], a[132:135], v[28:31], v[12:15]
	v_mfma_f32_16x16x32_bf16 v[16:19], a[204:207], v[24:27], v[16:19]
	v_mfma_f32_16x16x32_bf16 v[20:23], a[204:207], v[28:31], v[20:23]
	s_waitcnt lgkmcnt(2)
	v_mfma_f32_16x16x32_bf16 v[0:3], a[64:67], v[32:35], v[0:3]
	v_mfma_f32_16x16x32_bf16 v[4:7], a[64:67], v[36:39], v[4:7]
	v_mfma_f32_16x16x32_bf16 v[8:11], a[136:139], v[32:35], v[8:11]
	v_mfma_f32_16x16x32_bf16 v[12:15], a[136:139], v[36:39], v[12:15]
	v_mfma_f32_16x16x32_bf16 v[16:19], a[208:211], v[32:35], v[16:19]
	v_mfma_f32_16x16x32_bf16 v[20:23], a[208:211], v[36:39], v[20:23]
	s_waitcnt lgkmcnt(0)
	v_mfma_f32_16x16x32_bf16 v[0:3], a[68:71], v[40:43], v[0:3]
	v_mfma_f32_16x16x32_bf16 v[4:7], a[68:71], v[44:47], v[4:7]
	v_mfma_f32_16x16x32_bf16 v[8:11], a[140:143], v[40:43], v[8:11]
	v_mfma_f32_16x16x32_bf16 v[12:15], a[140:143], v[44:47], v[12:15]
	v_mfma_f32_16x16x32_bf16 v[16:19], a[212:215], v[40:43], v[16:19]
	v_mfma_f32_16x16x32_bf16 v[20:23], a[212:215], v[44:47], v[20:23]
	s_sub_i32 s57, s28, 3
	s_max_i32 s57, s57, 0
	v_cmp_gt_u32 vcc, s57, v69
	s_cbranch_vccz .pck_372
	s_mov_b32 s20, 400000
.pre_373:
	buffer_load_dword v69, v68, s[4:7], 0 offen sc1
	s_waitcnt vmcnt(0)
	v_cmp_gt_u32 vcc, s57, v69
	s_cbranch_vccz .pok_374
	s_sub_u32 s20, s20, 1
	s_cmp_lg_u32 s20, 0
	s_cbranch_scc1 .pre_373
	s_branch L_FAIL
.pok_374:
.pck_372:
	s_and_b32 s34, s28, 3
	s_mul_i32 s34, s34, 110592
	s_add_u32 s34, s34, s55
	v_cvt_pk_bf16_f32 v0, v0, v1
	v_cvt_pk_bf16_f32 v1, v2, v3
	v_cvt_pk_bf16_f32 v2, v4, v5
	v_cvt_pk_bf16_f32 v3, v6, v7
	buffer_store_dwordx2 v[0:1], v66, s[4:7], s34 offen offset:0 sc1
	buffer_store_dwordx2 v[2:3], v66, s[4:7], s34 offen offset:512 sc1
	v_cvt_pk_bf16_f32 v8, v8, v9
	v_cvt_pk_bf16_f32 v9, v10, v11
	v_cvt_pk_bf16_f32 v10, v12, v13
	v_cvt_pk_bf16_f32 v11, v14, v15
	buffer_store_dwordx2 v[8:9], v66, s[4:7], s34 offen offset:1024 sc1
	buffer_store_dwordx2 v[10:11], v66, s[4:7], s34 offen offset:1536 sc1
	v_cvt_pk_bf16_f32 v16, v16, v17
	v_cvt_pk_bf16_f32 v17, v18, v19
	v_cvt_pk_bf16_f32 v18, v20, v21
	v_cvt_pk_bf16_f32 v19, v22, v23
	buffer_store_dwordx2 v[16:17], v66, s[4:7], s34 offen offset:2048 sc1
	buffer_store_dwordx2 v[18:19], v66, s[4:7], s34 offen offset:2560 sc1
	s_add_u32 s34, s34, 110592
	v_xor_b32 v62, s46, v62
	v_xor_b32 v67, s46, v67
	s_add_u32 s28, s28, 1
	s_cmp_lg_u32 s29, 0
	s_cbranch_scc1 .gloop_364
	s_cmp_ge_u32 s28, 64
	s_cbranch_scc1 .gnofin_376
	s_waitcnt vmcnt(6)
	s_add_u32 s37, s28, 1
	v_cmp_gt_u32 vcc, s37, v63
	s_cbranch_vccnz .gnofin_376
	s_add_u32 s17, s32, 0
	s_mov_b32 m0, s17
	s_add_u32 s18, s31, 0
	buffer_load_dwordx4 v60, s[4:7], s18 offen offset:0 lds
	buffer_load_dwordx4 v60, s[4:7], s18 offen offset:1024 lds
	buffer_load_dwordx4 v60, s[4:7], s18 offen offset:2048 lds
	buffer_load_dwordx4 v60, s[4:7], s18 offen offset:3072 lds
	s_add_u32 s17, s32, 4096
	s_mov_b32 m0, s17
	s_add_u32 s18, s31, 4096
	buffer_load_dwordx4 v60, s[4:7], s18 offen offset:0 lds
	buffer_load_dwordx4 v60, s[4:7], s18 offen offset:1024 lds
	buffer_load_dwordx4 v60, s[4:7], s18 offen offset:2048 lds
	buffer_load_dwordx4 v60, s[4:7], s18 offen offset:3072 lds
	s_add_u32 s17, s32, 8192
	s_mov_b32 m0, s17
	s_add_u32 s18, s31, 8192
	buffer_load_dwordx4 v60, s[4:7], s18 offen offset:0 lds
	s_add_u32 s31, s31, 36864
	s_sub_u32 s32, s44, s32
	s_waitcnt vmcnt(9)
	v_mov_b32 v65, s28
	s_mov_b64 exec, 1
	buffer_store_dword v65, v64, s[4:7], s30 offen sc1
	s_mov_b64 exec, -1
	s_waitcnt vmcnt(1)
	s_branch .ggo_366
.gnofin_376:
	s_waitcnt vmcnt(0)
	v_mov_b32 v65, s28
	s_mov_b64 exec, 1
	buffer_store_dword v65, v64, s[4:7], s30 offen sc1
	s_mov_b64 exec, -1
	s_cmp_lt_u32 s28, 64
	s_cbranch_scc1 .gloop_364
	s_branch L_END
.a1v_363:
	s_mul_i32 s17, s15, 9216
	s_add_u32 s31, s31, s17
	s_mov_b32 s32, s17
	s_lshl_b32 s44, s17, 1
	s_add_u32 s44, s44, 36864
	s_mov_b32 s33, 0
	s_mov_b32 s28, 0
	s_mov_b32 s29, 0
	s_mov_b32 s55, s34
.gloop_377:
	s_cmp_lg_u32 s29, 0
	s_cbranch_scc1 .gpref_378
	s_add_u32 s37, s28, 1
	s_mov_b32 s20, 400000
.pre_380:
	buffer_load_dword v63, v62, s[4:7], 0 offen sc1
	s_waitcnt vmcnt(0)
	v_cmp_gt_u32 vcc, s37, v63
	s_cbranch_vccz .pok_381
	s_sub_u32 s20, s20, 1
	s_cmp_lg_u32 s20, 0
	s_cbranch_scc1 .pre_380
	s_branch L_FAIL
.pok_381:
	s_add_u32 s17, s32, 0
	s_mov_b32 m0, s17
	s_add_u32 s18, s31, 0
	buffer_load_dwordx4 v60, s[4:7], s18 offen offset:0 lds
	buffer_load_dwordx4 v60, s[4:7], s18 offen offset:1024 lds
	buffer_load_dwordx4 v60, s[4:7], s18 offen offset:2048 lds
	buffer_load_dwordx4 v60, s[4:7], s18 offen offset:3072 lds
	s_add_u32 s17, s32, 4096
	s_mov_b32 m0, s17
	s_add_u32 s18, s31, 4096
	buffer_load_dwordx4 v60, s[4:7], s18 offen offset:0 lds
	buffer_load_dwordx4 v60, s[4:7], s18 offen offset:1024 lds
	buffer_load_dwordx4 v60, s[4:7], s18 offen offset:2048 lds
	buffer_load_dwordx4 v60, s[4:7], s18 offen offset:3072 lds
	s_add_u32 s17, s32, 8192
	s_mov_b32 m0, s17
	s_add_u32 s18, s31, 8192
	buffer_load_dwordx4 v60, s[4:7], s18 offen offset:0 lds
	s_add_u32 s31, s31, 36864
	s_sub_u32 s32, s44, s32
	s_waitcnt vmcnt(0)
	s_branch .ggo_379
.gpref_378:
	s_waitcnt vmcnt(3)
.ggo_379:
	s_barrier
	s_mov_b32 s29, 0
	v_add_u32 v61, s33, v60
	s_sub_u32 s33, 36864, s33
	buffer_load_dword v63, v67, s[4:7], 0 offen sc1
	buffer_load_dword v69, v68, s[4:7], 0 offen sc1
	ds_read_b128 v[24:27], v61 offset:0
	ds_read_b128 v[28:31], v61 offset:18432
	ds_read_b128 v[32:35], v61 offset:1024
	ds_read_b128 v[36:39], v61 offset:19456
	ds_read_b128 v[40:43], v61 offset:2048
	ds_read_b128 v[44:47], v61 offset:20480
	s_waitcnt lgkmcnt(4)
	v_mfma_f32_16x16x32_bf16 v[0:3], v[24:27], a[0:3], 0
	v_mfma_f32_16x16x32_bf16 v[4:7], v[28:31], a[0:3], 0
	v_mfma_f32_16x16x32_bf16 v[8:11], v[24:27], a[72:75], 0
	v_mfma_f32_16x16x32_bf16 v[12:15], v[28:31], a[72:75], 0
	v_mfma_f32_16x16x32_bf16 v[16:19], v[24:27], a[144:147], 0
	v_mfma_f32_16x16x32_bf16 v[20:23], v[28:31], a[144:147], 0
	ds_read_b128 v[24:27], v61 offset:3072
	ds_read_b128 v[28:31], v61 offset:21504
	s_waitcnt lgkmcnt(4)
	v_mfma_f32_16x16x32_bf16 v[0:3], v[32:35], a[4:7], v[0:3]
	v_mfma_f32_16x16x32_bf16 v[4:7], v[36:39], a[4:7], v[4:7]
	v_mfma_f32_16x16x32_bf16 v[8:11], v[32:35], a[76:79], v[8:11]
	v_mfma_f32_16x16x32_bf16 v[12:15], v[36:39], a[76:79], v[12:15]
	v_mfma_f32_16x16x32_bf16 v[16:19], v[32:35], a[148:151], v[16:19]
	v_mfma_f32_16x16x32_bf16 v[20:23], v[36:39], a[148:151], v[20:23]
	ds_read_b128 v[32:35], v61 offset:4096
	ds_read_b128 v[36:39], v61 offset:22528
	s_waitcnt lgkmcnt(4)
	v_mfma_f32_16x16x32_bf16 v[0:3], v[40:43], a[8:11], v[0:3]
	v_mfma_f32_16x16x32_bf16 v[4:7], v[44:47], a[8:11], v[4:7]
	v_mfma_f32_16x16x32_bf16 v[8:11], v[40:43], a[80:83], v[8:11]
	v_mfma_f32_16x16x32_bf16 v[12:15], v[44:47], a[80:83], v[12:15]
	v_mfma_f32_16x16x32_bf16 v[16:19], v[40:43], a[152:155], v[16:19]
	v_mfma_f32_16x16x32_bf16 v[20:23], v[44:47], a[152:155], v[20:23]
	ds_read_b128 v[40:43], v61 offset:5120
	ds_read_b128 v[44:47], v61 offset:23552
	s_waitcnt lgkmcnt(4)
	v_mfma_f32_16x16x32_bf16 v[0:3], v[24:27], a[12:15], v[0:3]
	v_mfma_f32_16x16x32_bf16 v[4:7], v[28:31], a[12:15], v[4:7]
	v_mfma_f32_16x16x32_bf16 v[8:11], v[24:27], a[84:87], v[8:11]
	v_mfma_f32_16x16x32_bf16 v[12:15], v[28:31], a[84:87], v[12:15]
	v_mfma_f32_16x16x32_bf16 v[16:19], v[24:27], a[156:159], v[16:19]
	v_mfma_f32_16x16x32_bf16 v[20:23], v[28:31], a[156:159], v[20:23]
	ds_read_b128 v[24:27], v61 offset:6144
	ds_read_b128 v[28:31], v61 offset:24576
	s_waitcnt lgkmcnt(4)
	v_mfma_f32_16x16x32_bf16 v[0:3], v[32:35], a[16:19], v[0:3]
	v_mfma_f32_16x16x32_bf16 v[4:7], v[36:39], a[16:19], v[4:7]
	v_mfma_f32_16x16x32_bf16 v[8:11], v[32:35], a[88:91], v[8:11]
	v_mfma_f32_16x16x32_bf16 v[12:15], v[36:39], a[88:91], v[12:15]
	v_mfma_f32_16x16x32_bf16 v[16:19], v[32:35], a[160:163], v[16:19]
	v_mfma_f32_16x16x32_bf16 v[20:23], v[36:39], a[160:163], v[20:23]
	ds_read_b128 v[32:35], v61 offset:7168
	ds_read_b128 v[36:39], v61 offset:25600
	s_waitcnt lgkmcnt(4)
	v_mfma_f32_16x16x32_bf16 v[0:3], v[40:43], a[20:23], v[0:3]
	v_mfma_f32_16x16x32_bf16 v[4:7], v[44:47], a[20:23], v[4:7]
	v_mfma_f32_16x16x32_bf16 v[8:11], v[40:43], a[92:95], v[8:11]
	v_mfma_f32_16x16x32_bf16 v[12:15], v[44:47], a[92:95], v[12:15]
	v_mfma_f32_16x16x32_bf16 v[16:19], v[40:43], a[164:167], v[16:19]
	v_mfma_f32_16x16x32_bf16 v[20:23], v[44:47], a[164:167], v[20:23]
	ds_read_b128 v[40:43], v61 offset:8192
	ds_read_b128 v[44:47], v61 offset:26624
	s_waitcnt lgkmcnt(4)
	v_mfma_f32_16x16x32_bf16 v[0:3], v[24:27], a[24:27], v[0:3]
	v_mfma_f32_16x16x32_bf16 v[4:7], v[28:31], a[24:27], v[4:7]
	v_mfma_f32_16x16x32_bf16 v[8:11], v[24:27], a[96:99], v[8:11]
	v_mfma_f32_16x16x32_bf16 v[12:15], v[28:31], a[96:99], v[12:15]
	v_mfma_f32_16x16x32_bf16 v[16:19], v[24:27], a[168:171], v[16:19]
	v_mfma_f32_16x16x32_bf16 v[20:23], v[28:31], a[168:171], v[20:23]
	ds_read_b128 v[24:27], v61 offset:9216
	ds_read_b128 v[28:31], v61 offset:27648
	s_waitcnt lgkmcnt(4)
	v_mfma_f32_16x16x32_bf16 v[0:3], v[32:35], a[28:31], v[0:3]
	v_mfma_f32_16x16x32_bf16 v[4:7], v[36:39], a[28:31], v[4:7]
	v_mfma_f32_16x16x32_bf16 v[8:11], v[32:35], a[100:103], v[8:11]
	v_mfma_f32_16x16x32_bf16 v[12:15], v[36:39], a[100:103], v[12:15]
	v_mfma_f32_16x16x32_bf16 v[16:19], v[32:35], a[172:175], v[16:19]
	v_mfma_f32_16x16x32_bf16 v[20:23], v[36:39], a[172:175], v[20:23]
	ds_read_b128 v[32:35], v61 offset:10240
	ds_read_b128 v[36:39], v61 offset:28672
	s_waitcnt lgkmcnt(4)
	v_mfma_f32_16x16x32_bf16 v[0:3], v[40:43], a[32:35], v[0:3]
	v_mfma_f32_16x16x32_bf16 v[4:7], v[44:47], a[32:35], v[4:7]
	v_mfma_f32_16x16x32_bf16 v[8:11], v[40:43], a[104:107], v[8:11]
	v_mfma_f32_16x16x32_bf16 v[12:15], v[44:47], a[104:107], v[12:15]
	v_mfma_f32_16x16x32_bf16 v[16:19], v[40:43], a[176:179], v[16:19]
	v_mfma_f32_16x16x32_bf16 v[20:23], v[44:47], a[176:179], v[20:23]
	ds_read_b128 v[40:43], v61 offset:11264
	ds_read_b128 v[44:47], v61 offset:29696
	s_waitcnt vmcnt(0)
	v_mov_b32 v65, s28
	s_mov_b64 exec, 1
	buffer_store_dword v65, v64, s[4:7], s30 offen sc1
	s_mov_b64 exec, -1
	s_cmp_ge_u32 s28, 63
	s_cbranch_scc1 .gnopf_382
	s_add_u32 s37, s28, 2
	v_cmp_gt_u32 vcc, s37, v63
	s_cbranch_vccnz .gnopf2_383
	s_mov_b32 s29, 1
	s_waitcnt lgkmcnt(4)
	v_mfma_f32_16x16x32_bf16 v[0:3], v[24:27], a[36:39], v[0:3]
	s_add_u32 s17, s32, 0
	s_mov_b32 m0, s17
	s_add_u32 s18, s31, 0
	buffer_load_dwordx4 v60, s[4:7], s18 offen offset:0 lds
	v_mfma_f32_16x16x32_bf16 v[4:7], v[28:31], a[36:39], v[4:7]
	buffer_load_dwordx4 v60, s[4:7], s18 offen offset:1024 lds
	v_mfma_f32_16x16x32_bf16 v[8:11], v[24:27], a[108:111], v[8:11]
	buffer_load_dwordx4 v60, s[4:7], s18 offen offset:2048 lds
	v_mfma_f32_16x16x32_bf16 v[12:15], v[28:31], a[108:111], v[12:15]
	buffer_load_dwordx4 v60, s[4:7], s18 offen offset:3072 lds
	v_mfma_f32_16x16x32_bf16 v[16:19], v[24:27], a[180:183], v[16:19]
	s_add_u32 s17, s32, 4096
	s_mov_b32 m0, s17
	s_add_u32 s18, s31, 4096
	buffer_load_dwordx4 v60, s[4:7], s18 offen offset:0 lds
	v_mfma_f32_16x16x32_bf16 v[20:23], v[28:31], a[180:183], v[20:23]
	buffer_load_dwordx4 v60, s[4:7], s18 offen offset:1024 lds
	ds_read_b128 v[24:27], v61 offset:12288
	ds_read_b128 v[28:31], v61 offset:30720
	s_waitcnt lgkmcnt(4)
	v_mfma_f32_16x16x32_bf16 v[0:3], v[32:35], a[40:43], v[0:3]
	buffer_load_dwordx4 v60, s[4:7], s18 offen offset:2048 lds
	v_mfma_f32_16x16x32_bf16 v[4:7], v[36:39], a[40:43], v[4:7]
	buffer_load_dwordx4 v60, s[4:7], s18 offen offset:3072 lds
	v_mfma_f32_16x16x32_bf16 v[8:11], v[32:35], a[112:115], v[8:11]
	s_add_u32 s17, s32, 8192
	s_mov_b32 m0, s17
	s_add_u32 s18, s31, 8192
	buffer_load_dwordx4 v60, s[4:7], s18 offen offset:0 lds
	s_add_u32 s31, s31, 36864
	s_sub_u32 s32, s44, s32
	v_mfma_f32_16x16x32_bf16 v[12:15], v[36:39], a[112:115], v[12:15]
	v_mfma_f32_16x16x32_bf16 v[16:19], v[32:35], a[184:187], v[16:19]
	v_mfma_f32_16x16x32_bf16 v[20:23], v[36:39], a[184:187], v[20:23]
	ds_read_b128 v[32:35], v61 offset:13312
	ds_read_b128 v[36:39], v61 offset:31744
	s_branch .gaft_384
.gnopf2_383:
	buffer_load_dword v63, v67, s[4:7], 0 offen sc1
.gnopf_382:
	s_waitcnt lgkmcnt(4)
	v_mfma_f32_16x16x32_bf16 v[0:3], v[24:27], a[36:39], v[0:3]
	v_mfma_f32_16x16x32_bf16 v[4:7], v[28:31], a[36:39], v[4:7]
	v_mfma_f32_16x16x32_bf16 v[8:11], v[24:27], a[108:111], v[8:11]
	v_mfma_f32_16x16x32_bf16 v[12:15], v[28:31], a[108:111], v[12:15]
	v_mfma_f32_16x16x32_bf16 v[16:19], v[24:27], a[180:183], v[16:19]
	v_mfma_f32_16x16x32_bf16 v[20:23], v[28:31], a[180:183], v[20:23]
	ds_read_b128 v[24:27], v61 offset:12288
	ds_read_b128 v[28:31], v61 offset:30720
	s_waitcnt lgkmcnt(4)
	v_mfma_f32_16x16x32_bf16 v[0:3], v[32:35], a[40:43], v[0:3]
	v_mfma_f32_16x16x32_bf16 v[4:7], v[36:39], a[40:43], v[4:7]
	v_mfma_f32_16x16x32_bf16 v[8:11], v[32:35], a[112:115], v[8:11]
	v_mfma_f32_16x16x32_bf16 v[12:15], v[36:39], a[112:115], v[12:15]
	v_mfma_f32_16x16x32_bf16 v[16:19], v[32:35], a[184:187], v[16:19]
	v_mfma_f32_16x16x32_bf16 v[20:23], v[36:39], a[184:187], v[20:23]
	ds_read_b128 v[32:35], v61 offset:13312
	ds_read_b128 v[36:39], v61 offset:31744
.gaft_384:
	s_waitcnt lgkmcnt(4)
	v_mfma_f32_16x16x32_bf16 v[0:3], v[40:43], a[44:47], v[0:3]
	v_mfma_f32_16x16x32_bf16 v[4:7], v[44:47], a[44:47], v[4:7]
	v_mfma_f32_16x16x32_bf16 v[8:11], v[40:43], a[116:119], v[8:11]
	v_mfma_f32_16x16x32_bf16 v[12:15], v[44:47], a[116:119], v[12:15]
	v_mfma_f32_16x16x32_bf16 v[16:19], v[40:43], a[188:191], v[16:19]
	v_mfma_f32_16x16x32_bf16 v[20:23], v[44:47], a[188:191], v[20:23]
	ds_read_b128 v[40:43], v61 offset:14336
	ds_read_b128 v[44:47], v61 offset:32768
	s_waitcnt lgkmcnt(4)
	v_mfma_f32_16x16x32_bf16 v[0:3], v[24:27], a[48:51], v[0:3]
	v_mfma_f32_16x16x32_bf16 v[4:7], v[28:31], a[48:51], v[4:7]
	v_mfma_f32_16x16x32_bf16 v[8:11], v[24:27], a[120:123], v[8:11]
	v_mfma_f32_16x16x32_bf16 v[12:15], v[28:31], a[120:123], v[12:15]
	v_mfma_f32_16x16x32_bf16 v[16:19], v[24:27], a[192:195], v[16:19]
	v_mfma_f32_16x16x32_bf16 v[20:23], v[28:31], a[192:195], v[20:23]
	ds_read_b128 v[24:27], v61 offset:15360
	ds_read_b128 v[28:31], v61 offset:33792
	s_waitcnt lgkmcnt(4)
	v_mfma_f32_16x16x32_bf16 v[0:3], v[32:35], a[52:55], v[0:3]
	v_mfma_f32_16x16x32_bf16 v[4:7], v[36:39], a[52:55], v[4:7]
	v_mfma_f32_16x16x32_bf16 v[8:11], v[32:35], a[124:127], v[8:11]
	v_mfma_f32_16x16x32_bf16 v[12:15], v[36:39], a[124:127], v[12:15]
	v_mfma_f32_16x16x32_bf16 v[16:19], v[32:35], a[196:199], v[16:19]
	v_mfma_f32_16x16x32_bf16 v[20:23], v[36:39], a[196:199], v[20:23]
	ds_read_b128 v[32:35], v61 offset:16384
	ds_read_b128 v[36:39], v61 offset:34816
	s_waitcnt lgkmcnt(4)
	v_mfma_f32_16x16x32_bf16 v[0:3], v[40:43], a[56:59], v[0:3]
	v_mfma_f32_16x16x32_bf16 v[4:7], v[44:47], a[56:59], v[4:7]
	v_mfma_f32_16x16x32_bf16 v[8:11], v[40:43], a[128:131], v[8:11]
	v_mfma_f32_16x16x32_bf16 v[12:15], v[44:47], a[128:131], v[12:15]
	v_mfma_f32_16x16x32_bf16 v[16:19], v[40:43], a[200:203], v[16:19]
	v_mfma_f32_16x16x32_bf16 v[20:23], v[44:47], a[200:203], v[20:23]
	ds_read_b128 v[40:43], v61 offset:17408
	ds_read_b128 v[44:47], v61 offset:35840
	s_waitcnt lgkmcnt(4)
	v_mfma_f32_16x16x32_bf16 v[0:3], v[24:27], a[60:63], v[0:3]
	v_mfma_f32_16x16x32_bf16 v[4:7], v[28:31], a[60:63], v[4:7]
	v_mfma_f32_16x16x32_bf16 v[8:11], v[24:27], a[132:135], v[8:11]
	v_mfma_f32_16x16x32_bf16 v[12:15], v[28:31], a[132:135], v[12:15]
	v_mfma_f32_16x16x32_bf16 v[16:19], v[24:27], a[204:207], v[16:19]
	v_mfma_f32_16x16x32_bf16 v[20:23], v[28:31], a[204:207], v[20:23]
	s_waitcnt lgkmcnt(2)
	v_mfma_f32_16x16x32_bf16 v[0:3], v[32:35], a[64:67], v[0:3]
	v_mfma_f32_16x16x32_bf16 v[4:7], v[36:39], a[64:67], v[4:7]
	v_mfma_f32_16x16x32_bf16 v[8:11], v[32:35], a[136:139], v[8:11]
	v_mfma_f32_16x16x32_bf16 v[12:15], v[36:39], a[136:139], v[12:15]
	v_mfma_f32_16x16x32_bf16 v[16:19], v[32:35], a[208:211], v[16:19]
	v_mfma_f32_16x16x32_bf16 v[20:23], v[36:39], a[208:211], v[20:23]
	s_waitcnt lgkmcnt(0)
	v_mfma_f32_16x16x32_bf16 v[0:3], v[40:43], a[68:71], v[0:3]
	v_mfma_f32_16x16x32_bf16 v[4:7], v[44:47], a[68:71], v[4:7]
	v_mfma_f32_16x16x32_bf16 v[8:11], v[40:43], a[140:143], v[8:11]
	v_mfma_f32_16x16x32_bf16 v[12:15], v[44:47], a[140:143], v[12:15]
	v_mfma_f32_16x16x32_bf16 v[16:19], v[40:43], a[212:215], v[16:19]
	v_mfma_f32_16x16x32_bf16 v[20:23], v[44:47], a[212:215], v[20:23]
	s_sub_i32 s57, s28, 3
	s_max_i32 s57, s57, 0
	v_cmp_gt_u32 vcc, s57, v69
	s_cbranch_vccz .pck_385
	s_mov_b32 s20, 400000
.pre_386:
	buffer_load_dword v69, v68, s[4:7], 0 offen sc1
	s_waitcnt vmcnt(0)
	v_cmp_gt_u32 vcc, s57, v69
	s_cbranch_vccz .pok_387
	s_sub_u32 s20, s20, 1
	s_cmp_lg_u32 s20, 0
	s_cbranch_scc1 .pre_386
	s_branch L_FAIL
.pok_387:
.pck_385:
	s_and_b32 s34, s28, 3
	s_mul_i32 s34, s34, 110592
	s_add_u32 s34, s34, s55
	v_cvt_pk_bf16_f32 v0, v0, v1
	v_cvt_pk_bf16_f32 v1, v2, v3
	v_cvt_pk_bf16_f32 v2, v4, v5
	v_cvt_pk_bf16_f32 v3, v6, v7
	buffer_store_dwordx4 v[0:3], v60, s[4:7], s34 offen offset:0 sc1
	v_cvt_pk_bf16_f32 v8, v8, v9
	v_cvt_pk_bf16_f32 v9, v10, v11
	v_cvt_pk_bf16_f32 v10, v12, v13
	v_cvt_pk_bf16_f32 v11, v14, v15
	buffer_store_dwordx4 v[8:11], v60, s[4:7], s34 offen offset:1024 sc1
	v_cvt_pk_bf16_f32 v16, v16, v17
	v_cvt_pk_bf16_f32 v17, v18, v19
	v_cvt_pk_bf16_f32 v18, v20, v21
	v_cvt_pk_bf16_f32 v19, v22, v23
	buffer_store_dwordx4 v[16:19], v60, s[4:7], s34 offen offset:2048 sc1
	s_add_u32 s34, s34, 110592
	v_xor_b32 v62, s46, v62
	v_xor_b32 v67, s46, v67
	s_add_u32 s28, s28, 1
	s_cmp_lg_u32 s29, 0
	s_cbranch_scc1 .gloop_377
	s_cmp_ge_u32 s28, 64
	s_cbranch_scc1 .gnofin_389
	s_waitcnt vmcnt(3)
	s_add_u32 s37, s28, 1
	v_cmp_gt_u32 vcc, s37, v63
	s_cbranch_vccnz .gnofin_389
	s_add_u32 s17, s32, 0
	s_mov_b32 m0, s17
	s_add_u32 s18, s31, 0
	buffer_load_dwordx4 v60, s[4:7], s18 offen offset:0 lds
	buffer_load_dwordx4 v60, s[4:7], s18 offen offset:1024 lds
	buffer_load_dwordx4 v60, s[4:7], s18 offen offset:2048 lds
	buffer_load_dwordx4 v60, s[4:7], s18 offen offset:3072 lds
	s_add_u32 s17, s32, 4096
	s_mov_b32 m0, s17
	s_add_u32 s18, s31, 4096
	buffer_load_dwordx4 v60, s[4:7], s18 offen offset:0 lds
	buffer_load_dwordx4 v60, s[4:7], s18 offen offset:1024 lds
	buffer_load_dwordx4 v60, s[4:7], s18 offen offset:2048 lds
	buffer_load_dwordx4 v60, s[4:7], s18 offen offset:3072 lds
	s_add_u32 s17, s32, 8192
	s_mov_b32 m0, s17
	s_add_u32 s18, s31, 8192
	buffer_load_dwordx4 v60, s[4:7], s18 offen offset:0 lds
	s_add_u32 s31, s31, 36864
	s_sub_u32 s32, s44, s32
	s_waitcnt vmcnt(9)
	v_mov_b32 v65, s28
	s_mov_b64 exec, 1
	buffer_store_dword v65, v64, s[4:7], s30 offen sc1
	s_mov_b64 exec, -1
	s_waitcnt vmcnt(1)
	s_branch .ggo_379
.gnofin_389:
	s_waitcnt vmcnt(0)
	v_mov_b32 v65, s28
	s_mov_b64 exec, 1
	buffer_store_dword v65, v64, s[4:7], s30 offen sc1
	s_mov_b64 exec, -1
	s_cmp_lt_u32 s28, 64
	s_cbranch_scc1 .gloop_377
	s_branch L_END
.p2align 6
L_ATTA:
	v_and_b32 v79, 63, v0
	v_mov_b32 v75, v0
	v_and_b32 v78, 15, v79
	v_lshrrev_b32 v77, 4, v79
	v_and_b32 v76, 7, v79
	s_cmp_lg_u32 s27, 0
	s_cbranch_scc1 .nowpt_390
	v_lshlrev_b32 v10, 4, v79
	s_lshl_b32 s38, s26, 2
	s_add_u32 s38, s38, s15
	s_lshl_b32 s38, s38, 10
	s_load_dwordx2 s[22:23], s[0:1], 8
	s_waitcnt lgkmcnt(0)
	s_mov_b32 s8, s22
	s_and_b32 s9, s23, 0xffff
	s_mov_b32 s10, 0x1e6000
	s_mov_b32 s11, 0x00020000
	s_add_u32 s39, s38, 0
	buffer_load_dwordx4 v[112:115], v10, s[8:11], s39 offen
	s_add_u32 s39, s38, 65536
	buffer_load_dwordx4 v[112:115], v10, s[8:11], s39 offen
	s_add_u32 s39, s38, 131072
	buffer_load_dwordx4 v[112:115], v10, s[8:11], s39 offen
	s_add_u32 s39, s38, 196608
	buffer_load_dwordx4 v[112:115], v10, s[8:11], s39 offen
	s_add_u32 s39, s38, 262144
	buffer_load_dwordx4 v[112:115], v10, s[8:11], s39 offen
	s_add_u32 s39, s38, 327680
	buffer_load_dwordx4 v[112:115], v10, s[8:11], s39 offen
	s_add_u32 s39, s38, 393216
	buffer_load_dwordx4 v[112:115], v10, s[8:11], s39 offen
	s_add_u32 s39, s38, 458752
	buffer_load_dwordx4 v[112:115], v10, s[8:11], s39 offen
	s_add_u32 s39, s38, 524288
	buffer_load_dwordx4 v[112:115], v10, s[8:11], s39 offen
	s_add_u32 s39, s38, 589824
	buffer_load_dwordx4 v[112:115], v10, s[8:11], s39 offen
	s_add_u32 s39, s38, 655360
	buffer_load_dwordx4 v[112:115], v10, s[8:11], s39 offen
	s_add_u32 s39, s38, 720896
	buffer_load_dwordx4 v[112:115], v10, s[8:11], s39 offen
	s_add_u32 s39, s38, 786432
	buffer_load_dwordx4 v[112:115], v10, s[8:11], s39 offen
	s_add_u32 s39, s38, 851968
	buffer_load_dwordx4 v[112:115], v10, s[8:11], s39 offen
	s_add_u32 s39, s38, 917504
	buffer_load_dwordx4 v[112:115], v10, s[8:11], s39 offen
	s_add_u32 s39, s38, 983040
	buffer_load_dwordx4 v[112:115], v10, s[8:11], s39 offen
	s_add_u32 s39, s38, 1048576
	buffer_load_dwordx4 v[112:115], v10, s[8:11], s39 offen
	s_add_u32 s39, s38, 1114112
	buffer_load_dwordx4 v[112:115], v10, s[8:11], s39 offen
	s_add_u32 s39, s38, 1179648
	buffer_load_dwordx4 v[112:115], v10, s[8:11], s39 offen
	s_add_u32 s39, s38, 1245184
	buffer_load_dwordx4 v[112:115], v10, s[8:11], s39 offen
	s_add_u32 s39, s38, 1310720
	buffer_load_dwordx4 v[112:115], v10, s[8:11], s39 offen
	s_add_u32 s39, s38, 1376256
	buffer_load_dwordx4 v[112:115], v10, s[8:11], s39 offen
	s_add_u32 s39, s38, 1441792
	buffer_load_dwordx4 v[112:115], v10, s[8:11], s39 offen
	s_add_u32 s39, s38, 1507328
	buffer_load_dwordx4 v[112:115], v10, s[8:11], s39 offen
	s_add_u32 s39, s38, 1572864
	buffer_load_dwordx4 v[112:115], v10, s[8:11], s39 offen
	s_add_u32 s39, s38, 1638400
	buffer_load_dwordx4 v[112:115], v10, s[8:11], s39 offen
	s_add_u32 s39, s38, 1703936
	buffer_load_dwordx4 v[112:115], v10, s[8:11], s39 offen
	s_add_u32 s39, s38, 1769472
	buffer_load_dwordx4 v[112:115], v10, s[8:11], s39 offen
	s_add_u32 s39, s38, 1835008
	buffer_load_dwordx4 v[112:115], v10, s[8:11], s39 offen
	s_add_u32 s39, s38, 1900544
	buffer_load_dwordx4 v[112:115], v10, s[8:11], s39 offen
	s_add_u32 s39, s38, 1966080
	buffer_load_dwordx4 v[112:115], v10, s[8:11], s39 offen
	s_load_dwordx2 s[22:23], s[0:1], 16
	s_waitcnt lgkmcnt(0)
	s_mov_b32 s8, s22
	s_and_b32 s9, s23, 0xffff
	s_mov_b32 s10, 0xa2000
	s_mov_b32 s11, 0x00020000
	s_add_u32 s39, s38, 0
	buffer_load_dwordx4 v[112:115], v10, s[8:11], s39 offen
	s_add_u32 s39, s38, 65536
	buffer_load_dwordx4 v[112:115], v10, s[8:11], s39 offen
	s_add_u32 s39, s38, 131072
	buffer_load_dwordx4 v[112:115], v10, s[8:11], s39 offen
	s_add_u32 s39, s38, 196608
	buffer_load_dwordx4 v[112:115], v10, s[8:11], s39 offen
	s_add_u32 s39, s38, 262144
	buffer_load_dwordx4 v[112:115], v10, s[8:11], s39 offen
	s_add_u32 s39, s38, 327680
	buffer_load_dwordx4 v[112:115], v10, s[8:11], s39 offen
	s_add_u32 s39, s38, 393216
	buffer_load_dwordx4 v[112:115], v10, s[8:11], s39 offen
	s_add_u32 s39, s38, 458752
	buffer_load_dwordx4 v[112:115], v10, s[8:11], s39 offen
	s_add_u32 s39, s38, 524288
	buffer_load_dwordx4 v[112:115], v10, s[8:11], s39 offen
	s_add_u32 s39, s38, 589824
	buffer_load_dwordx4 v[112:115], v10, s[8:11], s39 offen
	s_add_u32 s39, s38, 655360
	buffer_load_dwordx4 v[112:115], v10, s[8:11], s39 offen
.nowpt_390:
	s_lshr_b32 s38, s15, 1
	s_and_b32 s39, s15, 1
	s_lshl_b32 s40, s26, 1
	s_add_u32 s40, s40, s38
	v_lshlrev_b32 v72, 2, v77
	v_add_u32 v73, 0, v72
	v_cmp_gt_u32 s[46:47], v73, v78
	v_add_u32 v73, 1, v72
	v_cmp_gt_u32 s[48:49], v73, v78
	v_add_u32 v73, 2, v72
	v_cmp_gt_u32 s[50:51], v73, v78
	v_add_u32 v73, 3, v72
	v_cmp_gt_u32 s[52:53], v73, v78
	v_lshlrev_b32 v152, 3, v79
	v_lshlrev_b32 v153, 4, v79
	s_lshl_b32 s17, s38, 12
	v_add_u32 v150, s17, v152
	v_add_u32 v151, s17, v153
	v_mov_b32 v156, 0
	v_mov_b32 v158, 0xff7fffff
	v_mov_b32 v164, 0x3eae1a93
	v_mov_b32 v165, 0x3eae1a93
	v_mov_b32 v128, 0x3f803f80
	v_mov_b32 v129, 0x3f803f80
	v_mov_b32 v130, 0x3f803f80
	v_mov_b32 v131, 0x3f803f80
	s_and_b32 s17, s26, 3
	v_cmp_eq_u32 vcc, s17, v77
	s_nop 0
	s_mov_b64 s[54:55], vcc
	v_cndmask_b32 v159, 0, -1, vcc
	v_mov_b32 v160, v159
	s_cmp_eq_u32 s38, 0
	s_cselect_b32 s17, -1, 0
	v_and_b32 v159, s17, v159
	s_not_b32 s17, s17
	v_and_b32 v160, s17, v160
	s_cmp_eq_u32 s38, 0
	s_cselect_b64 s[56:57], 0, -1
	s_lshl_b32 s17, s38, 3
	v_add_u32 v161, s17, v153
	s_bfe_u32 s17, s40, 0x10003
	s_lshl_b32 s17, s17, 3
	s_lshl_b32 s18, s38, 2
	s_add_u32 s17, s17, s18
	v_add_u32 v162, s17, v153
	s_mul_i32 s58, s27, 0x240000
	s_add_u32 s58, s58, 0x9400000
	s_mul_i32 s17, s39, 18432
	s_add_u32 s58, s58, s17
	s_lshr_b32 s17, s40, 4
	s_add_u32 s17, s17, 16
	s_lshl_b32 s17, s17, 10
	s_add_u32 s59, s58, s17
	s_lshr_b32 s17, s40, 1
	s_lshl_b32 s17, s17, 10
	s_add_u32 s58, s58, s17
	s_mul_i32 s64, s27, 0x6c0000
	s_add_u32 s64, s64, 0x8680000
	s_lshl_b32 s17, s40, 10
	s_lshr_b32 s18, s40, 3
	s_add_u32 s18, s18, 32
	s_lshl_b32 s18, s18, 10
	s_add_u32 s65, s64, s18
	s_add_u32 s64, s64, s17
	s_add_u32 s17, s39, 1
	s_mul_i32 s17, s17, 36864
	s_add_u32 s60, s64, s17
	s_add_u32 s61, s65, s17
	s_lshl_b32 s17, s39, 9
	s_add_u32 s64, s64, s17
	s_add_u32 s65, s65, s17
	s_lshl_b32 s66, s38, 12
	s_lshl_b32 s17, s39, 11
	s_add_u32 s66, s66, s17
	s_mul_i32 s19, s27, 0x40
	s_add_u32 s19, s19, 0x84
	v_min_u32 v154, 35, v79
	v_lshrrev_b32 v74, 2, v154
	v_add_u32 v74, s19, v74
	v_lshlrev_b32 v74, 7, v74
	v_and_b32 v154, 3, v154
	v_lshlrev_b32 v154, 2, v154
	v_add_u32 v154, v154, v74
	s_mul_i32 s19, s27, 0x40
	s_add_u32 s19, s19, 0x9d
	v_min_u32 v172, 11, v79
	v_lshrrev_b32 v74, 2, v172
	v_add_u32 v74, s19, v74
	v_lshlrev_b32 v74, 7, v74
	v_and_b32 v172, 3, v172
	v_lshlrev_b32 v172, 2, v172
	v_add_u32 v172, v172, v74
	s_lshl_b32 s30, s14, 7
	s_lshl_b32 s17, s15, 2
	s_add_u32 s30, s30, s17
	s_mul_i32 s77, s27, 0x6c0000
	s_add_u32 s77, s77, 0x8680000
	s_mul_i32 s78, s27, 0x240000
	s_add_u32 s78, s78, 0x9400000
	s_mul_i32 s79, s27, 0x480000
	s_add_u32 s79, s79, 0x9880000
	s_lshl_b32 s67, s26, 2
	s_add_u32 s67, s67, s15
	v_mov_b32 v0, 0
	v_mov_b32 v1, 0
	v_mov_b32 v2, 0
	v_mov_b32 v3, 0
	v_lshlrev_b32 v4, 4, v75
	v_add_u32 v5, 0x10000, v4
	ds_write_b128 v4, v[0:3] offset:0
	ds_write_b128 v4, v[0:3] offset:4096
	ds_write_b128 v4, v[0:3] offset:8192
	ds_write_b128 v4, v[0:3] offset:12288
	ds_write_b128 v4, v[0:3] offset:16384
	ds_write_b128 v4, v[0:3] offset:20480
	ds_write_b128 v4, v[0:3] offset:24576
	ds_write_b128 v4, v[0:3] offset:28672
	ds_write_b128 v4, v[0:3] offset:32768
	ds_write_b128 v4, v[0:3] offset:36864
	ds_write_b128 v4, v[0:3] offset:40960
	ds_write_b128 v4, v[0:3] offset:45056
	ds_write_b128 v4, v[0:3] offset:49152
	ds_write_b128 v4, v[0:3] offset:53248
	ds_write_b128 v4, v[0:3] offset:57344
	ds_write_b128 v4, v[0:3] offset:61440
	ds_write_b128 v5, v[0:3] offset:0
	ds_write_b128 v5, v[0:3] offset:4096
	ds_write_b128 v5, v[0:3] offset:8192
	ds_write_b128 v5, v[0:3] offset:12288
	s_waitcnt lgkmcnt(0)
	v_mov_b32 v74, 0
	s_mov_b32 s20, 400000
	v_and_b32 v72, 7, v79
	v_lshrrev_b32 v73, 2, v72
	v_mul_u32_u24 v73, 112, v73
	v_lshlrev_b32 v72, 2, v72
	v_add_u32 v72, v72, v73
	s_getpc_b64 s[18:19]
.ct_394:
	s_sub_u32 s18, s18, .ct_394-L_ATTA
	s_subb_u32 s19, s19, 0
	v_lshlrev_b32 v74, 7, v79
	s_lshl_b32 s17, s15, 13
	v_add_u32 v74, s17, v74
	s_mov_b32 s17, L_ATTA_CE-L_ATTA-4
	v_min_u32 v74, s17, v74
	global_load_dword v73, v74, s[18:19]
	v_mov_b32 v74, 0
.gbre_391:
	global_load_dword v73, v72, s[12:13] offset:16 sc1
	s_waitcnt vmcnt(0)
	v_readlane_b32 s17, v73, 0
	v_readlane_b32 s18, v73, 1
	s_nop 0
	s_add_u32 s17, s17, s18
	v_readlane_b32 s18, v73, 2
	s_nop 0
	s_add_u32 s17, s17, s18
	v_readlane_b32 s18, v73, 3
	s_nop 0
	s_add_u32 s17, s17, s18
	v_readlane_b32 s18, v73, 4
	s_nop 0
	s_add_u32 s17, s17, s18
	v_readlane_b32 s18, v73, 5
	s_nop 0
	s_add_u32 s17, s17, s18
	v_readlane_b32 s18, v73, 6
	s_nop 0
	s_add_u32 s17, s17, s18
	v_readlane_b32 s18, v73, 7
	s_nop 0
	s_add_u32 s17, s17, s18
	s_cmp_ge_u32 s17, 256
	s_cbranch_scc1 .gbok_392
	s_sub_u32 s20, s20, 1
	s_cmp_lg_u32 s20, 0
	s_cbranch_scc1 .gbre_391
	s_branch L_FAIL
.gbok_392:
	v_cmp_ne_u32 vcc, 32, v73
	s_cbranch_vccnz L_ATTA_DEV
	s_lshl_b32 s17, s67, 10
	s_add_u32 s17, s17, s77
	s_add_u32 s18, s77, 442368
.pt_395:
	buffer_load_dwordx4 v[112:115], v153, s[4:7], s17 offen
	s_add_u32 s17, s17, 65536
	s_cmp_lt_u32 s17, s18
	s_cbranch_scc1 .pt_395
	s_lshl_b32 s17, s67, 10
	s_add_u32 s17, s17, s78
	s_add_u32 s18, s78, 147456
.pt_396:
	buffer_load_dwordx4 v[112:115], v153, s[4:7], s17 offen
	s_add_u32 s17, s17, 65536
	s_cmp_lt_u32 s17, s18
	s_cbranch_scc1 .pt_396
	s_lshl_b32 s17, s67, 10
	s_add_u32 s17, s17, s79
	s_add_u32 s18, s79, 294912
.pt_397:
	buffer_load_dwordx4 v[112:115], v153, s[4:7], s17 offen
	s_add_u32 s17, s17, 65536
	s_cmp_lt_u32 s17, s18
	s_cbranch_scc1 .pt_397
	s_waitcnt vmcnt(0)
	s_barrier
	s_mov_b32 s68, 16384
	s_mov_b32 s69, 24576
	s_mov_b32 s70, 32768
	s_mov_b32 s71, 40960
	s_mov_b32 s72, 49152
	s_mov_b32 s73, 57344
	s_mov_b32 s74, 65536
	s_mov_b32 s75, 73728
	s_mov_b32 s76, 0
	s_mov_b32 s28, 0
	s_cmp_eq_u32 s39, 1
	s_cbranch_scc1 .aatt1_398
	s_add_u32 s37, s28, 1
	s_mov_b32 s20, 400000
.pre_400:
	buffer_load_dword v155, v154, s[4:7], 0 offen sc1
	s_waitcnt vmcnt(0)
	v_cmp_gt_u32 vcc, s37, v155
	s_cbranch_vccz .pok_401
	s_sub_u32 s20, s20, 1
	s_cmp_lg_u32 s20, 0
	s_cbranch_scc1 .pre_400
	s_branch L_FAIL
.pok_401:
.aloop_399:
	s_and_b32 s77, s28, 3
	s_mul_i32 s77, s77, 110592
	s_and_b32 s78, s28, 3
	s_mul_i32 s78, s78, 36864
	s_add_u32 s17, s66, s76
	s_mov_b32 m0, s17
	s_add_u32 s18, s60, s77
	buffer_load_dwordx4 v153, s[4:7], s18 offen sc1 lds
	s_add_u32 s17, s17, 1024
	s_mov_b32 m0, s17
	s_add_u32 s18, s61, s77
	buffer_load_dwordx4 v153, s[4:7], s18 offen sc1 lds
	s_add_u32 s18, s64, s77
	buffer_load_dwordx2 v[112:113], v152, s[4:7], s18 offen sc1
	s_add_u32 s18, s65, s77
	buffer_load_dwordx2 v[114:115], v152, s[4:7], s18 offen sc1
	buffer_load_dword v173, v172, s[4:7], 0 offen sc1
	v_add_u32 v132, s68, v150
	v_add_u32 v141, s68, v151
	v_add_u32 v133, s69, v150
	v_add_u32 v142, s69, v151
	v_add_u32 v134, s70, v150
	v_add_u32 v143, s70, v151
	v_add_u32 v135, s71, v150
	v_add_u32 v144, s71, v151
	v_add_u32 v136, s72, v150
	v_add_u32 v145, s72, v151
	v_add_u32 v137, s73, v150
	v_add_u32 v146, s73, v151
	v_add_u32 v138, s74, v150
	v_add_u32 v147, s74, v151
	v_add_u32 v139, s75, v150
	v_add_u32 v148, s75, v151
	v_add_u32 v140, s76, v150
	v_add_u32 v149, s76, v151
	s_waitcnt vmcnt(0)
	v_and_b32 v114, v159, v114
	v_and_b32 v115, v160, v115
	s_barrier
	s_cmp_ge_u32 s28, 8
	s_cbranch_scc1 .aknorm_402
	s_cmp_lg_u32 s28, 0
	s_cbranch_scc1 .aknx_403
	ds_read2st64_b64 v[72:75], v140 offset0:0 offset1:2
	s_branch .akent_404
.aknx_403:
	s_cmp_lg_u32 s28, 1
	s_cbranch_scc1 .aknx_405
	ds_read2st64_b64 v[80:83], v139 offset0:0 offset1:2
	ds_read2st64_b64 v[84:87], v139 offset0:1 offset1:3
	ds_read2st64_b64 v[72:75], v140 offset0:0 offset1:2
	s_branch .akent_406
.aknx_405:
	s_cmp_lg_u32 s28, 2
	s_cbranch_scc1 .aknx_407
	ds_read2st64_b64 v[72:75], v138 offset0:0 offset1:2
	ds_read2st64_b64 v[76:79], v138 offset0:1 offset1:3
	ds_read2st64_b64 v[80:83], v139 offset0:0 offset1:2
	ds_read2st64_b64 v[84:87], v139 offset0:1 offset1:3
	s_branch .akent_408
.aknx_407:
	s_cmp_lg_u32 s28, 3
	s_cbranch_scc1 .aknx_409
	ds_read2st64_b64 v[80:83], v137 offset0:0 offset1:2
	ds_read2st64_b64 v[84:87], v137 offset0:1 offset1:3
	ds_read2st64_b64 v[72:75], v138 offset0:0 offset1:2
	ds_read2st64_b64 v[76:79], v138 offset0:1 offset1:3
	s_branch .akent_410
.aknx_409:
	s_cmp_lg_u32 s28, 4
	s_cbranch_scc1 .aknx_411
	ds_read2st64_b64 v[72:75], v136 offset0:0 offset1:2
	ds_read2st64_b64 v[76:79], v136 offset0:1 offset1:3
	ds_read2st64_b64 v[80:83], v137 offset0:0 offset1:2
	ds_read2st64_b64 v[84:87], v137 offset0:1 offset1:3
	s_branch .akent_412
.aknx_411:
	s_cmp_lg_u32 s28, 5
	s_cbranch_scc1 .aknx_413
	ds_read2st64_b64 v[80:83], v135 offset0:0 offset1:2
	ds_read2st64_b64 v[84:87], v135 offset0:1 offset1:3
	ds_read2st64_b64 v[72:75], v136 offset0:0 offset1:2
	ds_read2st64_b64 v[76:79], v136 offset0:1 offset1:3
	s_branch .akent_414
.aknx_413:
	s_cmp_lg_u32 s28, 6
	s_cbranch_scc1 .aknx_415
	ds_read2st64_b64 v[72:75], v134 offset0:0 offset1:2
	ds_read2st64_b64 v[76:79], v134 offset0:1 offset1:3
	ds_read2st64_b64 v[80:83], v135 offset0:0 offset1:2
	ds_read2st64_b64 v[84:87], v135 offset0:1 offset1:3
	s_branch .akent_416
.aknx_415:
	ds_read2st64_b64 v[80:83], v133 offset0:0 offset1:2
	ds_read2st64_b64 v[84:87], v133 offset0:1 offset1:3
	ds_read2st64_b64 v[72:75], v134 offset0:0 offset1:2
	ds_read2st64_b64 v[76:79], v134 offset0:1 offset1:3
	s_branch .akent_418
.aknx_417:
.aknorm_402:
	ds_read2st64_b64 v[72:75], v132 offset0:0 offset1:2
	ds_read2st64_b64 v[76:79], v132 offset0:1 offset1:3
	ds_read2st64_b64 v[80:83], v133 offset0:0 offset1:2
	ds_read2st64_b64 v[84:87], v133 offset0:1 offset1:3
	s_waitcnt lgkmcnt(3)
	v_mfma_f32_16x16x32_bf16 v[0:3], v[72:75], v[112:115], 0
	ds_read2st64_b64 v[72:75], v134 offset0:0 offset1:2
	s_waitcnt lgkmcnt(3)
	v_mfma_f32_16x16x32_bf16 v[4:7], v[76:79], v[112:115], 0
	ds_read2st64_b64 v[76:79], v134 offset0:1 offset1:3
.akent_418:
	s_waitcnt lgkmcnt(3)
	v_mfma_f32_16x16x32_bf16 v[8:11], v[80:83], v[112:115], 0
	ds_read2st64_b64 v[80:83], v135 offset0:0 offset1:2
	s_waitcnt lgkmcnt(3)
	v_mfma_f32_16x16x32_bf16 v[12:15], v[84:87], v[112:115], 0
	ds_read2st64_b64 v[84:87], v135 offset0:1 offset1:3
.akent_416:
	s_waitcnt lgkmcnt(3)
	v_mfma_f32_16x16x32_bf16 v[16:19], v[72:75], v[112:115], 0
	ds_read2st64_b64 v[72:75], v136 offset0:0 offset1:2
	s_waitcnt lgkmcnt(3)
	v_mfma_f32_16x16x32_bf16 v[20:23], v[76:79], v[112:115], 0
	ds_read2st64_b64 v[76:79], v136 offset0:1 offset1:3
.akent_414:
	s_waitcnt lgkmcnt(3)
	v_mfma_f32_16x16x32_bf16 v[24:27], v[80:83], v[112:115], 0
	ds_read2st64_b64 v[80:83], v137 offset0:0 offset1:2
	s_waitcnt lgkmcnt(3)
	v_mfma_f32_16x16x32_bf16 v[28:31], v[84:87], v[112:115], 0
	ds_read2st64_b64 v[84:87], v137 offset0:1 offset1:3
.akent_412:
	s_waitcnt lgkmcnt(3)
	v_mfma_f32_16x16x32_bf16 v[32:35], v[72:75], v[112:115], 0
	ds_read2st64_b64 v[72:75], v138 offset0:0 offset1:2
	s_waitcnt lgkmcnt(3)
	v_mfma_f32_16x16x32_bf16 v[36:39], v[76:79], v[112:115], 0
	ds_read2st64_b64 v[76:79], v138 offset0:1 offset1:3
.akent_410:
	s_waitcnt lgkmcnt(3)
	v_mfma_f32_16x16x32_bf16 v[40:43], v[80:83], v[112:115], 0
	ds_read2st64_b64 v[80:83], v139 offset0:0 offset1:2
	s_waitcnt lgkmcnt(3)
	v_mfma_f32_16x16x32_bf16 v[44:47], v[84:87], v[112:115], 0
	ds_read2st64_b64 v[84:87], v139 offset0:1 offset1:3
.akent_408:
	s_waitcnt lgkmcnt(3)
	v_mfma_f32_16x16x32_bf16 v[48:51], v[72:75], v[112:115], 0
	ds_read2st64_b64 v[72:75], v140 offset0:0 offset1:2
	s_waitcnt lgkmcnt(3)
	v_mfma_f32_16x16x32_bf16 v[52:55], v[76:79], v[112:115], 0
.akent_406:
	s_waitcnt lgkmcnt(2)
	v_mfma_f32_16x16x32_bf16 v[56:59], v[80:83], v[112:115], 0
	s_waitcnt lgkmcnt(1)
	v_mfma_f32_16x16x32_bf16 v[60:63], v[84:87], v[112:115], 0
.akent_404:
	s_waitcnt lgkmcnt(0)
	v_mfma_f32_16x16x32_bf16 v[64:67], v[72:75], v[112:115], 0
	s_cmp_ge_u32 s28, 8
	s_cbranch_scc1 .avnorm_419
	v_mov_b32 v116, 0
	v_mov_b32 v117, 0
	v_mov_b32 v118, 0
	v_mov_b32 v119, 0
	v_mov_b32 v120, 0
	v_mov_b32 v121, 0
	v_mov_b32 v122, 0
	v_mov_b32 v123, 0
	v_mov_b32 v124, 0
	v_mov_b32 v125, 0
	v_mov_b32 v126, 0
	v_mov_b32 v127, 0
	s_cmp_lg_u32 s28, 0
	s_cbranch_scc1 .avnx_421
	ds_read_b128 v[104:107], v149 offset:2048
	ds_read_b128 v[108:111], v149 offset:3072
	s_branch .avjoin_420
.avnx_421:
	s_cmp_lg_u32 s28, 1
	s_cbranch_scc1 .avnx_422
	ds_read_b128 v[96:99], v148 offset:2048
	ds_read_b128 v[100:103], v148 offset:3072
	ds_read_b128 v[104:107], v149 offset:2048
	ds_read_b128 v[108:111], v149 offset:3072
	s_branch .avjoin_420
.avnx_422:
	s_cmp_lg_u32 s28, 2
	s_cbranch_scc1 .avnx_423
	ds_read_b128 v[88:91], v147 offset:2048
	ds_read_b128 v[92:95], v147 offset:3072
	ds_read_b128 v[96:99], v148 offset:2048
	ds_read_b128 v[100:103], v148 offset:3072
	ds_read_b128 v[104:107], v149 offset:2048
	ds_read_b128 v[108:111], v149 offset:3072
	s_branch .avjoin_420
.avnx_423:
	s_cmp_lg_u32 s28, 3
	s_cbranch_scc1 .avnx_424
	ds_read_b128 v[104:107], v146 offset:2048
	ds_read_b128 v[108:111], v146 offset:3072
	ds_read_b128 v[88:91], v147 offset:2048
	ds_read_b128 v[92:95], v147 offset:3072
	ds_read_b128 v[96:99], v148 offset:2048
	ds_read_b128 v[100:103], v148 offset:3072
	s_branch .avjoin_420
.avnx_424:
	s_cmp_lg_u32 s28, 4
	s_cbranch_scc1 .avnx_425
	ds_read_b128 v[96:99], v145 offset:2048
	ds_read_b128 v[100:103], v145 offset:3072
	ds_read_b128 v[104:107], v146 offset:2048
	ds_read_b128 v[108:111], v146 offset:3072
	ds_read_b128 v[88:91], v147 offset:2048
	ds_read_b128 v[92:95], v147 offset:3072
	s_branch .avjoin_420
.avnx_425:
	s_cmp_lg_u32 s28, 5
	s_cbranch_scc1 .avnx_426
	ds_read_b128 v[88:91], v144 offset:2048
	ds_read_b128 v[92:95], v144 offset:3072
	ds_read_b128 v[96:99], v145 offset:2048
	ds_read_b128 v[100:103], v145 offset:3072
	ds_read_b128 v[104:107], v146 offset:2048
	ds_read_b128 v[108:111], v146 offset:3072
	s_branch .avjoin_420
.avnx_426:
	s_cmp_lg_u32 s28, 6
	s_cbranch_scc1 .avnx_427
	ds_read_b128 v[104:107], v143 offset:2048
	ds_read_b128 v[108:111], v143 offset:3072
	ds_read_b128 v[88:91], v144 offset:2048
	ds_read_b128 v[92:95], v144 offset:3072
	ds_read_b128 v[96:99], v145 offset:2048
	ds_read_b128 v[100:103], v145 offset:3072
	s_branch .avjoin_420
.avnx_427:
	ds_read_b128 v[96:99], v142 offset:2048
	ds_read_b128 v[100:103], v142 offset:3072
	ds_read_b128 v[104:107], v143 offset:2048
	ds_read_b128 v[108:111], v143 offset:3072
	ds_read_b128 v[88:91], v144 offset:2048
	ds_read_b128 v[92:95], v144 offset:3072
	s_branch .avjoin_420
.avnx_428:
.avnorm_419:
	ds_read_b128 v[88:91], v141 offset:2048
	ds_read_b128 v[92:95], v141 offset:3072
	ds_read_b128 v[96:99], v142 offset:2048
	ds_read_b128 v[100:103], v142 offset:3072
	ds_read_b128 v[104:107], v143 offset:2048
	ds_read_b128 v[108:111], v143 offset:3072
.avjoin_420:
	v_cndmask_b32 v0, v158, v0, s[46:47]
	v_cndmask_b32 v1, v158, v1, s[48:49]
	v_cndmask_b32 v2, v158, v2, s[50:51]
	v_cndmask_b32 v3, v158, v3, s[52:53]
	v_cndmask_b32 v64, v64, v158, s[46:47]
	v_cndmask_b32 v65, v65, v158, s[48:49]
	v_cndmask_b32 v66, v66, v158, s[50:51]
	v_cndmask_b32 v67, v67, v158, s[52:53]
	s_cmp_ge_u32 s28, 8
	s_cbranch_scc1 .aval_429
	s_cmp_ge_u32 s28, 8
	s_cbranch_scc1 .aval_429
	v_mov_b32 v0, v158
	v_mov_b32 v1, v158
	v_mov_b32 v2, v158
	v_mov_b32 v3, v158
	v_mov_b32 v4, v158
	v_mov_b32 v5, v158
	v_mov_b32 v6, v158
	v_mov_b32 v7, v158
	s_cmp_ge_u32 s28, 7
	s_cbranch_scc1 .aval_429
	v_mov_b32 v8, v158
	v_mov_b32 v9, v158
	v_mov_b32 v10, v158
	v_mov_b32 v11, v158
	v_mov_b32 v12, v158
	v_mov_b32 v13, v158
	v_mov_b32 v14, v158
	v_mov_b32 v15, v158
	s_cmp_ge_u32 s28, 6
	s_cbranch_scc1 .aval_429
	v_mov_b32 v16, v158
	v_mov_b32 v17, v158
	v_mov_b32 v18, v158
	v_mov_b32 v19, v158
	v_mov_b32 v20, v158
	v_mov_b32 v21, v158
	v_mov_b32 v22, v158
	v_mov_b32 v23, v158
	s_cmp_ge_u32 s28, 5
	s_cbranch_scc1 .aval_429
	v_mov_b32 v24, v158
	v_mov_b32 v25, v158
	v_mov_b32 v26, v158
	v_mov_b32 v27, v158
	v_mov_b32 v28, v158
	v_mov_b32 v29, v158
	v_mov_b32 v30, v158
	v_mov_b32 v31, v158
	s_cmp_ge_u32 s28, 4
	s_cbranch_scc1 .aval_429
	v_mov_b32 v32, v158
	v_mov_b32 v33, v158
	v_mov_b32 v34, v158
	v_mov_b32 v35, v158
	v_mov_b32 v36, v158
	v_mov_b32 v37, v158
	v_mov_b32 v38, v158
	v_mov_b32 v39, v158
	s_cmp_ge_u32 s28, 3
	s_cbranch_scc1 .aval_429
	v_mov_b32 v40, v158
	v_mov_b32 v41, v158
	v_mov_b32 v42, v158
	v_mov_b32 v43, v158
	v_mov_b32 v44, v158
	v_mov_b32 v45, v158
	v_mov_b32 v46, v158
	v_mov_b32 v47, v158
	s_cmp_ge_u32 s28, 2
	s_cbranch_scc1 .aval_429
	v_mov_b32 v48, v158
	v_mov_b32 v49, v158
	v_mov_b32 v50, v158
	v_mov_b32 v51, v158
	v_mov_b32 v52, v158
	v_mov_b32 v53, v158
	v_mov_b32 v54, v158
	v_mov_b32 v55, v158
	s_cmp_ge_u32 s28, 1
	s_cbranch_scc1 .aval_429
	v_mov_b32 v56, v158
	v_mov_b32 v57, v158
	v_mov_b32 v58, v158
	v_mov_b32 v59, v158
	v_mov_b32 v60, v158
	v_mov_b32 v61, v158
	v_mov_b32 v62, v158
	v_mov_b32 v63, v158
.aval_429:
	s_nop 7
	v_max3_f32 v168, v0, v1, v2
	v_max3_f32 v169, v3, v4, v5
	v_max3_f32 v168, v168, v6, v7
	v_max3_f32 v169, v169, v8, v9
	v_max3_f32 v168, v168, v10, v11
	v_max3_f32 v169, v169, v12, v13
	v_max3_f32 v168, v168, v14, v15
	v_max3_f32 v169, v169, v16, v17
	v_max3_f32 v168, v168, v18, v19
	v_max3_f32 v169, v169, v20, v21
	v_max3_f32 v168, v168, v22, v23
	v_max3_f32 v169, v169, v24, v25
	v_max3_f32 v168, v168, v26, v27
	v_max3_f32 v169, v169, v28, v29
	v_max3_f32 v168, v168, v30, v31
	v_max3_f32 v169, v169, v32, v33
	v_max3_f32 v168, v168, v34, v35
	v_max3_f32 v169, v169, v36, v37
	v_max3_f32 v168, v168, v38, v39
	v_max3_f32 v169, v169, v40, v41
	v_max3_f32 v168, v168, v42, v43
	v_max3_f32 v169, v169, v44, v45
	v_max3_f32 v168, v168, v46, v47
	v_max3_f32 v169, v169, v48, v49
	v_max3_f32 v168, v168, v50, v51
	v_max3_f32 v169, v169, v52, v53
	v_max3_f32 v168, v168, v54, v55
	v_max3_f32 v169, v169, v56, v57
	v_max3_f32 v168, v168, v58, v59
	v_max3_f32 v169, v169, v60, v61
	v_max3_f32 v168, v168, v62, v63
	v_max3_f32 v169, v169, v64, v65
	v_max3_f32 v168, v168, v66, v67
	v_max_f32 v168, v168, v169
	v_mov_b32 v170, v168
	s_nop 1
	v_permlane16_swap_b32 v168, v170
	v_max_f32 v168, v168, v170
	v_mov_b32 v170, v168
	s_nop 1
	v_permlane32_swap_b32 v168, v170
	v_max_f32 v168, v168, v170
	v_mul_f32 v166, 0xbeae1a93, v168
	v_mov_b32 v167, v166
	s_cmp_ge_u32 s28, 8
	s_cbranch_scc1 .amnorm_430
	s_cmp_eq_u32 s28, 0
	s_cbranch_scc1 .ament_431
	s_cmp_eq_u32 s28, 1
	s_cbranch_scc1 .ament_432
	s_cmp_eq_u32 s28, 2
	s_cbranch_scc1 .ament_433
	s_cmp_eq_u32 s28, 3
	s_cbranch_scc1 .ament_434
	s_cmp_eq_u32 s28, 4
	s_cbranch_scc1 .ament_435
	s_cmp_eq_u32 s28, 5
	s_cbranch_scc1 .ament_436
	s_cmp_eq_u32 s28, 6
	s_cbranch_scc1 .ament_437
	s_branch .ament_438
.amnorm_430:
	v_pk_fma_f32 v[0:1], v[0:1], v[164:165], v[166:167]
	v_pk_fma_f32 v[2:3], v[2:3], v[164:165], v[166:167]
	v_pk_fma_f32 v[4:5], v[4:5], v[164:165], v[166:167]
	v_pk_fma_f32 v[6:7], v[6:7], v[164:165], v[166:167]
	v_exp_f32 v0, v0
	v_exp_f32 v1, v1
	v_exp_f32 v2, v2
	v_exp_f32 v3, v3
	v_exp_f32 v4, v4
	v_exp_f32 v5, v5
	v_exp_f32 v6, v6
	v_exp_f32 v7, v7
	v_cvt_pk_bf16_f32 v0, v0, v1
	v_cvt_pk_bf16_f32 v1, v2, v3
	v_cvt_pk_bf16_f32 v2, v4, v5
	v_cvt_pk_bf16_f32 v3, v6, v7
	s_waitcnt lgkmcnt(4)
	s_nop 0
	v_mfma_f32_16x16x32_bf16 v[116:119], v[88:91], v[0:3], 0
	v_mfma_f32_16x16x32_bf16 v[120:123], v[92:95], v[0:3], 0
	v_mfma_f32_16x16x32_bf16 v[124:127], v[128:131], v[0:3], 0
	ds_read_b128 v[88:91], v144 offset:2048
	ds_read_b128 v[92:95], v144 offset:3072
.ament_438:
	v_pk_fma_f32 v[8:9], v[8:9], v[164:165], v[166:167]
	v_pk_fma_f32 v[10:11], v[10:11], v[164:165], v[166:167]
	v_pk_fma_f32 v[12:13], v[12:13], v[164:165], v[166:167]
	v_pk_fma_f32 v[14:15], v[14:15], v[164:165], v[166:167]
	v_exp_f32 v8, v8
	v_exp_f32 v9, v9
	v_exp_f32 v10, v10
	v_exp_f32 v11, v11
	v_exp_f32 v12, v12
	v_exp_f32 v13, v13
	v_exp_f32 v14, v14
	v_exp_f32 v15, v15
	v_cvt_pk_bf16_f32 v8, v8, v9
	v_cvt_pk_bf16_f32 v9, v10, v11
	v_cvt_pk_bf16_f32 v10, v12, v13
	v_cvt_pk_bf16_f32 v11, v14, v15
	s_waitcnt lgkmcnt(4)
	s_nop 0
	v_mfma_f32_16x16x32_bf16 v[116:119], v[96:99], v[8:11], v[116:119]
	v_mfma_f32_16x16x32_bf16 v[120:123], v[100:103], v[8:11], v[120:123]
	v_mfma_f32_16x16x32_bf16 v[124:127], v[128:131], v[8:11], v[124:127]
	ds_read_b128 v[96:99], v145 offset:2048
	ds_read_b128 v[100:103], v145 offset:3072
.ament_437:
	v_pk_fma_f32 v[16:17], v[16:17], v[164:165], v[166:167]
	v_pk_fma_f32 v[18:19], v[18:19], v[164:165], v[166:167]
	v_pk_fma_f32 v[20:21], v[20:21], v[164:165], v[166:167]
	v_pk_fma_f32 v[22:23], v[22:23], v[164:165], v[166:167]
	v_exp_f32 v16, v16
	v_exp_f32 v17, v17
	v_exp_f32 v18, v18
	v_exp_f32 v19, v19
	v_exp_f32 v20, v20
	v_exp_f32 v21, v21
	v_exp_f32 v22, v22
	v_exp_f32 v23, v23
	v_cvt_pk_bf16_f32 v16, v16, v17
	v_cvt_pk_bf16_f32 v17, v18, v19
	v_cvt_pk_bf16_f32 v18, v20, v21
	v_cvt_pk_bf16_f32 v19, v22, v23
	s_waitcnt lgkmcnt(4)
	s_nop 0
	v_mfma_f32_16x16x32_bf16 v[116:119], v[104:107], v[16:19], v[116:119]
	v_mfma_f32_16x16x32_bf16 v[120:123], v[108:111], v[16:19], v[120:123]
	v_mfma_f32_16x16x32_bf16 v[124:127], v[128:131], v[16:19], v[124:127]
	ds_read_b128 v[104:107], v146 offset:2048
	ds_read_b128 v[108:111], v146 offset:3072
.ament_436:
	v_pk_fma_f32 v[24:25], v[24:25], v[164:165], v[166:167]
	v_pk_fma_f32 v[26:27], v[26:27], v[164:165], v[166:167]
	v_pk_fma_f32 v[28:29], v[28:29], v[164:165], v[166:167]
	v_pk_fma_f32 v[30:31], v[30:31], v[164:165], v[166:167]
	v_exp_f32 v24, v24
	v_exp_f32 v25, v25
	v_exp_f32 v26, v26
	v_exp_f32 v27, v27
	v_exp_f32 v28, v28
	v_exp_f32 v29, v29
	v_exp_f32 v30, v30
	v_exp_f32 v31, v31
	v_cvt_pk_bf16_f32 v24, v24, v25
	v_cvt_pk_bf16_f32 v25, v26, v27
	v_cvt_pk_bf16_f32 v26, v28, v29
	v_cvt_pk_bf16_f32 v27, v30, v31
	s_waitcnt lgkmcnt(4)
	s_nop 0
	v_mfma_f32_16x16x32_bf16 v[116:119], v[88:91], v[24:27], v[116:119]
	v_mfma_f32_16x16x32_bf16 v[120:123], v[92:95], v[24:27], v[120:123]
	v_mfma_f32_16x16x32_bf16 v[124:127], v[128:131], v[24:27], v[124:127]
	ds_read_b128 v[88:91], v147 offset:2048
	ds_read_b128 v[92:95], v147 offset:3072
.ament_435:
	v_pk_fma_f32 v[32:33], v[32:33], v[164:165], v[166:167]
	v_pk_fma_f32 v[34:35], v[34:35], v[164:165], v[166:167]
	v_pk_fma_f32 v[36:37], v[36:37], v[164:165], v[166:167]
	v_pk_fma_f32 v[38:39], v[38:39], v[164:165], v[166:167]
	v_exp_f32 v32, v32
	v_exp_f32 v33, v33
	v_exp_f32 v34, v34
	v_exp_f32 v35, v35
	v_exp_f32 v36, v36
	v_exp_f32 v37, v37
	v_exp_f32 v38, v38
	v_exp_f32 v39, v39
	v_cvt_pk_bf16_f32 v32, v32, v33
	v_cvt_pk_bf16_f32 v33, v34, v35
	v_cvt_pk_bf16_f32 v34, v36, v37
	v_cvt_pk_bf16_f32 v35, v38, v39
	s_waitcnt lgkmcnt(4)
	s_nop 0
	v_mfma_f32_16x16x32_bf16 v[116:119], v[96:99], v[32:35], v[116:119]
	v_mfma_f32_16x16x32_bf16 v[120:123], v[100:103], v[32:35], v[120:123]
	v_mfma_f32_16x16x32_bf16 v[124:127], v[128:131], v[32:35], v[124:127]
	ds_read_b128 v[96:99], v148 offset:2048
	ds_read_b128 v[100:103], v148 offset:3072
.ament_434:
	v_pk_fma_f32 v[40:41], v[40:41], v[164:165], v[166:167]
	v_pk_fma_f32 v[42:43], v[42:43], v[164:165], v[166:167]
	v_pk_fma_f32 v[44:45], v[44:45], v[164:165], v[166:167]
	v_pk_fma_f32 v[46:47], v[46:47], v[164:165], v[166:167]
	v_exp_f32 v40, v40
	v_exp_f32 v41, v41
	v_exp_f32 v42, v42
	v_exp_f32 v43, v43
	v_exp_f32 v44, v44
	v_exp_f32 v45, v45
	v_exp_f32 v46, v46
	v_exp_f32 v47, v47
	v_cvt_pk_bf16_f32 v40, v40, v41
	v_cvt_pk_bf16_f32 v41, v42, v43
	v_cvt_pk_bf16_f32 v42, v44, v45
	v_cvt_pk_bf16_f32 v43, v46, v47
	s_waitcnt lgkmcnt(4)
	s_nop 0
	v_mfma_f32_16x16x32_bf16 v[116:119], v[104:107], v[40:43], v[116:119]
	v_mfma_f32_16x16x32_bf16 v[120:123], v[108:111], v[40:43], v[120:123]
	v_mfma_f32_16x16x32_bf16 v[124:127], v[128:131], v[40:43], v[124:127]
	ds_read_b128 v[104:107], v149 offset:2048
	ds_read_b128 v[108:111], v149 offset:3072
.ament_433:
	v_pk_fma_f32 v[48:49], v[48:49], v[164:165], v[166:167]
	v_pk_fma_f32 v[50:51], v[50:51], v[164:165], v[166:167]
	v_pk_fma_f32 v[52:53], v[52:53], v[164:165], v[166:167]
	v_pk_fma_f32 v[54:55], v[54:55], v[164:165], v[166:167]
	v_exp_f32 v48, v48
	v_exp_f32 v49, v49
	v_exp_f32 v50, v50
	v_exp_f32 v51, v51
	v_exp_f32 v52, v52
	v_exp_f32 v53, v53
	v_exp_f32 v54, v54
	v_exp_f32 v55, v55
	v_cvt_pk_bf16_f32 v48, v48, v49
	v_cvt_pk_bf16_f32 v49, v50, v51
	v_cvt_pk_bf16_f32 v50, v52, v53
	v_cvt_pk_bf16_f32 v51, v54, v55
	s_waitcnt lgkmcnt(4)
	s_nop 0
	v_mfma_f32_16x16x32_bf16 v[116:119], v[88:91], v[48:51], v[116:119]
	v_mfma_f32_16x16x32_bf16 v[120:123], v[92:95], v[48:51], v[120:123]
	v_mfma_f32_16x16x32_bf16 v[124:127], v[128:131], v[48:51], v[124:127]
.ament_432:
	v_pk_fma_f32 v[56:57], v[56:57], v[164:165], v[166:167]
	v_pk_fma_f32 v[58:59], v[58:59], v[164:165], v[166:167]
	v_pk_fma_f32 v[60:61], v[60:61], v[164:165], v[166:167]
	v_pk_fma_f32 v[62:63], v[62:63], v[164:165], v[166:167]
	v_exp_f32 v56, v56
	v_exp_f32 v57, v57
	v_exp_f32 v58, v58
	v_exp_f32 v59, v59
	v_exp_f32 v60, v60
	v_exp_f32 v61, v61
	v_exp_f32 v62, v62
	v_exp_f32 v63, v63
	v_cvt_pk_bf16_f32 v56, v56, v57
	v_cvt_pk_bf16_f32 v57, v58, v59
	v_cvt_pk_bf16_f32 v58, v60, v61
	v_cvt_pk_bf16_f32 v59, v62, v63
	s_waitcnt lgkmcnt(2)
	s_nop 0
	v_mfma_f32_16x16x32_bf16 v[116:119], v[96:99], v[56:59], v[116:119]
	v_mfma_f32_16x16x32_bf16 v[120:123], v[100:103], v[56:59], v[120:123]
	v_mfma_f32_16x16x32_bf16 v[124:127], v[128:131], v[56:59], v[124:127]
.ament_431:
	v_pk_fma_f32 v[64:65], v[64:65], v[164:165], v[166:167]
	v_pk_fma_f32 v[66:67], v[66:67], v[164:165], v[166:167]
	v_exp_f32 v64, v64
	v_exp_f32 v65, v65
	v_exp_f32 v66, v66
	v_exp_f32 v67, v67
	v_cvt_pk_bf16_f32 v64, v64, v65
	v_cvt_pk_bf16_f32 v65, v66, v67
	v_mov_b32 v66, 0
	v_mov_b32 v67, 0
	s_waitcnt lgkmcnt(0)
	s_nop 0
	v_mfma_f32_16x16x32_bf16 v[116:119], v[104:107], v[64:67], v[116:119]
	v_mfma_f32_16x16x32_bf16 v[120:123], v[108:111], v[64:67], v[120:123]
	v_mfma_f32_16x16x32_bf16 v[124:127], v[128:131], v[64:67], v[124:127]
	s_nop 7
	v_rcp_f32 v170, v124
	s_nop 0
	v_mul_f32 v116, v116, v170
	v_mul_f32 v120, v120, v170
	v_mul_f32 v117, v117, v170
	v_mul_f32 v121, v121, v170
	v_mul_f32 v118, v118, v170
	v_mul_f32 v122, v122, v170
	v_mul_f32 v119, v119, v170
	v_mul_f32 v123, v123, v170
	v_cvt_pk_bf16_f32 v116, v116, v117
	v_cvt_pk_bf16_f32 v117, v118, v119
	v_cvt_pk_bf16_f32 v120, v120, v121
	v_cvt_pk_bf16_f32 v121, v122, v123
	v_cndmask_b32 v120, v120, v121, s[56:57]
	s_sub_i32 s77, s28, 3
	s_max_i32 s77, s77, 0
	v_cmp_gt_u32 vcc, s77, v173
	s_cbranch_vccz .pck_439
	s_mov_b32 s20, 400000
.pre_440:
	buffer_load_dword v173, v172, s[4:7], 0 offen sc1
	s_waitcnt vmcnt(0)
	v_cmp_gt_u32 vcc, s77, v173
	s_cbranch_vccz .pok_441
	s_sub_u32 s20, s20, 1
	s_cmp_lg_u32 s20, 0
	s_cbranch_scc1 .pre_440
	s_branch L_FAIL
.pok_441:
.pck_439:
	s_add_u32 s17, s58, s78
	s_add_u32 s18, s59, s78
	buffer_store_dwordx2 v[116:117], v161, s[4:7], s17 offen
	s_mov_b64 exec, s[54:55]
	buffer_store_dword v120, v162, s[4:7], s18 offen
	s_mov_b64 exec, -1
	buffer_load_dword v155, v154, s[4:7], 0 offen sc1
	s_add_u32 s68, s68, 8192
	s_cmp_eq_u32 s68, 81920
	s_cselect_b32 s68, 0, s68
	s_add_u32 s69, s69, 8192
	s_cmp_eq_u32 s69, 81920
	s_cselect_b32 s69, 0, s69
	s_add_u32 s70, s70, 8192
	s_cmp_eq_u32 s70, 81920
	s_cselect_b32 s70, 0, s70
	s_add_u32 s71, s71, 8192
	s_cmp_eq_u32 s71, 81920
	s_cselect_b32 s71, 0, s71
	s_add_u32 s72, s72, 8192
	s_cmp_eq_u32 s72, 81920
	s_cselect_b32 s72, 0, s72
	s_add_u32 s73, s73, 8192
	s_cmp_eq_u32 s73, 81920
	s_cselect_b32 s73, 0, s73
	s_add_u32 s74, s74, 8192
	s_cmp_eq_u32 s74, 81920
	s_cselect_b32 s74, 0, s74
	s_add_u32 s75, s75, 8192
	s_cmp_eq_u32 s75, 81920
	s_cselect_b32 s75, 0, s75
	s_add_u32 s76, s76, 8192
	s_cmp_eq_u32 s76, 81920
	s_cselect_b32 s76, 0, s76
	s_add_u32 s28, s28, 1
	s_waitcnt vmcnt(0)
	v_mov_b32 v157, s28
	s_mov_b64 exec, 1
	buffer_store_dword v157, v156, s[4:7], s30 offen
	s_mov_b64 exec, -1
	s_cmp_ge_u32 s28, 64
	s_cbranch_scc1 L_END
	s_add_u32 s37, s28, 1
	v_cmp_gt_u32 vcc, s37, v155
	s_cbranch_vccz .pck_442
	s_mov_b32 s20, 400000
.pre_443:
	buffer_load_dword v155, v154, s[4:7], 0 offen sc1
	s_waitcnt vmcnt(0)
	v_cmp_gt_u32 vcc, s37, v155
	s_cbranch_vccz .pok_444
	s_sub_u32 s20, s20, 1
	s_cmp_lg_u32 s20, 0
	s_cbranch_scc1 .pre_443
	s_branch L_FAIL
.pok_444:
.pck_442:
	s_branch .aloop_399
.aatt1_398:
	s_add_u32 s37, s28, 1
	s_mov_b32 s20, 400000
.pre_446:
	buffer_load_dword v155, v154, s[4:7], 0 offen sc1
	s_waitcnt vmcnt(0)
	v_cmp_gt_u32 vcc, s37, v155
	s_cbranch_vccz .pok_447
	s_sub_u32 s20, s20, 1
	s_cmp_lg_u32 s20, 0
	s_cbranch_scc1 .pre_446
	s_branch L_FAIL
.pok_447:
.aloop_445:
	s_and_b32 s77, s28, 3
	s_mul_i32 s77, s77, 110592
	s_and_b32 s78, s28, 3
	s_mul_i32 s78, s78, 36864
	s_add_u32 s17, s66, s76
	s_mov_b32 m0, s17
	s_add_u32 s18, s60, s77
	buffer_load_dwordx4 v153, s[4:7], s18 offen sc1 lds
	s_add_u32 s17, s17, 1024
	s_mov_b32 m0, s17
	s_add_u32 s18, s61, s77
	buffer_load_dwordx4 v153, s[4:7], s18 offen sc1 lds
	s_add_u32 s18, s64, s77
	buffer_load_dwordx2 v[112:113], v152, s[4:7], s18 offen sc1
	s_add_u32 s18, s65, s77
	buffer_load_dwordx2 v[114:115], v152, s[4:7], s18 offen sc1
	buffer_load_dword v173, v172, s[4:7], 0 offen sc1
	v_add_u32 v132, s68, v150
	v_add_u32 v141, s68, v151
	v_add_u32 v133, s69, v150
	v_add_u32 v142, s69, v151
	v_add_u32 v134, s70, v150
	v_add_u32 v143, s70, v151
	v_add_u32 v135, s71, v150
	v_add_u32 v144, s71, v151
	v_add_u32 v136, s72, v150
	v_add_u32 v145, s72, v151
	v_add_u32 v137, s73, v150
	v_add_u32 v146, s73, v151
	v_add_u32 v138, s74, v150
	v_add_u32 v147, s74, v151
	v_add_u32 v139, s75, v150
	v_add_u32 v148, s75, v151
	v_add_u32 v140, s76, v150
	v_add_u32 v149, s76, v151
	s_waitcnt vmcnt(0)
	v_and_b32 v114, v159, v114
	v_and_b32 v115, v160, v115
	s_barrier
	s_cmp_ge_u32 s28, 8
	s_cbranch_scc1 .aknorm_448
	s_cmp_lg_u32 s28, 0
	s_cbranch_scc1 .aknx_449
	ds_read2st64_b64 v[84:87], v140 offset0:0 offset1:2
	ds_read2st64_b64 v[72:75], v140 offset0:1 offset1:3
	s_branch .akent_450
.aknx_449:
	s_cmp_lg_u32 s28, 1
	s_cbranch_scc1 .aknx_451
	ds_read2st64_b64 v[76:79], v139 offset0:0 offset1:2
	ds_read2st64_b64 v[80:83], v139 offset0:1 offset1:3
	ds_read2st64_b64 v[84:87], v140 offset0:0 offset1:2
	ds_read2st64_b64 v[72:75], v140 offset0:1 offset1:3
	s_branch .akent_452
.aknx_451:
	s_cmp_lg_u32 s28, 2
	s_cbranch_scc1 .aknx_453
	ds_read2st64_b64 v[84:87], v138 offset0:0 offset1:2
	ds_read2st64_b64 v[72:75], v138 offset0:1 offset1:3
	ds_read2st64_b64 v[76:79], v139 offset0:0 offset1:2
	ds_read2st64_b64 v[80:83], v139 offset0:1 offset1:3
	s_branch .akent_454
.aknx_453:
	s_cmp_lg_u32 s28, 3
	s_cbranch_scc1 .aknx_455
	ds_read2st64_b64 v[76:79], v137 offset0:0 offset1:2
	ds_read2st64_b64 v[80:83], v137 offset0:1 offset1:3
	ds_read2st64_b64 v[84:87], v138 offset0:0 offset1:2
	ds_read2st64_b64 v[72:75], v138 offset0:1 offset1:3
	s_branch .akent_456
.aknx_455:
	s_cmp_lg_u32 s28, 4
	s_cbranch_scc1 .aknx_457
	ds_read2st64_b64 v[84:87], v136 offset0:0 offset1:2
	ds_read2st64_b64 v[72:75], v136 offset0:1 offset1:3
	ds_read2st64_b64 v[76:79], v137 offset0:0 offset1:2
	ds_read2st64_b64 v[80:83], v137 offset0:1 offset1:3
	s_branch .akent_458
.aknx_457:
	s_cmp_lg_u32 s28, 5
	s_cbranch_scc1 .aknx_459
	ds_read2st64_b64 v[76:79], v135 offset0:0 offset1:2
	ds_read2st64_b64 v[80:83], v135 offset0:1 offset1:3
	ds_read2st64_b64 v[84:87], v136 offset0:0 offset1:2
	ds_read2st64_b64 v[72:75], v136 offset0:1 offset1:3
	s_branch .akent_460
.aknx_459:
	s_cmp_lg_u32 s28, 6
	s_cbranch_scc1 .aknx_461
	ds_read2st64_b64 v[84:87], v134 offset0:0 offset1:2
	ds_read2st64_b64 v[72:75], v134 offset0:1 offset1:3
	ds_read2st64_b64 v[76:79], v135 offset0:0 offset1:2
	ds_read2st64_b64 v[80:83], v135 offset0:1 offset1:3
	s_branch .akent_462
.aknx_461:
	ds_read2st64_b64 v[76:79], v133 offset0:0 offset1:2
	ds_read2st64_b64 v[80:83], v133 offset0:1 offset1:3
	ds_read2st64_b64 v[84:87], v134 offset0:0 offset1:2
	ds_read2st64_b64 v[72:75], v134 offset0:1 offset1:3
	s_branch .akent_464
.aknx_463:
.aknorm_448:
	ds_read2st64_b64 v[72:75], v132 offset0:1 offset1:3
	ds_read2st64_b64 v[76:79], v133 offset0:0 offset1:2
	ds_read2st64_b64 v[80:83], v133 offset0:1 offset1:3
	ds_read2st64_b64 v[84:87], v134 offset0:0 offset1:2
	s_waitcnt lgkmcnt(3)
	v_mfma_f32_16x16x32_bf16 v[4:7], v[72:75], v[112:115], 0
	ds_read2st64_b64 v[72:75], v134 offset0:1 offset1:3
.akent_464:
	s_waitcnt lgkmcnt(3)
	v_mfma_f32_16x16x32_bf16 v[8:11], v[76:79], v[112:115], 0
	ds_read2st64_b64 v[76:79], v135 offset0:0 offset1:2
	s_waitcnt lgkmcnt(3)
	v_mfma_f32_16x16x32_bf16 v[12:15], v[80:83], v[112:115], 0
	ds_read2st64_b64 v[80:83], v135 offset0:1 offset1:3
.akent_462:
	s_waitcnt lgkmcnt(3)
	v_mfma_f32_16x16x32_bf16 v[16:19], v[84:87], v[112:115], 0
	ds_read2st64_b64 v[84:87], v136 offset0:0 offset1:2
	s_waitcnt lgkmcnt(3)
	v_mfma_f32_16x16x32_bf16 v[20:23], v[72:75], v[112:115], 0
	ds_read2st64_b64 v[72:75], v136 offset0:1 offset1:3
.akent_460:
	s_waitcnt lgkmcnt(3)
	v_mfma_f32_16x16x32_bf16 v[24:27], v[76:79], v[112:115], 0
	ds_read2st64_b64 v[76:79], v137 offset0:0 offset1:2
	s_waitcnt lgkmcnt(3)
	v_mfma_f32_16x16x32_bf16 v[28:31], v[80:83], v[112:115], 0
	ds_read2st64_b64 v[80:83], v137 offset0:1 offset1:3
.akent_458:
	s_waitcnt lgkmcnt(3)
	v_mfma_f32_16x16x32_bf16 v[32:35], v[84:87], v[112:115], 0
	ds_read2st64_b64 v[84:87], v138 offset0:0 offset1:2
	s_waitcnt lgkmcnt(3)
	v_mfma_f32_16x16x32_bf16 v[36:39], v[72:75], v[112:115], 0
	ds_read2st64_b64 v[72:75], v138 offset0:1 offset1:3
.akent_456:
	s_waitcnt lgkmcnt(3)
	v_mfma_f32_16x16x32_bf16 v[40:43], v[76:79], v[112:115], 0
	ds_read2st64_b64 v[76:79], v139 offset0:0 offset1:2
	s_waitcnt lgkmcnt(3)
	v_mfma_f32_16x16x32_bf16 v[44:47], v[80:83], v[112:115], 0
	ds_read2st64_b64 v[80:83], v139 offset0:1 offset1:3
.akent_454:
	s_waitcnt lgkmcnt(3)
	v_mfma_f32_16x16x32_bf16 v[48:51], v[84:87], v[112:115], 0
	ds_read2st64_b64 v[84:87], v140 offset0:0 offset1:2
	s_waitcnt lgkmcnt(3)
	v_mfma_f32_16x16x32_bf16 v[52:55], v[72:75], v[112:115], 0
	ds_read2st64_b64 v[72:75], v140 offset0:1 offset1:3
.akent_452:
	s_waitcnt lgkmcnt(3)
	v_mfma_f32_16x16x32_bf16 v[56:59], v[76:79], v[112:115], 0
	s_waitcnt lgkmcnt(2)
	v_mfma_f32_16x16x32_bf16 v[60:63], v[80:83], v[112:115], 0
.akent_450:
	s_waitcnt lgkmcnt(1)
	v_mfma_f32_16x16x32_bf16 v[64:67], v[84:87], v[112:115], 0
	s_waitcnt lgkmcnt(0)
	v_mfma_f32_16x16x32_bf16 v[68:71], v[72:75], v[112:115], 0
	s_cmp_ge_u32 s28, 8
	s_cbranch_scc1 .avnorm_465
	v_mov_b32 v116, 0
	v_mov_b32 v117, 0
	v_mov_b32 v118, 0
	v_mov_b32 v119, 0
	v_mov_b32 v120, 0
	v_mov_b32 v121, 0
	v_mov_b32 v122, 0
	v_mov_b32 v123, 0
	v_mov_b32 v124, 0
	v_mov_b32 v125, 0
	v_mov_b32 v126, 0
	v_mov_b32 v127, 0
	s_cmp_lg_u32 s28, 0
	s_cbranch_scc1 .avnx_467
	ds_read_b128 v[104:107], v149 offset:2048
	ds_read_b128 v[108:111], v149 offset:3072
	s_branch .avjoin_466
.avnx_467:
	s_cmp_lg_u32 s28, 1
	s_cbranch_scc1 .avnx_468
	ds_read_b128 v[96:99], v148 offset:2048
	ds_read_b128 v[100:103], v148 offset:3072
	ds_read_b128 v[104:107], v149 offset:2048
	ds_read_b128 v[108:111], v149 offset:3072
	s_branch .avjoin_466
.avnx_468:
	s_cmp_lg_u32 s28, 2
	s_cbranch_scc1 .avnx_469
	ds_read_b128 v[88:91], v147 offset:2048
	ds_read_b128 v[92:95], v147 offset:3072
	ds_read_b128 v[96:99], v148 offset:2048
	ds_read_b128 v[100:103], v148 offset:3072
	ds_read_b128 v[104:107], v149 offset:2048
	ds_read_b128 v[108:111], v149 offset:3072
	s_branch .avjoin_466
.avnx_469:
	s_cmp_lg_u32 s28, 3
	s_cbranch_scc1 .avnx_470
	ds_read_b128 v[104:107], v146 offset:2048
	ds_read_b128 v[108:111], v146 offset:3072
	ds_read_b128 v[88:91], v147 offset:2048
	ds_read_b128 v[92:95], v147 offset:3072
	ds_read_b128 v[96:99], v148 offset:2048
	ds_read_b128 v[100:103], v148 offset:3072
	s_branch .avjoin_466
.avnx_470:
	s_cmp_lg_u32 s28, 4
	s_cbranch_scc1 .avnx_471
	ds_read_b128 v[96:99], v145 offset:2048
	ds_read_b128 v[100:103], v145 offset:3072
	ds_read_b128 v[104:107], v146 offset:2048
	ds_read_b128 v[108:111], v146 offset:3072
	ds_read_b128 v[88:91], v147 offset:2048
	ds_read_b128 v[92:95], v147 offset:3072
	s_branch .avjoin_466
.avnx_471:
	s_cmp_lg_u32 s28, 5
	s_cbranch_scc1 .avnx_472
	ds_read_b128 v[88:91], v144 offset:2048
	ds_read_b128 v[92:95], v144 offset:3072
	ds_read_b128 v[96:99], v145 offset:2048
	ds_read_b128 v[100:103], v145 offset:3072
	ds_read_b128 v[104:107], v146 offset:2048
	ds_read_b128 v[108:111], v146 offset:3072
	s_branch .avjoin_466
.avnx_472:
	s_cmp_lg_u32 s28, 6
	s_cbranch_scc1 .avnx_473
	ds_read_b128 v[104:107], v143 offset:2048
	ds_read_b128 v[108:111], v143 offset:3072
	ds_read_b128 v[88:91], v144 offset:2048
	ds_read_b128 v[92:95], v144 offset:3072
	ds_read_b128 v[96:99], v145 offset:2048
	ds_read_b128 v[100:103], v145 offset:3072
	s_branch .avjoin_466
.avnx_473:
	ds_read_b128 v[96:99], v142 offset:2048
	ds_read_b128 v[100:103], v142 offset:3072
	ds_read_b128 v[104:107], v143 offset:2048
	ds_read_b128 v[108:111], v143 offset:3072
	ds_read_b128 v[88:91], v144 offset:2048
	ds_read_b128 v[92:95], v144 offset:3072
	s_branch .avjoin_466
.avnx_474:
.avnorm_465:
	ds_read_b128 v[88:91], v141 offset:2048
	ds_read_b128 v[92:95], v141 offset:3072
	ds_read_b128 v[96:99], v142 offset:2048
	ds_read_b128 v[100:103], v142 offset:3072
	ds_read_b128 v[104:107], v143 offset:2048
	ds_read_b128 v[108:111], v143 offset:3072
.avjoin_466:
	v_cndmask_b32 v4, v158, v4, s[46:47]
	v_cndmask_b32 v5, v158, v5, s[48:49]
	v_cndmask_b32 v6, v158, v6, s[50:51]
	v_cndmask_b32 v7, v158, v7, s[52:53]
	v_cndmask_b32 v68, v68, v158, s[46:47]
	v_cndmask_b32 v69, v69, v158, s[48:49]
	v_cndmask_b32 v70, v70, v158, s[50:51]
	v_cndmask_b32 v71, v71, v158, s[52:53]
	s_cmp_ge_u32 s28, 8
	s_cbranch_scc1 .aval_475
	s_cmp_ge_u32 s28, 8
	s_cbranch_scc1 .aval_475
	v_mov_b32 v4, v158
	v_mov_b32 v5, v158
	v_mov_b32 v6, v158
	v_mov_b32 v7, v158
	s_cmp_ge_u32 s28, 7
	s_cbranch_scc1 .aval_475
	v_mov_b32 v8, v158
	v_mov_b32 v9, v158
	v_mov_b32 v10, v158
	v_mov_b32 v11, v158
	v_mov_b32 v12, v158
	v_mov_b32 v13, v158
	v_mov_b32 v14, v158
	v_mov_b32 v15, v158
	s_cmp_ge_u32 s28, 6
	s_cbranch_scc1 .aval_475
	v_mov_b32 v16, v158
	v_mov_b32 v17, v158
	v_mov_b32 v18, v158
	v_mov_b32 v19, v158
	v_mov_b32 v20, v158
	v_mov_b32 v21, v158
	v_mov_b32 v22, v158
	v_mov_b32 v23, v158
	s_cmp_ge_u32 s28, 5
	s_cbranch_scc1 .aval_475
	v_mov_b32 v24, v158
	v_mov_b32 v25, v158
	v_mov_b32 v26, v158
	v_mov_b32 v27, v158
	v_mov_b32 v28, v158
	v_mov_b32 v29, v158
	v_mov_b32 v30, v158
	v_mov_b32 v31, v158
	s_cmp_ge_u32 s28, 4
	s_cbranch_scc1 .aval_475
	v_mov_b32 v32, v158
	v_mov_b32 v33, v158
	v_mov_b32 v34, v158
	v_mov_b32 v35, v158
	v_mov_b32 v36, v158
	v_mov_b32 v37, v158
	v_mov_b32 v38, v158
	v_mov_b32 v39, v158
	s_cmp_ge_u32 s28, 3
	s_cbranch_scc1 .aval_475
	v_mov_b32 v40, v158
	v_mov_b32 v41, v158
	v_mov_b32 v42, v158
	v_mov_b32 v43, v158
	v_mov_b32 v44, v158
	v_mov_b32 v45, v158
	v_mov_b32 v46, v158
	v_mov_b32 v47, v158
	s_cmp_ge_u32 s28, 2
	s_cbranch_scc1 .aval_475
	v_mov_b32 v48, v158
	v_mov_b32 v49, v158
	v_mov_b32 v50, v158
	v_mov_b32 v51, v158
	v_mov_b32 v52, v158
	v_mov_b32 v53, v158
	v_mov_b32 v54, v158
	v_mov_b32 v55, v158
	s_cmp_ge_u32 s28, 1
	s_cbranch_scc1 .aval_475
	v_mov_b32 v56, v158
	v_mov_b32 v57, v158
	v_mov_b32 v58, v158
	v_mov_b32 v59, v158
	v_mov_b32 v60, v158
	v_mov_b32 v61, v158
	v_mov_b32 v62, v158
	v_mov_b32 v63, v158
.aval_475:
	s_nop 7
	v_max3_f32 v168, v4, v5, v6
	v_max3_f32 v169, v7, v8, v9
	v_max3_f32 v168, v168, v10, v11
	v_max3_f32 v169, v169, v12, v13
	v_max3_f32 v168, v168, v14, v15
	v_max3_f32 v169, v169, v16, v17
	v_max3_f32 v168, v168, v18, v19
	v_max3_f32 v169, v169, v20, v21
	v_max3_f32 v168, v168, v22, v23
	v_max3_f32 v169, v169, v24, v25
	v_max3_f32 v168, v168, v26, v27
	v_max3_f32 v169, v169, v28, v29
	v_max3_f32 v168, v168, v30, v31
	v_max3_f32 v169, v169, v32, v33
	v_max3_f32 v168, v168, v34, v35
	v_max3_f32 v169, v169, v36, v37
	v_max3_f32 v168, v168, v38, v39
	v_max3_f32 v169, v169, v40, v41
	v_max3_f32 v168, v168, v42, v43
	v_max3_f32 v169, v169, v44, v45
	v_max3_f32 v168, v168, v46, v47
	v_max3_f32 v169, v169, v48, v49
	v_max3_f32 v168, v168, v50, v51
	v_max3_f32 v169, v169, v52, v53
	v_max3_f32 v168, v168, v54, v55
	v_max3_f32 v169, v169, v56, v57
	v_max3_f32 v168, v168, v58, v59
	v_max3_f32 v169, v169, v60, v61
	v_max3_f32 v168, v168, v62, v63
	v_max3_f32 v169, v169, v64, v65
	v_max3_f32 v168, v168, v66, v67
	v_max3_f32 v169, v169, v68, v69
	v_max3_f32 v168, v168, v70, v71
	v_max_f32 v168, v168, v169
	v_mov_b32 v170, v168
	s_nop 1
	v_permlane16_swap_b32 v168, v170
	v_max_f32 v168, v168, v170
	v_mov_b32 v170, v168
	s_nop 1
	v_permlane32_swap_b32 v168, v170
	v_max_f32 v168, v168, v170
	v_mul_f32 v166, 0xbeae1a93, v168
	v_mov_b32 v167, v166
	s_cmp_ge_u32 s28, 8
	s_cbranch_scc1 .amnorm_476
	s_cmp_eq_u32 s28, 0
	s_cbranch_scc1 .ament_477
	s_cmp_eq_u32 s28, 1
	s_cbranch_scc1 .ament_478
	s_cmp_eq_u32 s28, 2
	s_cbranch_scc1 .ament_479
	s_cmp_eq_u32 s28, 3
	s_cbranch_scc1 .ament_480
	s_cmp_eq_u32 s28, 4
	s_cbranch_scc1 .ament_481
	s_cmp_eq_u32 s28, 5
	s_cbranch_scc1 .ament_482
	s_cmp_eq_u32 s28, 6
	s_cbranch_scc1 .ament_483
	s_branch .ament_484
.amnorm_476:
	v_pk_fma_f32 v[4:5], v[4:5], v[164:165], v[166:167]
	v_pk_fma_f32 v[6:7], v[6:7], v[164:165], v[166:167]
	v_exp_f32 v4, v4
	v_exp_f32 v5, v5
	v_exp_f32 v6, v6
	v_exp_f32 v7, v7
	v_mov_b32 v0, 0
	v_mov_b32 v1, 0
	v_cvt_pk_bf16_f32 v2, v4, v5
	v_cvt_pk_bf16_f32 v3, v6, v7
	s_waitcnt lgkmcnt(4)
	s_nop 0
	v_mfma_f32_16x16x32_bf16 v[116:119], v[88:91], v[0:3], 0
	v_mfma_f32_16x16x32_bf16 v[120:123], v[92:95], v[0:3], 0
	v_mfma_f32_16x16x32_bf16 v[124:127], v[128:131], v[0:3], 0
	ds_read_b128 v[88:91], v144 offset:2048
	ds_read_b128 v[92:95], v144 offset:3072
.ament_484:
	v_pk_fma_f32 v[8:9], v[8:9], v[164:165], v[166:167]
	v_pk_fma_f32 v[10:11], v[10:11], v[164:165], v[166:167]
	v_pk_fma_f32 v[12:13], v[12:13], v[164:165], v[166:167]
	v_pk_fma_f32 v[14:15], v[14:15], v[164:165], v[166:167]
	v_exp_f32 v8, v8
	v_exp_f32 v9, v9
	v_exp_f32 v10, v10
	v_exp_f32 v11, v11
	v_exp_f32 v12, v12
	v_exp_f32 v13, v13
	v_exp_f32 v14, v14
	v_exp_f32 v15, v15
	v_cvt_pk_bf16_f32 v8, v8, v9
	v_cvt_pk_bf16_f32 v9, v10, v11
	v_cvt_pk_bf16_f32 v10, v12, v13
	v_cvt_pk_bf16_f32 v11, v14, v15
	s_waitcnt lgkmcnt(4)
	s_nop 0
	v_mfma_f32_16x16x32_bf16 v[116:119], v[96:99], v[8:11], v[116:119]
	v_mfma_f32_16x16x32_bf16 v[120:123], v[100:103], v[8:11], v[120:123]
	v_mfma_f32_16x16x32_bf16 v[124:127], v[128:131], v[8:11], v[124:127]
	ds_read_b128 v[96:99], v145 offset:2048
	ds_read_b128 v[100:103], v145 offset:3072
.ament_483:
	v_pk_fma_f32 v[16:17], v[16:17], v[164:165], v[166:167]
	v_pk_fma_f32 v[18:19], v[18:19], v[164:165], v[166:167]
	v_pk_fma_f32 v[20:21], v[20:21], v[164:165], v[166:167]
	v_pk_fma_f32 v[22:23], v[22:23], v[164:165], v[166:167]
	v_exp_f32 v16, v16
	v_exp_f32 v17, v17
	v_exp_f32 v18, v18
	v_exp_f32 v19, v19
	v_exp_f32 v20, v20
	v_exp_f32 v21, v21
	v_exp_f32 v22, v22
	v_exp_f32 v23, v23
	v_cvt_pk_bf16_f32 v16, v16, v17
	v_cvt_pk_bf16_f32 v17, v18, v19
	v_cvt_pk_bf16_f32 v18, v20, v21
	v_cvt_pk_bf16_f32 v19, v22, v23
	s_waitcnt lgkmcnt(4)
	s_nop 0
	v_mfma_f32_16x16x32_bf16 v[116:119], v[104:107], v[16:19], v[116:119]
	v_mfma_f32_16x16x32_bf16 v[120:123], v[108:111], v[16:19], v[120:123]
	v_mfma_f32_16x16x32_bf16 v[124:127], v[128:131], v[16:19], v[124:127]
	ds_read_b128 v[104:107], v146 offset:2048
	ds_read_b128 v[108:111], v146 offset:3072
.ament_482:
	v_pk_fma_f32 v[24:25], v[24:25], v[164:165], v[166:167]
	v_pk_fma_f32 v[26:27], v[26:27], v[164:165], v[166:167]
	v_pk_fma_f32 v[28:29], v[28:29], v[164:165], v[166:167]
	v_pk_fma_f32 v[30:31], v[30:31], v[164:165], v[166:167]
	v_exp_f32 v24, v24
	v_exp_f32 v25, v25
	v_exp_f32 v26, v26
	v_exp_f32 v27, v27
	v_exp_f32 v28, v28
	v_exp_f32 v29, v29
	v_exp_f32 v30, v30
	v_exp_f32 v31, v31
	v_cvt_pk_bf16_f32 v24, v24, v25
	v_cvt_pk_bf16_f32 v25, v26, v27
	v_cvt_pk_bf16_f32 v26, v28, v29
	v_cvt_pk_bf16_f32 v27, v30, v31
	s_waitcnt lgkmcnt(4)
	s_nop 0
	v_mfma_f32_16x16x32_bf16 v[116:119], v[88:91], v[24:27], v[116:119]
	v_mfma_f32_16x16x32_bf16 v[120:123], v[92:95], v[24:27], v[120:123]
	v_mfma_f32_16x16x32_bf16 v[124:127], v[128:131], v[24:27], v[124:127]
	ds_read_b128 v[88:91], v147 offset:2048
	ds_read_b128 v[92:95], v147 offset:3072
.ament_481:
	v_pk_fma_f32 v[32:33], v[32:33], v[164:165], v[166:167]
	v_pk_fma_f32 v[34:35], v[34:35], v[164:165], v[166:167]
	v_pk_fma_f32 v[36:37], v[36:37], v[164:165], v[166:167]
	v_pk_fma_f32 v[38:39], v[38:39], v[164:165], v[166:167]
	v_exp_f32 v32, v32
	v_exp_f32 v33, v33
	v_exp_f32 v34, v34
	v_exp_f32 v35, v35
	v_exp_f32 v36, v36
	v_exp_f32 v37, v37
	v_exp_f32 v38, v38
	v_exp_f32 v39, v39
	v_cvt_pk_bf16_f32 v32, v32, v33
	v_cvt_pk_bf16_f32 v33, v34, v35
	v_cvt_pk_bf16_f32 v34, v36, v37
	v_cvt_pk_bf16_f32 v35, v38, v39
	s_waitcnt lgkmcnt(4)
	s_nop 0
	v_mfma_f32_16x16x32_bf16 v[116:119], v[96:99], v[32:35], v[116:119]
	v_mfma_f32_16x16x32_bf16 v[120:123], v[100:103], v[32:35], v[120:123]
	v_mfma_f32_16x16x32_bf16 v[124:127], v[128:131], v[32:35], v[124:127]
	ds_read_b128 v[96:99], v148 offset:2048
	ds_read_b128 v[100:103], v148 offset:3072
.ament_480:
	v_pk_fma_f32 v[40:41], v[40:41], v[164:165], v[166:167]
	v_pk_fma_f32 v[42:43], v[42:43], v[164:165], v[166:167]
	v_pk_fma_f32 v[44:45], v[44:45], v[164:165], v[166:167]
	v_pk_fma_f32 v[46:47], v[46:47], v[164:165], v[166:167]
	v_exp_f32 v40, v40
	v_exp_f32 v41, v41
	v_exp_f32 v42, v42
	v_exp_f32 v43, v43
	v_exp_f32 v44, v44
	v_exp_f32 v45, v45
	v_exp_f32 v46, v46
	v_exp_f32 v47, v47
	v_cvt_pk_bf16_f32 v40, v40, v41
	v_cvt_pk_bf16_f32 v41, v42, v43
	v_cvt_pk_bf16_f32 v42, v44, v45
	v_cvt_pk_bf16_f32 v43, v46, v47
	s_waitcnt lgkmcnt(4)
	s_nop 0
	v_mfma_f32_16x16x32_bf16 v[116:119], v[104:107], v[40:43], v[116:119]
	v_mfma_f32_16x16x32_bf16 v[120:123], v[108:111], v[40:43], v[120:123]
	v_mfma_f32_16x16x32_bf16 v[124:127], v[128:131], v[40:43], v[124:127]
	ds_read_b128 v[104:107], v149 offset:2048
	ds_read_b128 v[108:111], v149 offset:3072
.ament_479:
	v_pk_fma_f32 v[48:49], v[48:49], v[164:165], v[166:167]
	v_pk_fma_f32 v[50:51], v[50:51], v[164:165], v[166:167]
	v_pk_fma_f32 v[52:53], v[52:53], v[164:165], v[166:167]
	v_pk_fma_f32 v[54:55], v[54:55], v[164:165], v[166:167]
	v_exp_f32 v48, v48
	v_exp_f32 v49, v49
	v_exp_f32 v50, v50
	v_exp_f32 v51, v51
	v_exp_f32 v52, v52
	v_exp_f32 v53, v53
	v_exp_f32 v54, v54
	v_exp_f32 v55, v55
	v_cvt_pk_bf16_f32 v48, v48, v49
	v_cvt_pk_bf16_f32 v49, v50, v51
	v_cvt_pk_bf16_f32 v50, v52, v53
	v_cvt_pk_bf16_f32 v51, v54, v55
	s_waitcnt lgkmcnt(4)
	s_nop 0
	v_mfma_f32_16x16x32_bf16 v[116:119], v[88:91], v[48:51], v[116:119]
	v_mfma_f32_16x16x32_bf16 v[120:123], v[92:95], v[48:51], v[120:123]
	v_mfma_f32_16x16x32_bf16 v[124:127], v[128:131], v[48:51], v[124:127]
.ament_478:
	v_pk_fma_f32 v[56:57], v[56:57], v[164:165], v[166:167]
	v_pk_fma_f32 v[58:59], v[58:59], v[164:165], v[166:167]
	v_pk_fma_f32 v[60:61], v[60:61], v[164:165], v[166:167]
	v_pk_fma_f32 v[62:63], v[62:63], v[164:165], v[166:167]
	v_exp_f32 v56, v56
	v_exp_f32 v57, v57
	v_exp_f32 v58, v58
	v_exp_f32 v59, v59
	v_exp_f32 v60, v60
	v_exp_f32 v61, v61
	v_exp_f32 v62, v62
	v_exp_f32 v63, v63
	v_cvt_pk_bf16_f32 v56, v56, v57
	v_cvt_pk_bf16_f32 v57, v58, v59
	v_cvt_pk_bf16_f32 v58, v60, v61
	v_cvt_pk_bf16_f32 v59, v62, v63
	s_waitcnt lgkmcnt(2)
	s_nop 0
	v_mfma_f32_16x16x32_bf16 v[116:119], v[96:99], v[56:59], v[116:119]
	v_mfma_f32_16x16x32_bf16 v[120:123], v[100:103], v[56:59], v[120:123]
	v_mfma_f32_16x16x32_bf16 v[124:127], v[128:131], v[56:59], v[124:127]
.ament_477:
	v_pk_fma_f32 v[64:65], v[64:65], v[164:165], v[166:167]
	v_pk_fma_f32 v[66:67], v[66:67], v[164:165], v[166:167]
	v_pk_fma_f32 v[68:69], v[68:69], v[164:165], v[166:167]
	v_pk_fma_f32 v[70:71], v[70:71], v[164:165], v[166:167]
	v_exp_f32 v64, v64
	v_exp_f32 v65, v65
	v_exp_f32 v66, v66
	v_exp_f32 v67, v67
	v_exp_f32 v68, v68
	v_exp_f32 v69, v69
	v_exp_f32 v70, v70
	v_exp_f32 v71, v71
	v_cvt_pk_bf16_f32 v64, v64, v65
	v_cvt_pk_bf16_f32 v65, v66, v67
	v_cvt_pk_bf16_f32 v66, v68, v69
	v_cvt_pk_bf16_f32 v67, v70, v71
	s_waitcnt lgkmcnt(0)
	s_nop 0
	v_mfma_f32_16x16x32_bf16 v[116:119], v[104:107], v[64:67], v[116:119]
	v_mfma_f32_16x16x32_bf16 v[120:123], v[108:111], v[64:67], v[120:123]
	v_mfma_f32_16x16x32_bf16 v[124:127], v[128:131], v[64:67], v[124:127]
	s_nop 7
	v_rcp_f32 v170, v124
	s_nop 0
	v_mul_f32 v116, v116, v170
	v_mul_f32 v120, v120, v170
	v_mul_f32 v117, v117, v170
	v_mul_f32 v121, v121, v170
	v_mul_f32 v118, v118, v170
	v_mul_f32 v122, v122, v170
	v_mul_f32 v119, v119, v170
	v_mul_f32 v123, v123, v170
	v_cvt_pk_bf16_f32 v116, v116, v117
	v_cvt_pk_bf16_f32 v117, v118, v119
	v_cvt_pk_bf16_f32 v120, v120, v121
	v_cvt_pk_bf16_f32 v121, v122, v123
	v_cndmask_b32 v120, v120, v121, s[56:57]
	s_sub_i32 s77, s28, 3
	s_max_i32 s77, s77, 0
	v_cmp_gt_u32 vcc, s77, v173
	s_cbranch_vccz .pck_485
	s_mov_b32 s20, 400000
.pre_486:
	buffer_load_dword v173, v172, s[4:7], 0 offen sc1
	s_waitcnt vmcnt(0)
	v_cmp_gt_u32 vcc, s77, v173
	s_cbranch_vccz .pok_487
	s_sub_u32 s20, s20, 1
	s_cmp_lg_u32 s20, 0
	s_cbranch_scc1 .pre_486
	s_branch L_FAIL
.pok_487:
.pck_485:
	s_add_u32 s17, s58, s78
	s_add_u32 s18, s59, s78
	buffer_store_dwordx2 v[116:117], v161, s[4:7], s17 offen
	s_mov_b64 exec, s[54:55]
	buffer_store_dword v120, v162, s[4:7], s18 offen
	s_mov_b64 exec, -1
	buffer_load_dword v155, v154, s[4:7], 0 offen sc1
	s_add_u32 s68, s68, 8192
	s_cmp_eq_u32 s68, 81920
	s_cselect_b32 s68, 0, s68
	s_add_u32 s69, s69, 8192
	s_cmp_eq_u32 s69, 81920
	s_cselect_b32 s69, 0, s69
	s_add_u32 s70, s70, 8192
	s_cmp_eq_u32 s70, 81920
	s_cselect_b32 s70, 0, s70
	s_add_u32 s71, s71, 8192
	s_cmp_eq_u32 s71, 81920
	s_cselect_b32 s71, 0, s71
	s_add_u32 s72, s72, 8192
	s_cmp_eq_u32 s72, 81920
	s_cselect_b32 s72, 0, s72
	s_add_u32 s73, s73, 8192
	s_cmp_eq_u32 s73, 81920
	s_cselect_b32 s73, 0, s73
	s_add_u32 s74, s74, 8192
	s_cmp_eq_u32 s74, 81920
	s_cselect_b32 s74, 0, s74
	s_add_u32 s75, s75, 8192
	s_cmp_eq_u32 s75, 81920
	s_cselect_b32 s75, 0, s75
	s_add_u32 s76, s76, 8192
	s_cmp_eq_u32 s76, 81920
	s_cselect_b32 s76, 0, s76
	s_add_u32 s28, s28, 1
	s_waitcnt vmcnt(0)
	v_mov_b32 v157, s28
	s_mov_b64 exec, 1
	buffer_store_dword v157, v156, s[4:7], s30 offen
	s_mov_b64 exec, -1
	s_cmp_ge_u32 s28, 64
	s_cbranch_scc1 L_END
	s_add_u32 s37, s28, 1
	v_cmp_gt_u32 vcc, s37, v155
	s_cbranch_vccz .pck_488
	s_mov_b32 s20, 400000
.pre_489:
	buffer_load_dword v155, v154, s[4:7], 0 offen sc1
	s_waitcnt vmcnt(0)
	v_cmp_gt_u32 vcc, s37, v155
	s_cbranch_vccz .pok_490
	s_sub_u32 s20, s20, 1
	s_cmp_lg_u32 s20, 0
	s_cbranch_scc1 .pre_489
	s_branch L_FAIL
.pok_490:
.pck_488:
	s_branch .aloop_445
L_ATTA_CE:
L_ATTA_DEV:
	s_barrier
	s_mov_b32 s68, 16384
	s_mov_b32 s69, 24576
	s_mov_b32 s70, 32768
	s_mov_b32 s71, 40960
	s_mov_b32 s72, 49152
	s_mov_b32 s73, 57344
	s_mov_b32 s74, 65536
	s_mov_b32 s75, 73728
	s_mov_b32 s76, 0
	s_mov_b32 s28, 0
	s_cmp_eq_u32 s39, 1
	s_cbranch_scc1 .aatt1_496
	s_add_u32 s37, s28, 1
	s_mov_b32 s20, 400000
.pre_498:
	buffer_load_dword v155, v154, s[4:7], 0 offen sc1
	s_waitcnt vmcnt(0)
	v_cmp_gt_u32 vcc, s37, v155
	s_cbranch_vccz .pok_499
	s_sub_u32 s20, s20, 1
	s_cmp_lg_u32 s20, 0
	s_cbranch_scc1 .pre_498
	s_branch L_FAIL
.pok_499:
.aloop_497:
	s_and_b32 s77, s28, 3
	s_mul_i32 s77, s77, 110592
	s_and_b32 s78, s28, 3
	s_mul_i32 s78, s78, 36864
	s_add_u32 s17, s66, s76
	s_mov_b32 m0, s17
	s_add_u32 s18, s60, s77
	buffer_load_dwordx4 v153, s[4:7], s18 offen sc1 lds
	s_add_u32 s17, s17, 1024
	s_mov_b32 m0, s17
	s_add_u32 s18, s61, s77
	buffer_load_dwordx4 v153, s[4:7], s18 offen sc1 lds
	s_add_u32 s18, s64, s77
	buffer_load_dwordx2 v[112:113], v152, s[4:7], s18 offen sc1
	s_add_u32 s18, s65, s77
	buffer_load_dwordx2 v[114:115], v152, s[4:7], s18 offen sc1
	buffer_load_dword v173, v172, s[4:7], 0 offen sc1
	v_add_u32 v132, s68, v150
	v_add_u32 v141, s68, v151
	v_add_u32 v133, s69, v150
	v_add_u32 v142, s69, v151
	v_add_u32 v134, s70, v150
	v_add_u32 v143, s70, v151
	v_add_u32 v135, s71, v150
	v_add_u32 v144, s71, v151
	v_add_u32 v136, s72, v150
	v_add_u32 v145, s72, v151
	v_add_u32 v137, s73, v150
	v_add_u32 v146, s73, v151
	v_add_u32 v138, s74, v150
	v_add_u32 v147, s74, v151
	v_add_u32 v139, s75, v150
	v_add_u32 v148, s75, v151
	v_add_u32 v140, s76, v150
	v_add_u32 v149, s76, v151
	s_waitcnt vmcnt(0)
	v_and_b32 v114, v159, v114
	v_and_b32 v115, v160, v115
	s_barrier
	s_cmp_ge_u32 s28, 8
	s_cbranch_scc1 .aknorm_500
	s_cmp_lg_u32 s28, 0
	s_cbranch_scc1 .aknx_501
	ds_read2st64_b64 v[72:75], v140 offset0:0 offset1:2
	s_branch .akent_502
.aknx_501:
	s_cmp_lg_u32 s28, 1
	s_cbranch_scc1 .aknx_503
	ds_read2st64_b64 v[80:83], v139 offset0:0 offset1:2
	ds_read2st64_b64 v[84:87], v139 offset0:1 offset1:3
	ds_read2st64_b64 v[72:75], v140 offset0:0 offset1:2
	s_branch .akent_504
.aknx_503:
	s_cmp_lg_u32 s28, 2
	s_cbranch_scc1 .aknx_505
	ds_read2st64_b64 v[72:75], v138 offset0:0 offset1:2
	ds_read2st64_b64 v[76:79], v138 offset0:1 offset1:3
	ds_read2st64_b64 v[80:83], v139 offset0:0 offset1:2
	ds_read2st64_b64 v[84:87], v139 offset0:1 offset1:3
	s_branch .akent_506
.aknx_505:
	s_cmp_lg_u32 s28, 3
	s_cbranch_scc1 .aknx_507
	ds_read2st64_b64 v[80:83], v137 offset0:0 offset1:2
	ds_read2st64_b64 v[84:87], v137 offset0:1 offset1:3
	ds_read2st64_b64 v[72:75], v138 offset0:0 offset1:2
	ds_read2st64_b64 v[76:79], v138 offset0:1 offset1:3
	s_branch .akent_508
.aknx_507:
	s_cmp_lg_u32 s28, 4
	s_cbranch_scc1 .aknx_509
	ds_read2st64_b64 v[72:75], v136 offset0:0 offset1:2
	ds_read2st64_b64 v[76:79], v136 offset0:1 offset1:3
	ds_read2st64_b64 v[80:83], v137 offset0:0 offset1:2
	ds_read2st64_b64 v[84:87], v137 offset0:1 offset1:3
	s_branch .akent_510
.aknx_509:
	s_cmp_lg_u32 s28, 5
	s_cbranch_scc1 .aknx_511
	ds_read2st64_b64 v[80:83], v135 offset0:0 offset1:2
	ds_read2st64_b64 v[84:87], v135 offset0:1 offset1:3
	ds_read2st64_b64 v[72:75], v136 offset0:0 offset1:2
	ds_read2st64_b64 v[76:79], v136 offset0:1 offset1:3
	s_branch .akent_512
.aknx_511:
	s_cmp_lg_u32 s28, 6
	s_cbranch_scc1 .aknx_513
	ds_read2st64_b64 v[72:75], v134 offset0:0 offset1:2
	ds_read2st64_b64 v[76:79], v134 offset0:1 offset1:3
	ds_read2st64_b64 v[80:83], v135 offset0:0 offset1:2
	ds_read2st64_b64 v[84:87], v135 offset0:1 offset1:3
	s_branch .akent_514
.aknx_513:
	ds_read2st64_b64 v[80:83], v133 offset0:0 offset1:2
	ds_read2st64_b64 v[84:87], v133 offset0:1 offset1:3
	ds_read2st64_b64 v[72:75], v134 offset0:0 offset1:2
	ds_read2st64_b64 v[76:79], v134 offset0:1 offset1:3
	s_branch .akent_516
.aknx_515:
.aknorm_500:
	ds_read2st64_b64 v[72:75], v132 offset0:0 offset1:2
	ds_read2st64_b64 v[76:79], v132 offset0:1 offset1:3
	ds_read2st64_b64 v[80:83], v133 offset0:0 offset1:2
	ds_read2st64_b64 v[84:87], v133 offset0:1 offset1:3
	s_waitcnt lgkmcnt(3)
	v_mfma_f32_16x16x32_bf16 v[0:3], v[72:75], v[112:115], 0
	ds_read2st64_b64 v[72:75], v134 offset0:0 offset1:2
	s_waitcnt lgkmcnt(3)
	v_mfma_f32_16x16x32_bf16 v[4:7], v[76:79], v[112:115], 0
	ds_read2st64_b64 v[76:79], v134 offset0:1 offset1:3
.akent_516:
	s_waitcnt lgkmcnt(3)
	v_mfma_f32_16x16x32_bf16 v[8:11], v[80:83], v[112:115], 0
	ds_read2st64_b64 v[80:83], v135 offset0:0 offset1:2
	s_waitcnt lgkmcnt(3)
	v_mfma_f32_16x16x32_bf16 v[12:15], v[84:87], v[112:115], 0
	ds_read2st64_b64 v[84:87], v135 offset0:1 offset1:3
.akent_514:
	s_waitcnt lgkmcnt(3)
	v_mfma_f32_16x16x32_bf16 v[16:19], v[72:75], v[112:115], 0
	ds_read2st64_b64 v[72:75], v136 offset0:0 offset1:2
	s_waitcnt lgkmcnt(3)
	v_mfma_f32_16x16x32_bf16 v[20:23], v[76:79], v[112:115], 0
	ds_read2st64_b64 v[76:79], v136 offset0:1 offset1:3
.akent_512:
	s_waitcnt lgkmcnt(3)
	v_mfma_f32_16x16x32_bf16 v[24:27], v[80:83], v[112:115], 0
	ds_read2st64_b64 v[80:83], v137 offset0:0 offset1:2
	s_waitcnt lgkmcnt(3)
	v_mfma_f32_16x16x32_bf16 v[28:31], v[84:87], v[112:115], 0
	ds_read2st64_b64 v[84:87], v137 offset0:1 offset1:3
.akent_510:
	s_waitcnt lgkmcnt(3)
	v_mfma_f32_16x16x32_bf16 v[32:35], v[72:75], v[112:115], 0
	ds_read2st64_b64 v[72:75], v138 offset0:0 offset1:2
	s_waitcnt lgkmcnt(3)
	v_mfma_f32_16x16x32_bf16 v[36:39], v[76:79], v[112:115], 0
	ds_read2st64_b64 v[76:79], v138 offset0:1 offset1:3
.akent_508:
	s_waitcnt lgkmcnt(3)
	v_mfma_f32_16x16x32_bf16 v[40:43], v[80:83], v[112:115], 0
	ds_read2st64_b64 v[80:83], v139 offset0:0 offset1:2
	s_waitcnt lgkmcnt(3)
	v_mfma_f32_16x16x32_bf16 v[44:47], v[84:87], v[112:115], 0
	ds_read2st64_b64 v[84:87], v139 offset0:1 offset1:3
.akent_506:
	s_waitcnt lgkmcnt(3)
	v_mfma_f32_16x16x32_bf16 v[48:51], v[72:75], v[112:115], 0
	ds_read2st64_b64 v[72:75], v140 offset0:0 offset1:2
	s_waitcnt lgkmcnt(3)
	v_mfma_f32_16x16x32_bf16 v[52:55], v[76:79], v[112:115], 0
.akent_504:
	s_waitcnt lgkmcnt(2)
	v_mfma_f32_16x16x32_bf16 v[56:59], v[80:83], v[112:115], 0
	s_waitcnt lgkmcnt(1)
	v_mfma_f32_16x16x32_bf16 v[60:63], v[84:87], v[112:115], 0
.akent_502:
	s_waitcnt lgkmcnt(0)
	v_mfma_f32_16x16x32_bf16 v[64:67], v[72:75], v[112:115], 0
	s_cmp_ge_u32 s28, 8
	s_cbranch_scc1 .avnorm_517
	v_mov_b32 v116, 0
	v_mov_b32 v117, 0
	v_mov_b32 v118, 0
	v_mov_b32 v119, 0
	v_mov_b32 v120, 0
	v_mov_b32 v121, 0
	v_mov_b32 v122, 0
	v_mov_b32 v123, 0
	v_mov_b32 v124, 0
	v_mov_b32 v125, 0
	v_mov_b32 v126, 0
	v_mov_b32 v127, 0
	s_cmp_lg_u32 s28, 0
	s_cbranch_scc1 .avnx_519
	ds_read_b128 v[104:107], v149 offset:2048
	ds_read_b128 v[108:111], v149 offset:3072
	s_branch .avjoin_518
.avnx_519:
	s_cmp_lg_u32 s28, 1
	s_cbranch_scc1 .avnx_520
	ds_read_b128 v[96:99], v148 offset:2048
	ds_read_b128 v[100:103], v148 offset:3072
	ds_read_b128 v[104:107], v149 offset:2048
	ds_read_b128 v[108:111], v149 offset:3072
	s_branch .avjoin_518
.avnx_520:
	s_cmp_lg_u32 s28, 2
	s_cbranch_scc1 .avnx_521
	ds_read_b128 v[88:91], v147 offset:2048
	ds_read_b128 v[92:95], v147 offset:3072
	ds_read_b128 v[96:99], v148 offset:2048
	ds_read_b128 v[100:103], v148 offset:3072
	ds_read_b128 v[104:107], v149 offset:2048
	ds_read_b128 v[108:111], v149 offset:3072
	s_branch .avjoin_518
.avnx_521:
	s_cmp_lg_u32 s28, 3
	s_cbranch_scc1 .avnx_522
	ds_read_b128 v[104:107], v146 offset:2048
	ds_read_b128 v[108:111], v146 offset:3072
	ds_read_b128 v[88:91], v147 offset:2048
	ds_read_b128 v[92:95], v147 offset:3072
	ds_read_b128 v[96:99], v148 offset:2048
	ds_read_b128 v[100:103], v148 offset:3072
	s_branch .avjoin_518
.avnx_522:
	s_cmp_lg_u32 s28, 4
	s_cbranch_scc1 .avnx_523
	ds_read_b128 v[96:99], v145 offset:2048
	ds_read_b128 v[100:103], v145 offset:3072
	ds_read_b128 v[104:107], v146 offset:2048
	ds_read_b128 v[108:111], v146 offset:3072
	ds_read_b128 v[88:91], v147 offset:2048
	ds_read_b128 v[92:95], v147 offset:3072
	s_branch .avjoin_518
.avnx_523:
	s_cmp_lg_u32 s28, 5
	s_cbranch_scc1 .avnx_524
	ds_read_b128 v[88:91], v144 offset:2048
	ds_read_b128 v[92:95], v144 offset:3072
	ds_read_b128 v[96:99], v145 offset:2048
	ds_read_b128 v[100:103], v145 offset:3072
	ds_read_b128 v[104:107], v146 offset:2048
	ds_read_b128 v[108:111], v146 offset:3072
	s_branch .avjoin_518
.avnx_524:
	s_cmp_lg_u32 s28, 6
	s_cbranch_scc1 .avnx_525
	ds_read_b128 v[104:107], v143 offset:2048
	ds_read_b128 v[108:111], v143 offset:3072
	ds_read_b128 v[88:91], v144 offset:2048
	ds_read_b128 v[92:95], v144 offset:3072
	ds_read_b128 v[96:99], v145 offset:2048
	ds_read_b128 v[100:103], v145 offset:3072
	s_branch .avjoin_518
.avnx_525:
	ds_read_b128 v[96:99], v142 offset:2048
	ds_read_b128 v[100:103], v142 offset:3072
	ds_read_b128 v[104:107], v143 offset:2048
	ds_read_b128 v[108:111], v143 offset:3072
	ds_read_b128 v[88:91], v144 offset:2048
	ds_read_b128 v[92:95], v144 offset:3072
	s_branch .avjoin_518
.avnx_526:
.avnorm_517:
	ds_read_b128 v[88:91], v141 offset:2048
	ds_read_b128 v[92:95], v141 offset:3072
	ds_read_b128 v[96:99], v142 offset:2048
	ds_read_b128 v[100:103], v142 offset:3072
	ds_read_b128 v[104:107], v143 offset:2048
	ds_read_b128 v[108:111], v143 offset:3072
.avjoin_518:
	v_cndmask_b32 v0, v158, v0, s[46:47]
	v_cndmask_b32 v1, v158, v1, s[48:49]
	v_cndmask_b32 v2, v158, v2, s[50:51]
	v_cndmask_b32 v3, v158, v3, s[52:53]
	v_cndmask_b32 v64, v64, v158, s[46:47]
	v_cndmask_b32 v65, v65, v158, s[48:49]
	v_cndmask_b32 v66, v66, v158, s[50:51]
	v_cndmask_b32 v67, v67, v158, s[52:53]
	s_cmp_ge_u32 s28, 8
	s_cbranch_scc1 .aval_527
	s_cmp_ge_u32 s28, 8
	s_cbranch_scc1 .aval_527
	v_mov_b32 v0, v158
	v_mov_b32 v1, v158
	v_mov_b32 v2, v158
	v_mov_b32 v3, v158
	v_mov_b32 v4, v158
	v_mov_b32 v5, v158
	v_mov_b32 v6, v158
	v_mov_b32 v7, v158
	s_cmp_ge_u32 s28, 7
	s_cbranch_scc1 .aval_527
	v_mov_b32 v8, v158
	v_mov_b32 v9, v158
	v_mov_b32 v10, v158
	v_mov_b32 v11, v158
	v_mov_b32 v12, v158
	v_mov_b32 v13, v158
	v_mov_b32 v14, v158
	v_mov_b32 v15, v158
	s_cmp_ge_u32 s28, 6
	s_cbranch_scc1 .aval_527
	v_mov_b32 v16, v158
	v_mov_b32 v17, v158
	v_mov_b32 v18, v158
	v_mov_b32 v19, v158
	v_mov_b32 v20, v158
	v_mov_b32 v21, v158
	v_mov_b32 v22, v158
	v_mov_b32 v23, v158
	s_cmp_ge_u32 s28, 5
	s_cbranch_scc1 .aval_527
	v_mov_b32 v24, v158
	v_mov_b32 v25, v158
	v_mov_b32 v26, v158
	v_mov_b32 v27, v158
	v_mov_b32 v28, v158
	v_mov_b32 v29, v158
	v_mov_b32 v30, v158
	v_mov_b32 v31, v158
	s_cmp_ge_u32 s28, 4
	s_cbranch_scc1 .aval_527
	v_mov_b32 v32, v158
	v_mov_b32 v33, v158
	v_mov_b32 v34, v158
	v_mov_b32 v35, v158
	v_mov_b32 v36, v158
	v_mov_b32 v37, v158
	v_mov_b32 v38, v158
	v_mov_b32 v39, v158
	s_cmp_ge_u32 s28, 3
	s_cbranch_scc1 .aval_527
	v_mov_b32 v40, v158
	v_mov_b32 v41, v158
	v_mov_b32 v42, v158
	v_mov_b32 v43, v158
	v_mov_b32 v44, v158
	v_mov_b32 v45, v158
	v_mov_b32 v46, v158
	v_mov_b32 v47, v158
	s_cmp_ge_u32 s28, 2
	s_cbranch_scc1 .aval_527
	v_mov_b32 v48, v158
	v_mov_b32 v49, v158
	v_mov_b32 v50, v158
	v_mov_b32 v51, v158
	v_mov_b32 v52, v158
	v_mov_b32 v53, v158
	v_mov_b32 v54, v158
	v_mov_b32 v55, v158
	s_cmp_ge_u32 s28, 1
	s_cbranch_scc1 .aval_527
	v_mov_b32 v56, v158
	v_mov_b32 v57, v158
	v_mov_b32 v58, v158
	v_mov_b32 v59, v158
	v_mov_b32 v60, v158
	v_mov_b32 v61, v158
	v_mov_b32 v62, v158
	v_mov_b32 v63, v158
.aval_527:
	s_nop 7
	v_max3_f32 v168, v0, v1, v2
	v_max3_f32 v169, v3, v4, v5
	v_max3_f32 v168, v168, v6, v7
	v_max3_f32 v169, v169, v8, v9
	v_max3_f32 v168, v168, v10, v11
	v_max3_f32 v169, v169, v12, v13
	v_max3_f32 v168, v168, v14, v15
	v_max3_f32 v169, v169, v16, v17
	v_max3_f32 v168, v168, v18, v19
	v_max3_f32 v169, v169, v20, v21
	v_max3_f32 v168, v168, v22, v23
	v_max3_f32 v169, v169, v24, v25
	v_max3_f32 v168, v168, v26, v27
	v_max3_f32 v169, v169, v28, v29
	v_max3_f32 v168, v168, v30, v31
	v_max3_f32 v169, v169, v32, v33
	v_max3_f32 v168, v168, v34, v35
	v_max3_f32 v169, v169, v36, v37
	v_max3_f32 v168, v168, v38, v39
	v_max3_f32 v169, v169, v40, v41
	v_max3_f32 v168, v168, v42, v43
	v_max3_f32 v169, v169, v44, v45
	v_max3_f32 v168, v168, v46, v47
	v_max3_f32 v169, v169, v48, v49
	v_max3_f32 v168, v168, v50, v51
	v_max3_f32 v169, v169, v52, v53
	v_max3_f32 v168, v168, v54, v55
	v_max3_f32 v169, v169, v56, v57
	v_max3_f32 v168, v168, v58, v59
	v_max3_f32 v169, v169, v60, v61
	v_max3_f32 v168, v168, v62, v63
	v_max3_f32 v169, v169, v64, v65
	v_max3_f32 v168, v168, v66, v67
	v_max_f32 v168, v168, v169
	v_mov_b32 v170, v168
	s_nop 1
	v_permlane16_swap_b32 v168, v170
	v_max_f32 v168, v168, v170
	v_mov_b32 v170, v168
	s_nop 1
	v_permlane32_swap_b32 v168, v170
	v_max_f32 v168, v168, v170
	v_mul_f32 v166, 0xbeae1a93, v168
	v_mov_b32 v167, v166
	s_cmp_ge_u32 s28, 8
	s_cbranch_scc1 .amnorm_528
	s_cmp_eq_u32 s28, 0
	s_cbranch_scc1 .ament_529
	s_cmp_eq_u32 s28, 1
	s_cbranch_scc1 .ament_530
	s_cmp_eq_u32 s28, 2
	s_cbranch_scc1 .ament_531
	s_cmp_eq_u32 s28, 3
	s_cbranch_scc1 .ament_532
	s_cmp_eq_u32 s28, 4
	s_cbranch_scc1 .ament_533
	s_cmp_eq_u32 s28, 5
	s_cbranch_scc1 .ament_534
	s_cmp_eq_u32 s28, 6
	s_cbranch_scc1 .ament_535
	s_branch .ament_536
.amnorm_528:
	v_pk_fma_f32 v[0:1], v[0:1], v[164:165], v[166:167]
	v_pk_fma_f32 v[2:3], v[2:3], v[164:165], v[166:167]
	v_pk_fma_f32 v[4:5], v[4:5], v[164:165], v[166:167]
	v_pk_fma_f32 v[6:7], v[6:7], v[164:165], v[166:167]
	v_exp_f32 v0, v0
	v_exp_f32 v1, v1
	v_exp_f32 v2, v2
	v_exp_f32 v3, v3
	v_exp_f32 v4, v4
	v_exp_f32 v5, v5
	v_exp_f32 v6, v6
	v_exp_f32 v7, v7
	v_cvt_pk_bf16_f32 v0, v0, v1
	v_cvt_pk_bf16_f32 v1, v2, v3
	v_cvt_pk_bf16_f32 v2, v4, v5
	v_cvt_pk_bf16_f32 v3, v6, v7
	s_waitcnt lgkmcnt(4)
	s_nop 0
	v_mfma_f32_16x16x32_bf16 v[116:119], v[88:91], v[0:3], 0
	v_mfma_f32_16x16x32_bf16 v[120:123], v[92:95], v[0:3], 0
	v_mfma_f32_16x16x32_bf16 v[124:127], v[128:131], v[0:3], 0
	ds_read_b128 v[88:91], v144 offset:2048
	ds_read_b128 v[92:95], v144 offset:3072
.ament_536:
	v_pk_fma_f32 v[8:9], v[8:9], v[164:165], v[166:167]
	v_pk_fma_f32 v[10:11], v[10:11], v[164:165], v[166:167]
	v_pk_fma_f32 v[12:13], v[12:13], v[164:165], v[166:167]
	v_pk_fma_f32 v[14:15], v[14:15], v[164:165], v[166:167]
	v_exp_f32 v8, v8
	v_exp_f32 v9, v9
	v_exp_f32 v10, v10
	v_exp_f32 v11, v11
	v_exp_f32 v12, v12
	v_exp_f32 v13, v13
	v_exp_f32 v14, v14
	v_exp_f32 v15, v15
	v_cvt_pk_bf16_f32 v8, v8, v9
	v_cvt_pk_bf16_f32 v9, v10, v11
	v_cvt_pk_bf16_f32 v10, v12, v13
	v_cvt_pk_bf16_f32 v11, v14, v15
	s_waitcnt lgkmcnt(4)
	s_nop 0
	v_mfma_f32_16x16x32_bf16 v[116:119], v[96:99], v[8:11], v[116:119]
	v_mfma_f32_16x16x32_bf16 v[120:123], v[100:103], v[8:11], v[120:123]
	v_mfma_f32_16x16x32_bf16 v[124:127], v[128:131], v[8:11], v[124:127]
	ds_read_b128 v[96:99], v145 offset:2048
	ds_read_b128 v[100:103], v145 offset:3072
.ament_535:
	v_pk_fma_f32 v[16:17], v[16:17], v[164:165], v[166:167]
	v_pk_fma_f32 v[18:19], v[18:19], v[164:165], v[166:167]
	v_pk_fma_f32 v[20:21], v[20:21], v[164:165], v[166:167]
	v_pk_fma_f32 v[22:23], v[22:23], v[164:165], v[166:167]
	v_exp_f32 v16, v16
	v_exp_f32 v17, v17
	v_exp_f32 v18, v18
	v_exp_f32 v19, v19
	v_exp_f32 v20, v20
	v_exp_f32 v21, v21
	v_exp_f32 v22, v22
	v_exp_f32 v23, v23
	v_cvt_pk_bf16_f32 v16, v16, v17
	v_cvt_pk_bf16_f32 v17, v18, v19
	v_cvt_pk_bf16_f32 v18, v20, v21
	v_cvt_pk_bf16_f32 v19, v22, v23
	s_waitcnt lgkmcnt(4)
	s_nop 0
	v_mfma_f32_16x16x32_bf16 v[116:119], v[104:107], v[16:19], v[116:119]
	v_mfma_f32_16x16x32_bf16 v[120:123], v[108:111], v[16:19], v[120:123]
	v_mfma_f32_16x16x32_bf16 v[124:127], v[128:131], v[16:19], v[124:127]
	ds_read_b128 v[104:107], v146 offset:2048
	ds_read_b128 v[108:111], v146 offset:3072
.ament_534:
	v_pk_fma_f32 v[24:25], v[24:25], v[164:165], v[166:167]
	v_pk_fma_f32 v[26:27], v[26:27], v[164:165], v[166:167]
	v_pk_fma_f32 v[28:29], v[28:29], v[164:165], v[166:167]
	v_pk_fma_f32 v[30:31], v[30:31], v[164:165], v[166:167]
	v_exp_f32 v24, v24
	v_exp_f32 v25, v25
	v_exp_f32 v26, v26
	v_exp_f32 v27, v27
	v_exp_f32 v28, v28
	v_exp_f32 v29, v29
	v_exp_f32 v30, v30
	v_exp_f32 v31, v31
	v_cvt_pk_bf16_f32 v24, v24, v25
	v_cvt_pk_bf16_f32 v25, v26, v27
	v_cvt_pk_bf16_f32 v26, v28, v29
	v_cvt_pk_bf16_f32 v27, v30, v31
	s_waitcnt lgkmcnt(4)
	s_nop 0
	v_mfma_f32_16x16x32_bf16 v[116:119], v[88:91], v[24:27], v[116:119]
	v_mfma_f32_16x16x32_bf16 v[120:123], v[92:95], v[24:27], v[120:123]
	v_mfma_f32_16x16x32_bf16 v[124:127], v[128:131], v[24:27], v[124:127]
	ds_read_b128 v[88:91], v147 offset:2048
	ds_read_b128 v[92:95], v147 offset:3072
.ament_533:
	v_pk_fma_f32 v[32:33], v[32:33], v[164:165], v[166:167]
	v_pk_fma_f32 v[34:35], v[34:35], v[164:165], v[166:167]
	v_pk_fma_f32 v[36:37], v[36:37], v[164:165], v[166:167]
	v_pk_fma_f32 v[38:39], v[38:39], v[164:165], v[166:167]
	v_exp_f32 v32, v32
	v_exp_f32 v33, v33
	v_exp_f32 v34, v34
	v_exp_f32 v35, v35
	v_exp_f32 v36, v36
	v_exp_f32 v37, v37
	v_exp_f32 v38, v38
	v_exp_f32 v39, v39
	v_cvt_pk_bf16_f32 v32, v32, v33
	v_cvt_pk_bf16_f32 v33, v34, v35
	v_cvt_pk_bf16_f32 v34, v36, v37
	v_cvt_pk_bf16_f32 v35, v38, v39
	s_waitcnt lgkmcnt(4)
	s_nop 0
	v_mfma_f32_16x16x32_bf16 v[116:119], v[96:99], v[32:35], v[116:119]
	v_mfma_f32_16x16x32_bf16 v[120:123], v[100:103], v[32:35], v[120:123]
	v_mfma_f32_16x16x32_bf16 v[124:127], v[128:131], v[32:35], v[124:127]
	ds_read_b128 v[96:99], v148 offset:2048
	ds_read_b128 v[100:103], v148 offset:3072
.ament_532:
	v_pk_fma_f32 v[40:41], v[40:41], v[164:165], v[166:167]
	v_pk_fma_f32 v[42:43], v[42:43], v[164:165], v[166:167]
	v_pk_fma_f32 v[44:45], v[44:45], v[164:165], v[166:167]
	v_pk_fma_f32 v[46:47], v[46:47], v[164:165], v[166:167]
	v_exp_f32 v40, v40
	v_exp_f32 v41, v41
	v_exp_f32 v42, v42
	v_exp_f32 v43, v43
	v_exp_f32 v44, v44
	v_exp_f32 v45, v45
	v_exp_f32 v46, v46
	v_exp_f32 v47, v47
	v_cvt_pk_bf16_f32 v40, v40, v41
	v_cvt_pk_bf16_f32 v41, v42, v43
	v_cvt_pk_bf16_f32 v42, v44, v45
	v_cvt_pk_bf16_f32 v43, v46, v47
	s_waitcnt lgkmcnt(4)
	s_nop 0
	v_mfma_f32_16x16x32_bf16 v[116:119], v[104:107], v[40:43], v[116:119]
	v_mfma_f32_16x16x32_bf16 v[120:123], v[108:111], v[40:43], v[120:123]
	v_mfma_f32_16x16x32_bf16 v[124:127], v[128:131], v[40:43], v[124:127]
	ds_read_b128 v[104:107], v149 offset:2048
	ds_read_b128 v[108:111], v149 offset:3072
.ament_531:
	v_pk_fma_f32 v[48:49], v[48:49], v[164:165], v[166:167]
	v_pk_fma_f32 v[50:51], v[50:51], v[164:165], v[166:167]
	v_pk_fma_f32 v[52:53], v[52:53], v[164:165], v[166:167]
	v_pk_fma_f32 v[54:55], v[54:55], v[164:165], v[166:167]
	v_exp_f32 v48, v48
	v_exp_f32 v49, v49
	v_exp_f32 v50, v50
	v_exp_f32 v51, v51
	v_exp_f32 v52, v52
	v_exp_f32 v53, v53
	v_exp_f32 v54, v54
	v_exp_f32 v55, v55
	v_cvt_pk_bf16_f32 v48, v48, v49
	v_cvt_pk_bf16_f32 v49, v50, v51
	v_cvt_pk_bf16_f32 v50, v52, v53
	v_cvt_pk_bf16_f32 v51, v54, v55
	s_waitcnt lgkmcnt(4)
	s_nop 0
	v_mfma_f32_16x16x32_bf16 v[116:119], v[88:91], v[48:51], v[116:119]
	v_mfma_f32_16x16x32_bf16 v[120:123], v[92:95], v[48:51], v[120:123]
	v_mfma_f32_16x16x32_bf16 v[124:127], v[128:131], v[48:51], v[124:127]
.ament_530:
	v_pk_fma_f32 v[56:57], v[56:57], v[164:165], v[166:167]
	v_pk_fma_f32 v[58:59], v[58:59], v[164:165], v[166:167]
	v_pk_fma_f32 v[60:61], v[60:61], v[164:165], v[166:167]
	v_pk_fma_f32 v[62:63], v[62:63], v[164:165], v[166:167]
	v_exp_f32 v56, v56
	v_exp_f32 v57, v57
	v_exp_f32 v58, v58
	v_exp_f32 v59, v59
	v_exp_f32 v60, v60
	v_exp_f32 v61, v61
	v_exp_f32 v62, v62
	v_exp_f32 v63, v63
	v_cvt_pk_bf16_f32 v56, v56, v57
	v_cvt_pk_bf16_f32 v57, v58, v59
	v_cvt_pk_bf16_f32 v58, v60, v61
	v_cvt_pk_bf16_f32 v59, v62, v63
	s_waitcnt lgkmcnt(2)
	s_nop 0
	v_mfma_f32_16x16x32_bf16 v[116:119], v[96:99], v[56:59], v[116:119]
	v_mfma_f32_16x16x32_bf16 v[120:123], v[100:103], v[56:59], v[120:123]
	v_mfma_f32_16x16x32_bf16 v[124:127], v[128:131], v[56:59], v[124:127]
.ament_529:
	v_pk_fma_f32 v[64:65], v[64:65], v[164:165], v[166:167]
	v_pk_fma_f32 v[66:67], v[66:67], v[164:165], v[166:167]
	v_exp_f32 v64, v64
	v_exp_f32 v65, v65
	v_exp_f32 v66, v66
	v_exp_f32 v67, v67
	v_cvt_pk_bf16_f32 v64, v64, v65
	v_cvt_pk_bf16_f32 v65, v66, v67
	v_mov_b32 v66, 0
	v_mov_b32 v67, 0
	s_waitcnt lgkmcnt(0)
	s_nop 0
	v_mfma_f32_16x16x32_bf16 v[116:119], v[104:107], v[64:67], v[116:119]
	v_mfma_f32_16x16x32_bf16 v[120:123], v[108:111], v[64:67], v[120:123]
	v_mfma_f32_16x16x32_bf16 v[124:127], v[128:131], v[64:67], v[124:127]
	s_nop 7
	v_rcp_f32 v170, v124
	s_nop 0
	v_mul_f32 v116, v116, v170
	v_mul_f32 v120, v120, v170
	v_mul_f32 v117, v117, v170
	v_mul_f32 v121, v121, v170
	v_mul_f32 v118, v118, v170
	v_mul_f32 v122, v122, v170
	v_mul_f32 v119, v119, v170
	v_mul_f32 v123, v123, v170
	v_cvt_pk_bf16_f32 v116, v116, v117
	v_cvt_pk_bf16_f32 v117, v118, v119
	v_cvt_pk_bf16_f32 v120, v120, v121
	v_cvt_pk_bf16_f32 v121, v122, v123
	v_cndmask_b32 v120, v120, v121, s[56:57]
	s_sub_i32 s77, s28, 3
	s_max_i32 s77, s77, 0
	v_cmp_gt_u32 vcc, s77, v173
	s_cbranch_vccz .pck_537
	s_mov_b32 s20, 400000
.pre_538:
	buffer_load_dword v173, v172, s[4:7], 0 offen sc1
	s_waitcnt vmcnt(0)
	v_cmp_gt_u32 vcc, s77, v173
	s_cbranch_vccz .pok_539
	s_sub_u32 s20, s20, 1
	s_cmp_lg_u32 s20, 0
	s_cbranch_scc1 .pre_538
	s_branch L_FAIL
.pok_539:
.pck_537:
	s_add_u32 s17, s58, s78
	s_add_u32 s18, s59, s78
	buffer_store_dwordx2 v[116:117], v161, s[4:7], s17 offen sc1
	s_mov_b64 exec, s[54:55]
	buffer_store_dword v120, v162, s[4:7], s18 offen sc1
	s_mov_b64 exec, -1
	buffer_load_dword v155, v154, s[4:7], 0 offen sc1
	s_add_u32 s68, s68, 8192
	s_cmp_eq_u32 s68, 81920
	s_cselect_b32 s68, 0, s68
	s_add_u32 s69, s69, 8192
	s_cmp_eq_u32 s69, 81920
	s_cselect_b32 s69, 0, s69
	s_add_u32 s70, s70, 8192
	s_cmp_eq_u32 s70, 81920
	s_cselect_b32 s70, 0, s70
	s_add_u32 s71, s71, 8192
	s_cmp_eq_u32 s71, 81920
	s_cselect_b32 s71, 0, s71
	s_add_u32 s72, s72, 8192
	s_cmp_eq_u32 s72, 81920
	s_cselect_b32 s72, 0, s72
	s_add_u32 s73, s73, 8192
	s_cmp_eq_u32 s73, 81920
	s_cselect_b32 s73, 0, s73
	s_add_u32 s74, s74, 8192
	s_cmp_eq_u32 s74, 81920
	s_cselect_b32 s74, 0, s74
	s_add_u32 s75, s75, 8192
	s_cmp_eq_u32 s75, 81920
	s_cselect_b32 s75, 0, s75
	s_add_u32 s76, s76, 8192
	s_cmp_eq_u32 s76, 81920
	s_cselect_b32 s76, 0, s76
	s_add_u32 s28, s28, 1
	s_waitcnt vmcnt(0)
	v_mov_b32 v157, s28
	s_mov_b64 exec, 1
	buffer_store_dword v157, v156, s[4:7], s30 offen sc1
	s_mov_b64 exec, -1
	s_cmp_ge_u32 s28, 64
	s_cbranch_scc1 L_END
	s_add_u32 s37, s28, 1
	v_cmp_gt_u32 vcc, s37, v155
	s_cbranch_vccz .pck_540
	s_mov_b32 s20, 400000
.pre_541:
	buffer_load_dword v155, v154, s[4:7], 0 offen sc1
	s_waitcnt vmcnt(0)
	v_cmp_gt_u32 vcc, s37, v155
	s_cbranch_vccz .pok_542
	s_sub_u32 s20, s20, 1
	s_cmp_lg_u32 s20, 0
	s_cbranch_scc1 .pre_541
	s_branch L_FAIL
.pok_542:
.pck_540:
	s_branch .aloop_497
.aatt1_496:
	s_add_u32 s37, s28, 1
	s_mov_b32 s20, 400000
.pre_544:
	buffer_load_dword v155, v154, s[4:7], 0 offen sc1
	s_waitcnt vmcnt(0)
	v_cmp_gt_u32 vcc, s37, v155
	s_cbranch_vccz .pok_545
	s_sub_u32 s20, s20, 1
	s_cmp_lg_u32 s20, 0
	s_cbranch_scc1 .pre_544
	s_branch L_FAIL
.pok_545:
.aloop_543:
	s_and_b32 s77, s28, 3
	s_mul_i32 s77, s77, 110592
	s_and_b32 s78, s28, 3
	s_mul_i32 s78, s78, 36864
	s_add_u32 s17, s66, s76
	s_mov_b32 m0, s17
	s_add_u32 s18, s60, s77
	buffer_load_dwordx4 v153, s[4:7], s18 offen sc1 lds
	s_add_u32 s17, s17, 1024
	s_mov_b32 m0, s17
	s_add_u32 s18, s61, s77
	buffer_load_dwordx4 v153, s[4:7], s18 offen sc1 lds
	s_add_u32 s18, s64, s77
	buffer_load_dwordx2 v[112:113], v152, s[4:7], s18 offen sc1
	s_add_u32 s18, s65, s77
	buffer_load_dwordx2 v[114:115], v152, s[4:7], s18 offen sc1
	buffer_load_dword v173, v172, s[4:7], 0 offen sc1
	v_add_u32 v132, s68, v150
	v_add_u32 v141, s68, v151
	v_add_u32 v133, s69, v150
	v_add_u32 v142, s69, v151
	v_add_u32 v134, s70, v150
	v_add_u32 v143, s70, v151
	v_add_u32 v135, s71, v150
	v_add_u32 v144, s71, v151
	v_add_u32 v136, s72, v150
	v_add_u32 v145, s72, v151
	v_add_u32 v137, s73, v150
	v_add_u32 v146, s73, v151
	v_add_u32 v138, s74, v150
	v_add_u32 v147, s74, v151
	v_add_u32 v139, s75, v150
	v_add_u32 v148, s75, v151
	v_add_u32 v140, s76, v150
	v_add_u32 v149, s76, v151
	s_waitcnt vmcnt(0)
	v_and_b32 v114, v159, v114
	v_and_b32 v115, v160, v115
	s_barrier
	s_cmp_ge_u32 s28, 8
	s_cbranch_scc1 .aknorm_546
	s_cmp_lg_u32 s28, 0
	s_cbranch_scc1 .aknx_547
	ds_read2st64_b64 v[84:87], v140 offset0:0 offset1:2
	ds_read2st64_b64 v[72:75], v140 offset0:1 offset1:3
	s_branch .akent_548
.aknx_547:
	s_cmp_lg_u32 s28, 1
	s_cbranch_scc1 .aknx_549
	ds_read2st64_b64 v[76:79], v139 offset0:0 offset1:2
	ds_read2st64_b64 v[80:83], v139 offset0:1 offset1:3
	ds_read2st64_b64 v[84:87], v140 offset0:0 offset1:2
	ds_read2st64_b64 v[72:75], v140 offset0:1 offset1:3
	s_branch .akent_550
.aknx_549:
	s_cmp_lg_u32 s28, 2
	s_cbranch_scc1 .aknx_551
	ds_read2st64_b64 v[84:87], v138 offset0:0 offset1:2
	ds_read2st64_b64 v[72:75], v138 offset0:1 offset1:3
	ds_read2st64_b64 v[76:79], v139 offset0:0 offset1:2
	ds_read2st64_b64 v[80:83], v139 offset0:1 offset1:3
	s_branch .akent_552
.aknx_551:
	s_cmp_lg_u32 s28, 3
	s_cbranch_scc1 .aknx_553
	ds_read2st64_b64 v[76:79], v137 offset0:0 offset1:2
	ds_read2st64_b64 v[80:83], v137 offset0:1 offset1:3
	ds_read2st64_b64 v[84:87], v138 offset0:0 offset1:2
	ds_read2st64_b64 v[72:75], v138 offset0:1 offset1:3
	s_branch .akent_554
.aknx_553:
	s_cmp_lg_u32 s28, 4
	s_cbranch_scc1 .aknx_555
	ds_read2st64_b64 v[84:87], v136 offset0:0 offset1:2
	ds_read2st64_b64 v[72:75], v136 offset0:1 offset1:3
	ds_read2st64_b64 v[76:79], v137 offset0:0 offset1:2
	ds_read2st64_b64 v[80:83], v137 offset0:1 offset1:3
	s_branch .akent_556
.aknx_555:
	s_cmp_lg_u32 s28, 5
	s_cbranch_scc1 .aknx_557
	ds_read2st64_b64 v[76:79], v135 offset0:0 offset1:2
	ds_read2st64_b64 v[80:83], v135 offset0:1 offset1:3
	ds_read2st64_b64 v[84:87], v136 offset0:0 offset1:2
	ds_read2st64_b64 v[72:75], v136 offset0:1 offset1:3
	s_branch .akent_558
.aknx_557:
	s_cmp_lg_u32 s28, 6
	s_cbranch_scc1 .aknx_559
	ds_read2st64_b64 v[84:87], v134 offset0:0 offset1:2
	ds_read2st64_b64 v[72:75], v134 offset0:1 offset1:3
	ds_read2st64_b64 v[76:79], v135 offset0:0 offset1:2
	ds_read2st64_b64 v[80:83], v135 offset0:1 offset1:3
	s_branch .akent_560
.aknx_559:
	ds_read2st64_b64 v[76:79], v133 offset0:0 offset1:2
	ds_read2st64_b64 v[80:83], v133 offset0:1 offset1:3
	ds_read2st64_b64 v[84:87], v134 offset0:0 offset1:2
	ds_read2st64_b64 v[72:75], v134 offset0:1 offset1:3
	s_branch .akent_562
.aknx_561:
.aknorm_546:
	ds_read2st64_b64 v[72:75], v132 offset0:1 offset1:3
	ds_read2st64_b64 v[76:79], v133 offset0:0 offset1:2
	ds_read2st64_b64 v[80:83], v133 offset0:1 offset1:3
	ds_read2st64_b64 v[84:87], v134 offset0:0 offset1:2
	s_waitcnt lgkmcnt(3)
	v_mfma_f32_16x16x32_bf16 v[4:7], v[72:75], v[112:115], 0
	ds_read2st64_b64 v[72:75], v134 offset0:1 offset1:3
.akent_562:
	s_waitcnt lgkmcnt(3)
	v_mfma_f32_16x16x32_bf16 v[8:11], v[76:79], v[112:115], 0
	ds_read2st64_b64 v[76:79], v135 offset0:0 offset1:2
	s_waitcnt lgkmcnt(3)
	v_mfma_f32_16x16x32_bf16 v[12:15], v[80:83], v[112:115], 0
	ds_read2st64_b64 v[80:83], v135 offset0:1 offset1:3
.akent_560:
	s_waitcnt lgkmcnt(3)
	v_mfma_f32_16x16x32_bf16 v[16:19], v[84:87], v[112:115], 0
	ds_read2st64_b64 v[84:87], v136 offset0:0 offset1:2
	s_waitcnt lgkmcnt(3)
	v_mfma_f32_16x16x32_bf16 v[20:23], v[72:75], v[112:115], 0
	ds_read2st64_b64 v[72:75], v136 offset0:1 offset1:3
.akent_558:
	s_waitcnt lgkmcnt(3)
	v_mfma_f32_16x16x32_bf16 v[24:27], v[76:79], v[112:115], 0
	ds_read2st64_b64 v[76:79], v137 offset0:0 offset1:2
	s_waitcnt lgkmcnt(3)
	v_mfma_f32_16x16x32_bf16 v[28:31], v[80:83], v[112:115], 0
	ds_read2st64_b64 v[80:83], v137 offset0:1 offset1:3
.akent_556:
	s_waitcnt lgkmcnt(3)
	v_mfma_f32_16x16x32_bf16 v[32:35], v[84:87], v[112:115], 0
	ds_read2st64_b64 v[84:87], v138 offset0:0 offset1:2
	s_waitcnt lgkmcnt(3)
	v_mfma_f32_16x16x32_bf16 v[36:39], v[72:75], v[112:115], 0
	ds_read2st64_b64 v[72:75], v138 offset0:1 offset1:3
.akent_554:
	s_waitcnt lgkmcnt(3)
	v_mfma_f32_16x16x32_bf16 v[40:43], v[76:79], v[112:115], 0
	ds_read2st64_b64 v[76:79], v139 offset0:0 offset1:2
	s_waitcnt lgkmcnt(3)
	v_mfma_f32_16x16x32_bf16 v[44:47], v[80:83], v[112:115], 0
	ds_read2st64_b64 v[80:83], v139 offset0:1 offset1:3
.akent_552:
	s_waitcnt lgkmcnt(3)
	v_mfma_f32_16x16x32_bf16 v[48:51], v[84:87], v[112:115], 0
	ds_read2st64_b64 v[84:87], v140 offset0:0 offset1:2
	s_waitcnt lgkmcnt(3)
	v_mfma_f32_16x16x32_bf16 v[52:55], v[72:75], v[112:115], 0
	ds_read2st64_b64 v[72:75], v140 offset0:1 offset1:3
.akent_550:
	s_waitcnt lgkmcnt(3)
	v_mfma_f32_16x16x32_bf16 v[56:59], v[76:79], v[112:115], 0
	s_waitcnt lgkmcnt(2)
	v_mfma_f32_16x16x32_bf16 v[60:63], v[80:83], v[112:115], 0
.akent_548:
	s_waitcnt lgkmcnt(1)
	v_mfma_f32_16x16x32_bf16 v[64:67], v[84:87], v[112:115], 0
	s_waitcnt lgkmcnt(0)
	v_mfma_f32_16x16x32_bf16 v[68:71], v[72:75], v[112:115], 0
	s_cmp_ge_u32 s28, 8
	s_cbranch_scc1 .avnorm_563
	v_mov_b32 v116, 0
	v_mov_b32 v117, 0
	v_mov_b32 v118, 0
	v_mov_b32 v119, 0
	v_mov_b32 v120, 0
	v_mov_b32 v121, 0
	v_mov_b32 v122, 0
	v_mov_b32 v123, 0
	v_mov_b32 v124, 0
	v_mov_b32 v125, 0
	v_mov_b32 v126, 0
	v_mov_b32 v127, 0
	s_cmp_lg_u32 s28, 0
	s_cbranch_scc1 .avnx_565
	ds_read_b128 v[104:107], v149 offset:2048
	ds_read_b128 v[108:111], v149 offset:3072
	s_branch .avjoin_564
.avnx_565:
	s_cmp_lg_u32 s28, 1
	s_cbranch_scc1 .avnx_566
	ds_read_b128 v[96:99], v148 offset:2048
	ds_read_b128 v[100:103], v148 offset:3072
	ds_read_b128 v[104:107], v149 offset:2048
	ds_read_b128 v[108:111], v149 offset:3072
	s_branch .avjoin_564
.avnx_566:
	s_cmp_lg_u32 s28, 2
	s_cbranch_scc1 .avnx_567
	ds_read_b128 v[88:91], v147 offset:2048
	ds_read_b128 v[92:95], v147 offset:3072
	ds_read_b128 v[96:99], v148 offset:2048
	ds_read_b128 v[100:103], v148 offset:3072
	ds_read_b128 v[104:107], v149 offset:2048
	ds_read_b128 v[108:111], v149 offset:3072
	s_branch .avjoin_564
.avnx_567:
	s_cmp_lg_u32 s28, 3
	s_cbranch_scc1 .avnx_568
	ds_read_b128 v[104:107], v146 offset:2048
	ds_read_b128 v[108:111], v146 offset:3072
	ds_read_b128 v[88:91], v147 offset:2048
	ds_read_b128 v[92:95], v147 offset:3072
	ds_read_b128 v[96:99], v148 offset:2048
	ds_read_b128 v[100:103], v148 offset:3072
	s_branch .avjoin_564
.avnx_568:
	s_cmp_lg_u32 s28, 4
	s_cbranch_scc1 .avnx_569
	ds_read_b128 v[96:99], v145 offset:2048
	ds_read_b128 v[100:103], v145 offset:3072
	ds_read_b128 v[104:107], v146 offset:2048
	ds_read_b128 v[108:111], v146 offset:3072
	ds_read_b128 v[88:91], v147 offset:2048
	ds_read_b128 v[92:95], v147 offset:3072
	s_branch .avjoin_564
.avnx_569:
	s_cmp_lg_u32 s28, 5
	s_cbranch_scc1 .avnx_570
	ds_read_b128 v[88:91], v144 offset:2048
	ds_read_b128 v[92:95], v144 offset:3072
	ds_read_b128 v[96:99], v145 offset:2048
	ds_read_b128 v[100:103], v145 offset:3072
	ds_read_b128 v[104:107], v146 offset:2048
	ds_read_b128 v[108:111], v146 offset:3072
	s_branch .avjoin_564
.avnx_570:
	s_cmp_lg_u32 s28, 6
	s_cbranch_scc1 .avnx_571
	ds_read_b128 v[104:107], v143 offset:2048
	ds_read_b128 v[108:111], v143 offset:3072
	ds_read_b128 v[88:91], v144 offset:2048
	ds_read_b128 v[92:95], v144 offset:3072
	ds_read_b128 v[96:99], v145 offset:2048
	ds_read_b128 v[100:103], v145 offset:3072
	s_branch .avjoin_564
.avnx_571:
	ds_read_b128 v[96:99], v142 offset:2048
	ds_read_b128 v[100:103], v142 offset:3072
	ds_read_b128 v[104:107], v143 offset:2048
	ds_read_b128 v[108:111], v143 offset:3072
	ds_read_b128 v[88:91], v144 offset:2048
	ds_read_b128 v[92:95], v144 offset:3072
	s_branch .avjoin_564
.avnx_572:
.avnorm_563:
	ds_read_b128 v[88:91], v141 offset:2048
	ds_read_b128 v[92:95], v141 offset:3072
	ds_read_b128 v[96:99], v142 offset:2048
	ds_read_b128 v[100:103], v142 offset:3072
	ds_read_b128 v[104:107], v143 offset:2048
	ds_read_b128 v[108:111], v143 offset:3072
.avjoin_564:
	v_cndmask_b32 v4, v158, v4, s[46:47]
	v_cndmask_b32 v5, v158, v5, s[48:49]
	v_cndmask_b32 v6, v158, v6, s[50:51]
	v_cndmask_b32 v7, v158, v7, s[52:53]
	v_cndmask_b32 v68, v68, v158, s[46:47]
	v_cndmask_b32 v69, v69, v158, s[48:49]
	v_cndmask_b32 v70, v70, v158, s[50:51]
	v_cndmask_b32 v71, v71, v158, s[52:53]
	s_cmp_ge_u32 s28, 8
	s_cbranch_scc1 .aval_573
	s_cmp_ge_u32 s28, 8
	s_cbranch_scc1 .aval_573
	v_mov_b32 v4, v158
	v_mov_b32 v5, v158
	v_mov_b32 v6, v158
	v_mov_b32 v7, v158
	s_cmp_ge_u32 s28, 7
	s_cbranch_scc1 .aval_573
	v_mov_b32 v8, v158
	v_mov_b32 v9, v158
	v_mov_b32 v10, v158
	v_mov_b32 v11, v158
	v_mov_b32 v12, v158
	v_mov_b32 v13, v158
	v_mov_b32 v14, v158
	v_mov_b32 v15, v158
	s_cmp_ge_u32 s28, 6
	s_cbranch_scc1 .aval_573
	v_mov_b32 v16, v158
	v_mov_b32 v17, v158
	v_mov_b32 v18, v158
	v_mov_b32 v19, v158
	v_mov_b32 v20, v158
	v_mov_b32 v21, v158
	v_mov_b32 v22, v158
	v_mov_b32 v23, v158
	s_cmp_ge_u32 s28, 5
	s_cbranch_scc1 .aval_573
	v_mov_b32 v24, v158
	v_mov_b32 v25, v158
	v_mov_b32 v26, v158
	v_mov_b32 v27, v158
	v_mov_b32 v28, v158
	v_mov_b32 v29, v158
	v_mov_b32 v30, v158
	v_mov_b32 v31, v158
	s_cmp_ge_u32 s28, 4
	s_cbranch_scc1 .aval_573
	v_mov_b32 v32, v158
	v_mov_b32 v33, v158
	v_mov_b32 v34, v158
	v_mov_b32 v35, v158
	v_mov_b32 v36, v158
	v_mov_b32 v37, v158
	v_mov_b32 v38, v158
	v_mov_b32 v39, v158
	s_cmp_ge_u32 s28, 3
	s_cbranch_scc1 .aval_573
	v_mov_b32 v40, v158
	v_mov_b32 v41, v158
	v_mov_b32 v42, v158
	v_mov_b32 v43, v158
	v_mov_b32 v44, v158
	v_mov_b32 v45, v158
	v_mov_b32 v46, v158
	v_mov_b32 v47, v158
	s_cmp_ge_u32 s28, 2
	s_cbranch_scc1 .aval_573
	v_mov_b32 v48, v158
	v_mov_b32 v49, v158
	v_mov_b32 v50, v158
	v_mov_b32 v51, v158
	v_mov_b32 v52, v158
	v_mov_b32 v53, v158
	v_mov_b32 v54, v158
	v_mov_b32 v55, v158
	s_cmp_ge_u32 s28, 1
	s_cbranch_scc1 .aval_573
	v_mov_b32 v56, v158
	v_mov_b32 v57, v158
	v_mov_b32 v58, v158
	v_mov_b32 v59, v158
	v_mov_b32 v60, v158
	v_mov_b32 v61, v158
	v_mov_b32 v62, v158
	v_mov_b32 v63, v158
.aval_573:
	s_nop 7
	v_max3_f32 v168, v4, v5, v6
	v_max3_f32 v169, v7, v8, v9
	v_max3_f32 v168, v168, v10, v11
	v_max3_f32 v169, v169, v12, v13
	v_max3_f32 v168, v168, v14, v15
	v_max3_f32 v169, v169, v16, v17
	v_max3_f32 v168, v168, v18, v19
	v_max3_f32 v169, v169, v20, v21
	v_max3_f32 v168, v168, v22, v23
	v_max3_f32 v169, v169, v24, v25
	v_max3_f32 v168, v168, v26, v27
	v_max3_f32 v169, v169, v28, v29
	v_max3_f32 v168, v168, v30, v31
	v_max3_f32 v169, v169, v32, v33
	v_max3_f32 v168, v168, v34, v35
	v_max3_f32 v169, v169, v36, v37
	v_max3_f32 v168, v168, v38, v39
	v_max3_f32 v169, v169, v40, v41
	v_max3_f32 v168, v168, v42, v43
	v_max3_f32 v169, v169, v44, v45
	v_max3_f32 v168, v168, v46, v47
	v_max3_f32 v169, v169, v48, v49
	v_max3_f32 v168, v168, v50, v51
	v_max3_f32 v169, v169, v52, v53
	v_max3_f32 v168, v168, v54, v55
	v_max3_f32 v169, v169, v56, v57
	v_max3_f32 v168, v168, v58, v59
	v_max3_f32 v169, v169, v60, v61
	v_max3_f32 v168, v168, v62, v63
	v_max3_f32 v169, v169, v64, v65
	v_max3_f32 v168, v168, v66, v67
	v_max3_f32 v169, v169, v68, v69
	v_max3_f32 v168, v168, v70, v71
	v_max_f32 v168, v168, v169
	v_mov_b32 v170, v168
	s_nop 1
	v_permlane16_swap_b32 v168, v170
	v_max_f32 v168, v168, v170
	v_mov_b32 v170, v168
	s_nop 1
	v_permlane32_swap_b32 v168, v170
	v_max_f32 v168, v168, v170
	v_mul_f32 v166, 0xbeae1a93, v168
	v_mov_b32 v167, v166
	s_cmp_ge_u32 s28, 8
	s_cbranch_scc1 .amnorm_574
	s_cmp_eq_u32 s28, 0
	s_cbranch_scc1 .ament_575
	s_cmp_eq_u32 s28, 1
	s_cbranch_scc1 .ament_576
	s_cmp_eq_u32 s28, 2
	s_cbranch_scc1 .ament_577
	s_cmp_eq_u32 s28, 3
	s_cbranch_scc1 .ament_578
	s_cmp_eq_u32 s28, 4
	s_cbranch_scc1 .ament_579
	s_cmp_eq_u32 s28, 5
	s_cbranch_scc1 .ament_580
	s_cmp_eq_u32 s28, 6
	s_cbranch_scc1 .ament_581
	s_branch .ament_582
.amnorm_574:
	v_pk_fma_f32 v[4:5], v[4:5], v[164:165], v[166:167]
	v_pk_fma_f32 v[6:7], v[6:7], v[164:165], v[166:167]
	v_exp_f32 v4, v4
	v_exp_f32 v5, v5
	v_exp_f32 v6, v6
	v_exp_f32 v7, v7
	v_mov_b32 v0, 0
	v_mov_b32 v1, 0
	v_cvt_pk_bf16_f32 v2, v4, v5
	v_cvt_pk_bf16_f32 v3, v6, v7
	s_waitcnt lgkmcnt(4)
	s_nop 0
	v_mfma_f32_16x16x32_bf16 v[116:119], v[88:91], v[0:3], 0
	v_mfma_f32_16x16x32_bf16 v[120:123], v[92:95], v[0:3], 0
	v_mfma_f32_16x16x32_bf16 v[124:127], v[128:131], v[0:3], 0
	ds_read_b128 v[88:91], v144 offset:2048
	ds_read_b128 v[92:95], v144 offset:3072
.ament_582:
	v_pk_fma_f32 v[8:9], v[8:9], v[164:165], v[166:167]
	v_pk_fma_f32 v[10:11], v[10:11], v[164:165], v[166:167]
	v_pk_fma_f32 v[12:13], v[12:13], v[164:165], v[166:167]
	v_pk_fma_f32 v[14:15], v[14:15], v[164:165], v[166:167]
	v_exp_f32 v8, v8
	v_exp_f32 v9, v9
	v_exp_f32 v10, v10
	v_exp_f32 v11, v11
	v_exp_f32 v12, v12
	v_exp_f32 v13, v13
	v_exp_f32 v14, v14
	v_exp_f32 v15, v15
	v_cvt_pk_bf16_f32 v8, v8, v9
	v_cvt_pk_bf16_f32 v9, v10, v11
	v_cvt_pk_bf16_f32 v10, v12, v13
	v_cvt_pk_bf16_f32 v11, v14, v15
	s_waitcnt lgkmcnt(4)
	s_nop 0
	v_mfma_f32_16x16x32_bf16 v[116:119], v[96:99], v[8:11], v[116:119]
	v_mfma_f32_16x16x32_bf16 v[120:123], v[100:103], v[8:11], v[120:123]
	v_mfma_f32_16x16x32_bf16 v[124:127], v[128:131], v[8:11], v[124:127]
	ds_read_b128 v[96:99], v145 offset:2048
	ds_read_b128 v[100:103], v145 offset:3072
.ament_581:
	v_pk_fma_f32 v[16:17], v[16:17], v[164:165], v[166:167]
	v_pk_fma_f32 v[18:19], v[18:19], v[164:165], v[166:167]
	v_pk_fma_f32 v[20:21], v[20:21], v[164:165], v[166:167]
	v_pk_fma_f32 v[22:23], v[22:23], v[164:165], v[166:167]
	v_exp_f32 v16, v16
	v_exp_f32 v17, v17
	v_exp_f32 v18, v18
	v_exp_f32 v19, v19
	v_exp_f32 v20, v20
	v_exp_f32 v21, v21
	v_exp_f32 v22, v22
	v_exp_f32 v23, v23
	v_cvt_pk_bf16_f32 v16, v16, v17
	v_cvt_pk_bf16_f32 v17, v18, v19
	v_cvt_pk_bf16_f32 v18, v20, v21
	v_cvt_pk_bf16_f32 v19, v22, v23
	s_waitcnt lgkmcnt(4)
	s_nop 0
	v_mfma_f32_16x16x32_bf16 v[116:119], v[104:107], v[16:19], v[116:119]
	v_mfma_f32_16x16x32_bf16 v[120:123], v[108:111], v[16:19], v[120:123]
	v_mfma_f32_16x16x32_bf16 v[124:127], v[128:131], v[16:19], v[124:127]
	ds_read_b128 v[104:107], v146 offset:2048
	ds_read_b128 v[108:111], v146 offset:3072
.ament_580:
	v_pk_fma_f32 v[24:25], v[24:25], v[164:165], v[166:167]
	v_pk_fma_f32 v[26:27], v[26:27], v[164:165], v[166:167]
	v_pk_fma_f32 v[28:29], v[28:29], v[164:165], v[166:167]
	v_pk_fma_f32 v[30:31], v[30:31], v[164:165], v[166:167]
	v_exp_f32 v24, v24
	v_exp_f32 v25, v25
	v_exp_f32 v26, v26
	v_exp_f32 v27, v27
	v_exp_f32 v28, v28
	v_exp_f32 v29, v29
	v_exp_f32 v30, v30
	v_exp_f32 v31, v31
	v_cvt_pk_bf16_f32 v24, v24, v25
	v_cvt_pk_bf16_f32 v25, v26, v27
	v_cvt_pk_bf16_f32 v26, v28, v29
	v_cvt_pk_bf16_f32 v27, v30, v31
	s_waitcnt lgkmcnt(4)
	s_nop 0
	v_mfma_f32_16x16x32_bf16 v[116:119], v[88:91], v[24:27], v[116:119]
	v_mfma_f32_16x16x32_bf16 v[120:123], v[92:95], v[24:27], v[120:123]
	v_mfma_f32_16x16x32_bf16 v[124:127], v[128:131], v[24:27], v[124:127]
	ds_read_b128 v[88:91], v147 offset:2048
	ds_read_b128 v[92:95], v147 offset:3072
.ament_579:
	v_pk_fma_f32 v[32:33], v[32:33], v[164:165], v[166:167]
	v_pk_fma_f32 v[34:35], v[34:35], v[164:165], v[166:167]
	v_pk_fma_f32 v[36:37], v[36:37], v[164:165], v[166:167]
	v_pk_fma_f32 v[38:39], v[38:39], v[164:165], v[166:167]
	v_exp_f32 v32, v32
	v_exp_f32 v33, v33
	v_exp_f32 v34, v34
	v_exp_f32 v35, v35
	v_exp_f32 v36, v36
	v_exp_f32 v37, v37
	v_exp_f32 v38, v38
	v_exp_f32 v39, v39
	v_cvt_pk_bf16_f32 v32, v32, v33
	v_cvt_pk_bf16_f32 v33, v34, v35
	v_cvt_pk_bf16_f32 v34, v36, v37
	v_cvt_pk_bf16_f32 v35, v38, v39
	s_waitcnt lgkmcnt(4)
	s_nop 0
	v_mfma_f32_16x16x32_bf16 v[116:119], v[96:99], v[32:35], v[116:119]
	v_mfma_f32_16x16x32_bf16 v[120:123], v[100:103], v[32:35], v[120:123]
	v_mfma_f32_16x16x32_bf16 v[124:127], v[128:131], v[32:35], v[124:127]
	ds_read_b128 v[96:99], v148 offset:2048
	ds_read_b128 v[100:103], v148 offset:3072
.ament_578:
	v_pk_fma_f32 v[40:41], v[40:41], v[164:165], v[166:167]
	v_pk_fma_f32 v[42:43], v[42:43], v[164:165], v[166:167]
	v_pk_fma_f32 v[44:45], v[44:45], v[164:165], v[166:167]
	v_pk_fma_f32 v[46:47], v[46:47], v[164:165], v[166:167]
	v_exp_f32 v40, v40
	v_exp_f32 v41, v41
	v_exp_f32 v42, v42
	v_exp_f32 v43, v43
	v_exp_f32 v44, v44
	v_exp_f32 v45, v45
	v_exp_f32 v46, v46
	v_exp_f32 v47, v47
	v_cvt_pk_bf16_f32 v40, v40, v41
	v_cvt_pk_bf16_f32 v41, v42, v43
	v_cvt_pk_bf16_f32 v42, v44, v45
	v_cvt_pk_bf16_f32 v43, v46, v47
	s_waitcnt lgkmcnt(4)
	s_nop 0
	v_mfma_f32_16x16x32_bf16 v[116:119], v[104:107], v[40:43], v[116:119]
	v_mfma_f32_16x16x32_bf16 v[120:123], v[108:111], v[40:43], v[120:123]
	v_mfma_f32_16x16x32_bf16 v[124:127], v[128:131], v[40:43], v[124:127]
	ds_read_b128 v[104:107], v149 offset:2048
	ds_read_b128 v[108:111], v149 offset:3072
.ament_577:
	v_pk_fma_f32 v[48:49], v[48:49], v[164:165], v[166:167]
	v_pk_fma_f32 v[50:51], v[50:51], v[164:165], v[166:167]
	v_pk_fma_f32 v[52:53], v[52:53], v[164:165], v[166:167]
	v_pk_fma_f32 v[54:55], v[54:55], v[164:165], v[166:167]
	v_exp_f32 v48, v48
	v_exp_f32 v49, v49
	v_exp_f32 v50, v50
	v_exp_f32 v51, v51
	v_exp_f32 v52, v52
	v_exp_f32 v53, v53
	v_exp_f32 v54, v54
	v_exp_f32 v55, v55
	v_cvt_pk_bf16_f32 v48, v48, v49
	v_cvt_pk_bf16_f32 v49, v50, v51
	v_cvt_pk_bf16_f32 v50, v52, v53
	v_cvt_pk_bf16_f32 v51, v54, v55
	s_waitcnt lgkmcnt(4)
	s_nop 0
	v_mfma_f32_16x16x32_bf16 v[116:119], v[88:91], v[48:51], v[116:119]
	v_mfma_f32_16x16x32_bf16 v[120:123], v[92:95], v[48:51], v[120:123]
	v_mfma_f32_16x16x32_bf16 v[124:127], v[128:131], v[48:51], v[124:127]
.ament_576:
	v_pk_fma_f32 v[56:57], v[56:57], v[164:165], v[166:167]
	v_pk_fma_f32 v[58:59], v[58:59], v[164:165], v[166:167]
	v_pk_fma_f32 v[60:61], v[60:61], v[164:165], v[166:167]
	v_pk_fma_f32 v[62:63], v[62:63], v[164:165], v[166:167]
	v_exp_f32 v56, v56
	v_exp_f32 v57, v57
	v_exp_f32 v58, v58
	v_exp_f32 v59, v59
	v_exp_f32 v60, v60
	v_exp_f32 v61, v61
	v_exp_f32 v62, v62
	v_exp_f32 v63, v63
	v_cvt_pk_bf16_f32 v56, v56, v57
	v_cvt_pk_bf16_f32 v57, v58, v59
	v_cvt_pk_bf16_f32 v58, v60, v61
	v_cvt_pk_bf16_f32 v59, v62, v63
	s_waitcnt lgkmcnt(2)
	s_nop 0
	v_mfma_f32_16x16x32_bf16 v[116:119], v[96:99], v[56:59], v[116:119]
	v_mfma_f32_16x16x32_bf16 v[120:123], v[100:103], v[56:59], v[120:123]
	v_mfma_f32_16x16x32_bf16 v[124:127], v[128:131], v[56:59], v[124:127]
.ament_575:
	v_pk_fma_f32 v[64:65], v[64:65], v[164:165], v[166:167]
	v_pk_fma_f32 v[66:67], v[66:67], v[164:165], v[166:167]
	v_pk_fma_f32 v[68:69], v[68:69], v[164:165], v[166:167]
	v_pk_fma_f32 v[70:71], v[70:71], v[164:165], v[166:167]
	v_exp_f32 v64, v64
	v_exp_f32 v65, v65
	v_exp_f32 v66, v66
	v_exp_f32 v67, v67
	v_exp_f32 v68, v68
	v_exp_f32 v69, v69
	v_exp_f32 v70, v70
	v_exp_f32 v71, v71
	v_cvt_pk_bf16_f32 v64, v64, v65
	v_cvt_pk_bf16_f32 v65, v66, v67
	v_cvt_pk_bf16_f32 v66, v68, v69
	v_cvt_pk_bf16_f32 v67, v70, v71
	s_waitcnt lgkmcnt(0)
	s_nop 0
	v_mfma_f32_16x16x32_bf16 v[116:119], v[104:107], v[64:67], v[116:119]
	v_mfma_f32_16x16x32_bf16 v[120:123], v[108:111], v[64:67], v[120:123]
	v_mfma_f32_16x16x32_bf16 v[124:127], v[128:131], v[64:67], v[124:127]
	s_nop 7
	v_rcp_f32 v170, v124
	s_nop 0
	v_mul_f32 v116, v116, v170
	v_mul_f32 v120, v120, v170
	v_mul_f32 v117, v117, v170
	v_mul_f32 v121, v121, v170
	v_mul_f32 v118, v118, v170
	v_mul_f32 v122, v122, v170
	v_mul_f32 v119, v119, v170
	v_mul_f32 v123, v123, v170
	v_cvt_pk_bf16_f32 v116, v116, v117
	v_cvt_pk_bf16_f32 v117, v118, v119
	v_cvt_pk_bf16_f32 v120, v120, v121
	v_cvt_pk_bf16_f32 v121, v122, v123
	v_cndmask_b32 v120, v120, v121, s[56:57]
	s_sub_i32 s77, s28, 3
	s_max_i32 s77, s77, 0
	v_cmp_gt_u32 vcc, s77, v173
	s_cbranch_vccz .pck_583
	s_mov_b32 s20, 400000
.pre_584:
	buffer_load_dword v173, v172, s[4:7], 0 offen sc1
	s_waitcnt vmcnt(0)
	v_cmp_gt_u32 vcc, s77, v173
	s_cbranch_vccz .pok_585
	s_sub_u32 s20, s20, 1
	s_cmp_lg_u32 s20, 0
	s_cbranch_scc1 .pre_584
	s_branch L_FAIL
.pok_585:
.pck_583:
	s_add_u32 s17, s58, s78
	s_add_u32 s18, s59, s78
	buffer_store_dwordx2 v[116:117], v161, s[4:7], s17 offen sc1
	s_mov_b64 exec, s[54:55]
	buffer_store_dword v120, v162, s[4:7], s18 offen sc1
	s_mov_b64 exec, -1
	buffer_load_dword v155, v154, s[4:7], 0 offen sc1
	s_add_u32 s68, s68, 8192
	s_cmp_eq_u32 s68, 81920
	s_cselect_b32 s68, 0, s68
	s_add_u32 s69, s69, 8192
	s_cmp_eq_u32 s69, 81920
	s_cselect_b32 s69, 0, s69
	s_add_u32 s70, s70, 8192
	s_cmp_eq_u32 s70, 81920
	s_cselect_b32 s70, 0, s70
	s_add_u32 s71, s71, 8192
	s_cmp_eq_u32 s71, 81920
	s_cselect_b32 s71, 0, s71
	s_add_u32 s72, s72, 8192
	s_cmp_eq_u32 s72, 81920
	s_cselect_b32 s72, 0, s72
	s_add_u32 s73, s73, 8192
	s_cmp_eq_u32 s73, 81920
	s_cselect_b32 s73, 0, s73
	s_add_u32 s74, s74, 8192
	s_cmp_eq_u32 s74, 81920
	s_cselect_b32 s74, 0, s74
	s_add_u32 s75, s75, 8192
	s_cmp_eq_u32 s75, 81920
	s_cselect_b32 s75, 0, s75
	s_add_u32 s76, s76, 8192
	s_cmp_eq_u32 s76, 81920
	s_cselect_b32 s76, 0, s76
	s_add_u32 s28, s28, 1
	s_waitcnt vmcnt(0)
	v_mov_b32 v157, s28
	s_mov_b64 exec, 1
	buffer_store_dword v157, v156, s[4:7], s30 offen sc1
	s_mov_b64 exec, -1
	s_cmp_ge_u32 s28, 64
	s_cbranch_scc1 L_END
	s_add_u32 s37, s28, 1
	v_cmp_gt_u32 vcc, s37, v155
	s_cbranch_vccz .pck_586
	s_mov_b32 s20, 400000
.pre_587:
	buffer_load_dword v155, v154, s[4:7], 0 offen sc1
	s_waitcnt vmcnt(0)
	v_cmp_gt_u32 vcc, s37, v155
	s_cbranch_vccz .pok_588
	s_sub_u32 s20, s20, 1
	s_cmp_lg_u32 s20, 0
	s_cbranch_scc1 .pre_587
	s_branch L_FAIL
.pok_588:
.pck_586:
	s_branch .aloop_543
.p2align 6
L_A3:
	v_and_b32 v79, 63, v0
	v_mov_b32 v75, v0
	v_and_b32 v78, 15, v79
	v_lshrrev_b32 v77, 4, v79
	v_and_b32 v76, 7, v79
	s_mul_i32 s38, s26, 12
	s_mul_i32 s17, s15, 3
	s_add_u32 s38, s38, s17
	s_lshl_b32 s39, s38, 5
	v_lshrrev_b32 v70, 1, v79
	v_lshrrev_b32 v71, 4, v70
	v_and_b32 v72, 15, v70
	v_mul_u32_u24 v73, 18, v71
	v_add_u32 v73, v73, v72
	v_mul_u32_u24 v68, 1152, v73
	v_mul_u32_u24 v73, 144, v71
	v_lshrrev_b32 v71, 1, v72
	v_mul_u32_u24 v71, 18, v71
	v_add_u32 v73, v73, v71
	v_and_b32 v71, 1, v72
	v_add_u32 v73, v73, v71
	v_add_u32 v73, 16, v73
	v_mul_u32_u24 v69, 1152, v73
	v_and_b32 v72, 1, v79
	v_lshlrev_b32 v72, 4, v72
	v_add_u32 v68, v68, v72
	v_add_u32 v69, v69, v72
	s_load_dwordx2 s[22:23], s[0:1], 16
	s_waitcnt lgkmcnt(0)
	s_mov_b32 s8, s22
	s_and_b32 s9, s23, 0xffff
	s_mov_b32 s10, 0xa2000
	s_mov_b32 s11, 0x00020000
	v_lshrrev_b32 v72, 2, v78
	v_lshlrev_b32 v73, 2, v77
	v_add_u32 v72, v72, v73
	v_lshlrev_b32 v72, 5, v72
	v_and_b32 v73, 3, v78
	v_lshlrev_b32 v73, 3, v73
	v_add_u32 v72, v72, v73
	s_mul_i32 s17, s15, 36864
	v_add_u32 v70, s17, v72
	s_mul_i32 s63, s15, 36864
	s_add_u32 s62, s39, 0
	s_mov_b32 m0, s63
	s_nop 0
	buffer_load_dwordx4 v68, s[8:11], s62 offen lds
	s_mul_i32 s63, s15, 36864
	s_add_u32 s63, s63, 1024
	s_add_u32 s62, s39, 32
	s_mov_b32 m0, s63
	s_nop 0
	buffer_load_dwordx4 v68, s[8:11], s62 offen lds
	s_mul_i32 s63, s15, 36864
	s_add_u32 s63, s63, 2048
	s_add_u32 s62, s39, 64
	s_mov_b32 m0, s63
	s_nop 0
	buffer_load_dwordx4 v68, s[8:11], s62 offen lds
	s_mul_i32 s63, s15, 36864
	s_add_u32 s63, s63, 3072
	s_add_u32 s62, s39, 41472
	s_mov_b32 m0, s63
	s_nop 0
	buffer_load_dwordx4 v68, s[8:11], s62 offen lds
	s_mul_i32 s63, s15, 36864
	s_add_u32 s63, s63, 4096
	s_add_u32 s62, s39, 41504
	s_mov_b32 m0, s63
	s_nop 0
	buffer_load_dwordx4 v68, s[8:11], s62 offen lds
	s_mul_i32 s63, s15, 36864
	s_add_u32 s63, s63, 5120
	s_add_u32 s62, s39, 41536
	s_mov_b32 m0, s63
	s_nop 0
	buffer_load_dwordx4 v68, s[8:11], s62 offen lds
	s_mul_i32 s63, s15, 36864
	s_add_u32 s63, s63, 6144
	s_add_u32 s62, s39, 82944
	s_mov_b32 m0, s63
	s_nop 0
	buffer_load_dwordx4 v68, s[8:11], s62 offen lds
	s_mul_i32 s63, s15, 36864
	s_add_u32 s63, s63, 7168
	s_add_u32 s62, s39, 82976
	s_mov_b32 m0, s63
	s_nop 0
	buffer_load_dwordx4 v68, s[8:11], s62 offen lds
	s_mul_i32 s63, s15, 36864
	s_add_u32 s63, s63, 8192
	s_add_u32 s62, s39, 83008
	s_mov_b32 m0, s63
	s_nop 0
	buffer_load_dwordx4 v68, s[8:11], s62 offen lds
	s_mul_i32 s63, s15, 36864
	s_add_u32 s63, s63, 9216
	s_add_u32 s62, s39, 124416
	s_mov_b32 m0, s63
	s_nop 0
	buffer_load_dwordx4 v68, s[8:11], s62 offen lds
	s_mul_i32 s63, s15, 36864
	s_add_u32 s63, s63, 10240
	s_add_u32 s62, s39, 124448
	s_mov_b32 m0, s63
	s_nop 0
	buffer_load_dwordx4 v68, s[8:11], s62 offen lds
	s_mul_i32 s63, s15, 36864
	s_add_u32 s63, s63, 11264
	s_add_u32 s62, s39, 124480
	s_mov_b32 m0, s63
	s_nop 0
	buffer_load_dwordx4 v68, s[8:11], s62 offen lds
	s_mul_i32 s63, s15, 36864
	s_add_u32 s63, s63, 12288
	s_add_u32 s62, s39, 165888
	s_mov_b32 m0, s63
	s_nop 0
	buffer_load_dwordx4 v68, s[8:11], s62 offen lds
	s_mul_i32 s63, s15, 36864
	s_add_u32 s63, s63, 13312
	s_add_u32 s62, s39, 165920
	s_mov_b32 m0, s63
	s_nop 0
	buffer_load_dwordx4 v68, s[8:11], s62 offen lds
	s_mul_i32 s63, s15, 36864
	s_add_u32 s63, s63, 14336
	s_add_u32 s62, s39, 165952
	s_mov_b32 m0, s63
	s_nop 0
	buffer_load_dwordx4 v68, s[8:11], s62 offen lds
	s_mul_i32 s63, s15, 36864
	s_add_u32 s63, s63, 15360
	s_add_u32 s62, s39, 207360
	s_mov_b32 m0, s63
	s_nop 0
	buffer_load_dwordx4 v68, s[8:11], s62 offen lds
	s_mul_i32 s63, s15, 36864
	s_add_u32 s63, s63, 16384
	s_add_u32 s62, s39, 207392
	s_mov_b32 m0, s63
	s_nop 0
	buffer_load_dwordx4 v68, s[8:11], s62 offen lds
	s_mul_i32 s63, s15, 36864
	s_add_u32 s63, s63, 17408
	s_add_u32 s62, s39, 207424
	s_mov_b32 m0, s63
	s_nop 0
	buffer_load_dwordx4 v68, s[8:11], s62 offen lds
	s_mul_i32 s63, s15, 36864
	s_add_u32 s63, s63, 18432
	s_add_u32 s62, s39, 248832
	s_mov_b32 m0, s63
	s_nop 0
	buffer_load_dwordx4 v68, s[8:11], s62 offen lds
	s_mul_i32 s63, s15, 36864
	s_add_u32 s63, s63, 19456
	s_add_u32 s62, s39, 248864
	s_mov_b32 m0, s63
	s_nop 0
	buffer_load_dwordx4 v68, s[8:11], s62 offen lds
	s_mul_i32 s63, s15, 36864
	s_add_u32 s63, s63, 20480
	s_add_u32 s62, s39, 248896
	s_mov_b32 m0, s63
	s_nop 0
	buffer_load_dwordx4 v68, s[8:11], s62 offen lds
	s_mul_i32 s63, s15, 36864
	s_add_u32 s63, s63, 21504
	s_add_u32 s62, s39, 290304
	s_mov_b32 m0, s63
	s_nop 0
	buffer_load_dwordx4 v68, s[8:11], s62 offen lds
	s_mul_i32 s63, s15, 36864
	s_add_u32 s63, s63, 22528
	s_add_u32 s62, s39, 290336
	s_mov_b32 m0, s63
	s_nop 0
	buffer_load_dwordx4 v68, s[8:11], s62 offen lds
	s_mul_i32 s63, s15, 36864
	s_add_u32 s63, s63, 23552
	s_add_u32 s62, s39, 290368
	s_mov_b32 m0, s63
	s_nop 0
	buffer_load_dwordx4 v68, s[8:11], s62 offen lds
	s_mul_i32 s63, s15, 36864
	s_add_u32 s63, s63, 24576
	s_add_u32 s62, s39, 331776
	s_mov_b32 m0, s63
	s_nop 0
	buffer_load_dwordx4 v68, s[8:11], s62 offen lds
	s_mul_i32 s63, s15, 36864
	s_add_u32 s63, s63, 25600
	s_add_u32 s62, s39, 331808
	s_mov_b32 m0, s63
	s_nop 0
	buffer_load_dwordx4 v68, s[8:11], s62 offen lds
	s_mul_i32 s63, s15, 36864
	s_add_u32 s63, s63, 26624
	s_add_u32 s62, s39, 331840
	s_mov_b32 m0, s63
	s_nop 0
	buffer_load_dwordx4 v68, s[8:11], s62 offen lds
	s_waitcnt vmcnt(0)
	ds_read_b64_tr_b16 a[0:1], v70 offset:0
	ds_read_b64_tr_b16 a[2:3], v70 offset:512
	ds_read_b64_tr_b16 a[72:73], v70 offset:1024
	ds_read_b64_tr_b16 a[74:75], v70 offset:1536
	ds_read_b64_tr_b16 a[144:145], v70 offset:2048
	ds_read_b64_tr_b16 a[146:147], v70 offset:2560
	ds_read_b64_tr_b16 a[4:5], v70 offset:3072
	ds_read_b64_tr_b16 a[6:7], v70 offset:3584
	s_waitcnt lgkmcnt(8)
	ds_read_b64_tr_b16 a[76:77], v70 offset:4096
	ds_read_b64_tr_b16 a[78:79], v70 offset:4608
	ds_read_b64_tr_b16 a[148:149], v70 offset:5120
	ds_read_b64_tr_b16 a[150:151], v70 offset:5632
	ds_read_b64_tr_b16 a[8:9], v70 offset:6144
	ds_read_b64_tr_b16 a[10:11], v70 offset:6656
	ds_read_b64_tr_b16 a[80:81], v70 offset:7168
	ds_read_b64_tr_b16 a[82:83], v70 offset:7680
	s_waitcnt lgkmcnt(8)
	ds_read_b64_tr_b16 a[152:153], v70 offset:8192
	ds_read_b64_tr_b16 a[154:155], v70 offset:8704
	ds_read_b64_tr_b16 a[12:13], v70 offset:9216
	ds_read_b64_tr_b16 a[14:15], v70 offset:9728
	ds_read_b64_tr_b16 a[84:85], v70 offset:10240
	ds_read_b64_tr_b16 a[86:87], v70 offset:10752
	ds_read_b64_tr_b16 a[156:157], v70 offset:11264
	ds_read_b64_tr_b16 a[158:159], v70 offset:11776
	s_waitcnt lgkmcnt(8)
	ds_read_b64_tr_b16 a[16:17], v70 offset:12288
	ds_read_b64_tr_b16 a[18:19], v70 offset:12800
	ds_read_b64_tr_b16 a[88:89], v70 offset:13312
	ds_read_b64_tr_b16 a[90:91], v70 offset:13824
	ds_read_b64_tr_b16 a[160:161], v70 offset:14336
	ds_read_b64_tr_b16 a[162:163], v70 offset:14848
	ds_read_b64_tr_b16 a[20:21], v70 offset:15360
	ds_read_b64_tr_b16 a[22:23], v70 offset:15872
	s_waitcnt lgkmcnt(8)
	ds_read_b64_tr_b16 a[92:93], v70 offset:16384
	ds_read_b64_tr_b16 a[94:95], v70 offset:16896
	ds_read_b64_tr_b16 a[164:165], v70 offset:17408
	ds_read_b64_tr_b16 a[166:167], v70 offset:17920
	ds_read_b64_tr_b16 a[24:25], v70 offset:18432
	ds_read_b64_tr_b16 a[26:27], v70 offset:18944
	ds_read_b64_tr_b16 a[96:97], v70 offset:19456
	ds_read_b64_tr_b16 a[98:99], v70 offset:19968
	s_waitcnt lgkmcnt(8)
	ds_read_b64_tr_b16 a[168:169], v70 offset:20480
	ds_read_b64_tr_b16 a[170:171], v70 offset:20992
	ds_read_b64_tr_b16 a[28:29], v70 offset:21504
	ds_read_b64_tr_b16 a[30:31], v70 offset:22016
	ds_read_b64_tr_b16 a[100:101], v70 offset:22528
	ds_read_b64_tr_b16 a[102:103], v70 offset:23040
	ds_read_b64_tr_b16 a[172:173], v70 offset:23552
	ds_read_b64_tr_b16 a[174:175], v70 offset:24064
	s_waitcnt lgkmcnt(8)
	ds_read_b64_tr_b16 a[32:33], v70 offset:24576
	ds_read_b64_tr_b16 a[34:35], v70 offset:25088
	ds_read_b64_tr_b16 a[104:105], v70 offset:25600
	ds_read_b64_tr_b16 a[106:107], v70 offset:26112
	ds_read_b64_tr_b16 a[176:177], v70 offset:26624
	ds_read_b64_tr_b16 a[178:179], v70 offset:27136
	s_waitcnt lgkmcnt(0)
	s_mul_i32 s63, s15, 36864
	s_add_u32 s62, s39, 373248
	s_mov_b32 m0, s63
	s_nop 0
	buffer_load_dwordx4 v68, s[8:11], s62 offen lds
	s_mul_i32 s63, s15, 36864
	s_add_u32 s63, s63, 1024
	s_add_u32 s62, s39, 373280
	s_mov_b32 m0, s63
	s_nop 0
	buffer_load_dwordx4 v68, s[8:11], s62 offen lds
	s_mul_i32 s63, s15, 36864
	s_add_u32 s63, s63, 2048
	s_add_u32 s62, s39, 373312
	s_mov_b32 m0, s63
	s_nop 0
	buffer_load_dwordx4 v68, s[8:11], s62 offen lds
	s_mul_i32 s63, s15, 36864
	s_add_u32 s63, s63, 3072
	s_add_u32 s62, s39, 414720
	s_mov_b32 m0, s63
	s_nop 0
	buffer_load_dwordx4 v68, s[8:11], s62 offen lds
	s_mul_i32 s63, s15, 36864
	s_add_u32 s63, s63, 4096
	s_add_u32 s62, s39, 414752
	s_mov_b32 m0, s63
	s_nop 0
	buffer_load_dwordx4 v68, s[8:11], s62 offen lds
	s_mul_i32 s63, s15, 36864
	s_add_u32 s63, s63, 5120
	s_add_u32 s62, s39, 414784
	s_mov_b32 m0, s63
	s_nop 0
	buffer_load_dwordx4 v68, s[8:11], s62 offen lds
	s_mul_i32 s63, s15, 36864
	s_add_u32 s63, s63, 6144
	s_add_u32 s62, s39, 456192
	s_mov_b32 m0, s63
	s_nop 0
	buffer_load_dwordx4 v68, s[8:11], s62 offen lds
	s_mul_i32 s63, s15, 36864
	s_add_u32 s63, s63, 7168
	s_add_u32 s62, s39, 456224
	s_mov_b32 m0, s63
	s_nop 0
	buffer_load_dwordx4 v68, s[8:11], s62 offen lds
	s_mul_i32 s63, s15, 36864
	s_add_u32 s63, s63, 8192
	s_add_u32 s62, s39, 456256
	s_mov_b32 m0, s63
	s_nop 0
	buffer_load_dwordx4 v68, s[8:11], s62 offen lds
	s_mul_i32 s63, s15, 36864
	s_add_u32 s63, s63, 9216
	s_add_u32 s62, s39, 497664
	s_mov_b32 m0, s63
	s_nop 0
	buffer_load_dwordx4 v68, s[8:11], s62 offen lds
	s_mul_i32 s63, s15, 36864
	s_add_u32 s63, s63, 10240
	s_add_u32 s62, s39, 497696
	s_mov_b32 m0, s63
	s_nop 0
	buffer_load_dwordx4 v68, s[8:11], s62 offen lds
	s_mul_i32 s63, s15, 36864
	s_add_u32 s63, s63, 11264
	s_add_u32 s62, s39, 497728
	s_mov_b32 m0, s63
	s_nop 0
	buffer_load_dwordx4 v68, s[8:11], s62 offen lds
	s_mul_i32 s63, s15, 36864
	s_add_u32 s63, s63, 12288
	s_add_u32 s62, s39, 539136
	s_mov_b32 m0, s63
	s_nop 0
	buffer_load_dwordx4 v68, s[8:11], s62 offen lds
	s_mul_i32 s63, s15, 36864
	s_add_u32 s63, s63, 13312
	s_add_u32 s62, s39, 539168
	s_mov_b32 m0, s63
	s_nop 0
	buffer_load_dwordx4 v68, s[8:11], s62 offen lds
	s_mul_i32 s63, s15, 36864
	s_add_u32 s63, s63, 14336
	s_add_u32 s62, s39, 539200
	s_mov_b32 m0, s63
	s_nop 0
	buffer_load_dwordx4 v68, s[8:11], s62 offen lds
	s_mul_i32 s63, s15, 36864
	s_add_u32 s63, s63, 15360
	s_add_u32 s62, s39, 580608
	s_mov_b32 m0, s63
	s_nop 0
	buffer_load_dwordx4 v68, s[8:11], s62 offen lds
	s_mul_i32 s63, s15, 36864
	s_add_u32 s63, s63, 16384
	s_add_u32 s62, s39, 580640
	s_mov_b32 m0, s63
	s_nop 0
	buffer_load_dwordx4 v68, s[8:11], s62 offen lds
	s_mul_i32 s63, s15, 36864
	s_add_u32 s63, s63, 17408
	s_add_u32 s62, s39, 580672
	s_mov_b32 m0, s63
	s_nop 0
	buffer_load_dwordx4 v68, s[8:11], s62 offen lds
	s_mul_i32 s63, s15, 36864
	s_add_u32 s63, s63, 18432
	s_add_u32 s62, s39, 622080
	s_mov_b32 m0, s63
	s_nop 0
	buffer_load_dwordx4 v68, s[8:11], s62 offen lds
	s_mul_i32 s63, s15, 36864
	s_add_u32 s63, s63, 19456
	s_add_u32 s62, s39, 622112
	s_mov_b32 m0, s63
	s_nop 0
	buffer_load_dwordx4 v68, s[8:11], s62 offen lds
	s_mul_i32 s63, s15, 36864
	s_add_u32 s63, s63, 20480
	s_add_u32 s62, s39, 622144
	s_mov_b32 m0, s63
	s_nop 0
	buffer_load_dwordx4 v68, s[8:11], s62 offen lds
	s_mul_i32 s63, s15, 36864
	s_add_u32 s63, s63, 21504
	s_add_u32 s62, s39, 0
	s_mov_b32 m0, s63
	s_nop 0
	buffer_load_dwordx4 v69, s[8:11], s62 offen lds
	s_mul_i32 s63, s15, 36864
	s_add_u32 s63, s63, 22528
	s_add_u32 s62, s39, 32
	s_mov_b32 m0, s63
	s_nop 0
	buffer_load_dwordx4 v69, s[8:11], s62 offen lds
	s_mul_i32 s63, s15, 36864
	s_add_u32 s63, s63, 23552
	s_add_u32 s62, s39, 64
	s_mov_b32 m0, s63
	s_nop 0
	buffer_load_dwordx4 v69, s[8:11], s62 offen lds
	s_mul_i32 s63, s15, 36864
	s_add_u32 s63, s63, 24576
	s_add_u32 s62, s39, 331776
	s_mov_b32 m0, s63
	s_nop 0
	buffer_load_dwordx4 v69, s[8:11], s62 offen lds
	s_mul_i32 s63, s15, 36864
	s_add_u32 s63, s63, 25600
	s_add_u32 s62, s39, 331808
	s_mov_b32 m0, s63
	s_nop 0
	buffer_load_dwordx4 v69, s[8:11], s62 offen lds
	s_mul_i32 s63, s15, 36864
	s_add_u32 s63, s63, 26624
	s_add_u32 s62, s39, 331840
	s_mov_b32 m0, s63
	s_nop 0
	buffer_load_dwordx4 v69, s[8:11], s62 offen lds
	s_waitcnt vmcnt(0)
	ds_read_b64_tr_b16 a[36:37], v70 offset:0
	ds_read_b64_tr_b16 a[38:39], v70 offset:512
	ds_read_b64_tr_b16 a[108:109], v70 offset:1024
	ds_read_b64_tr_b16 a[110:111], v70 offset:1536
	ds_read_b64_tr_b16 a[180:181], v70 offset:2048
	ds_read_b64_tr_b16 a[182:183], v70 offset:2560
	ds_read_b64_tr_b16 a[40:41], v70 offset:3072
	ds_read_b64_tr_b16 a[42:43], v70 offset:3584
	s_waitcnt lgkmcnt(8)
	ds_read_b64_tr_b16 a[112:113], v70 offset:4096
	ds_read_b64_tr_b16 a[114:115], v70 offset:4608
	ds_read_b64_tr_b16 a[184:185], v70 offset:5120
	ds_read_b64_tr_b16 a[186:187], v70 offset:5632
	ds_read_b64_tr_b16 a[44:45], v70 offset:6144
	ds_read_b64_tr_b16 a[46:47], v70 offset:6656
	ds_read_b64_tr_b16 a[116:117], v70 offset:7168
	ds_read_b64_tr_b16 a[118:119], v70 offset:7680
	s_waitcnt lgkmcnt(8)
	ds_read_b64_tr_b16 a[188:189], v70 offset:8192
	ds_read_b64_tr_b16 a[190:191], v70 offset:8704
	ds_read_b64_tr_b16 a[48:49], v70 offset:9216
	ds_read_b64_tr_b16 a[50:51], v70 offset:9728
	ds_read_b64_tr_b16 a[120:121], v70 offset:10240
	ds_read_b64_tr_b16 a[122:123], v70 offset:10752
	ds_read_b64_tr_b16 a[192:193], v70 offset:11264
	ds_read_b64_tr_b16 a[194:195], v70 offset:11776
	s_waitcnt lgkmcnt(8)
	ds_read_b64_tr_b16 a[52:53], v70 offset:12288
	ds_read_b64_tr_b16 a[54:55], v70 offset:12800
	ds_read_b64_tr_b16 a[124:125], v70 offset:13312
	ds_read_b64_tr_b16 a[126:127], v70 offset:13824
	ds_read_b64_tr_b16 a[196:197], v70 offset:14336
	ds_read_b64_tr_b16 a[198:199], v70 offset:14848
	ds_read_b64_tr_b16 a[56:57], v70 offset:15360
	ds_read_b64_tr_b16 a[58:59], v70 offset:15872
	s_waitcnt lgkmcnt(8)
	ds_read_b64_tr_b16 a[128:129], v70 offset:16384
	ds_read_b64_tr_b16 a[130:131], v70 offset:16896
	ds_read_b64_tr_b16 a[200:201], v70 offset:17408
	ds_read_b64_tr_b16 a[202:203], v70 offset:17920
	ds_read_b64_tr_b16 a[60:61], v70 offset:18432
	ds_read_b64_tr_b16 a[62:63], v70 offset:18944
	ds_read_b64_tr_b16 a[132:133], v70 offset:19456
	ds_read_b64_tr_b16 a[134:135], v70 offset:19968
	s_waitcnt lgkmcnt(8)
	ds_read_b64_tr_b16 a[204:205], v70 offset:20480
	ds_read_b64_tr_b16 a[206:207], v70 offset:20992
	ds_read_b64_tr_b16 a[64:65], v70 offset:21504
	ds_read_b64_tr_b16 a[66:67], v70 offset:22016
	ds_read_b64_tr_b16 a[136:137], v70 offset:22528
	ds_read_b64_tr_b16 a[138:139], v70 offset:23040
	ds_read_b64_tr_b16 a[208:209], v70 offset:23552
	ds_read_b64_tr_b16 a[210:211], v70 offset:24064
	s_waitcnt lgkmcnt(8)
	ds_read_b64_tr_b16 a[68:69], v70 offset:24576
	ds_read_b64_tr_b16 a[70:71], v70 offset:25088
	ds_read_b64_tr_b16 a[140:141], v70 offset:25600
	ds_read_b64_tr_b16 a[142:143], v70 offset:26112
	ds_read_b64_tr_b16 a[212:213], v70 offset:26624
	ds_read_b64_tr_b16 a[214:215], v70 offset:27136
	s_waitcnt lgkmcnt(0)
	s_barrier
	v_lshlrev_b32 v60, 4, v79
	v_mov_b32 v64, 0
	s_mul_i32 s19, s27, 0x40
	s_add_u32 s19, s19, 0x8d
	v_min_u32 v62, 63, v79
	v_lshrrev_b32 v74, 2, v62
	v_add_u32 v74, s19, v74
	v_lshlrev_b32 v74, 7, v74
	v_and_b32 v62, 3, v62
	v_lshlrev_b32 v62, 2, v62
	v_add_u32 v62, v62, v74
	s_mul_i32 s19, s27, 0x40
	s_add_u32 s19, s19, 0x80
	v_min_u32 v67, 15, v79
	v_lshrrev_b32 v74, 2, v67
	v_add_u32 v74, s19, v74
	v_lshlrev_b32 v74, 7, v74
	v_and_b32 v67, 3, v67
	v_lshlrev_b32 v67, 2, v67
	v_add_u32 v67, v67, v74
	s_lshl_b32 s30, s14, 7
	s_lshl_b32 s17, s15, 2
	s_add_u32 s30, s30, s17
	v_lshrrev_b32 v72, 3, v78
	v_mul_u32_u24 v72, 18432, v72
	v_lshlrev_b32 v73, 7, v77
	v_add_u32 v72, v72, v73
	v_lshlrev_b32 v73, 4, v76
	v_add_u32 v66, v72, v73
	s_mul_i32 s31, s27, 0x240000
	s_add_u32 s31, s31, 0x9400000
	s_mul_i32 s34, s27, 0x480000
	s_add_u32 s34, s34, 0x9880000
	s_lshl_b32 s17, s38, 9
	s_add_u32 s34, s34, s17
	v_mov_b32 v74, 0
	s_mov_b32 s20, 400000
	v_and_b32 v72, 7, v79
	v_lshrrev_b32 v73, 2, v72
	v_mul_u32_u24 v73, 112, v73
	v_lshlrev_b32 v72, 2, v72
	v_add_u32 v72, v72, v73
	s_getpc_b64 s[18:19]
.ct_592:
	s_sub_u32 s18, s18, .ct_592-L_A3
	s_subb_u32 s19, s19, 0
	v_lshlrev_b32 v74, 7, v79
	s_lshl_b32 s17, s15, 13
	v_add_u32 v74, s17, v74
	s_mov_b32 s17, L_A3_CE-L_A3-4
	v_min_u32 v74, s17, v74
	global_load_dword v73, v74, s[18:19]
	v_mov_b32 v74, 0
.gbre_589:
	global_load_dword v73, v72, s[12:13] offset:16 sc1
	s_waitcnt vmcnt(0)
	v_readlane_b32 s17, v73, 0
	v_readlane_b32 s18, v73, 1
	s_nop 0
	s_add_u32 s17, s17, s18
	v_readlane_b32 s18, v73, 2
	s_nop 0
	s_add_u32 s17, s17, s18
	v_readlane_b32 s18, v73, 3
	s_nop 0
	s_add_u32 s17, s17, s18
	v_readlane_b32 s18, v73, 4
	s_nop 0
	s_add_u32 s17, s17, s18
	v_readlane_b32 s18, v73, 5
	s_nop 0
	s_add_u32 s17, s17, s18
	v_readlane_b32 s18, v73, 6
	s_nop 0
	s_add_u32 s17, s17, s18
	v_readlane_b32 s18, v73, 7
	s_nop 0
	s_add_u32 s17, s17, s18
	s_cmp_ge_u32 s17, 256
	s_cbranch_scc1 .gbok_590
	s_sub_u32 s20, s20, 1
	s_cmp_lg_u32 s20, 0
	s_cbranch_scc1 .gbre_589
	s_branch L_FAIL
.gbok_590:
	v_cmp_ne_u32 vcc, 32, v73
	s_cbranch_vccnz L_A3_DEV
	s_mul_i32 s17, s15, 9216
	s_add_u32 s31, s31, s17
	s_mov_b32 s32, s17
	s_lshl_b32 s44, s17, 1
	s_add_u32 s44, s44, 36864
	s_mov_b32 s33, 0
	s_mov_b32 s28, 0
	s_mov_b32 s29, 0
	s_mov_b32 s54, s31
	s_mov_b32 s56, 0
	s_mov_b32 s55, s34
.gloop_593:
	s_cmp_lg_u32 s29, 0
	s_cbranch_scc1 .gpref_594
	s_add_u32 s37, s28, 1
	s_mov_b32 s20, 400000
.pre_596:
	buffer_load_dword v63, v62, s[4:7], 0 offen sc1
	s_waitcnt vmcnt(0)
	v_cmp_gt_u32 vcc, s37, v63
	s_cbranch_vccz .pok_597
	s_sub_u32 s20, s20, 1
	s_cmp_lg_u32 s20, 0
	s_cbranch_scc1 .pre_596
	s_branch L_FAIL
.pok_597:
	s_and_b32 s31, s56, 3
	s_mul_i32 s31, s31, 36864
	s_add_u32 s31, s31, s54
	s_add_u32 s56, s56, 1
	s_add_u32 s17, s32, 0
	s_mov_b32 m0, s17
	s_add_u32 s18, s31, 0
	buffer_load_dwordx4 v60, s[4:7], s18 offen offset:0 sc1 lds
	buffer_load_dwordx4 v60, s[4:7], s18 offen offset:1024 sc1 lds
	buffer_load_dwordx4 v60, s[4:7], s18 offen offset:2048 sc1 lds
	buffer_load_dwordx4 v60, s[4:7], s18 offen offset:3072 sc1 lds
	s_add_u32 s17, s32, 4096
	s_mov_b32 m0, s17
	s_add_u32 s18, s31, 4096
	buffer_load_dwordx4 v60, s[4:7], s18 offen offset:0 sc1 lds
	buffer_load_dwordx4 v60, s[4:7], s18 offen offset:1024 sc1 lds
	buffer_load_dwordx4 v60, s[4:7], s18 offen offset:2048 sc1 lds
	buffer_load_dwordx4 v60, s[4:7], s18 offen offset:3072 sc1 lds
	s_add_u32 s17, s32, 8192
	s_mov_b32 m0, s17
	s_add_u32 s18, s31, 8192
	buffer_load_dwordx4 v60, s[4:7], s18 offen offset:0 sc1 lds
	s_sub_u32 s32, s44, s32
	s_waitcnt vmcnt(0)
	s_branch .ggo_595
.gpref_594:
	s_waitcnt vmcnt(6)
.ggo_595:
	s_barrier
	s_mov_b32 s29, 0
	v_add_u32 v61, s33, v60
	s_sub_u32 s33, 36864, s33
	buffer_load_dword v63, v62, s[4:7], 0 offen sc1
	buffer_load_dword v68, v67, s[4:7], 0 offen sc1
	ds_read_b128 v[24:27], v61 offset:0
	ds_read_b128 v[28:31], v61 offset:18432
	ds_read_b128 v[32:35], v61 offset:1024
	ds_read_b128 v[36:39], v61 offset:19456
	ds_read_b128 v[40:43], v61 offset:2048
	ds_read_b128 v[44:47], v61 offset:20480
	s_waitcnt lgkmcnt(4)
	v_mfma_f32_16x16x32_bf16 v[0:3], a[0:3], v[24:27], 0
	v_mfma_f32_16x16x32_bf16 v[4:7], a[0:3], v[28:31], 0
	v_mfma_f32_16x16x32_bf16 v[8:11], a[72:75], v[24:27], 0
	v_mfma_f32_16x16x32_bf16 v[12:15], a[72:75], v[28:31], 0
	v_mfma_f32_16x16x32_bf16 v[16:19], a[144:147], v[24:27], 0
	v_mfma_f32_16x16x32_bf16 v[20:23], a[144:147], v[28:31], 0
	ds_read_b128 v[24:27], v61 offset:3072
	ds_read_b128 v[28:31], v61 offset:21504
	s_waitcnt lgkmcnt(4)
	v_mfma_f32_16x16x32_bf16 v[0:3], a[4:7], v[32:35], v[0:3]
	v_mfma_f32_16x16x32_bf16 v[4:7], a[4:7], v[36:39], v[4:7]
	v_mfma_f32_16x16x32_bf16 v[8:11], a[76:79], v[32:35], v[8:11]
	v_mfma_f32_16x16x32_bf16 v[12:15], a[76:79], v[36:39], v[12:15]
	v_mfma_f32_16x16x32_bf16 v[16:19], a[148:151], v[32:35], v[16:19]
	v_mfma_f32_16x16x32_bf16 v[20:23], a[148:151], v[36:39], v[20:23]
	ds_read_b128 v[32:35], v61 offset:4096
	ds_read_b128 v[36:39], v61 offset:22528
	s_waitcnt lgkmcnt(4)
	v_mfma_f32_16x16x32_bf16 v[0:3], a[8:11], v[40:43], v[0:3]
	v_mfma_f32_16x16x32_bf16 v[4:7], a[8:11], v[44:47], v[4:7]
	v_mfma_f32_16x16x32_bf16 v[8:11], a[80:83], v[40:43], v[8:11]
	v_mfma_f32_16x16x32_bf16 v[12:15], a[80:83], v[44:47], v[12:15]
	v_mfma_f32_16x16x32_bf16 v[16:19], a[152:155], v[40:43], v[16:19]
	v_mfma_f32_16x16x32_bf16 v[20:23], a[152:155], v[44:47], v[20:23]
	ds_read_b128 v[40:43], v61 offset:5120
	ds_read_b128 v[44:47], v61 offset:23552
	s_waitcnt lgkmcnt(4)
	v_mfma_f32_16x16x32_bf16 v[0:3], a[12:15], v[24:27], v[0:3]
	v_mfma_f32_16x16x32_bf16 v[4:7], a[12:15], v[28:31], v[4:7]
	v_mfma_f32_16x16x32_bf16 v[8:11], a[84:87], v[24:27], v[8:11]
	v_mfma_f32_16x16x32_bf16 v[12:15], a[84:87], v[28:31], v[12:15]
	v_mfma_f32_16x16x32_bf16 v[16:19], a[156:159], v[24:27], v[16:19]
	v_mfma_f32_16x16x32_bf16 v[20:23], a[156:159], v[28:31], v[20:23]
	ds_read_b128 v[24:27], v61 offset:6144
	ds_read_b128 v[28:31], v61 offset:24576
	s_waitcnt lgkmcnt(4)
	v_mfma_f32_16x16x32_bf16 v[0:3], a[16:19], v[32:35], v[0:3]
	v_mfma_f32_16x16x32_bf16 v[4:7], a[16:19], v[36:39], v[4:7]
	v_mfma_f32_16x16x32_bf16 v[8:11], a[88:91], v[32:35], v[8:11]
	v_mfma_f32_16x16x32_bf16 v[12:15], a[88:91], v[36:39], v[12:15]
	v_mfma_f32_16x16x32_bf16 v[16:19], a[160:163], v[32:35], v[16:19]
	v_mfma_f32_16x16x32_bf16 v[20:23], a[160:163], v[36:39], v[20:23]
	ds_read_b128 v[32:35], v61 offset:7168
	ds_read_b128 v[36:39], v61 offset:25600
	s_waitcnt lgkmcnt(4)
	v_mfma_f32_16x16x32_bf16 v[0:3], a[20:23], v[40:43], v[0:3]
	v_mfma_f32_16x16x32_bf16 v[4:7], a[20:23], v[44:47], v[4:7]
	v_mfma_f32_16x16x32_bf16 v[8:11], a[92:95], v[40:43], v[8:11]
	v_mfma_f32_16x16x32_bf16 v[12:15], a[92:95], v[44:47], v[12:15]
	v_mfma_f32_16x16x32_bf16 v[16:19], a[164:167], v[40:43], v[16:19]
	v_mfma_f32_16x16x32_bf16 v[20:23], a[164:167], v[44:47], v[20:23]
	ds_read_b128 v[40:43], v61 offset:8192
	ds_read_b128 v[44:47], v61 offset:26624
	s_waitcnt lgkmcnt(4)
	v_mfma_f32_16x16x32_bf16 v[0:3], a[24:27], v[24:27], v[0:3]
	v_mfma_f32_16x16x32_bf16 v[4:7], a[24:27], v[28:31], v[4:7]
	v_mfma_f32_16x16x32_bf16 v[8:11], a[96:99], v[24:27], v[8:11]
	v_mfma_f32_16x16x32_bf16 v[12:15], a[96:99], v[28:31], v[12:15]
	v_mfma_f32_16x16x32_bf16 v[16:19], a[168:171], v[24:27], v[16:19]
	v_mfma_f32_16x16x32_bf16 v[20:23], a[168:171], v[28:31], v[20:23]
	ds_read_b128 v[24:27], v61 offset:9216
	ds_read_b128 v[28:31], v61 offset:27648
	s_waitcnt lgkmcnt(4)
	v_mfma_f32_16x16x32_bf16 v[0:3], a[28:31], v[32:35], v[0:3]
	v_mfma_f32_16x16x32_bf16 v[4:7], a[28:31], v[36:39], v[4:7]
	v_mfma_f32_16x16x32_bf16 v[8:11], a[100:103], v[32:35], v[8:11]
	v_mfma_f32_16x16x32_bf16 v[12:15], a[100:103], v[36:39], v[12:15]
	v_mfma_f32_16x16x32_bf16 v[16:19], a[172:175], v[32:35], v[16:19]
	v_mfma_f32_16x16x32_bf16 v[20:23], a[172:175], v[36:39], v[20:23]
	ds_read_b128 v[32:35], v61 offset:10240
	ds_read_b128 v[36:39], v61 offset:28672
	s_waitcnt lgkmcnt(4)
	v_mfma_f32_16x16x32_bf16 v[0:3], a[32:35], v[40:43], v[0:3]
	v_mfma_f32_16x16x32_bf16 v[4:7], a[32:35], v[44:47], v[4:7]
	v_mfma_f32_16x16x32_bf16 v[8:11], a[104:107], v[40:43], v[8:11]
	v_mfma_f32_16x16x32_bf16 v[12:15], a[104:107], v[44:47], v[12:15]
	v_mfma_f32_16x16x32_bf16 v[16:19], a[176:179], v[40:43], v[16:19]
	v_mfma_f32_16x16x32_bf16 v[20:23], a[176:179], v[44:47], v[20:23]
	ds_read_b128 v[40:43], v61 offset:11264
	ds_read_b128 v[44:47], v61 offset:29696
	s_waitcnt vmcnt(0)
	v_mov_b32 v65, s28
	s_mov_b64 exec, 1
	buffer_store_dword v65, v64, s[4:7], s30 offen
	s_mov_b64 exec, -1
	s_cmp_ge_u32 s28, 63
	s_cbranch_scc1 .gnopf_598
	s_add_u32 s37, s28, 2
	v_cmp_gt_u32 vcc, s37, v63
	s_cbranch_vccnz .gnopf2_599
	s_mov_b32 s29, 1
	s_waitcnt lgkmcnt(4)
	v_mfma_f32_16x16x32_bf16 v[0:3], a[36:39], v[24:27], v[0:3]
	s_and_b32 s31, s56, 3
	s_mul_i32 s31, s31, 36864
	s_add_u32 s31, s31, s54
	s_add_u32 s56, s56, 1
	s_add_u32 s17, s32, 0
	s_mov_b32 m0, s17
	s_add_u32 s18, s31, 0
	buffer_load_dwordx4 v60, s[4:7], s18 offen offset:0 sc1 lds
	v_mfma_f32_16x16x32_bf16 v[4:7], a[36:39], v[28:31], v[4:7]
	buffer_load_dwordx4 v60, s[4:7], s18 offen offset:1024 sc1 lds
	v_mfma_f32_16x16x32_bf16 v[8:11], a[108:111], v[24:27], v[8:11]
	buffer_load_dwordx4 v60, s[4:7], s18 offen offset:2048 sc1 lds
	v_mfma_f32_16x16x32_bf16 v[12:15], a[108:111], v[28:31], v[12:15]
	buffer_load_dwordx4 v60, s[4:7], s18 offen offset:3072 sc1 lds
	v_mfma_f32_16x16x32_bf16 v[16:19], a[180:183], v[24:27], v[16:19]
	s_add_u32 s17, s32, 4096
	s_mov_b32 m0, s17
	s_add_u32 s18, s31, 4096
	buffer_load_dwordx4 v60, s[4:7], s18 offen offset:0 sc1 lds
	v_mfma_f32_16x16x32_bf16 v[20:23], a[180:183], v[28:31], v[20:23]
	buffer_load_dwordx4 v60, s[4:7], s18 offen offset:1024 sc1 lds
	ds_read_b128 v[24:27], v61 offset:12288
	ds_read_b128 v[28:31], v61 offset:30720
	s_waitcnt lgkmcnt(4)
	v_mfma_f32_16x16x32_bf16 v[0:3], a[40:43], v[32:35], v[0:3]
	buffer_load_dwordx4 v60, s[4:7], s18 offen offset:2048 sc1 lds
	v_mfma_f32_16x16x32_bf16 v[4:7], a[40:43], v[36:39], v[4:7]
	buffer_load_dwordx4 v60, s[4:7], s18 offen offset:3072 sc1 lds
	v_mfma_f32_16x16x32_bf16 v[8:11], a[112:115], v[32:35], v[8:11]
	s_add_u32 s17, s32, 8192
	s_mov_b32 m0, s17
	s_add_u32 s18, s31, 8192
	buffer_load_dwordx4 v60, s[4:7], s18 offen offset:0 sc1 lds
	s_sub_u32 s32, s44, s32
	v_mfma_f32_16x16x32_bf16 v[12:15], a[112:115], v[36:39], v[12:15]
	v_mfma_f32_16x16x32_bf16 v[16:19], a[184:187], v[32:35], v[16:19]
	v_mfma_f32_16x16x32_bf16 v[20:23], a[184:187], v[36:39], v[20:23]
	ds_read_b128 v[32:35], v61 offset:13312
	ds_read_b128 v[36:39], v61 offset:31744
	s_branch .gaft_600
.gnopf2_599:
	buffer_load_dword v63, v62, s[4:7], 0 offen sc1
.gnopf_598:
	s_waitcnt lgkmcnt(4)
	v_mfma_f32_16x16x32_bf16 v[0:3], a[36:39], v[24:27], v[0:3]
	v_mfma_f32_16x16x32_bf16 v[4:7], a[36:39], v[28:31], v[4:7]
	v_mfma_f32_16x16x32_bf16 v[8:11], a[108:111], v[24:27], v[8:11]
	v_mfma_f32_16x16x32_bf16 v[12:15], a[108:111], v[28:31], v[12:15]
	v_mfma_f32_16x16x32_bf16 v[16:19], a[180:183], v[24:27], v[16:19]
	v_mfma_f32_16x16x32_bf16 v[20:23], a[180:183], v[28:31], v[20:23]
	ds_read_b128 v[24:27], v61 offset:12288
	ds_read_b128 v[28:31], v61 offset:30720
	s_waitcnt lgkmcnt(4)
	v_mfma_f32_16x16x32_bf16 v[0:3], a[40:43], v[32:35], v[0:3]
	v_mfma_f32_16x16x32_bf16 v[4:7], a[40:43], v[36:39], v[4:7]
	v_mfma_f32_16x16x32_bf16 v[8:11], a[112:115], v[32:35], v[8:11]
	v_mfma_f32_16x16x32_bf16 v[12:15], a[112:115], v[36:39], v[12:15]
	v_mfma_f32_16x16x32_bf16 v[16:19], a[184:187], v[32:35], v[16:19]
	v_mfma_f32_16x16x32_bf16 v[20:23], a[184:187], v[36:39], v[20:23]
	ds_read_b128 v[32:35], v61 offset:13312
	ds_read_b128 v[36:39], v61 offset:31744
.gaft_600:
	s_waitcnt lgkmcnt(4)
	v_mfma_f32_16x16x32_bf16 v[0:3], a[44:47], v[40:43], v[0:3]
	v_mfma_f32_16x16x32_bf16 v[4:7], a[44:47], v[44:47], v[4:7]
	v_mfma_f32_16x16x32_bf16 v[8:11], a[116:119], v[40:43], v[8:11]
	v_mfma_f32_16x16x32_bf16 v[12:15], a[116:119], v[44:47], v[12:15]
	v_mfma_f32_16x16x32_bf16 v[16:19], a[188:191], v[40:43], v[16:19]
	v_mfma_f32_16x16x32_bf16 v[20:23], a[188:191], v[44:47], v[20:23]
	ds_read_b128 v[40:43], v61 offset:14336
	ds_read_b128 v[44:47], v61 offset:32768
	s_waitcnt lgkmcnt(4)
	v_mfma_f32_16x16x32_bf16 v[0:3], a[48:51], v[24:27], v[0:3]
	v_mfma_f32_16x16x32_bf16 v[4:7], a[48:51], v[28:31], v[4:7]
	v_mfma_f32_16x16x32_bf16 v[8:11], a[120:123], v[24:27], v[8:11]
	v_mfma_f32_16x16x32_bf16 v[12:15], a[120:123], v[28:31], v[12:15]
	v_mfma_f32_16x16x32_bf16 v[16:19], a[192:195], v[24:27], v[16:19]
	v_mfma_f32_16x16x32_bf16 v[20:23], a[192:195], v[28:31], v[20:23]
	ds_read_b128 v[24:27], v61 offset:15360
	ds_read_b128 v[28:31], v61 offset:33792
	s_cmp_lg_u32 s29, 0
	s_cbranch_scc1 .gnopf_601
	s_cmp_ge_u32 s28, 63
	s_cbranch_scc1 .gnopf_601
	s_waitcnt vmcnt(0)
	s_add_u32 s37, s28, 2
	v_cmp_gt_u32 vcc, s37, v63
	s_cbranch_vccnz .gnopf2_602
	s_mov_b32 s29, 1
	s_waitcnt lgkmcnt(4)
	v_mfma_f32_16x16x32_bf16 v[0:3], a[52:55], v[32:35], v[0:3]
	s_and_b32 s31, s56, 3
	s_mul_i32 s31, s31, 36864
	s_add_u32 s31, s31, s54
	s_add_u32 s56, s56, 1
	s_add_u32 s17, s32, 0
	s_mov_b32 m0, s17
	s_add_u32 s18, s31, 0
	buffer_load_dwordx4 v60, s[4:7], s18 offen offset:0 sc1 lds
	v_mfma_f32_16x16x32_bf16 v[4:7], a[52:55], v[36:39], v[4:7]
	buffer_load_dwordx4 v60, s[4:7], s18 offen offset:1024 sc1 lds
	v_mfma_f32_16x16x32_bf16 v[8:11], a[124:127], v[32:35], v[8:11]
	buffer_load_dwordx4 v60, s[4:7], s18 offen offset:2048 sc1 lds
	v_mfma_f32_16x16x32_bf16 v[12:15], a[124:127], v[36:39], v[12:15]
	buffer_load_dwordx4 v60, s[4:7], s18 offen offset:3072 sc1 lds
	v_mfma_f32_16x16x32_bf16 v[16:19], a[196:199], v[32:35], v[16:19]
	s_add_u32 s17, s32, 4096
	s_mov_b32 m0, s17
	s_add_u32 s18, s31, 4096
	buffer_load_dwordx4 v60, s[4:7], s18 offen offset:0 sc1 lds
	v_mfma_f32_16x16x32_bf16 v[20:23], a[196:199], v[36:39], v[20:23]
	buffer_load_dwordx4 v60, s[4:7], s18 offen offset:1024 sc1 lds
	ds_read_b128 v[32:35], v61 offset:16384
	ds_read_b128 v[36:39], v61 offset:34816
	s_waitcnt lgkmcnt(4)
	v_mfma_f32_16x16x32_bf16 v[0:3], a[56:59], v[40:43], v[0:3]
	buffer_load_dwordx4 v60, s[4:7], s18 offen offset:2048 sc1 lds
	v_mfma_f32_16x16x32_bf16 v[4:7], a[56:59], v[44:47], v[4:7]
	buffer_load_dwordx4 v60, s[4:7], s18 offen offset:3072 sc1 lds
	v_mfma_f32_16x16x32_bf16 v[8:11], a[128:131], v[40:43], v[8:11]
	s_add_u32 s17, s32, 8192
	s_mov_b32 m0, s17
	s_add_u32 s18, s31, 8192
	buffer_load_dwordx4 v60, s[4:7], s18 offen offset:0 sc1 lds
	s_sub_u32 s32, s44, s32
	v_mfma_f32_16x16x32_bf16 v[12:15], a[128:131], v[44:47], v[12:15]
	v_mfma_f32_16x16x32_bf16 v[16:19], a[200:203], v[40:43], v[16:19]
	v_mfma_f32_16x16x32_bf16 v[20:23], a[200:203], v[44:47], v[20:23]
	ds_read_b128 v[40:43], v61 offset:17408
	ds_read_b128 v[44:47], v61 offset:35840
	s_branch .gaft_603
.gnopf2_602:
	buffer_load_dword v63, v62, s[4:7], 0 offen sc1
.gnopf_601:
	s_waitcnt lgkmcnt(4)
	v_mfma_f32_16x16x32_bf16 v[0:3], a[52:55], v[32:35], v[0:3]
	v_mfma_f32_16x16x32_bf16 v[4:7], a[52:55], v[36:39], v[4:7]
	v_mfma_f32_16x16x32_bf16 v[8:11], a[124:127], v[32:35], v[8:11]
	v_mfma_f32_16x16x32_bf16 v[12:15], a[124:127], v[36:39], v[12:15]
	v_mfma_f32_16x16x32_bf16 v[16:19], a[196:199], v[32:35], v[16:19]
	v_mfma_f32_16x16x32_bf16 v[20:23], a[196:199], v[36:39], v[20:23]
	ds_read_b128 v[32:35], v61 offset:16384
	ds_read_b128 v[36:39], v61 offset:34816
	s_waitcnt lgkmcnt(4)
	v_mfma_f32_16x16x32_bf16 v[0:3], a[56:59], v[40:43], v[0:3]
	v_mfma_f32_16x16x32_bf16 v[4:7], a[56:59], v[44:47], v[4:7]
	v_mfma_f32_16x16x32_bf16 v[8:11], a[128:131], v[40:43], v[8:11]
	v_mfma_f32_16x16x32_bf16 v[12:15], a[128:131], v[44:47], v[12:15]
	v_mfma_f32_16x16x32_bf16 v[16:19], a[200:203], v[40:43], v[16:19]
	v_mfma_f32_16x16x32_bf16 v[20:23], a[200:203], v[44:47], v[20:23]
	ds_read_b128 v[40:43], v61 offset:17408
	ds_read_b128 v[44:47], v61 offset:35840
.gaft_603:
	s_waitcnt lgkmcnt(4)
	v_mfma_f32_16x16x32_bf16 v[0:3], a[60:63], v[24:27], v[0:3]
	v_mfma_f32_16x16x32_bf16 v[4:7], a[60:63], v[28:31], v[4:7]
	v_mfma_f32_16x16x32_bf16 v[8:11], a[132:135], v[24:27], v[8:11]
	v_mfma_f32_16x16x32_bf16 v[12:15], a[132:135], v[28:31], v[12:15]
	v_mfma_f32_16x16x32_bf16 v[16:19], a[204:207], v[24:27], v[16:19]
	v_mfma_f32_16x16x32_bf16 v[20:23], a[204:207], v[28:31], v[20:23]
	s_waitcnt lgkmcnt(2)
	v_mfma_f32_16x16x32_bf16 v[0:3], a[64:67], v[32:35], v[0:3]
	v_mfma_f32_16x16x32_bf16 v[4:7], a[64:67], v[36:39], v[4:7]
	v_mfma_f32_16x16x32_bf16 v[8:11], a[136:139], v[32:35], v[8:11]
	v_mfma_f32_16x16x32_bf16 v[12:15], a[136:139], v[36:39], v[12:15]
	v_mfma_f32_16x16x32_bf16 v[16:19], a[208:211], v[32:35], v[16:19]
	v_mfma_f32_16x16x32_bf16 v[20:23], a[208:211], v[36:39], v[20:23]
	s_waitcnt lgkmcnt(0)
	v_mfma_f32_16x16x32_bf16 v[0:3], a[68:71], v[40:43], v[0:3]
	v_mfma_f32_16x16x32_bf16 v[4:7], a[68:71], v[44:47], v[4:7]
	v_mfma_f32_16x16x32_bf16 v[8:11], a[140:143], v[40:43], v[8:11]
	v_mfma_f32_16x16x32_bf16 v[12:15], a[140:143], v[44:47], v[12:15]
	v_mfma_f32_16x16x32_bf16 v[16:19], a[212:215], v[40:43], v[16:19]
	v_mfma_f32_16x16x32_bf16 v[20:23], a[212:215], v[44:47], v[20:23]
	s_sub_i32 s57, s28, 3
	s_max_i32 s57, s57, 0
	v_cmp_gt_u32 vcc, s57, v68
	s_cbranch_vccz .pck_604
	s_mov_b32 s20, 400000
.pre_605:
	buffer_load_dword v68, v67, s[4:7], 0 offen sc1
	s_waitcnt vmcnt(0)
	v_cmp_gt_u32 vcc, s57, v68
	s_cbranch_vccz .pok_606
	s_sub_u32 s20, s20, 1
	s_cmp_lg_u32 s20, 0
	s_cbranch_scc1 .pre_605
	s_branch L_FAIL
.pok_606:
.pck_604:
	s_and_b32 s34, s28, 3
	s_mul_i32 s34, s34, 73728
	s_add_u32 s34, s34, s55
	s_add_u32 s35, s34, 36864
	buffer_store_dwordx4 v[0:3], v66, s[4:7], s34 offen offset:0
	buffer_store_dwordx4 v[4:7], v66, s[4:7], s35 offen offset:0
	buffer_store_dwordx4 v[8:11], v66, s[4:7], s34 offen offset:512
	buffer_store_dwordx4 v[12:15], v66, s[4:7], s35 offen offset:512
	buffer_store_dwordx4 v[16:19], v66, s[4:7], s34 offen offset:1024
	buffer_store_dwordx4 v[20:23], v66, s[4:7], s35 offen offset:1024
	s_add_u32 s34, s34, 73728
	s_add_u32 s28, s28, 1
	s_cmp_lg_u32 s29, 0
	s_cbranch_scc1 .gloop_593
	s_cmp_ge_u32 s28, 64
	s_cbranch_scc1 .gnofin_608
	s_waitcnt vmcnt(6)
	s_add_u32 s37, s28, 1
	v_cmp_gt_u32 vcc, s37, v63
	s_cbranch_vccnz .gnofin_608
	s_and_b32 s31, s56, 3
	s_mul_i32 s31, s31, 36864
	s_add_u32 s31, s31, s54
	s_add_u32 s56, s56, 1
	s_add_u32 s17, s32, 0
	s_mov_b32 m0, s17
	s_add_u32 s18, s31, 0
	buffer_load_dwordx4 v60, s[4:7], s18 offen offset:0 sc1 lds
	buffer_load_dwordx4 v60, s[4:7], s18 offen offset:1024 sc1 lds
	buffer_load_dwordx4 v60, s[4:7], s18 offen offset:2048 sc1 lds
	buffer_load_dwordx4 v60, s[4:7], s18 offen offset:3072 sc1 lds
	s_add_u32 s17, s32, 4096
	s_mov_b32 m0, s17
	s_add_u32 s18, s31, 4096
	buffer_load_dwordx4 v60, s[4:7], s18 offen offset:0 sc1 lds
	buffer_load_dwordx4 v60, s[4:7], s18 offen offset:1024 sc1 lds
	buffer_load_dwordx4 v60, s[4:7], s18 offen offset:2048 sc1 lds
	buffer_load_dwordx4 v60, s[4:7], s18 offen offset:3072 sc1 lds
	s_add_u32 s17, s32, 8192
	s_mov_b32 m0, s17
	s_add_u32 s18, s31, 8192
	buffer_load_dwordx4 v60, s[4:7], s18 offen offset:0 sc1 lds
	s_sub_u32 s32, s44, s32
	s_waitcnt vmcnt(9)
	v_mov_b32 v65, s28
	s_mov_b64 exec, 1
	buffer_store_dword v65, v64, s[4:7], s30 offen
	s_mov_b64 exec, -1
	s_waitcnt vmcnt(1)
	s_branch .ggo_595
.gnofin_608:
	s_waitcnt vmcnt(0)
	v_mov_b32 v65, s28
	s_mov_b64 exec, 1
	buffer_store_dword v65, v64, s[4:7], s30 offen
	s_mov_b64 exec, -1
	s_cmp_lt_u32 s28, 64
	s_cbranch_scc1 .gloop_593
	s_branch L_END
L_A3_CE:
L_A3_DEV:
	s_mul_i32 s17, s15, 9216
	s_add_u32 s31, s31, s17
	s_mov_b32 s32, s17
	s_lshl_b32 s44, s17, 1
	s_add_u32 s44, s44, 36864
	s_mov_b32 s33, 0
	s_mov_b32 s28, 0
	s_mov_b32 s29, 0
	s_mov_b32 s54, s31
	s_mov_b32 s56, 0
	s_mov_b32 s55, s34
.gloop_613:
	s_cmp_lg_u32 s29, 0
	s_cbranch_scc1 .gpref_614
	s_add_u32 s37, s28, 1
	s_mov_b32 s20, 400000
.pre_616:
	buffer_load_dword v63, v62, s[4:7], 0 offen sc1
	s_waitcnt vmcnt(0)
	v_cmp_gt_u32 vcc, s37, v63
	s_cbranch_vccz .pok_617
	s_sub_u32 s20, s20, 1
	s_cmp_lg_u32 s20, 0
	s_cbranch_scc1 .pre_616
	s_branch L_FAIL
.pok_617:
	s_and_b32 s31, s56, 3
	s_mul_i32 s31, s31, 36864
	s_add_u32 s31, s31, s54
	s_add_u32 s56, s56, 1
	s_add_u32 s17, s32, 0
	s_mov_b32 m0, s17
	s_add_u32 s18, s31, 0
	buffer_load_dwordx4 v60, s[4:7], s18 offen offset:0 sc1 lds
	buffer_load_dwordx4 v60, s[4:7], s18 offen offset:1024 sc1 lds
	buffer_load_dwordx4 v60, s[4:7], s18 offen offset:2048 sc1 lds
	buffer_load_dwordx4 v60, s[4:7], s18 offen offset:3072 sc1 lds
	s_add_u32 s17, s32, 4096
	s_mov_b32 m0, s17
	s_add_u32 s18, s31, 4096
	buffer_load_dwordx4 v60, s[4:7], s18 offen offset:0 sc1 lds
	buffer_load_dwordx4 v60, s[4:7], s18 offen offset:1024 sc1 lds
	buffer_load_dwordx4 v60, s[4:7], s18 offen offset:2048 sc1 lds
	buffer_load_dwordx4 v60, s[4:7], s18 offen offset:3072 sc1 lds
	s_add_u32 s17, s32, 8192
	s_mov_b32 m0, s17
	s_add_u32 s18, s31, 8192
	buffer_load_dwordx4 v60, s[4:7], s18 offen offset:0 sc1 lds
	s_sub_u32 s32, s44, s32
	s_waitcnt vmcnt(0)
	s_branch .ggo_615
.gpref_614:
	s_waitcnt vmcnt(6)
.ggo_615:
	s_barrier
	s_mov_b32 s29, 0
	v_add_u32 v61, s33, v60
	s_sub_u32 s33, 36864, s33
	buffer_load_dword v63, v62, s[4:7], 0 offen sc1
	buffer_load_dword v68, v67, s[4:7], 0 offen sc1
	ds_read_b128 v[24:27], v61 offset:0
	ds_read_b128 v[28:31], v61 offset:18432
	ds_read_b128 v[32:35], v61 offset:1024
	ds_read_b128 v[36:39], v61 offset:19456
	ds_read_b128 v[40:43], v61 offset:2048
	ds_read_b128 v[44:47], v61 offset:20480
	s_waitcnt lgkmcnt(4)
	v_mfma_f32_16x16x32_bf16 v[0:3], a[0:3], v[24:27], 0
	v_mfma_f32_16x16x32_bf16 v[4:7], a[0:3], v[28:31], 0
	v_mfma_f32_16x16x32_bf16 v[8:11], a[72:75], v[24:27], 0
	v_mfma_f32_16x16x32_bf16 v[12:15], a[72:75], v[28:31], 0
	v_mfma_f32_16x16x32_bf16 v[16:19], a[144:147], v[24:27], 0
	v_mfma_f32_16x16x32_bf16 v[20:23], a[144:147], v[28:31], 0
	ds_read_b128 v[24:27], v61 offset:3072
	ds_read_b128 v[28:31], v61 offset:21504
	s_waitcnt lgkmcnt(4)
	v_mfma_f32_16x16x32_bf16 v[0:3], a[4:7], v[32:35], v[0:3]
	v_mfma_f32_16x16x32_bf16 v[4:7], a[4:7], v[36:39], v[4:7]
	v_mfma_f32_16x16x32_bf16 v[8:11], a[76:79], v[32:35], v[8:11]
	v_mfma_f32_16x16x32_bf16 v[12:15], a[76:79], v[36:39], v[12:15]
	v_mfma_f32_16x16x32_bf16 v[16:19], a[148:151], v[32:35], v[16:19]
	v_mfma_f32_16x16x32_bf16 v[20:23], a[148:151], v[36:39], v[20:23]
	ds_read_b128 v[32:35], v61 offset:4096
	ds_read_b128 v[36:39], v61 offset:22528
	s_waitcnt lgkmcnt(4)
	v_mfma_f32_16x16x32_bf16 v[0:3], a[8:11], v[40:43], v[0:3]
	v_mfma_f32_16x16x32_bf16 v[4:7], a[8:11], v[44:47], v[4:7]
	v_mfma_f32_16x16x32_bf16 v[8:11], a[80:83], v[40:43], v[8:11]
	v_mfma_f32_16x16x32_bf16 v[12:15], a[80:83], v[44:47], v[12:15]
	v_mfma_f32_16x16x32_bf16 v[16:19], a[152:155], v[40:43], v[16:19]
	v_mfma_f32_16x16x32_bf16 v[20:23], a[152:155], v[44:47], v[20:23]
	ds_read_b128 v[40:43], v61 offset:5120
	ds_read_b128 v[44:47], v61 offset:23552
	s_waitcnt lgkmcnt(4)
	v_mfma_f32_16x16x32_bf16 v[0:3], a[12:15], v[24:27], v[0:3]
	v_mfma_f32_16x16x32_bf16 v[4:7], a[12:15], v[28:31], v[4:7]
	v_mfma_f32_16x16x32_bf16 v[8:11], a[84:87], v[24:27], v[8:11]
	v_mfma_f32_16x16x32_bf16 v[12:15], a[84:87], v[28:31], v[12:15]
	v_mfma_f32_16x16x32_bf16 v[16:19], a[156:159], v[24:27], v[16:19]
	v_mfma_f32_16x16x32_bf16 v[20:23], a[156:159], v[28:31], v[20:23]
	ds_read_b128 v[24:27], v61 offset:6144
	ds_read_b128 v[28:31], v61 offset:24576
	s_waitcnt lgkmcnt(4)
	v_mfma_f32_16x16x32_bf16 v[0:3], a[16:19], v[32:35], v[0:3]
	v_mfma_f32_16x16x32_bf16 v[4:7], a[16:19], v[36:39], v[4:7]
	v_mfma_f32_16x16x32_bf16 v[8:11], a[88:91], v[32:35], v[8:11]
	v_mfma_f32_16x16x32_bf16 v[12:15], a[88:91], v[36:39], v[12:15]
	v_mfma_f32_16x16x32_bf16 v[16:19], a[160:163], v[32:35], v[16:19]
	v_mfma_f32_16x16x32_bf16 v[20:23], a[160:163], v[36:39], v[20:23]
	ds_read_b128 v[32:35], v61 offset:7168
	ds_read_b128 v[36:39], v61 offset:25600
	s_waitcnt lgkmcnt(4)
	v_mfma_f32_16x16x32_bf16 v[0:3], a[20:23], v[40:43], v[0:3]
	v_mfma_f32_16x16x32_bf16 v[4:7], a[20:23], v[44:47], v[4:7]
	v_mfma_f32_16x16x32_bf16 v[8:11], a[92:95], v[40:43], v[8:11]
	v_mfma_f32_16x16x32_bf16 v[12:15], a[92:95], v[44:47], v[12:15]
	v_mfma_f32_16x16x32_bf16 v[16:19], a[164:167], v[40:43], v[16:19]
	v_mfma_f32_16x16x32_bf16 v[20:23], a[164:167], v[44:47], v[20:23]
	ds_read_b128 v[40:43], v61 offset:8192
	ds_read_b128 v[44:47], v61 offset:26624
	s_waitcnt lgkmcnt(4)
	v_mfma_f32_16x16x32_bf16 v[0:3], a[24:27], v[24:27], v[0:3]
	v_mfma_f32_16x16x32_bf16 v[4:7], a[24:27], v[28:31], v[4:7]
	v_mfma_f32_16x16x32_bf16 v[8:11], a[96:99], v[24:27], v[8:11]
	v_mfma_f32_16x16x32_bf16 v[12:15], a[96:99], v[28:31], v[12:15]
	v_mfma_f32_16x16x32_bf16 v[16:19], a[168:171], v[24:27], v[16:19]
	v_mfma_f32_16x16x32_bf16 v[20:23], a[168:171], v[28:31], v[20:23]
	ds_read_b128 v[24:27], v61 offset:9216
	ds_read_b128 v[28:31], v61 offset:27648
	s_waitcnt lgkmcnt(4)
	v_mfma_f32_16x16x32_bf16 v[0:3], a[28:31], v[32:35], v[0:3]
	v_mfma_f32_16x16x32_bf16 v[4:7], a[28:31], v[36:39], v[4:7]
	v_mfma_f32_16x16x32_bf16 v[8:11], a[100:103], v[32:35], v[8:11]
	v_mfma_f32_16x16x32_bf16 v[12:15], a[100:103], v[36:39], v[12:15]
	v_mfma_f32_16x16x32_bf16 v[16:19], a[172:175], v[32:35], v[16:19]
	v_mfma_f32_16x16x32_bf16 v[20:23], a[172:175], v[36:39], v[20:23]
	ds_read_b128 v[32:35], v61 offset:10240
	ds_read_b128 v[36:39], v61 offset:28672
	s_waitcnt lgkmcnt(4)
	v_mfma_f32_16x16x32_bf16 v[0:3], a[32:35], v[40:43], v[0:3]
	v_mfma_f32_16x16x32_bf16 v[4:7], a[32:35], v[44:47], v[4:7]
	v_mfma_f32_16x16x32_bf16 v[8:11], a[104:107], v[40:43], v[8:11]
	v_mfma_f32_16x16x32_bf16 v[12:15], a[104:107], v[44:47], v[12:15]
	v_mfma_f32_16x16x32_bf16 v[16:19], a[176:179], v[40:43], v[16:19]
	v_mfma_f32_16x16x32_bf16 v[20:23], a[176:179], v[44:47], v[20:23]
	ds_read_b128 v[40:43], v61 offset:11264
	ds_read_b128 v[44:47], v61 offset:29696
	s_waitcnt vmcnt(0)
	v_mov_b32 v65, s28
	s_mov_b64 exec, 1
	buffer_store_dword v65, v64, s[4:7], s30 offen sc1
	s_mov_b64 exec, -1
	s_cmp_ge_u32 s28, 63
	s_cbranch_scc1 .gnopf_618
	s_add_u32 s37, s28, 2
	v_cmp_gt_u32 vcc, s37, v63
	s_cbranch_vccnz .gnopf2_619
	s_mov_b32 s29, 1
	s_waitcnt lgkmcnt(4)
	v_mfma_f32_16x16x32_bf16 v[0:3], a[36:39], v[24:27], v[0:3]
	s_and_b32 s31, s56, 3
	s_mul_i32 s31, s31, 36864
	s_add_u32 s31, s31, s54
	s_add_u32 s56, s56, 1
	s_add_u32 s17, s32, 0
	s_mov_b32 m0, s17
	s_add_u32 s18, s31, 0
	buffer_load_dwordx4 v60, s[4:7], s18 offen offset:0 sc1 lds
	v_mfma_f32_16x16x32_bf16 v[4:7], a[36:39], v[28:31], v[4:7]
	buffer_load_dwordx4 v60, s[4:7], s18 offen offset:1024 sc1 lds
	v_mfma_f32_16x16x32_bf16 v[8:11], a[108:111], v[24:27], v[8:11]
	buffer_load_dwordx4 v60, s[4:7], s18 offen offset:2048 sc1 lds
	v_mfma_f32_16x16x32_bf16 v[12:15], a[108:111], v[28:31], v[12:15]
	buffer_load_dwordx4 v60, s[4:7], s18 offen offset:3072 sc1 lds
	v_mfma_f32_16x16x32_bf16 v[16:19], a[180:183], v[24:27], v[16:19]
	s_add_u32 s17, s32, 4096
	s_mov_b32 m0, s17
	s_add_u32 s18, s31, 4096
	buffer_load_dwordx4 v60, s[4:7], s18 offen offset:0 sc1 lds
	v_mfma_f32_16x16x32_bf16 v[20:23], a[180:183], v[28:31], v[20:23]
	buffer_load_dwordx4 v60, s[4:7], s18 offen offset:1024 sc1 lds
	ds_read_b128 v[24:27], v61 offset:12288
	ds_read_b128 v[28:31], v61 offset:30720
	s_waitcnt lgkmcnt(4)
	v_mfma_f32_16x16x32_bf16 v[0:3], a[40:43], v[32:35], v[0:3]
	buffer_load_dwordx4 v60, s[4:7], s18 offen offset:2048 sc1 lds
	v_mfma_f32_16x16x32_bf16 v[4:7], a[40:43], v[36:39], v[4:7]
	buffer_load_dwordx4 v60, s[4:7], s18 offen offset:3072 sc1 lds
	v_mfma_f32_16x16x32_bf16 v[8:11], a[112:115], v[32:35], v[8:11]
	s_add_u32 s17, s32, 8192
	s_mov_b32 m0, s17
	s_add_u32 s18, s31, 8192
	buffer_load_dwordx4 v60, s[4:7], s18 offen offset:0 sc1 lds
	s_sub_u32 s32, s44, s32
	v_mfma_f32_16x16x32_bf16 v[12:15], a[112:115], v[36:39], v[12:15]
	v_mfma_f32_16x16x32_bf16 v[16:19], a[184:187], v[32:35], v[16:19]
	v_mfma_f32_16x16x32_bf16 v[20:23], a[184:187], v[36:39], v[20:23]
	ds_read_b128 v[32:35], v61 offset:13312
	ds_read_b128 v[36:39], v61 offset:31744
	s_branch .gaft_620
.gnopf2_619:
	buffer_load_dword v63, v62, s[4:7], 0 offen sc1
.gnopf_618:
	s_waitcnt lgkmcnt(4)
	v_mfma_f32_16x16x32_bf16 v[0:3], a[36:39], v[24:27], v[0:3]
	v_mfma_f32_16x16x32_bf16 v[4:7], a[36:39], v[28:31], v[4:7]
	v_mfma_f32_16x16x32_bf16 v[8:11], a[108:111], v[24:27], v[8:11]
	v_mfma_f32_16x16x32_bf16 v[12:15], a[108:111], v[28:31], v[12:15]
	v_mfma_f32_16x16x32_bf16 v[16:19], a[180:183], v[24:27], v[16:19]
	v_mfma_f32_16x16x32_bf16 v[20:23], a[180:183], v[28:31], v[20:23]
	ds_read_b128 v[24:27], v61 offset:12288
	ds_read_b128 v[28:31], v61 offset:30720
	s_waitcnt lgkmcnt(4)
	v_mfma_f32_16x16x32_bf16 v[0:3], a[40:43], v[32:35], v[0:3]
	v_mfma_f32_16x16x32_bf16 v[4:7], a[40:43], v[36:39], v[4:7]
	v_mfma_f32_16x16x32_bf16 v[8:11], a[112:115], v[32:35], v[8:11]
	v_mfma_f32_16x16x32_bf16 v[12:15], a[112:115], v[36:39], v[12:15]
	v_mfma_f32_16x16x32_bf16 v[16:19], a[184:187], v[32:35], v[16:19]
	v_mfma_f32_16x16x32_bf16 v[20:23], a[184:187], v[36:39], v[20:23]
	ds_read_b128 v[32:35], v61 offset:13312
	ds_read_b128 v[36:39], v61 offset:31744
.gaft_620:
	s_waitcnt lgkmcnt(4)
	v_mfma_f32_16x16x32_bf16 v[0:3], a[44:47], v[40:43], v[0:3]
	v_mfma_f32_16x16x32_bf16 v[4:7], a[44:47], v[44:47], v[4:7]
	v_mfma_f32_16x16x32_bf16 v[8:11], a[116:119], v[40:43], v[8:11]
	v_mfma_f32_16x16x32_bf16 v[12:15], a[116:119], v[44:47], v[12:15]
	v_mfma_f32_16x16x32_bf16 v[16:19], a[188:191], v[40:43], v[16:19]
	v_mfma_f32_16x16x32_bf16 v[20:23], a[188:191], v[44:47], v[20:23]
	ds_read_b128 v[40:43], v61 offset:14336
	ds_read_b128 v[44:47], v61 offset:32768
	s_waitcnt lgkmcnt(4)
	v_mfma_f32_16x16x32_bf16 v[0:3], a[48:51], v[24:27], v[0:3]
	v_mfma_f32_16x16x32_bf16 v[4:7], a[48:51], v[28:31], v[4:7]
	v_mfma_f32_16x16x32_bf16 v[8:11], a[120:123], v[24:27], v[8:11]
	v_mfma_f32_16x16x32_bf16 v[12:15], a[120:123], v[28:31], v[12:15]
	v_mfma_f32_16x16x32_bf16 v[16:19], a[192:195], v[24:27], v[16:19]
	v_mfma_f32_16x16x32_bf16 v[20:23], a[192:195], v[28:31], v[20:23]
	ds_read_b128 v[24:27], v61 offset:15360
	ds_read_b128 v[28:31], v61 offset:33792
	s_cmp_lg_u32 s29, 0
	s_cbranch_scc1 .gnopf_621
	s_cmp_ge_u32 s28, 63
	s_cbranch_scc1 .gnopf_621
	s_waitcnt vmcnt(0)
	s_add_u32 s37, s28, 2
	v_cmp_gt_u32 vcc, s37, v63
	s_cbranch_vccnz .gnopf2_622
	s_mov_b32 s29, 1
	s_waitcnt lgkmcnt(4)
	v_mfma_f32_16x16x32_bf16 v[0:3], a[52:55], v[32:35], v[0:3]
	s_and_b32 s31, s56, 3
	s_mul_i32 s31, s31, 36864
	s_add_u32 s31, s31, s54
	s_add_u32 s56, s56, 1
	s_add_u32 s17, s32, 0
	s_mov_b32 m0, s17
	s_add_u32 s18, s31, 0
	buffer_load_dwordx4 v60, s[4:7], s18 offen offset:0 sc1 lds
	v_mfma_f32_16x16x32_bf16 v[4:7], a[52:55], v[36:39], v[4:7]
	buffer_load_dwordx4 v60, s[4:7], s18 offen offset:1024 sc1 lds
	v_mfma_f32_16x16x32_bf16 v[8:11], a[124:127], v[32:35], v[8:11]
	buffer_load_dwordx4 v60, s[4:7], s18 offen offset:2048 sc1 lds
	v_mfma_f32_16x16x32_bf16 v[12:15], a[124:127], v[36:39], v[12:15]
	buffer_load_dwordx4 v60, s[4:7], s18 offen offset:3072 sc1 lds
	v_mfma_f32_16x16x32_bf16 v[16:19], a[196:199], v[32:35], v[16:19]
	s_add_u32 s17, s32, 4096
	s_mov_b32 m0, s17
	s_add_u32 s18, s31, 4096
	buffer_load_dwordx4 v60, s[4:7], s18 offen offset:0 sc1 lds
	v_mfma_f32_16x16x32_bf16 v[20:23], a[196:199], v[36:39], v[20:23]
	buffer_load_dwordx4 v60, s[4:7], s18 offen offset:1024 sc1 lds
	ds_read_b128 v[32:35], v61 offset:16384
	ds_read_b128 v[36:39], v61 offset:34816
	s_waitcnt lgkmcnt(4)
	v_mfma_f32_16x16x32_bf16 v[0:3], a[56:59], v[40:43], v[0:3]
	buffer_load_dwordx4 v60, s[4:7], s18 offen offset:2048 sc1 lds
	v_mfma_f32_16x16x32_bf16 v[4:7], a[56:59], v[44:47], v[4:7]
	buffer_load_dwordx4 v60, s[4:7], s18 offen offset:3072 sc1 lds
	v_mfma_f32_16x16x32_bf16 v[8:11], a[128:131], v[40:43], v[8:11]
	s_add_u32 s17, s32, 8192
	s_mov_b32 m0, s17
	s_add_u32 s18, s31, 8192
	buffer_load_dwordx4 v60, s[4:7], s18 offen offset:0 sc1 lds
	s_sub_u32 s32, s44, s32
	v_mfma_f32_16x16x32_bf16 v[12:15], a[128:131], v[44:47], v[12:15]
	v_mfma_f32_16x16x32_bf16 v[16:19], a[200:203], v[40:43], v[16:19]
	v_mfma_f32_16x16x32_bf16 v[20:23], a[200:203], v[44:47], v[20:23]
	ds_read_b128 v[40:43], v61 offset:17408
	ds_read_b128 v[44:47], v61 offset:35840
	s_branch .gaft_623
.gnopf2_622:
	buffer_load_dword v63, v62, s[4:7], 0 offen sc1
.gnopf_621:
	s_waitcnt lgkmcnt(4)
	v_mfma_f32_16x16x32_bf16 v[0:3], a[52:55], v[32:35], v[0:3]
	v_mfma_f32_16x16x32_bf16 v[4:7], a[52:55], v[36:39], v[4:7]
	v_mfma_f32_16x16x32_bf16 v[8:11], a[124:127], v[32:35], v[8:11]
	v_mfma_f32_16x16x32_bf16 v[12:15], a[124:127], v[36:39], v[12:15]
	v_mfma_f32_16x16x32_bf16 v[16:19], a[196:199], v[32:35], v[16:19]
	v_mfma_f32_16x16x32_bf16 v[20:23], a[196:199], v[36:39], v[20:23]
	ds_read_b128 v[32:35], v61 offset:16384
	ds_read_b128 v[36:39], v61 offset:34816
	s_waitcnt lgkmcnt(4)
	v_mfma_f32_16x16x32_bf16 v[0:3], a[56:59], v[40:43], v[0:3]
	v_mfma_f32_16x16x32_bf16 v[4:7], a[56:59], v[44:47], v[4:7]
	v_mfma_f32_16x16x32_bf16 v[8:11], a[128:131], v[40:43], v[8:11]
	v_mfma_f32_16x16x32_bf16 v[12:15], a[128:131], v[44:47], v[12:15]
	v_mfma_f32_16x16x32_bf16 v[16:19], a[200:203], v[40:43], v[16:19]
	v_mfma_f32_16x16x32_bf16 v[20:23], a[200:203], v[44:47], v[20:23]
	ds_read_b128 v[40:43], v61 offset:17408
	ds_read_b128 v[44:47], v61 offset:35840
.gaft_623:
	s_waitcnt lgkmcnt(4)
	v_mfma_f32_16x16x32_bf16 v[0:3], a[60:63], v[24:27], v[0:3]
	v_mfma_f32_16x16x32_bf16 v[4:7], a[60:63], v[28:31], v[4:7]
	v_mfma_f32_16x16x32_bf16 v[8:11], a[132:135], v[24:27], v[8:11]
	v_mfma_f32_16x16x32_bf16 v[12:15], a[132:135], v[28:31], v[12:15]
	v_mfma_f32_16x16x32_bf16 v[16:19], a[204:207], v[24:27], v[16:19]
	v_mfma_f32_16x16x32_bf16 v[20:23], a[204:207], v[28:31], v[20:23]
	s_waitcnt lgkmcnt(2)
	v_mfma_f32_16x16x32_bf16 v[0:3], a[64:67], v[32:35], v[0:3]
	v_mfma_f32_16x16x32_bf16 v[4:7], a[64:67], v[36:39], v[4:7]
	v_mfma_f32_16x16x32_bf16 v[8:11], a[136:139], v[32:35], v[8:11]
	v_mfma_f32_16x16x32_bf16 v[12:15], a[136:139], v[36:39], v[12:15]
	v_mfma_f32_16x16x32_bf16 v[16:19], a[208:211], v[32:35], v[16:19]
	v_mfma_f32_16x16x32_bf16 v[20:23], a[208:211], v[36:39], v[20:23]
	s_waitcnt lgkmcnt(0)
	v_mfma_f32_16x16x32_bf16 v[0:3], a[68:71], v[40:43], v[0:3]
	v_mfma_f32_16x16x32_bf16 v[4:7], a[68:71], v[44:47], v[4:7]
	v_mfma_f32_16x16x32_bf16 v[8:11], a[140:143], v[40:43], v[8:11]
	v_mfma_f32_16x16x32_bf16 v[12:15], a[140:143], v[44:47], v[12:15]
	v_mfma_f32_16x16x32_bf16 v[16:19], a[212:215], v[40:43], v[16:19]
	v_mfma_f32_16x16x32_bf16 v[20:23], a[212:215], v[44:47], v[20:23]
	s_sub_i32 s57, s28, 3
	s_max_i32 s57, s57, 0
	v_cmp_gt_u32 vcc, s57, v68
	s_cbranch_vccz .pck_624
	s_mov_b32 s20, 400000
.pre_625:
	buffer_load_dword v68, v67, s[4:7], 0 offen sc1
	s_waitcnt vmcnt(0)
	v_cmp_gt_u32 vcc, s57, v68
	s_cbranch_vccz .pok_626
	s_sub_u32 s20, s20, 1
	s_cmp_lg_u32 s20, 0
	s_cbranch_scc1 .pre_625
	s_branch L_FAIL
.pok_626:
.pck_624:
	s_and_b32 s34, s28, 3
	s_mul_i32 s34, s34, 73728
	s_add_u32 s34, s34, s55
	s_add_u32 s35, s34, 36864
	buffer_store_dwordx4 v[0:3], v66, s[4:7], s34 offen offset:0 sc1
	buffer_store_dwordx4 v[4:7], v66, s[4:7], s35 offen offset:0 sc1
	buffer_store_dwordx4 v[8:11], v66, s[4:7], s34 offen offset:512 sc1
	buffer_store_dwordx4 v[12:15], v66, s[4:7], s35 offen offset:512 sc1
	buffer_store_dwordx4 v[16:19], v66, s[4:7], s34 offen offset:1024 sc1
	buffer_store_dwordx4 v[20:23], v66, s[4:7], s35 offen offset:1024 sc1
	s_add_u32 s34, s34, 73728
	s_add_u32 s28, s28, 1
	s_cmp_lg_u32 s29, 0
	s_cbranch_scc1 .gloop_613
	s_cmp_ge_u32 s28, 64
	s_cbranch_scc1 .gnofin_628
	s_waitcnt vmcnt(6)
	s_add_u32 s37, s28, 1
	v_cmp_gt_u32 vcc, s37, v63
	s_cbranch_vccnz .gnofin_628
	s_and_b32 s31, s56, 3
	s_mul_i32 s31, s31, 36864
	s_add_u32 s31, s31, s54
	s_add_u32 s56, s56, 1
	s_add_u32 s17, s32, 0
	s_mov_b32 m0, s17
	s_add_u32 s18, s31, 0
	buffer_load_dwordx4 v60, s[4:7], s18 offen offset:0 sc1 lds
	buffer_load_dwordx4 v60, s[4:7], s18 offen offset:1024 sc1 lds
	buffer_load_dwordx4 v60, s[4:7], s18 offen offset:2048 sc1 lds
	buffer_load_dwordx4 v60, s[4:7], s18 offen offset:3072 sc1 lds
	s_add_u32 s17, s32, 4096
	s_mov_b32 m0, s17
	s_add_u32 s18, s31, 4096
	buffer_load_dwordx4 v60, s[4:7], s18 offen offset:0 sc1 lds
	buffer_load_dwordx4 v60, s[4:7], s18 offen offset:1024 sc1 lds
	buffer_load_dwordx4 v60, s[4:7], s18 offen offset:2048 sc1 lds
	buffer_load_dwordx4 v60, s[4:7], s18 offen offset:3072 sc1 lds
	s_add_u32 s17, s32, 8192
	s_mov_b32 m0, s17
	s_add_u32 s18, s31, 8192
	buffer_load_dwordx4 v60, s[4:7], s18 offen offset:0 sc1 lds
	s_sub_u32 s32, s44, s32
	s_waitcnt vmcnt(9)
	v_mov_b32 v65, s28
	s_mov_b64 exec, 1
	buffer_store_dword v65, v64, s[4:7], s30 offen sc1
	s_mov_b64 exec, -1
	s_waitcnt vmcnt(1)
	s_branch .ggo_615
.gnofin_628:
	s_waitcnt vmcnt(0)
	v_mov_b32 v65, s28
	s_mov_b64 exec, 1
	buffer_store_dword v65, v64, s[4:7], s30 offen sc1
	s_mov_b64 exec, -1
	s_cmp_lt_u32 s28, 64
	s_cbranch_scc1 .gloop_613
	s_branch L_END
.p2align 6
L_ATTB:
	v_and_b32 v79, 63, v0
	v_mov_b32 v75, v0
	v_and_b32 v78, 15, v79
	v_lshrrev_b32 v77, 4, v79
	v_and_b32 v76, 7, v79
	s_lshl_b32 s38, s26, 2
	s_add_u32 s38, s38, s15
	v_lshlrev_b32 v72, 2, v77
	v_add_u32 v73, 0, v72
	v_cmp_gt_u32 s[46:47], v73, v78
	v_add_u32 v73, 1, v72
	v_cmp_gt_u32 s[48:49], v73, v78
	v_add_u32 v73, 2, v72
	v_cmp_gt_u32 s[50:51], v73, v78
	v_add_u32 v73, 3, v72
	v_cmp_gt_u32 s[52:53], v73, v78
	v_lshlrev_b32 v220, 4, v79
	v_lshlrev_b32 v228, 3, v79
	v_mov_b32 v224, 0
	v_mov_b32 v226, 0x3e0293ee
	v_mov_b32 v227, 0xff7fffff
	s_mul_i32 s19, s27, 0x20
	s_add_u32 s19, s19, 0x40
	s_add_u32 s19, s19, s38
	v_min_u32 v221, 3, v79
	v_lshrrev_b32 v74, 2, v221
	v_add_u32 v74, s19, v74
	v_lshlrev_b32 v74, 7, v74
	v_and_b32 v221, 3, v221
	v_lshlrev_b32 v221, 2, v221
	v_add_u32 v221, v221, v74
	s_mul_i32 s19, s27, 0x20
	s_add_u32 s19, s19, 0x0
	s_add_u32 s19, s19, s38
	v_min_u32 v222, 3, v79
	v_lshrrev_b32 v74, 2, v222
	v_add_u32 v74, s19, v74
	v_lshlrev_b32 v74, 7, v74
	v_and_b32 v222, 3, v222
	v_lshlrev_b32 v222, 2, v222
	v_add_u32 v222, v222, v74
	s_mul_i32 s19, s27, 0x3c
	s_add_u32 s19, s19, 0xac
	s_lshr_b32 s17, s26, 1
	s_mul_i32 s17, s17, 3
	s_add_u32 s19, s19, s17
	v_min_u32 v212, 11, v79
	v_lshrrev_b32 v74, 2, v212
	v_add_u32 v74, s19, v74
	v_lshlrev_b32 v74, 7, v74
	v_and_b32 v212, 3, v212
	v_lshlrev_b32 v212, 2, v212
	v_add_u32 v212, v212, v74
	s_lshl_b32 s30, s14, 7
	s_lshl_b32 s17, s15, 2
	s_add_u32 s30, s30, s17
	s_mul_i32 s60, s27, 0x1000000
	s_add_u32 s60, s60, 0xaa80000
	s_mul_i32 s61, s27, 0x1200000
	s_add_u32 s61, s61, 0xca80000
	s_lshl_b32 s62, s26, 2
	s_add_u32 s62, s62, s15
	s_mul_i32 s39, s27, 50331648
	s_mul_i32 s17, s38, 24576
	s_add_u32 s39, s39, s17
	s_add_u32 s39, s39, 2097152
	s_mul_i32 s40, s27, 16777216
	s_lshl_b32 s17, s38, 13
	s_add_u32 s40, s40, s17
	s_add_u32 s40, s40, 102760448
	s_mul_i32 s41, s27, 0x1000000
	s_add_u32 s41, s41, 0xaa80000
	s_lshr_b32 s17, s38, 3
	s_lshl_b32 s17, s17, 16
	s_add_u32 s41, s41, s17
	s_and_b32 s17, s38, 7
	s_lshl_b32 s17, s17, 12
	s_add_u32 s41, s41, s17
	v_mov_b32 v74, 0
	s_mov_b32 s20, 400000
	v_and_b32 v72, 7, v79
	v_lshrrev_b32 v73, 2, v72
	v_mul_u32_u24 v73, 112, v73
	v_lshlrev_b32 v72, 2, v72
	v_add_u32 v72, v72, v73
	s_getpc_b64 s[18:19]
.ct_632:
	s_sub_u32 s18, s18, .ct_632-L_ATTB
	s_subb_u32 s19, s19, 0
	v_lshlrev_b32 v74, 7, v79
	s_lshl_b32 s17, s15, 13
	v_add_u32 v74, s17, v74
	s_mov_b32 s17, L_ATTB_CE-L_ATTB-4
	v_min_u32 v74, s17, v74
	global_load_dword v73, v74, s[18:19]
	v_mov_b32 v74, 0
.gbre_629:
	global_load_dword v73, v72, s[12:13] offset:16 sc1
	s_waitcnt vmcnt(0)
	v_readlane_b32 s17, v73, 0
	v_readlane_b32 s18, v73, 1
	s_nop 0
	s_add_u32 s17, s17, s18
	v_readlane_b32 s18, v73, 2
	s_nop 0
	s_add_u32 s17, s17, s18
	v_readlane_b32 s18, v73, 3
	s_nop 0
	s_add_u32 s17, s17, s18
	v_readlane_b32 s18, v73, 4
	s_nop 0
	s_add_u32 s17, s17, s18
	v_readlane_b32 s18, v73, 5
	s_nop 0
	s_add_u32 s17, s17, s18
	v_readlane_b32 s18, v73, 6
	s_nop 0
	s_add_u32 s17, s17, s18
	v_readlane_b32 s18, v73, 7
	s_nop 0
	s_add_u32 s17, s17, s18
	s_cmp_ge_u32 s17, 256
	s_cbranch_scc1 .gbok_630
	s_sub_u32 s20, s20, 1
	s_cmp_lg_u32 s20, 0
	s_cbranch_scc1 .gbre_629
	s_branch L_FAIL
.gbok_630:
	v_cmp_ne_u32 vcc, 32, v73
	s_cbranch_vccnz L_ATTB_DEV
	s_lshl_b32 s17, s62, 10
	s_add_u32 s17, s17, s60
	s_add_u32 s18, s60, 1048576
.pt_633:
	buffer_load_dwordx4 v[0:3], v220, s[4:7], s17 offen
	s_add_u32 s17, s17, 32768
	s_cmp_lt_u32 s17, s18
	s_cbranch_scc1 .pt_633
	s_lshl_b32 s17, s62, 10
	s_add_u32 s17, s17, s61
	s_add_u32 s18, s61, 1179648
.pt_634:
	buffer_load_dwordx4 v[0:3], v220, s[4:7], s17 offen
	s_add_u32 s17, s17, 32768
	s_cmp_lt_u32 s17, s18
	s_cbranch_scc1 .pt_634
	s_waitcnt vmcnt(0)
	s_mov_b32 s28, 0
	s_mov_b32 s37, 1
	s_mov_b32 s20, 400000
.pre_635:
	buffer_load_dword v223, v221, s[4:7], 0 offen sc1
	s_waitcnt vmcnt(0)
	v_cmp_gt_u32 vcc, s37, v223
	s_cbranch_vccz .pok_636
	s_sub_u32 s20, s20, 1
	s_cmp_lg_u32 s20, 0
	s_cbranch_scc1 .pre_635
	s_branch L_FAIL
.pok_636:
	s_add_u32 s17, s39, 0
	buffer_load_dwordx4 v[0:3], v220, s[4:7], s17 offen offset:0 nt
	buffer_load_dwordx4 v[4:7], v220, s[4:7], s17 offen offset:1024 nt
	buffer_load_dwordx4 v[8:11], v220, s[4:7], s17 offen offset:2048 nt
	buffer_load_dwordx4 v[12:15], v220, s[4:7], s17 offen offset:3072 nt
	s_add_u32 s17, s39, 4096
	buffer_load_dwordx4 v[16:19], v220, s[4:7], s17 offen offset:0 nt
	buffer_load_dwordx4 v[20:23], v220, s[4:7], s17 offen offset:1024 nt
	buffer_load_dwordx4 v[24:27], v220, s[4:7], s17 offen offset:2048 nt
	buffer_load_dwordx4 v[28:31], v220, s[4:7], s17 offen offset:3072 nt
	s_add_u32 s17, s39, 8192
	buffer_load_dwordx4 v[32:35], v220, s[4:7], s17 offen offset:0 nt
	buffer_load_dwordx4 v[36:39], v220, s[4:7], s17 offen offset:1024 nt
	buffer_load_dwordx4 v[40:43], v220, s[4:7], s17 offen offset:2048 nt
	buffer_load_dwordx4 v[44:47], v220, s[4:7], s17 offen offset:3072 nt
	s_add_u32 s17, s39, 12288
	buffer_load_dwordx4 v[48:51], v220, s[4:7], s17 offen offset:0 nt
	buffer_load_dwordx4 v[52:55], v220, s[4:7], s17 offen offset:1024 nt
	buffer_load_dwordx4 v[56:59], v220, s[4:7], s17 offen offset:2048 nt
	buffer_load_dwordx4 v[60:63], v220, s[4:7], s17 offen offset:3072 nt
	s_add_u32 s17, s39, 16384
	buffer_load_dwordx4 v[64:67], v220, s[4:7], s17 offen offset:0 nt
	buffer_load_dwordx4 v[68:71], v220, s[4:7], s17 offen offset:1024 nt
	buffer_load_dwordx4 v[72:75], v220, s[4:7], s17 offen offset:2048 nt
	buffer_load_dwordx4 v[76:79], v220, s[4:7], s17 offen offset:3072 nt
	s_add_u32 s17, s39, 20480
	buffer_load_dwordx4 v[80:83], v220, s[4:7], s17 offen offset:0 nt
	buffer_load_dwordx4 v[84:87], v220, s[4:7], s17 offen offset:1024 nt
	buffer_load_dwordx4 v[88:91], v220, s[4:7], s17 offen offset:2048 nt
	buffer_load_dwordx4 v[92:95], v220, s[4:7], s17 offen offset:3072 nt
	s_add_u32 s39, s39, 786432
	s_waitcnt vmcnt(8)
	s_branch .bslow_637_2
.bloop_639:
	v_cmp_gt_u32 vcc, s37, v223
	s_cbranch_vccnz .bslow_637
	buffer_load_dword v213, v212, s[4:7], 0 offen sc1
	s_add_u32 s17, s40, 4096
	buffer_load_dwordx4 v[96:99], v220, s[4:7], s40 offen offset:0
	buffer_load_dwordx4 v[100:103], v220, s[4:7], s40 offen offset:1024
	buffer_load_dwordx4 v[104:107], v220, s[4:7], s40 offen offset:2048
	buffer_load_dwordx4 v[108:111], v220, s[4:7], s40 offen offset:3072
	buffer_load_dwordx2 v[112:113], v228, s[4:7], s17 offen offset:0
	buffer_load_dwordx2 v[114:115], v228, s[4:7], s17 offen offset:512
	buffer_load_dwordx2 v[116:117], v228, s[4:7], s17 offen offset:1024
	buffer_load_dwordx2 v[118:119], v228, s[4:7], s17 offen offset:1536
	s_add_u32 s40, s40, 262144
	s_waitcnt vmcnt(18)
	v_mfma_f32_16x16x32_bf16 v[128:131], v[32:35], v[0:3], 0
	v_mfma_f32_16x16x32_bf16 v[132:135], v[32:35], v[16:19], 0
	v_mfma_f32_16x16x32_bf16 v[136:139], v[48:51], v[16:19], 0
	v_mfma_f32_16x16x32_bf16 v[128:131], v[36:39], v[4:7], v[128:131]
	v_mfma_f32_16x16x32_bf16 v[132:135], v[36:39], v[20:23], v[132:135]
	v_mfma_f32_16x16x32_bf16 v[136:139], v[52:55], v[20:23], v[136:139]
	v_mfma_f32_16x16x32_bf16 v[128:131], v[40:43], v[8:11], v[128:131]
	v_mfma_f32_16x16x32_bf16 v[132:135], v[40:43], v[24:27], v[132:135]
	v_mfma_f32_16x16x32_bf16 v[136:139], v[56:59], v[24:27], v[136:139]
	v_mfma_f32_16x16x32_bf16 v[128:131], v[44:47], v[12:15], v[128:131]
	v_mfma_f32_16x16x32_bf16 v[132:135], v[44:47], v[28:31], v[132:135]
	v_mfma_f32_16x16x32_bf16 v[136:139], v[60:63], v[28:31], v[136:139]
	s_nop 7
	s_branch .bjoin_638
.bslow_637:
	s_waitcnt vmcnt(9)
.bslow_637_2:
	v_mfma_f32_16x16x32_bf16 v[128:131], v[32:35], v[0:3], 0
	v_mfma_f32_16x16x32_bf16 v[132:135], v[32:35], v[16:19], 0
	v_mfma_f32_16x16x32_bf16 v[136:139], v[48:51], v[16:19], 0
	v_mfma_f32_16x16x32_bf16 v[128:131], v[36:39], v[4:7], v[128:131]
	v_mfma_f32_16x16x32_bf16 v[132:135], v[36:39], v[20:23], v[132:135]
	v_mfma_f32_16x16x32_bf16 v[136:139], v[52:55], v[20:23], v[136:139]
	v_mfma_f32_16x16x32_bf16 v[128:131], v[40:43], v[8:11], v[128:131]
	v_mfma_f32_16x16x32_bf16 v[132:135], v[40:43], v[24:27], v[132:135]
	v_mfma_f32_16x16x32_bf16 v[136:139], v[56:59], v[24:27], v[136:139]
	v_mfma_f32_16x16x32_bf16 v[128:131], v[44:47], v[12:15], v[128:131]
	v_mfma_f32_16x16x32_bf16 v[132:135], v[44:47], v[28:31], v[132:135]
	v_mfma_f32_16x16x32_bf16 v[136:139], v[60:63], v[28:31], v[136:139]
	s_mov_b32 s20, 400000
.pre_640:
	buffer_load_dword v223, v222, s[4:7], 0 offen sc1
	s_waitcnt vmcnt(0)
	v_cmp_gt_u32 vcc, s37, v223
	s_cbranch_vccz .pok_641
	s_sub_u32 s20, s20, 1
	s_cmp_lg_u32 s20, 0
	s_cbranch_scc1 .pre_640
	s_branch L_FAIL
.pok_641:
	buffer_load_dword v213, v212, s[4:7], 0 offen sc1
	s_add_u32 s17, s40, 4096
	buffer_load_dwordx4 v[96:99], v220, s[4:7], s40 offen offset:0
	buffer_load_dwordx4 v[100:103], v220, s[4:7], s40 offen offset:1024
	buffer_load_dwordx4 v[104:107], v220, s[4:7], s40 offen offset:2048
	buffer_load_dwordx4 v[108:111], v220, s[4:7], s40 offen offset:3072
	buffer_load_dwordx2 v[112:113], v228, s[4:7], s17 offen offset:0
	buffer_load_dwordx2 v[114:115], v228, s[4:7], s17 offen offset:512
	buffer_load_dwordx2 v[116:117], v228, s[4:7], s17 offen offset:1024
	buffer_load_dwordx2 v[118:119], v228, s[4:7], s17 offen offset:1536
	s_add_u32 s40, s40, 262144
.bjoin_638:
	v_cndmask_b32 v128, v128, v227, s[46:47]
	v_cndmask_b32 v136, v136, v227, s[46:47]
	v_cndmask_b32 v129, v129, v227, s[48:49]
	v_cndmask_b32 v137, v137, v227, s[48:49]
	v_cndmask_b32 v130, v130, v227, s[50:51]
	v_cndmask_b32 v138, v138, v227, s[50:51]
	v_cndmask_b32 v131, v131, v227, s[52:53]
	v_cndmask_b32 v139, v139, v227, s[52:53]
	s_waitcnt vmcnt(4)
	v_mfma_f32_16x16x32_bf16 v[140:143], v[96:99], v[0:3], 0
	v_mfma_f32_16x16x32_bf16 v[144:147], v[96:99], v[16:19], 0
	v_mfma_f32_16x16x32_bf16 v[140:143], v[100:103], v[4:7], v[140:143]
	v_mfma_f32_16x16x32_bf16 v[144:147], v[100:103], v[20:23], v[144:147]
	v_mfma_f32_16x16x32_bf16 v[140:143], v[104:107], v[8:11], v[140:143]
	v_mfma_f32_16x16x32_bf16 v[144:147], v[104:107], v[24:27], v[144:147]
	v_mfma_f32_16x16x32_bf16 v[140:143], v[108:111], v[12:15], v[140:143]
	v_mfma_f32_16x16x32_bf16 v[144:147], v[108:111], v[28:31], v[144:147]
	v_max3_f32 v230, v128, v129, v130
	s_nop 5
	v_max3_f32 v230, v230, v131, v140
	v_max_f32 v230, v230, v141
	v_max3_f32 v232, v132, v133, v134
	v_max3_f32 v232, v232, v135, v136
	v_max3_f32 v232, v232, v137, v138
	v_max3_f32 v232, v232, v139, v144
	v_max_f32 v232, v232, v145
	v_mov_b32 v234, v230
	s_nop 1
	v_permlane16_swap_b32 v230, v234
	v_max_f32 v230, v230, v234
	v_mov_b32 v234, v230
	s_nop 1
	v_permlane32_swap_b32 v230, v234
	v_max_f32 v230, v230, v234
	v_mov_b32 v235, v232
	s_nop 1
	v_permlane16_swap_b32 v232, v235
	v_max_f32 v232, v232, v235
	v_mov_b32 v235, v232
	s_nop 1
	v_permlane32_swap_b32 v232, v235
	v_max_f32 v232, v232, v235
	v_mul_f32 v236, 0xbe0293ee, v230
	v_mul_f32 v237, 0xbe0293ee, v232
	v_fma_f32 v128, v128, v226, v236
	v_fma_f32 v129, v129, v226, v236
	v_fma_f32 v130, v130, v226, v236
	v_fma_f32 v131, v131, v226, v236
	v_fma_f32 v140, v140, v226, v236
	v_fma_f32 v141, v141, v226, v236
	v_fma_f32 v132, v132, v226, v237
	v_fma_f32 v133, v133, v226, v237
	v_fma_f32 v134, v134, v226, v237
	v_fma_f32 v135, v135, v226, v237
	v_fma_f32 v136, v136, v226, v237
	v_fma_f32 v137, v137, v226, v237
	v_fma_f32 v138, v138, v226, v237
	v_fma_f32 v139, v139, v226, v237
	v_fma_f32 v144, v144, v226, v237
	v_fma_f32 v145, v145, v226, v237
	v_exp_f32 v128, v128
	v_exp_f32 v129, v129
	v_exp_f32 v130, v130
	v_exp_f32 v131, v131
	v_exp_f32 v140, v140
	v_exp_f32 v141, v141
	v_exp_f32 v132, v132
	v_exp_f32 v133, v133
	v_exp_f32 v134, v134
	v_exp_f32 v135, v135
	v_exp_f32 v136, v136
	v_exp_f32 v137, v137
	v_exp_f32 v138, v138
	v_exp_f32 v139, v139
	v_exp_f32 v144, v144
	v_exp_f32 v145, v145
	v_cvt_pk_bf16_f32 v240, v128, v129
	v_cvt_pk_bf16_f32 v241, v130, v131
	v_mov_b32 v242, 0
	v_mov_b32 v243, 0
	v_cvt_pk_bf16_f32 v244, v132, v133
	v_cvt_pk_bf16_f32 v245, v134, v135
	v_cvt_pk_bf16_f32 v246, v136, v137
	v_cvt_pk_bf16_f32 v247, v138, v139
	v_cvt_pk_bf16_f32 v248, v140, v141
	v_mov_b32 v249, 0
	v_mov_b32 v250, 0
	v_mov_b32 v251, v248
	v_cvt_pk_bf16_f32 v252, v144, v145
	v_mov_b32 v253, 0
	v_mov_b32 v254, 0
	v_mov_b32 v255, v252
	v_mfma_f32_16x16x32_bf16 v[148:151], v[64:67], v[240:243], 0
	v_mfma_f32_16x16x32_bf16 v[180:183], v[64:67], v[244:247], 0
	v_mfma_f32_16x16x32_bf16 v[152:155], v[68:71], v[240:243], 0
	v_mfma_f32_16x16x32_bf16 v[184:187], v[68:71], v[244:247], 0
	v_mfma_f32_16x16x32_bf16 v[156:159], v[72:75], v[240:243], 0
	v_mfma_f32_16x16x32_bf16 v[188:191], v[72:75], v[244:247], 0
	v_mfma_f32_16x16x32_bf16 v[160:163], v[76:79], v[240:243], 0
	v_mfma_f32_16x16x32_bf16 v[192:195], v[76:79], v[244:247], 0
	v_mfma_f32_16x16x32_bf16 v[164:167], v[80:83], v[240:243], 0
	v_mfma_f32_16x16x32_bf16 v[196:199], v[80:83], v[244:247], 0
	v_mfma_f32_16x16x32_bf16 v[168:171], v[84:87], v[240:243], 0
	v_mfma_f32_16x16x32_bf16 v[200:203], v[84:87], v[244:247], 0
	v_mfma_f32_16x16x32_bf16 v[172:175], v[88:91], v[240:243], 0
	v_mfma_f32_16x16x32_bf16 v[204:207], v[88:91], v[244:247], 0
	v_mfma_f32_16x16x32_bf16 v[176:179], v[92:95], v[240:243], 0
	v_mfma_f32_16x16x32_bf16 v[208:211], v[92:95], v[244:247], 0
	v_add_f32 v238, v128, v129
	v_add_f32 v238, v238, v130
	v_add_f32 v238, v238, v131
	v_add_f32 v238, v238, v140
	v_add_f32 v238, v238, v141
	v_add_f32 v239, v132, v133
	v_add_f32 v239, v239, v134
	v_add_f32 v239, v239, v135
	v_add_f32 v239, v239, v136
	v_add_f32 v239, v239, v137
	v_add_f32 v239, v239, v138
	v_add_f32 v239, v239, v139
	v_add_f32 v239, v239, v144
	v_add_f32 v239, v239, v145
	s_waitcnt vmcnt(0)
	v_mfma_f32_16x16x16_bf16 v[148:151], v[112:113], v[248:249], v[148:151]
	v_mfma_f32_16x16x16_bf16 v[180:183], v[112:113], v[252:253], v[180:183]
	v_mfma_f32_16x16x16_bf16 v[152:155], v[112:113], v[250:251], v[152:155]
	v_mfma_f32_16x16x16_bf16 v[184:187], v[112:113], v[254:255], v[184:187]
	v_mfma_f32_16x16x16_bf16 v[156:159], v[114:115], v[248:249], v[156:159]
	v_mfma_f32_16x16x16_bf16 v[188:191], v[114:115], v[252:253], v[188:191]
	v_mfma_f32_16x16x16_bf16 v[160:163], v[114:115], v[250:251], v[160:163]
	v_mfma_f32_16x16x16_bf16 v[192:195], v[114:115], v[254:255], v[192:195]
	v_mfma_f32_16x16x16_bf16 v[164:167], v[116:117], v[248:249], v[164:167]
	v_mfma_f32_16x16x16_bf16 v[196:199], v[116:117], v[252:253], v[196:199]
	v_mfma_f32_16x16x16_bf16 v[168:171], v[116:117], v[250:251], v[168:171]
	v_mfma_f32_16x16x16_bf16 v[200:203], v[116:117], v[254:255], v[200:203]
	v_mfma_f32_16x16x16_bf16 v[172:175], v[118:119], v[248:249], v[172:175]
	v_mfma_f32_16x16x16_bf16 v[204:207], v[118:119], v[252:253], v[204:207]
	v_mfma_f32_16x16x16_bf16 v[176:179], v[118:119], v[250:251], v[176:179]
	v_mfma_f32_16x16x16_bf16 v[208:211], v[118:119], v[254:255], v[208:211]
	v_mov_b32 v234, v238
	s_nop 1
	v_permlane16_swap_b32 v238, v234
	v_add_f32 v238, v238, v234
	v_mov_b32 v234, v238
	s_nop 1
	v_permlane32_swap_b32 v238, v234
	v_add_f32 v238, v238, v234
	v_mov_b32 v235, v239
	s_nop 1
	v_permlane16_swap_b32 v239, v235
	v_add_f32 v239, v239, v235
	v_mov_b32 v235, v239
	s_nop 1
	v_permlane32_swap_b32 v239, v235
	v_add_f32 v239, v239, v235
	v_rcp_f32 v238, v238
	v_rcp_f32 v239, v239
	s_sub_i32 s60, s28, 3
	s_max_i32 s60, s60, 0
	v_cmp_gt_u32 vcc, s60, v213
	s_cbranch_vccz .pck_642
	s_mov_b32 s20, 400000
.pre_643:
	buffer_load_dword v213, v212, s[4:7], 0 offen sc1
	s_waitcnt vmcnt(0)
	v_cmp_gt_u32 vcc, s60, v213
	s_cbranch_vccz .pok_644
	s_sub_u32 s20, s20, 1
	s_cmp_lg_u32 s20, 0
	s_cbranch_scc1 .pre_643
	s_branch L_FAIL
.pok_644:
.pck_642:
	s_and_b32 s61, s28, 3
	s_mul_i32 s61, s61, 262144
	s_add_u32 s61, s61, s41
	s_add_u32 s17, s61, 0
	v_mul_f32 v148, v148, v238
	v_mul_f32 v149, v149, v238
	v_mul_f32 v150, v150, v238
	v_mul_f32 v151, v151, v238
	v_mul_f32 v152, v152, v238
	v_mul_f32 v153, v153, v238
	v_mul_f32 v154, v154, v238
	v_mul_f32 v155, v155, v238
	v_cvt_pk_bf16_f32 v148, v148, v149
	v_cvt_pk_bf16_f32 v149, v150, v151
	v_cvt_pk_bf16_f32 v150, v152, v153
	v_cvt_pk_bf16_f32 v151, v154, v155
	buffer_store_dwordx4 v[148:151], v220, s[4:7], s17 offen offset:0
	v_mul_f32 v156, v156, v238
	v_mul_f32 v157, v157, v238
	v_mul_f32 v158, v158, v238
	v_mul_f32 v159, v159, v238
	v_mul_f32 v160, v160, v238
	v_mul_f32 v161, v161, v238
	v_mul_f32 v162, v162, v238
	v_mul_f32 v163, v163, v238
	v_cvt_pk_bf16_f32 v156, v156, v157
	v_cvt_pk_bf16_f32 v157, v158, v159
	v_cvt_pk_bf16_f32 v158, v160, v161
	v_cvt_pk_bf16_f32 v159, v162, v163
	buffer_store_dwordx4 v[156:159], v220, s[4:7], s17 offen offset:1024
	v_mul_f32 v164, v164, v238
	v_mul_f32 v165, v165, v238
	v_mul_f32 v166, v166, v238
	v_mul_f32 v167, v167, v238
	v_mul_f32 v168, v168, v238
	v_mul_f32 v169, v169, v238
	v_mul_f32 v170, v170, v238
	v_mul_f32 v171, v171, v238
	v_cvt_pk_bf16_f32 v164, v164, v165
	v_cvt_pk_bf16_f32 v165, v166, v167
	v_cvt_pk_bf16_f32 v166, v168, v169
	v_cvt_pk_bf16_f32 v167, v170, v171
	buffer_store_dwordx4 v[164:167], v220, s[4:7], s17 offen offset:2048
	v_mul_f32 v172, v172, v238
	v_mul_f32 v173, v173, v238
	v_mul_f32 v174, v174, v238
	v_mul_f32 v175, v175, v238
	v_mul_f32 v176, v176, v238
	v_mul_f32 v177, v177, v238
	v_mul_f32 v178, v178, v238
	v_mul_f32 v179, v179, v238
	v_cvt_pk_bf16_f32 v172, v172, v173
	v_cvt_pk_bf16_f32 v173, v174, v175
	v_cvt_pk_bf16_f32 v174, v176, v177
	v_cvt_pk_bf16_f32 v175, v178, v179
	buffer_store_dwordx4 v[172:175], v220, s[4:7], s17 offen offset:3072
	s_add_u32 s17, s61, 32768
	v_mul_f32 v180, v180, v239
	v_mul_f32 v181, v181, v239
	v_mul_f32 v182, v182, v239
	v_mul_f32 v183, v183, v239
	v_mul_f32 v184, v184, v239
	v_mul_f32 v185, v185, v239
	v_mul_f32 v186, v186, v239
	v_mul_f32 v187, v187, v239
	v_cvt_pk_bf16_f32 v180, v180, v181
	v_cvt_pk_bf16_f32 v181, v182, v183
	v_cvt_pk_bf16_f32 v182, v184, v185
	v_cvt_pk_bf16_f32 v183, v186, v187
	buffer_store_dwordx4 v[180:183], v220, s[4:7], s17 offen offset:0
	v_mul_f32 v188, v188, v239
	v_mul_f32 v189, v189, v239
	v_mul_f32 v190, v190, v239
	v_mul_f32 v191, v191, v239
	v_mul_f32 v192, v192, v239
	v_mul_f32 v193, v193, v239
	v_mul_f32 v194, v194, v239
	v_mul_f32 v195, v195, v239
	v_cvt_pk_bf16_f32 v188, v188, v189
	v_cvt_pk_bf16_f32 v189, v190, v191
	v_cvt_pk_bf16_f32 v190, v192, v193
	v_cvt_pk_bf16_f32 v191, v194, v195
	buffer_store_dwordx4 v[188:191], v220, s[4:7], s17 offen offset:1024
	v_mul_f32 v196, v196, v239
	v_mul_f32 v197, v197, v239
	v_mul_f32 v198, v198, v239
	v_mul_f32 v199, v199, v239
	v_mul_f32 v200, v200, v239
	v_mul_f32 v201, v201, v239
	v_mul_f32 v202, v202, v239
	v_mul_f32 v203, v203, v239
	v_cvt_pk_bf16_f32 v196, v196, v197
	v_cvt_pk_bf16_f32 v197, v198, v199
	v_cvt_pk_bf16_f32 v198, v200, v201
	v_cvt_pk_bf16_f32 v199, v202, v203
	buffer_store_dwordx4 v[196:199], v220, s[4:7], s17 offen offset:2048
	v_mul_f32 v204, v204, v239
	v_mul_f32 v205, v205, v239
	v_mul_f32 v206, v206, v239
	v_mul_f32 v207, v207, v239
	v_mul_f32 v208, v208, v239
	v_mul_f32 v209, v209, v239
	v_mul_f32 v210, v210, v239
	v_mul_f32 v211, v211, v239
	v_cvt_pk_bf16_f32 v204, v204, v205
	v_cvt_pk_bf16_f32 v205, v206, v207
	v_cvt_pk_bf16_f32 v206, v208, v209
	v_cvt_pk_bf16_f32 v207, v210, v211
	buffer_store_dwordx4 v[204:207], v220, s[4:7], s17 offen offset:3072
	s_add_u32 s28, s28, 1
	s_cmp_ge_u32 s28, 64
	s_cbranch_scc1 .blast_645
	buffer_load_dword v223, v222, s[4:7], 0 offen sc1
	s_add_u32 s17, s39, 0
	buffer_load_dwordx4 v[0:3], v220, s[4:7], s17 offen offset:0 nt
	buffer_load_dwordx4 v[4:7], v220, s[4:7], s17 offen offset:1024 nt
	buffer_load_dwordx4 v[8:11], v220, s[4:7], s17 offen offset:2048 nt
	buffer_load_dwordx4 v[12:15], v220, s[4:7], s17 offen offset:3072 nt
	s_add_u32 s17, s39, 4096
	buffer_load_dwordx4 v[16:19], v220, s[4:7], s17 offen offset:0 nt
	buffer_load_dwordx4 v[20:23], v220, s[4:7], s17 offen offset:1024 nt
	buffer_load_dwordx4 v[24:27], v220, s[4:7], s17 offen offset:2048 nt
	buffer_load_dwordx4 v[28:31], v220, s[4:7], s17 offen offset:3072 nt
	s_add_u32 s17, s39, 8192
	buffer_load_dwordx4 v[32:35], v220, s[4:7], s17 offen offset:0 nt
	buffer_load_dwordx4 v[36:39], v220, s[4:7], s17 offen offset:1024 nt
	buffer_load_dwordx4 v[40:43], v220, s[4:7], s17 offen offset:2048 nt
	buffer_load_dwordx4 v[44:47], v220, s[4:7], s17 offen offset:3072 nt
	s_add_u32 s17, s39, 12288
	buffer_load_dwordx4 v[48:51], v220, s[4:7], s17 offen offset:0 nt
	buffer_load_dwordx4 v[52:55], v220, s[4:7], s17 offen offset:1024 nt
	buffer_load_dwordx4 v[56:59], v220, s[4:7], s17 offen offset:2048 nt
	buffer_load_dwordx4 v[60:63], v220, s[4:7], s17 offen offset:3072 nt
	s_add_u32 s17, s39, 16384
	buffer_load_dwordx4 v[64:67], v220, s[4:7], s17 offen offset:0 nt
	buffer_load_dwordx4 v[68:71], v220, s[4:7], s17 offen offset:1024 nt
	buffer_load_dwordx4 v[72:75], v220, s[4:7], s17 offen offset:2048 nt
	buffer_load_dwordx4 v[76:79], v220, s[4:7], s17 offen offset:3072 nt
	s_add_u32 s17, s39, 20480
	buffer_load_dwordx4 v[80:83], v220, s[4:7], s17 offen offset:0 nt
	buffer_load_dwordx4 v[84:87], v220, s[4:7], s17 offen offset:1024 nt
	buffer_load_dwordx4 v[88:91], v220, s[4:7], s17 offen offset:2048 nt
	buffer_load_dwordx4 v[92:95], v220, s[4:7], s17 offen offset:3072 nt
	s_add_u32 s39, s39, 786432
	s_waitcnt vmcnt(24)
	v_mov_b32 v225, s28
	s_mov_b64 exec, 1
	buffer_store_dword v225, v224, s[4:7], s30 offen
	s_mov_b64 exec, -1
	s_add_u32 s37, s28, 1
	s_branch .bloop_639
.blast_645:
	s_waitcnt vmcnt(0)
	v_mov_b32 v225, s28
	s_mov_b64 exec, 1
	buffer_store_dword v225, v224, s[4:7], s30 offen
	s_mov_b64 exec, -1
	s_branch L_END
L_ATTB_CE:
L_ATTB_DEV:
	s_mov_b32 s28, 0
	s_mov_b32 s37, 1
	s_mov_b32 s20, 400000
.pre_650:
	buffer_load_dword v223, v221, s[4:7], 0 offen sc1
	s_waitcnt vmcnt(0)
	v_cmp_gt_u32 vcc, s37, v223
	s_cbranch_vccz .pok_651
	s_sub_u32 s20, s20, 1
	s_cmp_lg_u32 s20, 0
	s_cbranch_scc1 .pre_650
	s_branch L_FAIL
.pok_651:
	s_add_u32 s17, s39, 0
	buffer_load_dwordx4 v[0:3], v220, s[4:7], s17 offen offset:0 nt
	buffer_load_dwordx4 v[4:7], v220, s[4:7], s17 offen offset:1024 nt
	buffer_load_dwordx4 v[8:11], v220, s[4:7], s17 offen offset:2048 nt
	buffer_load_dwordx4 v[12:15], v220, s[4:7], s17 offen offset:3072 nt
	s_add_u32 s17, s39, 4096
	buffer_load_dwordx4 v[16:19], v220, s[4:7], s17 offen offset:0 nt
	buffer_load_dwordx4 v[20:23], v220, s[4:7], s17 offen offset:1024 nt
	buffer_load_dwordx4 v[24:27], v220, s[4:7], s17 offen offset:2048 nt
	buffer_load_dwordx4 v[28:31], v220, s[4:7], s17 offen offset:3072 nt
	s_add_u32 s17, s39, 8192
	buffer_load_dwordx4 v[32:35], v220, s[4:7], s17 offen offset:0 nt
	buffer_load_dwordx4 v[36:39], v220, s[4:7], s17 offen offset:1024 nt
	buffer_load_dwordx4 v[40:43], v220, s[4:7], s17 offen offset:2048 nt
	buffer_load_dwordx4 v[44:47], v220, s[4:7], s17 offen offset:3072 nt
	s_add_u32 s17, s39, 12288
	buffer_load_dwordx4 v[48:51], v220, s[4:7], s17 offen offset:0 nt
	buffer_load_dwordx4 v[52:55], v220, s[4:7], s17 offen offset:1024 nt
	buffer_load_dwordx4 v[56:59], v220, s[4:7], s17 offen offset:2048 nt
	buffer_load_dwordx4 v[60:63], v220, s[4:7], s17 offen offset:3072 nt
	s_add_u32 s17, s39, 16384
	buffer_load_dwordx4 v[64:67], v220, s[4:7], s17 offen offset:0 nt
	buffer_load_dwordx4 v[68:71], v220, s[4:7], s17 offen offset:1024 nt
	buffer_load_dwordx4 v[72:75], v220, s[4:7], s17 offen offset:2048 nt
	buffer_load_dwordx4 v[76:79], v220, s[4:7], s17 offen offset:3072 nt
	s_add_u32 s17, s39, 20480
	buffer_load_dwordx4 v[80:83], v220, s[4:7], s17 offen offset:0 nt
	buffer_load_dwordx4 v[84:87], v220, s[4:7], s17 offen offset:1024 nt
	buffer_load_dwordx4 v[88:91], v220, s[4:7], s17 offen offset:2048 nt
	buffer_load_dwordx4 v[92:95], v220, s[4:7], s17 offen offset:3072 nt
	s_add_u32 s39, s39, 786432
	s_waitcnt vmcnt(8)
	s_branch .bslow_652_2
.bloop_654:
	v_cmp_gt_u32 vcc, s37, v223
	s_cbranch_vccnz .bslow_652
	buffer_load_dword v213, v212, s[4:7], 0 offen sc1
	s_add_u32 s17, s40, 4096
	buffer_load_dwordx4 v[96:99], v220, s[4:7], s40 offen offset:0
	buffer_load_dwordx4 v[100:103], v220, s[4:7], s40 offen offset:1024
	buffer_load_dwordx4 v[104:107], v220, s[4:7], s40 offen offset:2048
	buffer_load_dwordx4 v[108:111], v220, s[4:7], s40 offen offset:3072
	buffer_load_dwordx2 v[112:113], v228, s[4:7], s17 offen offset:0
	buffer_load_dwordx2 v[114:115], v228, s[4:7], s17 offen offset:512
	buffer_load_dwordx2 v[116:117], v228, s[4:7], s17 offen offset:1024
	buffer_load_dwordx2 v[118:119], v228, s[4:7], s17 offen offset:1536
	s_add_u32 s40, s40, 262144
	s_waitcnt vmcnt(18)
	v_mfma_f32_16x16x32_bf16 v[128:131], v[32:35], v[0:3], 0
	v_mfma_f32_16x16x32_bf16 v[132:135], v[32:35], v[16:19], 0
	v_mfma_f32_16x16x32_bf16 v[136:139], v[48:51], v[16:19], 0
	v_mfma_f32_16x16x32_bf16 v[128:131], v[36:39], v[4:7], v[128:131]
	v_mfma_f32_16x16x32_bf16 v[132:135], v[36:39], v[20:23], v[132:135]
	v_mfma_f32_16x16x32_bf16 v[136:139], v[52:55], v[20:23], v[136:139]
	v_mfma_f32_16x16x32_bf16 v[128:131], v[40:43], v[8:11], v[128:131]
	v_mfma_f32_16x16x32_bf16 v[132:135], v[40:43], v[24:27], v[132:135]
	v_mfma_f32_16x16x32_bf16 v[136:139], v[56:59], v[24:27], v[136:139]
	v_mfma_f32_16x16x32_bf16 v[128:131], v[44:47], v[12:15], v[128:131]
	v_mfma_f32_16x16x32_bf16 v[132:135], v[44:47], v[28:31], v[132:135]
	v_mfma_f32_16x16x32_bf16 v[136:139], v[60:63], v[28:31], v[136:139]
	s_nop 7
	s_branch .bjoin_653
.bslow_652:
	s_waitcnt vmcnt(9)
.bslow_652_2:
	v_mfma_f32_16x16x32_bf16 v[128:131], v[32:35], v[0:3], 0
	v_mfma_f32_16x16x32_bf16 v[132:135], v[32:35], v[16:19], 0
	v_mfma_f32_16x16x32_bf16 v[136:139], v[48:51], v[16:19], 0
	v_mfma_f32_16x16x32_bf16 v[128:131], v[36:39], v[4:7], v[128:131]
	v_mfma_f32_16x16x32_bf16 v[132:135], v[36:39], v[20:23], v[132:135]
	v_mfma_f32_16x16x32_bf16 v[136:139], v[52:55], v[20:23], v[136:139]
	v_mfma_f32_16x16x32_bf16 v[128:131], v[40:43], v[8:11], v[128:131]
	v_mfma_f32_16x16x32_bf16 v[132:135], v[40:43], v[24:27], v[132:135]
	v_mfma_f32_16x16x32_bf16 v[136:139], v[56:59], v[24:27], v[136:139]
	v_mfma_f32_16x16x32_bf16 v[128:131], v[44:47], v[12:15], v[128:131]
	v_mfma_f32_16x16x32_bf16 v[132:135], v[44:47], v[28:31], v[132:135]
	v_mfma_f32_16x16x32_bf16 v[136:139], v[60:63], v[28:31], v[136:139]
	s_mov_b32 s20, 400000
.pre_655:
	buffer_load_dword v223, v222, s[4:7], 0 offen sc1
	s_waitcnt vmcnt(0)
	v_cmp_gt_u32 vcc, s37, v223
	s_cbranch_vccz .pok_656
	s_sub_u32 s20, s20, 1
	s_cmp_lg_u32 s20, 0
	s_cbranch_scc1 .pre_655
	s_branch L_FAIL
.pok_656:
	buffer_load_dword v213, v212, s[4:7], 0 offen sc1
	s_add_u32 s17, s40, 4096
	buffer_load_dwordx4 v[96:99], v220, s[4:7], s40 offen offset:0
	buffer_load_dwordx4 v[100:103], v220, s[4:7], s40 offen offset:1024
	buffer_load_dwordx4 v[104:107], v220, s[4:7], s40 offen offset:2048
	buffer_load_dwordx4 v[108:111], v220, s[4:7], s40 offen offset:3072
	buffer_load_dwordx2 v[112:113], v228, s[4:7], s17 offen offset:0
	buffer_load_dwordx2 v[114:115], v228, s[4:7], s17 offen offset:512
	buffer_load_dwordx2 v[116:117], v228, s[4:7], s17 offen offset:1024
	buffer_load_dwordx2 v[118:119], v228, s[4:7], s17 offen offset:1536
	s_add_u32 s40, s40, 262144
.bjoin_653:
	v_cndmask_b32 v128, v128, v227, s[46:47]
	v_cndmask_b32 v136, v136, v227, s[46:47]
	v_cndmask_b32 v129, v129, v227, s[48:49]
	v_cndmask_b32 v137, v137, v227, s[48:49]
	v_cndmask_b32 v130, v130, v227, s[50:51]
	v_cndmask_b32 v138, v138, v227, s[50:51]
	v_cndmask_b32 v131, v131, v227, s[52:53]
	v_cndmask_b32 v139, v139, v227, s[52:53]
	s_waitcnt vmcnt(4)
	v_mfma_f32_16x16x32_bf16 v[140:143], v[96:99], v[0:3], 0
	v_mfma_f32_16x16x32_bf16 v[144:147], v[96:99], v[16:19], 0
	v_mfma_f32_16x16x32_bf16 v[140:143], v[100:103], v[4:7], v[140:143]
	v_mfma_f32_16x16x32_bf16 v[144:147], v[100:103], v[20:23], v[144:147]
	v_mfma_f32_16x16x32_bf16 v[140:143], v[104:107], v[8:11], v[140:143]
	v_mfma_f32_16x16x32_bf16 v[144:147], v[104:107], v[24:27], v[144:147]
	v_mfma_f32_16x16x32_bf16 v[140:143], v[108:111], v[12:15], v[140:143]
	v_mfma_f32_16x16x32_bf16 v[144:147], v[108:111], v[28:31], v[144:147]
	v_max3_f32 v230, v128, v129, v130
	s_nop 5
	v_max3_f32 v230, v230, v131, v140
	v_max_f32 v230, v230, v141
	v_max3_f32 v232, v132, v133, v134
	v_max3_f32 v232, v232, v135, v136
	v_max3_f32 v232, v232, v137, v138
	v_max3_f32 v232, v232, v139, v144
	v_max_f32 v232, v232, v145
	v_mov_b32 v234, v230
	s_nop 1
	v_permlane16_swap_b32 v230, v234
	v_max_f32 v230, v230, v234
	v_mov_b32 v234, v230
	s_nop 1
	v_permlane32_swap_b32 v230, v234
	v_max_f32 v230, v230, v234
	v_mov_b32 v235, v232
	s_nop 1
	v_permlane16_swap_b32 v232, v235
	v_max_f32 v232, v232, v235
	v_mov_b32 v235, v232
	s_nop 1
	v_permlane32_swap_b32 v232, v235
	v_max_f32 v232, v232, v235
	v_mul_f32 v236, 0xbe0293ee, v230
	v_mul_f32 v237, 0xbe0293ee, v232
	v_fma_f32 v128, v128, v226, v236
	v_fma_f32 v129, v129, v226, v236
	v_fma_f32 v130, v130, v226, v236
	v_fma_f32 v131, v131, v226, v236
	v_fma_f32 v140, v140, v226, v236
	v_fma_f32 v141, v141, v226, v236
	v_fma_f32 v132, v132, v226, v237
	v_fma_f32 v133, v133, v226, v237
	v_fma_f32 v134, v134, v226, v237
	v_fma_f32 v135, v135, v226, v237
	v_fma_f32 v136, v136, v226, v237
	v_fma_f32 v137, v137, v226, v237
	v_fma_f32 v138, v138, v226, v237
	v_fma_f32 v139, v139, v226, v237
	v_fma_f32 v144, v144, v226, v237
	v_fma_f32 v145, v145, v226, v237
	v_exp_f32 v128, v128
	v_exp_f32 v129, v129
	v_exp_f32 v130, v130
	v_exp_f32 v131, v131
	v_exp_f32 v140, v140
	v_exp_f32 v141, v141
	v_exp_f32 v132, v132
	v_exp_f32 v133, v133
	v_exp_f32 v134, v134
	v_exp_f32 v135, v135
	v_exp_f32 v136, v136
	v_exp_f32 v137, v137
	v_exp_f32 v138, v138
	v_exp_f32 v139, v139
	v_exp_f32 v144, v144
	v_exp_f32 v145, v145
	v_cvt_pk_bf16_f32 v240, v128, v129
	v_cvt_pk_bf16_f32 v241, v130, v131
	v_mov_b32 v242, 0
	v_mov_b32 v243, 0
	v_cvt_pk_bf16_f32 v244, v132, v133
	v_cvt_pk_bf16_f32 v245, v134, v135
	v_cvt_pk_bf16_f32 v246, v136, v137
	v_cvt_pk_bf16_f32 v247, v138, v139
	v_cvt_pk_bf16_f32 v248, v140, v141
	v_mov_b32 v249, 0
	v_mov_b32 v250, 0
	v_mov_b32 v251, v248
	v_cvt_pk_bf16_f32 v252, v144, v145
	v_mov_b32 v253, 0
	v_mov_b32 v254, 0
	v_mov_b32 v255, v252
	v_mfma_f32_16x16x32_bf16 v[148:151], v[64:67], v[240:243], 0
	v_mfma_f32_16x16x32_bf16 v[180:183], v[64:67], v[244:247], 0
	v_mfma_f32_16x16x32_bf16 v[152:155], v[68:71], v[240:243], 0
	v_mfma_f32_16x16x32_bf16 v[184:187], v[68:71], v[244:247], 0
	v_mfma_f32_16x16x32_bf16 v[156:159], v[72:75], v[240:243], 0
	v_mfma_f32_16x16x32_bf16 v[188:191], v[72:75], v[244:247], 0
	v_mfma_f32_16x16x32_bf16 v[160:163], v[76:79], v[240:243], 0
	v_mfma_f32_16x16x32_bf16 v[192:195], v[76:79], v[244:247], 0
	v_mfma_f32_16x16x32_bf16 v[164:167], v[80:83], v[240:243], 0
	v_mfma_f32_16x16x32_bf16 v[196:199], v[80:83], v[244:247], 0
	v_mfma_f32_16x16x32_bf16 v[168:171], v[84:87], v[240:243], 0
	v_mfma_f32_16x16x32_bf16 v[200:203], v[84:87], v[244:247], 0
	v_mfma_f32_16x16x32_bf16 v[172:175], v[88:91], v[240:243], 0
	v_mfma_f32_16x16x32_bf16 v[204:207], v[88:91], v[244:247], 0
	v_mfma_f32_16x16x32_bf16 v[176:179], v[92:95], v[240:243], 0
	v_mfma_f32_16x16x32_bf16 v[208:211], v[92:95], v[244:247], 0
	v_add_f32 v238, v128, v129
	v_add_f32 v238, v238, v130
	v_add_f32 v238, v238, v131
	v_add_f32 v238, v238, v140
	v_add_f32 v238, v238, v141
	v_add_f32 v239, v132, v133
	v_add_f32 v239, v239, v134
	v_add_f32 v239, v239, v135
	v_add_f32 v239, v239, v136
	v_add_f32 v239, v239, v137
	v_add_f32 v239, v239, v138
	v_add_f32 v239, v239, v139
	v_add_f32 v239, v239, v144
	v_add_f32 v239, v239, v145
	s_waitcnt vmcnt(0)
	v_mfma_f32_16x16x16_bf16 v[148:151], v[112:113], v[248:249], v[148:151]
	v_mfma_f32_16x16x16_bf16 v[180:183], v[112:113], v[252:253], v[180:183]
	v_mfma_f32_16x16x16_bf16 v[152:155], v[112:113], v[250:251], v[152:155]
	v_mfma_f32_16x16x16_bf16 v[184:187], v[112:113], v[254:255], v[184:187]
	v_mfma_f32_16x16x16_bf16 v[156:159], v[114:115], v[248:249], v[156:159]
	v_mfma_f32_16x16x16_bf16 v[188:191], v[114:115], v[252:253], v[188:191]
	v_mfma_f32_16x16x16_bf16 v[160:163], v[114:115], v[250:251], v[160:163]
	v_mfma_f32_16x16x16_bf16 v[192:195], v[114:115], v[254:255], v[192:195]
	v_mfma_f32_16x16x16_bf16 v[164:167], v[116:117], v[248:249], v[164:167]
	v_mfma_f32_16x16x16_bf16 v[196:199], v[116:117], v[252:253], v[196:199]
	v_mfma_f32_16x16x16_bf16 v[168:171], v[116:117], v[250:251], v[168:171]
	v_mfma_f32_16x16x16_bf16 v[200:203], v[116:117], v[254:255], v[200:203]
	v_mfma_f32_16x16x16_bf16 v[172:175], v[118:119], v[248:249], v[172:175]
	v_mfma_f32_16x16x16_bf16 v[204:207], v[118:119], v[252:253], v[204:207]
	v_mfma_f32_16x16x16_bf16 v[176:179], v[118:119], v[250:251], v[176:179]
	v_mfma_f32_16x16x16_bf16 v[208:211], v[118:119], v[254:255], v[208:211]
	v_mov_b32 v234, v238
	s_nop 1
	v_permlane16_swap_b32 v238, v234
	v_add_f32 v238, v238, v234
	v_mov_b32 v234, v238
	s_nop 1
	v_permlane32_swap_b32 v238, v234
	v_add_f32 v238, v238, v234
	v_mov_b32 v235, v239
	s_nop 1
	v_permlane16_swap_b32 v239, v235
	v_add_f32 v239, v239, v235
	v_mov_b32 v235, v239
	s_nop 1
	v_permlane32_swap_b32 v239, v235
	v_add_f32 v239, v239, v235
	v_rcp_f32 v238, v238
	v_rcp_f32 v239, v239
	s_sub_i32 s60, s28, 3
	s_max_i32 s60, s60, 0
	v_cmp_gt_u32 vcc, s60, v213
	s_cbranch_vccz .pck_657
	s_mov_b32 s20, 400000
.pre_658:
	buffer_load_dword v213, v212, s[4:7], 0 offen sc1
	s_waitcnt vmcnt(0)
	v_cmp_gt_u32 vcc, s60, v213
	s_cbranch_vccz .pok_659
	s_sub_u32 s20, s20, 1
	s_cmp_lg_u32 s20, 0
	s_cbranch_scc1 .pre_658
	s_branch L_FAIL
.pok_659:
.pck_657:
	s_and_b32 s61, s28, 3
	s_mul_i32 s61, s61, 262144
	s_add_u32 s61, s61, s41
	s_add_u32 s17, s61, 0
	v_mul_f32 v148, v148, v238
	v_mul_f32 v149, v149, v238
	v_mul_f32 v150, v150, v238
	v_mul_f32 v151, v151, v238
	v_mul_f32 v152, v152, v238
	v_mul_f32 v153, v153, v238
	v_mul_f32 v154, v154, v238
	v_mul_f32 v155, v155, v238
	v_cvt_pk_bf16_f32 v148, v148, v149
	v_cvt_pk_bf16_f32 v149, v150, v151
	v_cvt_pk_bf16_f32 v150, v152, v153
	v_cvt_pk_bf16_f32 v151, v154, v155
	buffer_store_dwordx4 v[148:151], v220, s[4:7], s17 offen offset:0 sc1
	v_mul_f32 v156, v156, v238
	v_mul_f32 v157, v157, v238
	v_mul_f32 v158, v158, v238
	v_mul_f32 v159, v159, v238
	v_mul_f32 v160, v160, v238
	v_mul_f32 v161, v161, v238
	v_mul_f32 v162, v162, v238
	v_mul_f32 v163, v163, v238
	v_cvt_pk_bf16_f32 v156, v156, v157
	v_cvt_pk_bf16_f32 v157, v158, v159
	v_cvt_pk_bf16_f32 v158, v160, v161
	v_cvt_pk_bf16_f32 v159, v162, v163
	buffer_store_dwordx4 v[156:159], v220, s[4:7], s17 offen offset:1024 sc1
	v_mul_f32 v164, v164, v238
	v_mul_f32 v165, v165, v238
	v_mul_f32 v166, v166, v238
	v_mul_f32 v167, v167, v238
	v_mul_f32 v168, v168, v238
	v_mul_f32 v169, v169, v238
	v_mul_f32 v170, v170, v238
	v_mul_f32 v171, v171, v238
	v_cvt_pk_bf16_f32 v164, v164, v165
	v_cvt_pk_bf16_f32 v165, v166, v167
	v_cvt_pk_bf16_f32 v166, v168, v169
	v_cvt_pk_bf16_f32 v167, v170, v171
	buffer_store_dwordx4 v[164:167], v220, s[4:7], s17 offen offset:2048 sc1
	v_mul_f32 v172, v172, v238
	v_mul_f32 v173, v173, v238
	v_mul_f32 v174, v174, v238
	v_mul_f32 v175, v175, v238
	v_mul_f32 v176, v176, v238
	v_mul_f32 v177, v177, v238
	v_mul_f32 v178, v178, v238
	v_mul_f32 v179, v179, v238
	v_cvt_pk_bf16_f32 v172, v172, v173
	v_cvt_pk_bf16_f32 v173, v174, v175
	v_cvt_pk_bf16_f32 v174, v176, v177
	v_cvt_pk_bf16_f32 v175, v178, v179
	buffer_store_dwordx4 v[172:175], v220, s[4:7], s17 offen offset:3072 sc1
	s_add_u32 s17, s61, 32768
	v_mul_f32 v180, v180, v239
	v_mul_f32 v181, v181, v239
	v_mul_f32 v182, v182, v239
	v_mul_f32 v183, v183, v239
	v_mul_f32 v184, v184, v239
	v_mul_f32 v185, v185, v239
	v_mul_f32 v186, v186, v239
	v_mul_f32 v187, v187, v239
	v_cvt_pk_bf16_f32 v180, v180, v181
	v_cvt_pk_bf16_f32 v181, v182, v183
	v_cvt_pk_bf16_f32 v182, v184, v185
	v_cvt_pk_bf16_f32 v183, v186, v187
	buffer_store_dwordx4 v[180:183], v220, s[4:7], s17 offen offset:0 sc1
	v_mul_f32 v188, v188, v239
	v_mul_f32 v189, v189, v239
	v_mul_f32 v190, v190, v239
	v_mul_f32 v191, v191, v239
	v_mul_f32 v192, v192, v239
	v_mul_f32 v193, v193, v239
	v_mul_f32 v194, v194, v239
	v_mul_f32 v195, v195, v239
	v_cvt_pk_bf16_f32 v188, v188, v189
	v_cvt_pk_bf16_f32 v189, v190, v191
	v_cvt_pk_bf16_f32 v190, v192, v193
	v_cvt_pk_bf16_f32 v191, v194, v195
	buffer_store_dwordx4 v[188:191], v220, s[4:7], s17 offen offset:1024 sc1
	v_mul_f32 v196, v196, v239
	v_mul_f32 v197, v197, v239
	v_mul_f32 v198, v198, v239
	v_mul_f32 v199, v199, v239
	v_mul_f32 v200, v200, v239
	v_mul_f32 v201, v201, v239
	v_mul_f32 v202, v202, v239
	v_mul_f32 v203, v203, v239
	v_cvt_pk_bf16_f32 v196, v196, v197
	v_cvt_pk_bf16_f32 v197, v198, v199
	v_cvt_pk_bf16_f32 v198, v200, v201
	v_cvt_pk_bf16_f32 v199, v202, v203
	buffer_store_dwordx4 v[196:199], v220, s[4:7], s17 offen offset:2048 sc1
	v_mul_f32 v204, v204, v239
	v_mul_f32 v205, v205, v239
	v_mul_f32 v206, v206, v239
	v_mul_f32 v207, v207, v239
	v_mul_f32 v208, v208, v239
	v_mul_f32 v209, v209, v239
	v_mul_f32 v210, v210, v239
	v_mul_f32 v211, v211, v239
	v_cvt_pk_bf16_f32 v204, v204, v205
	v_cvt_pk_bf16_f32 v205, v206, v207
	v_cvt_pk_bf16_f32 v206, v208, v209
	v_cvt_pk_bf16_f32 v207, v210, v211
	buffer_store_dwordx4 v[204:207], v220, s[4:7], s17 offen offset:3072 sc1
	s_add_u32 s28, s28, 1
	s_cmp_ge_u32 s28, 64
	s_cbranch_scc1 .blast_660
	buffer_load_dword v223, v222, s[4:7], 0 offen sc1
	s_add_u32 s17, s39, 0
	buffer_load_dwordx4 v[0:3], v220, s[4:7], s17 offen offset:0 nt
	buffer_load_dwordx4 v[4:7], v220, s[4:7], s17 offen offset:1024 nt
	buffer_load_dwordx4 v[8:11], v220, s[4:7], s17 offen offset:2048 nt
	buffer_load_dwordx4 v[12:15], v220, s[4:7], s17 offen offset:3072 nt
	s_add_u32 s17, s39, 4096
	buffer_load_dwordx4 v[16:19], v220, s[4:7], s17 offen offset:0 nt
	buffer_load_dwordx4 v[20:23], v220, s[4:7], s17 offen offset:1024 nt
	buffer_load_dwordx4 v[24:27], v220, s[4:7], s17 offen offset:2048 nt
	buffer_load_dwordx4 v[28:31], v220, s[4:7], s17 offen offset:3072 nt
	s_add_u32 s17, s39, 8192
	buffer_load_dwordx4 v[32:35], v220, s[4:7], s17 offen offset:0 nt
	buffer_load_dwordx4 v[36:39], v220, s[4:7], s17 offen offset:1024 nt
	buffer_load_dwordx4 v[40:43], v220, s[4:7], s17 offen offset:2048 nt
	buffer_load_dwordx4 v[44:47], v220, s[4:7], s17 offen offset:3072 nt
	s_add_u32 s17, s39, 12288
	buffer_load_dwordx4 v[48:51], v220, s[4:7], s17 offen offset:0 nt
	buffer_load_dwordx4 v[52:55], v220, s[4:7], s17 offen offset:1024 nt
	buffer_load_dwordx4 v[56:59], v220, s[4:7], s17 offen offset:2048 nt
	buffer_load_dwordx4 v[60:63], v220, s[4:7], s17 offen offset:3072 nt
	s_add_u32 s17, s39, 16384
	buffer_load_dwordx4 v[64:67], v220, s[4:7], s17 offen offset:0 nt
	buffer_load_dwordx4 v[68:71], v220, s[4:7], s17 offen offset:1024 nt
	buffer_load_dwordx4 v[72:75], v220, s[4:7], s17 offen offset:2048 nt
	buffer_load_dwordx4 v[76:79], v220, s[4:7], s17 offen offset:3072 nt
	s_add_u32 s17, s39, 20480
	buffer_load_dwordx4 v[80:83], v220, s[4:7], s17 offen offset:0 nt
	buffer_load_dwordx4 v[84:87], v220, s[4:7], s17 offen offset:1024 nt
	buffer_load_dwordx4 v[88:91], v220, s[4:7], s17 offen offset:2048 nt
	buffer_load_dwordx4 v[92:95], v220, s[4:7], s17 offen offset:3072 nt
	s_add_u32 s39, s39, 786432
	s_waitcnt vmcnt(24)
	v_mov_b32 v225, s28
	s_mov_b64 exec, 1
	buffer_store_dword v225, v224, s[4:7], s30 offen sc1
	s_mov_b64 exec, -1
	s_add_u32 s37, s28, 1
	s_branch .bloop_654
.blast_660:
	s_waitcnt vmcnt(0)
	v_mov_b32 v225, s28
	s_mov_b64 exec, 1
	buffer_store_dword v225, v224, s[4:7], s30 offen sc1
	s_mov_b64 exec, -1
	s_branch L_END
.p2align 6
L_B3:
	v_and_b32 v79, 63, v0
	v_mov_b32 v75, v0
	v_and_b32 v78, 15, v79
	v_lshrrev_b32 v77, 4, v79
	v_and_b32 v76, 7, v79
	s_cmp_eq_u32 s27, 0
	s_cbranch_scc1 .idef_661
	s_cmp_lg_u32 s15, 0
	s_cbranch_scc1 .idok_663
	s_mov_b32 s20, 400000
	v_mov_b32 v10, 0
.idre_662:
	global_load_dword v11, v10, s[12:13] offset:176 sc1
	s_waitcnt vmcnt(0)
	v_readfirstlane_b32 s17, v11
	s_nop 0
	s_cmp_ge_u32 s17, 64
	s_cbranch_scc1 .idok_663
	s_sleep 8
	s_sub_u32 s20, s20, 1
	s_cmp_lg_u32 s20, 0
	s_cbranch_scc1 .idre_662
	s_branch L_FAIL
.idok_663:
	s_barrier
.idef_661:
	s_mul_i32 s38, s26, 43
	s_lshr_b32 s38, s38, 7
	s_mul_i32 s17, s38, 3
	s_sub_u32 s17, s26, s17
	s_mul_i32 s39, s17, 12
	s_mul_i32 s17, s15, 3
	s_add_u32 s39, s39, s17
	s_mul_i32 s40, s38, 1179648
	s_lshl_b32 s17, s39, 5
	s_add_u32 s40, s40, s17
	v_lshrrev_b32 v68, 1, v79
	v_mul_u32_u24 v68, 1152, v68
	v_and_b32 v72, 1, v79
	v_lshlrev_b32 v72, 4, v72
	v_add_u32 v68, v68, v72
	s_load_dwordx2 s[22:23], s[0:1], 64
	s_waitcnt lgkmcnt(0)
	s_mov_b32 s8, s22
	s_and_b32 s9, s23, 0xffff
	s_mov_b32 s10, 0x480000
	s_mov_b32 s11, 0x00020000
	v_lshrrev_b32 v72, 2, v78
	v_lshlrev_b32 v73, 2, v77
	v_add_u32 v72, v72, v73
	v_lshlrev_b32 v72, 5, v72
	v_and_b32 v73, 3, v78
	v_lshlrev_b32 v73, 3, v73
	v_add_u32 v72, v72, v73
	s_mul_i32 s17, s15, 36864
	v_add_u32 v70, s17, v72
	s_mul_i32 s63, s15, 36864
	s_add_u32 s62, s40, 0
	s_mov_b32 m0, s63
	s_nop 0
	buffer_load_dwordx4 v68, s[8:11], s62 offen lds
	s_mul_i32 s63, s15, 36864
	s_add_u32 s63, s63, 1024
	s_add_u32 s62, s40, 32
	s_mov_b32 m0, s63
	s_nop 0
	buffer_load_dwordx4 v68, s[8:11], s62 offen lds
	s_mul_i32 s63, s15, 36864
	s_add_u32 s63, s63, 2048
	s_add_u32 s62, s40, 64
	s_mov_b32 m0, s63
	s_nop 0
	buffer_load_dwordx4 v68, s[8:11], s62 offen lds
	s_mul_i32 s63, s15, 36864
	s_add_u32 s63, s63, 3072
	s_add_u32 s62, s40, 36864
	s_mov_b32 m0, s63
	s_nop 0
	buffer_load_dwordx4 v68, s[8:11], s62 offen lds
	s_mul_i32 s63, s15, 36864
	s_add_u32 s63, s63, 4096
	s_add_u32 s62, s40, 36896
	s_mov_b32 m0, s63
	s_nop 0
	buffer_load_dwordx4 v68, s[8:11], s62 offen lds
	s_mul_i32 s63, s15, 36864
	s_add_u32 s63, s63, 5120
	s_add_u32 s62, s40, 36928
	s_mov_b32 m0, s63
	s_nop 0
	buffer_load_dwordx4 v68, s[8:11], s62 offen lds
	s_mul_i32 s63, s15, 36864
	s_add_u32 s63, s63, 6144
	s_add_u32 s62, s40, 73728
	s_mov_b32 m0, s63
	s_nop 0
	buffer_load_dwordx4 v68, s[8:11], s62 offen lds
	s_mul_i32 s63, s15, 36864
	s_add_u32 s63, s63, 7168
	s_add_u32 s62, s40, 73760
	s_mov_b32 m0, s63
	s_nop 0
	buffer_load_dwordx4 v68, s[8:11], s62 offen lds
	s_mul_i32 s63, s15, 36864
	s_add_u32 s63, s63, 8192
	s_add_u32 s62, s40, 73792
	s_mov_b32 m0, s63
	s_nop 0
	buffer_load_dwordx4 v68, s[8:11], s62 offen lds
	s_mul_i32 s63, s15, 36864
	s_add_u32 s63, s63, 9216
	s_add_u32 s62, s40, 110592
	s_mov_b32 m0, s63
	s_nop 0
	buffer_load_dwordx4 v68, s[8:11], s62 offen lds
	s_mul_i32 s63, s15, 36864
	s_add_u32 s63, s63, 10240
	s_add_u32 s62, s40, 110624
	s_mov_b32 m0, s63
	s_nop 0
	buffer_load_dwordx4 v68, s[8:11], s62 offen lds
	s_mul_i32 s63, s15, 36864
	s_add_u32 s63, s63, 11264
	s_add_u32 s62, s40, 110656
	s_mov_b32 m0, s63
	s_nop 0
	buffer_load_dwordx4 v68, s[8:11], s62 offen lds
	s_mul_i32 s63, s15, 36864
	s_add_u32 s63, s63, 12288
	s_add_u32 s62, s40, 147456
	s_mov_b32 m0, s63
	s_nop 0
	buffer_load_dwordx4 v68, s[8:11], s62 offen lds
	s_mul_i32 s63, s15, 36864
	s_add_u32 s63, s63, 13312
	s_add_u32 s62, s40, 147488
	s_mov_b32 m0, s63
	s_nop 0
	buffer_load_dwordx4 v68, s[8:11], s62 offen lds
	s_mul_i32 s63, s15, 36864
	s_add_u32 s63, s63, 14336
	s_add_u32 s62, s40, 147520
	s_mov_b32 m0, s63
	s_nop 0
	buffer_load_dwordx4 v68, s[8:11], s62 offen lds
	s_mul_i32 s63, s15, 36864
	s_add_u32 s63, s63, 15360
	s_add_u32 s62, s40, 184320
	s_mov_b32 m0, s63
	s_nop 0
	buffer_load_dwordx4 v68, s[8:11], s62 offen lds
	s_mul_i32 s63, s15, 36864
	s_add_u32 s63, s63, 16384
	s_add_u32 s62, s40, 184352
	s_mov_b32 m0, s63
	s_nop 0
	buffer_load_dwordx4 v68, s[8:11], s62 offen lds
	s_mul_i32 s63, s15, 36864
	s_add_u32 s63, s63, 17408
	s_add_u32 s62, s40, 184384
	s_mov_b32 m0, s63
	s_nop 0
	buffer_load_dwordx4 v68, s[8:11], s62 offen lds
	s_mul_i32 s63, s15, 36864
	s_add_u32 s63, s63, 18432
	s_add_u32 s62, s40, 221184
	s_mov_b32 m0, s63
	s_nop 0
	buffer_load_dwordx4 v68, s[8:11], s62 offen lds
	s_mul_i32 s63, s15, 36864
	s_add_u32 s63, s63, 19456
	s_add_u32 s62, s40, 221216
	s_mov_b32 m0, s63
	s_nop 0
	buffer_load_dwordx4 v68, s[8:11], s62 offen lds
	s_mul_i32 s63, s15, 36864
	s_add_u32 s63, s63, 20480
	s_add_u32 s62, s40, 221248
	s_mov_b32 m0, s63
	s_nop 0
	buffer_load_dwordx4 v68, s[8:11], s62 offen lds
	s_mul_i32 s63, s15, 36864
	s_add_u32 s63, s63, 21504
	s_add_u32 s62, s40, 258048
	s_mov_b32 m0, s63
	s_nop 0
	buffer_load_dwordx4 v68, s[8:11], s62 offen lds
	s_mul_i32 s63, s15, 36864
	s_add_u32 s63, s63, 22528
	s_add_u32 s62, s40, 258080
	s_mov_b32 m0, s63
	s_nop 0
	buffer_load_dwordx4 v68, s[8:11], s62 offen lds
	s_mul_i32 s63, s15, 36864
	s_add_u32 s63, s63, 23552
	s_add_u32 s62, s40, 258112
	s_mov_b32 m0, s63
	s_nop 0
	buffer_load_dwordx4 v68, s[8:11], s62 offen lds
	s_mul_i32 s63, s15, 36864
	s_add_u32 s63, s63, 24576
	s_add_u32 s62, s40, 294912
	s_mov_b32 m0, s63
	s_nop 0
	buffer_load_dwordx4 v68, s[8:11], s62 offen lds
	s_mul_i32 s63, s15, 36864
	s_add_u32 s63, s63, 25600
	s_add_u32 s62, s40, 294944
	s_mov_b32 m0, s63
	s_nop 0
	buffer_load_dwordx4 v68, s[8:11], s62 offen lds
	s_mul_i32 s63, s15, 36864
	s_add_u32 s63, s63, 26624
	s_add_u32 s62, s40, 294976
	s_mov_b32 m0, s63
	s_nop 0
	buffer_load_dwordx4 v68, s[8:11], s62 offen lds
	s_mul_i32 s63, s15, 36864
	s_add_u32 s63, s63, 27648
	s_add_u32 s62, s40, 331776
	s_mov_b32 m0, s63
	s_nop 0
	buffer_load_dwordx4 v68, s[8:11], s62 offen lds
	s_mul_i32 s63, s15, 36864
	s_add_u32 s63, s63, 28672
	s_add_u32 s62, s40, 331808
	s_mov_b32 m0, s63
	s_nop 0
	buffer_load_dwordx4 v68, s[8:11], s62 offen lds
	s_mul_i32 s63, s15, 36864
	s_add_u32 s63, s63, 29696
	s_add_u32 s62, s40, 331840
	s_mov_b32 m0, s63
	s_nop 0
	buffer_load_dwordx4 v68, s[8:11], s62 offen lds
	s_mul_i32 s63, s15, 36864
	s_add_u32 s63, s63, 30720
	s_add_u32 s62, s40, 368640
	s_mov_b32 m0, s63
	s_nop 0
	buffer_load_dwordx4 v68, s[8:11], s62 offen lds
	s_mul_i32 s63, s15, 36864
	s_add_u32 s63, s63, 31744
	s_add_u32 s62, s40, 368672
	s_mov_b32 m0, s63
	s_nop 0
	buffer_load_dwordx4 v68, s[8:11], s62 offen lds
	s_waitcnt vmcnt(0)
	ds_read_b64_tr_b16 a[0:1], v70 offset:0
	ds_read_b64_tr_b16 a[2:3], v70 offset:512
	ds_read_b64_tr_b16 a[128:129], v70 offset:1024
	ds_read_b64_tr_b16 a[130:131], v70 offset:1536
	ds_read_b64_tr_b16 v[128:129], v70 offset:2048
	ds_read_b64_tr_b16 v[130:131], v70 offset:2560
	ds_read_b64_tr_b16 a[4:5], v70 offset:3072
	ds_read_b64_tr_b16 a[6:7], v70 offset:3584
	s_waitcnt lgkmcnt(8)
	ds_read_b64_tr_b16 a[132:133], v70 offset:4096
	ds_read_b64_tr_b16 a[134:135], v70 offset:4608
	ds_read_b64_tr_b16 v[132:133], v70 offset:5120
	ds_read_b64_tr_b16 v[134:135], v70 offset:5632
	ds_read_b64_tr_b16 a[8:9], v70 offset:6144
	ds_read_b64_tr_b16 a[10:11], v70 offset:6656
	ds_read_b64_tr_b16 a[136:137], v70 offset:7168
	ds_read_b64_tr_b16 a[138:139], v70 offset:7680
	s_waitcnt lgkmcnt(8)
	ds_read_b64_tr_b16 v[136:137], v70 offset:8192
	ds_read_b64_tr_b16 v[138:139], v70 offset:8704
	ds_read_b64_tr_b16 a[12:13], v70 offset:9216
	ds_read_b64_tr_b16 a[14:15], v70 offset:9728
	ds_read_b64_tr_b16 a[140:141], v70 offset:10240
	ds_read_b64_tr_b16 a[142:143], v70 offset:10752
	ds_read_b64_tr_b16 v[140:141], v70 offset:11264
	ds_read_b64_tr_b16 v[142:143], v70 offset:11776
	s_waitcnt lgkmcnt(8)
	ds_read_b64_tr_b16 a[16:17], v70 offset:12288
	ds_read_b64_tr_b16 a[18:19], v70 offset:12800
	ds_read_b64_tr_b16 a[144:145], v70 offset:13312
	ds_read_b64_tr_b16 a[146:147], v70 offset:13824
	ds_read_b64_tr_b16 v[144:145], v70 offset:14336
	ds_read_b64_tr_b16 v[146:147], v70 offset:14848
	ds_read_b64_tr_b16 a[20:21], v70 offset:15360
	ds_read_b64_tr_b16 a[22:23], v70 offset:15872
	s_waitcnt lgkmcnt(8)
	ds_read_b64_tr_b16 a[148:149], v70 offset:16384
	ds_read_b64_tr_b16 a[150:151], v70 offset:16896
	ds_read_b64_tr_b16 v[148:149], v70 offset:17408
	ds_read_b64_tr_b16 v[150:151], v70 offset:17920
	ds_read_b64_tr_b16 a[24:25], v70 offset:18432
	ds_read_b64_tr_b16 a[26:27], v70 offset:18944
	ds_read_b64_tr_b16 a[152:153], v70 offset:19456
	ds_read_b64_tr_b16 a[154:155], v70 offset:19968
	s_waitcnt lgkmcnt(8)
	ds_read_b64_tr_b16 v[152:153], v70 offset:20480
	ds_read_b64_tr_b16 v[154:155], v70 offset:20992
	ds_read_b64_tr_b16 a[28:29], v70 offset:21504
	ds_read_b64_tr_b16 a[30:31], v70 offset:22016
	ds_read_b64_tr_b16 a[156:157], v70 offset:22528
	ds_read_b64_tr_b16 a[158:159], v70 offset:23040
	ds_read_b64_tr_b16 v[156:157], v70 offset:23552
	ds_read_b64_tr_b16 v[158:159], v70 offset:24064
	s_waitcnt lgkmcnt(8)
	ds_read_b64_tr_b16 a[32:33], v70 offset:24576
	ds_read_b64_tr_b16 a[34:35], v70 offset:25088
	ds_read_b64_tr_b16 a[160:161], v70 offset:25600
	ds_read_b64_tr_b16 a[162:163], v70 offset:26112
	ds_read_b64_tr_b16 v[160:161], v70 offset:26624
	ds_read_b64_tr_b16 v[162:163], v70 offset:27136
	ds_read_b64_tr_b16 a[36:37], v70 offset:27648
	ds_read_b64_tr_b16 a[38:39], v70 offset:28160
	s_waitcnt lgkmcnt(8)
	ds_read_b64_tr_b16 a[164:165], v70 offset:28672
	ds_read_b64_tr_b16 a[166:167], v70 offset:29184
	ds_read_b64_tr_b16 v[164:165], v70 offset:29696
	ds_read_b64_tr_b16 v[166:167], v70 offset:30208
	ds_read_b64_tr_b16 a[40:41], v70 offset:30720
	ds_read_b64_tr_b16 a[42:43], v70 offset:31232
	ds_read_b64_tr_b16 a[168:169], v70 offset:31744
	ds_read_b64_tr_b16 a[170:171], v70 offset:32256
	s_waitcnt lgkmcnt(8)
	s_waitcnt lgkmcnt(0)
	s_mul_i32 s63, s15, 36864
	s_add_u32 s62, s40, 368704
	s_mov_b32 m0, s63
	s_nop 0
	buffer_load_dwordx4 v68, s[8:11], s62 offen lds
	s_mul_i32 s63, s15, 36864
	s_add_u32 s63, s63, 1024
	s_add_u32 s62, s40, 405504
	s_mov_b32 m0, s63
	s_nop 0
	buffer_load_dwordx4 v68, s[8:11], s62 offen lds
	s_mul_i32 s63, s15, 36864
	s_add_u32 s63, s63, 2048
	s_add_u32 s62, s40, 405536
	s_mov_b32 m0, s63
	s_nop 0
	buffer_load_dwordx4 v68, s[8:11], s62 offen lds
	s_mul_i32 s63, s15, 36864
	s_add_u32 s63, s63, 3072
	s_add_u32 s62, s40, 405568
	s_mov_b32 m0, s63
	s_nop 0
	buffer_load_dwordx4 v68, s[8:11], s62 offen lds
	s_mul_i32 s63, s15, 36864
	s_add_u32 s63, s63, 4096
	s_add_u32 s62, s40, 442368
	s_mov_b32 m0, s63
	s_nop 0
	buffer_load_dwordx4 v68, s[8:11], s62 offen lds
	s_mul_i32 s63, s15, 36864
	s_add_u32 s63, s63, 5120
	s_add_u32 s62, s40, 442400
	s_mov_b32 m0, s63
	s_nop 0
	buffer_load_dwordx4 v68, s[8:11], s62 offen lds
	s_mul_i32 s63, s15, 36864
	s_add_u32 s63, s63, 6144
	s_add_u32 s62, s40, 442432
	s_mov_b32 m0, s63
	s_nop 0
	buffer_load_dwordx4 v68, s[8:11], s62 offen lds
	s_mul_i32 s63, s15, 36864
	s_add_u32 s63, s63, 7168
	s_add_u32 s62, s40, 479232
	s_mov_b32 m0, s63
	s_nop 0
	buffer_load_dwordx4 v68, s[8:11], s62 offen lds
	s_mul_i32 s63, s15, 36864
	s_add_u32 s63, s63, 8192
	s_add_u32 s62, s40, 479264
	s_mov_b32 m0, s63
	s_nop 0
	buffer_load_dwordx4 v68, s[8:11], s62 offen lds
	s_mul_i32 s63, s15, 36864
	s_add_u32 s63, s63, 9216
	s_add_u32 s62, s40, 479296
	s_mov_b32 m0, s63
	s_nop 0
	buffer_load_dwordx4 v68, s[8:11], s62 offen lds
	s_mul_i32 s63, s15, 36864
	s_add_u32 s63, s63, 10240
	s_add_u32 s62, s40, 516096
	s_mov_b32 m0, s63
	s_nop 0
	buffer_load_dwordx4 v68, s[8:11], s62 offen lds
	s_mul_i32 s63, s15, 36864
	s_add_u32 s63, s63, 11264
	s_add_u32 s62, s40, 516128
	s_mov_b32 m0, s63
	s_nop 0
	buffer_load_dwordx4 v68, s[8:11], s62 offen lds
	s_mul_i32 s63, s15, 36864
	s_add_u32 s63, s63, 12288
	s_add_u32 s62, s40, 516160
	s_mov_b32 m0, s63
	s_nop 0
	buffer_load_dwordx4 v68, s[8:11], s62 offen lds
	s_mul_i32 s63, s15, 36864
	s_add_u32 s63, s63, 13312
	s_add_u32 s62, s40, 552960
	s_mov_b32 m0, s63
	s_nop 0
	buffer_load_dwordx4 v68, s[8:11], s62 offen lds
	s_mul_i32 s63, s15, 36864
	s_add_u32 s63, s63, 14336
	s_add_u32 s62, s40, 552992
	s_mov_b32 m0, s63
	s_nop 0
	buffer_load_dwordx4 v68, s[8:11], s62 offen lds
	s_mul_i32 s63, s15, 36864
	s_add_u32 s63, s63, 15360
	s_add_u32 s62, s40, 553024
	s_mov_b32 m0, s63
	s_nop 0
	buffer_load_dwordx4 v68, s[8:11], s62 offen lds
	s_mul_i32 s63, s15, 36864
	s_add_u32 s63, s63, 16384
	s_add_u32 s62, s40, 589824
	s_mov_b32 m0, s63
	s_nop 0
	buffer_load_dwordx4 v68, s[8:11], s62 offen lds
	s_mul_i32 s63, s15, 36864
	s_add_u32 s63, s63, 17408
	s_add_u32 s62, s40, 589856
	s_mov_b32 m0, s63
	s_nop 0
	buffer_load_dwordx4 v68, s[8:11], s62 offen lds
	s_mul_i32 s63, s15, 36864
	s_add_u32 s63, s63, 18432
	s_add_u32 s62, s40, 589888
	s_mov_b32 m0, s63
	s_nop 0
	buffer_load_dwordx4 v68, s[8:11], s62 offen lds
	s_mul_i32 s63, s15, 36864
	s_add_u32 s63, s63, 19456
	s_add_u32 s62, s40, 626688
	s_mov_b32 m0, s63
	s_nop 0
	buffer_load_dwordx4 v68, s[8:11], s62 offen lds
	s_mul_i32 s63, s15, 36864
	s_add_u32 s63, s63, 20480
	s_add_u32 s62, s40, 626720
	s_mov_b32 m0, s63
	s_nop 0
	buffer_load_dwordx4 v68, s[8:11], s62 offen lds
	s_mul_i32 s63, s15, 36864
	s_add_u32 s63, s63, 21504
	s_add_u32 s62, s40, 626752
	s_mov_b32 m0, s63
	s_nop 0
	buffer_load_dwordx4 v68, s[8:11], s62 offen lds
	s_mul_i32 s63, s15, 36864
	s_add_u32 s63, s63, 22528
	s_add_u32 s62, s40, 663552
	s_mov_b32 m0, s63
	s_nop 0
	buffer_load_dwordx4 v68, s[8:11], s62 offen lds
	s_mul_i32 s63, s15, 36864
	s_add_u32 s63, s63, 23552
	s_add_u32 s62, s40, 663584
	s_mov_b32 m0, s63
	s_nop 0
	buffer_load_dwordx4 v68, s[8:11], s62 offen lds
	s_mul_i32 s63, s15, 36864
	s_add_u32 s63, s63, 24576
	s_add_u32 s62, s40, 663616
	s_mov_b32 m0, s63
	s_nop 0
	buffer_load_dwordx4 v68, s[8:11], s62 offen lds
	s_mul_i32 s63, s15, 36864
	s_add_u32 s63, s63, 25600
	s_add_u32 s62, s40, 700416
	s_mov_b32 m0, s63
	s_nop 0
	buffer_load_dwordx4 v68, s[8:11], s62 offen lds
	s_mul_i32 s63, s15, 36864
	s_add_u32 s63, s63, 26624
	s_add_u32 s62, s40, 700448
	s_mov_b32 m0, s63
	s_nop 0
	buffer_load_dwordx4 v68, s[8:11], s62 offen lds
	s_mul_i32 s63, s15, 36864
	s_add_u32 s63, s63, 27648
	s_add_u32 s62, s40, 700480
	s_mov_b32 m0, s63
	s_nop 0
	buffer_load_dwordx4 v68, s[8:11], s62 offen lds
	s_mul_i32 s63, s15, 36864
	s_add_u32 s63, s63, 28672
	s_add_u32 s62, s40, 737280
	s_mov_b32 m0, s63
	s_nop 0
	buffer_load_dwordx4 v68, s[8:11], s62 offen lds
	s_mul_i32 s63, s15, 36864
	s_add_u32 s63, s63, 29696
	s_add_u32 s62, s40, 737312
	s_mov_b32 m0, s63
	s_nop 0
	buffer_load_dwordx4 v68, s[8:11], s62 offen lds
	s_mul_i32 s63, s15, 36864
	s_add_u32 s63, s63, 30720
	s_add_u32 s62, s40, 737344
	s_mov_b32 m0, s63
	s_nop 0
	buffer_load_dwordx4 v68, s[8:11], s62 offen lds
	s_mul_i32 s63, s15, 36864
	s_add_u32 s63, s63, 31744
	s_add_u32 s62, s40, 774144
	s_mov_b32 m0, s63
	s_nop 0
	buffer_load_dwordx4 v68, s[8:11], s62 offen lds
	s_waitcnt vmcnt(0)
	ds_read_b64_tr_b16 v[168:169], v70 offset:0
	ds_read_b64_tr_b16 v[170:171], v70 offset:512
	ds_read_b64_tr_b16 a[44:45], v70 offset:1024
	ds_read_b64_tr_b16 a[46:47], v70 offset:1536
	ds_read_b64_tr_b16 a[172:173], v70 offset:2048
	ds_read_b64_tr_b16 a[174:175], v70 offset:2560
	ds_read_b64_tr_b16 v[172:173], v70 offset:3072
	ds_read_b64_tr_b16 v[174:175], v70 offset:3584
	s_waitcnt lgkmcnt(8)
	ds_read_b64_tr_b16 a[48:49], v70 offset:4096
	ds_read_b64_tr_b16 a[50:51], v70 offset:4608
	ds_read_b64_tr_b16 a[176:177], v70 offset:5120
	ds_read_b64_tr_b16 a[178:179], v70 offset:5632
	ds_read_b64_tr_b16 v[176:177], v70 offset:6144
	ds_read_b64_tr_b16 v[178:179], v70 offset:6656
	ds_read_b64_tr_b16 a[52:53], v70 offset:7168
	ds_read_b64_tr_b16 a[54:55], v70 offset:7680
	s_waitcnt lgkmcnt(8)
	ds_read_b64_tr_b16 a[180:181], v70 offset:8192
	ds_read_b64_tr_b16 a[182:183], v70 offset:8704
	ds_read_b64_tr_b16 v[180:181], v70 offset:9216
	ds_read_b64_tr_b16 v[182:183], v70 offset:9728
	ds_read_b64_tr_b16 a[56:57], v70 offset:10240
	ds_read_b64_tr_b16 a[58:59], v70 offset:10752
	ds_read_b64_tr_b16 a[184:185], v70 offset:11264
	ds_read_b64_tr_b16 a[186:187], v70 offset:11776
	s_waitcnt lgkmcnt(8)
	ds_read_b64_tr_b16 v[184:185], v70 offset:12288
	ds_read_b64_tr_b16 v[186:187], v70 offset:12800
	ds_read_b64_tr_b16 a[60:61], v70 offset:13312
	ds_read_b64_tr_b16 a[62:63], v70 offset:13824
	ds_read_b64_tr_b16 a[188:189], v70 offset:14336
	ds_read_b64_tr_b16 a[190:191], v70 offset:14848
	ds_read_b64_tr_b16 v[188:189], v70 offset:15360
	ds_read_b64_tr_b16 v[190:191], v70 offset:15872
	s_waitcnt lgkmcnt(8)
	ds_read_b64_tr_b16 a[64:65], v70 offset:16384
	ds_read_b64_tr_b16 a[66:67], v70 offset:16896
	ds_read_b64_tr_b16 a[192:193], v70 offset:17408
	ds_read_b64_tr_b16 a[194:195], v70 offset:17920
	ds_read_b64_tr_b16 v[192:193], v70 offset:18432
	ds_read_b64_tr_b16 v[194:195], v70 offset:18944
	ds_read_b64_tr_b16 a[68:69], v70 offset:19456
	ds_read_b64_tr_b16 a[70:71], v70 offset:19968
	s_waitcnt lgkmcnt(8)
	ds_read_b64_tr_b16 a[196:197], v70 offset:20480
	ds_read_b64_tr_b16 a[198:199], v70 offset:20992
	ds_read_b64_tr_b16 v[196:197], v70 offset:21504
	ds_read_b64_tr_b16 v[198:199], v70 offset:22016
	ds_read_b64_tr_b16 a[72:73], v70 offset:22528
	ds_read_b64_tr_b16 a[74:75], v70 offset:23040
	ds_read_b64_tr_b16 a[200:201], v70 offset:23552
	ds_read_b64_tr_b16 a[202:203], v70 offset:24064
	s_waitcnt lgkmcnt(8)
	ds_read_b64_tr_b16 v[200:201], v70 offset:24576
	ds_read_b64_tr_b16 v[202:203], v70 offset:25088
	ds_read_b64_tr_b16 a[76:77], v70 offset:25600
	ds_read_b64_tr_b16 a[78:79], v70 offset:26112
	ds_read_b64_tr_b16 a[204:205], v70 offset:26624
	ds_read_b64_tr_b16 a[206:207], v70 offset:27136
	ds_read_b64_tr_b16 v[204:205], v70 offset:27648
	ds_read_b64_tr_b16 v[206:207], v70 offset:28160
	s_waitcnt lgkmcnt(8)
	ds_read_b64_tr_b16 a[80:81], v70 offset:28672
	ds_read_b64_tr_b16 a[82:83], v70 offset:29184
	ds_read_b64_tr_b16 a[208:209], v70 offset:29696
	ds_read_b64_tr_b16 a[210:211], v70 offset:30208
	ds_read_b64_tr_b16 v[208:209], v70 offset:30720
	ds_read_b64_tr_b16 v[210:211], v70 offset:31232
	ds_read_b64_tr_b16 a[84:85], v70 offset:31744
	ds_read_b64_tr_b16 a[86:87], v70 offset:32256
	s_waitcnt lgkmcnt(8)
	s_waitcnt lgkmcnt(0)
	s_mul_i32 s63, s15, 36864
	s_add_u32 s62, s40, 774176
	s_mov_b32 m0, s63
	s_nop 0
	buffer_load_dwordx4 v68, s[8:11], s62 offen lds
	s_mul_i32 s63, s15, 36864
	s_add_u32 s63, s63, 1024
	s_add_u32 s62, s40, 774208
	s_mov_b32 m0, s63
	s_nop 0
	buffer_load_dwordx4 v68, s[8:11], s62 offen lds
	s_mul_i32 s63, s15, 36864
	s_add_u32 s63, s63, 2048
	s_add_u32 s62, s40, 811008
	s_mov_b32 m0, s63
	s_nop 0
	buffer_load_dwordx4 v68, s[8:11], s62 offen lds
	s_mul_i32 s63, s15, 36864
	s_add_u32 s63, s63, 3072
	s_add_u32 s62, s40, 811040
	s_mov_b32 m0, s63
	s_nop 0
	buffer_load_dwordx4 v68, s[8:11], s62 offen lds
	s_mul_i32 s63, s15, 36864
	s_add_u32 s63, s63, 4096
	s_add_u32 s62, s40, 811072
	s_mov_b32 m0, s63
	s_nop 0
	buffer_load_dwordx4 v68, s[8:11], s62 offen lds
	s_mul_i32 s63, s15, 36864
	s_add_u32 s63, s63, 5120
	s_add_u32 s62, s40, 847872
	s_mov_b32 m0, s63
	s_nop 0
	buffer_load_dwordx4 v68, s[8:11], s62 offen lds
	s_mul_i32 s63, s15, 36864
	s_add_u32 s63, s63, 6144
	s_add_u32 s62, s40, 847904
	s_mov_b32 m0, s63
	s_nop 0
	buffer_load_dwordx4 v68, s[8:11], s62 offen lds
	s_mul_i32 s63, s15, 36864
	s_add_u32 s63, s63, 7168
	s_add_u32 s62, s40, 847936
	s_mov_b32 m0, s63
	s_nop 0
	buffer_load_dwordx4 v68, s[8:11], s62 offen lds
	s_mul_i32 s63, s15, 36864
	s_add_u32 s63, s63, 8192
	s_add_u32 s62, s40, 884736
	s_mov_b32 m0, s63
	s_nop 0
	buffer_load_dwordx4 v68, s[8:11], s62 offen lds
	s_mul_i32 s63, s15, 36864
	s_add_u32 s63, s63, 9216
	s_add_u32 s62, s40, 884768
	s_mov_b32 m0, s63
	s_nop 0
	buffer_load_dwordx4 v68, s[8:11], s62 offen lds
	s_mul_i32 s63, s15, 36864
	s_add_u32 s63, s63, 10240
	s_add_u32 s62, s40, 884800
	s_mov_b32 m0, s63
	s_nop 0
	buffer_load_dwordx4 v68, s[8:11], s62 offen lds
	s_mul_i32 s63, s15, 36864
	s_add_u32 s63, s63, 11264
	s_add_u32 s62, s40, 921600
	s_mov_b32 m0, s63
	s_nop 0
	buffer_load_dwordx4 v68, s[8:11], s62 offen lds
	s_mul_i32 s63, s15, 36864
	s_add_u32 s63, s63, 12288
	s_add_u32 s62, s40, 921632
	s_mov_b32 m0, s63
	s_nop 0
	buffer_load_dwordx4 v68, s[8:11], s62 offen lds
	s_mul_i32 s63, s15, 36864
	s_add_u32 s63, s63, 13312
	s_add_u32 s62, s40, 921664
	s_mov_b32 m0, s63
	s_nop 0
	buffer_load_dwordx4 v68, s[8:11], s62 offen lds
	s_mul_i32 s63, s15, 36864
	s_add_u32 s63, s63, 14336
	s_add_u32 s62, s40, 958464
	s_mov_b32 m0, s63
	s_nop 0
	buffer_load_dwordx4 v68, s[8:11], s62 offen lds
	s_mul_i32 s63, s15, 36864
	s_add_u32 s63, s63, 15360
	s_add_u32 s62, s40, 958496
	s_mov_b32 m0, s63
	s_nop 0
	buffer_load_dwordx4 v68, s[8:11], s62 offen lds
	s_mul_i32 s63, s15, 36864
	s_add_u32 s63, s63, 16384
	s_add_u32 s62, s40, 958528
	s_mov_b32 m0, s63
	s_nop 0
	buffer_load_dwordx4 v68, s[8:11], s62 offen lds
	s_mul_i32 s63, s15, 36864
	s_add_u32 s63, s63, 17408
	s_add_u32 s62, s40, 995328
	s_mov_b32 m0, s63
	s_nop 0
	buffer_load_dwordx4 v68, s[8:11], s62 offen lds
	s_mul_i32 s63, s15, 36864
	s_add_u32 s63, s63, 18432
	s_add_u32 s62, s40, 995360
	s_mov_b32 m0, s63
	s_nop 0
	buffer_load_dwordx4 v68, s[8:11], s62 offen lds
	s_mul_i32 s63, s15, 36864
	s_add_u32 s63, s63, 19456
	s_add_u32 s62, s40, 995392
	s_mov_b32 m0, s63
	s_nop 0
	buffer_load_dwordx4 v68, s[8:11], s62 offen lds
	s_mul_i32 s63, s15, 36864
	s_add_u32 s63, s63, 20480
	s_add_u32 s62, s40, 1032192
	s_mov_b32 m0, s63
	s_nop 0
	buffer_load_dwordx4 v68, s[8:11], s62 offen lds
	s_mul_i32 s63, s15, 36864
	s_add_u32 s63, s63, 21504
	s_add_u32 s62, s40, 1032224
	s_mov_b32 m0, s63
	s_nop 0
	buffer_load_dwordx4 v68, s[8:11], s62 offen lds
	s_mul_i32 s63, s15, 36864
	s_add_u32 s63, s63, 22528
	s_add_u32 s62, s40, 1032256
	s_mov_b32 m0, s63
	s_nop 0
	buffer_load_dwordx4 v68, s[8:11], s62 offen lds
	s_mul_i32 s63, s15, 36864
	s_add_u32 s63, s63, 23552
	s_add_u32 s62, s40, 1069056
	s_mov_b32 m0, s63
	s_nop 0
	buffer_load_dwordx4 v68, s[8:11], s62 offen lds
	s_mul_i32 s63, s15, 36864
	s_add_u32 s63, s63, 24576
	s_add_u32 s62, s40, 1069088
	s_mov_b32 m0, s63
	s_nop 0
	buffer_load_dwordx4 v68, s[8:11], s62 offen lds
	s_mul_i32 s63, s15, 36864
	s_add_u32 s63, s63, 25600
	s_add_u32 s62, s40, 1069120
	s_mov_b32 m0, s63
	s_nop 0
	buffer_load_dwordx4 v68, s[8:11], s62 offen lds
	s_mul_i32 s63, s15, 36864
	s_add_u32 s63, s63, 26624
	s_add_u32 s62, s40, 1105920
	s_mov_b32 m0, s63
	s_nop 0
	buffer_load_dwordx4 v68, s[8:11], s62 offen lds
	s_mul_i32 s63, s15, 36864
	s_add_u32 s63, s63, 27648
	s_add_u32 s62, s40, 1105952
	s_mov_b32 m0, s63
	s_nop 0
	buffer_load_dwordx4 v68, s[8:11], s62 offen lds
	s_mul_i32 s63, s15, 36864
	s_add_u32 s63, s63, 28672
	s_add_u32 s62, s40, 1105984
	s_mov_b32 m0, s63
	s_nop 0
	buffer_load_dwordx4 v68, s[8:11], s62 offen lds
	s_mul_i32 s63, s15, 36864
	s_add_u32 s63, s63, 29696
	s_add_u32 s62, s40, 1142784
	s_mov_b32 m0, s63
	s_nop 0
	buffer_load_dwordx4 v68, s[8:11], s62 offen lds
	s_mul_i32 s63, s15, 36864
	s_add_u32 s63, s63, 30720
	s_add_u32 s62, s40, 1142816
	s_mov_b32 m0, s63
	s_nop 0
	buffer_load_dwordx4 v68, s[8:11], s62 offen lds
	s_mul_i32 s63, s15, 36864
	s_add_u32 s63, s63, 31744
	s_add_u32 s62, s40, 1142848
	s_mov_b32 m0, s63
	s_nop 0
	buffer_load_dwordx4 v68, s[8:11], s62 offen lds
	s_waitcnt vmcnt(0)
	ds_read_b64_tr_b16 a[212:213], v70 offset:0
	ds_read_b64_tr_b16 a[214:215], v70 offset:512
	ds_read_b64_tr_b16 v[212:213], v70 offset:1024
	ds_read_b64_tr_b16 v[214:215], v70 offset:1536
	ds_read_b64_tr_b16 a[88:89], v70 offset:2048
	ds_read_b64_tr_b16 a[90:91], v70 offset:2560
	ds_read_b64_tr_b16 a[216:217], v70 offset:3072
	ds_read_b64_tr_b16 a[218:219], v70 offset:3584
	s_waitcnt lgkmcnt(8)
	ds_read_b64_tr_b16 v[216:217], v70 offset:4096
	ds_read_b64_tr_b16 v[218:219], v70 offset:4608
	ds_read_b64_tr_b16 a[92:93], v70 offset:5120
	ds_read_b64_tr_b16 a[94:95], v70 offset:5632
	ds_read_b64_tr_b16 a[220:221], v70 offset:6144
	ds_read_b64_tr_b16 a[222:223], v70 offset:6656
	ds_read_b64_tr_b16 v[220:221], v70 offset:7168
	ds_read_b64_tr_b16 v[222:223], v70 offset:7680
	s_waitcnt lgkmcnt(8)
	ds_read_b64_tr_b16 a[96:97], v70 offset:8192
	ds_read_b64_tr_b16 a[98:99], v70 offset:8704
	ds_read_b64_tr_b16 a[224:225], v70 offset:9216
	ds_read_b64_tr_b16 a[226:227], v70 offset:9728
	ds_read_b64_tr_b16 v[224:225], v70 offset:10240
	ds_read_b64_tr_b16 v[226:227], v70 offset:10752
	ds_read_b64_tr_b16 a[100:101], v70 offset:11264
	ds_read_b64_tr_b16 a[102:103], v70 offset:11776
	s_waitcnt lgkmcnt(8)
	ds_read_b64_tr_b16 a[228:229], v70 offset:12288
	ds_read_b64_tr_b16 a[230:231], v70 offset:12800
	ds_read_b64_tr_b16 v[228:229], v70 offset:13312
	ds_read_b64_tr_b16 v[230:231], v70 offset:13824
	ds_read_b64_tr_b16 a[104:105], v70 offset:14336
	ds_read_b64_tr_b16 a[106:107], v70 offset:14848
	ds_read_b64_tr_b16 a[232:233], v70 offset:15360
	ds_read_b64_tr_b16 a[234:235], v70 offset:15872
	s_waitcnt lgkmcnt(8)
	ds_read_b64_tr_b16 v[232:233], v70 offset:16384
	ds_read_b64_tr_b16 v[234:235], v70 offset:16896
	ds_read_b64_tr_b16 a[108:109], v70 offset:17408
	ds_read_b64_tr_b16 a[110:111], v70 offset:17920
	ds_read_b64_tr_b16 a[236:237], v70 offset:18432
	ds_read_b64_tr_b16 a[238:239], v70 offset:18944
	ds_read_b64_tr_b16 v[236:237], v70 offset:19456
	ds_read_b64_tr_b16 v[238:239], v70 offset:19968
	s_waitcnt lgkmcnt(8)
	ds_read_b64_tr_b16 a[112:113], v70 offset:20480
	ds_read_b64_tr_b16 a[114:115], v70 offset:20992
	ds_read_b64_tr_b16 a[240:241], v70 offset:21504
	ds_read_b64_tr_b16 a[242:243], v70 offset:22016
	ds_read_b64_tr_b16 v[240:241], v70 offset:22528
	ds_read_b64_tr_b16 v[242:243], v70 offset:23040
	ds_read_b64_tr_b16 a[116:117], v70 offset:23552
	ds_read_b64_tr_b16 a[118:119], v70 offset:24064
	s_waitcnt lgkmcnt(8)
	ds_read_b64_tr_b16 a[244:245], v70 offset:24576
	ds_read_b64_tr_b16 a[246:247], v70 offset:25088
	ds_read_b64_tr_b16 v[244:245], v70 offset:25600
	ds_read_b64_tr_b16 v[246:247], v70 offset:26112
	ds_read_b64_tr_b16 a[120:121], v70 offset:26624
	ds_read_b64_tr_b16 a[122:123], v70 offset:27136
	ds_read_b64_tr_b16 a[248:249], v70 offset:27648
	ds_read_b64_tr_b16 a[250:251], v70 offset:28160
	s_waitcnt lgkmcnt(8)
	ds_read_b64_tr_b16 v[248:249], v70 offset:28672
	ds_read_b64_tr_b16 v[250:251], v70 offset:29184
	ds_read_b64_tr_b16 a[124:125], v70 offset:29696
	ds_read_b64_tr_b16 a[126:127], v70 offset:30208
	ds_read_b64_tr_b16 a[252:253], v70 offset:30720
	ds_read_b64_tr_b16 a[254:255], v70 offset:31232
	ds_read_b64_tr_b16 v[252:253], v70 offset:31744
	ds_read_b64_tr_b16 v[254:255], v70 offset:32256
	s_waitcnt lgkmcnt(8)
	s_waitcnt lgkmcnt(0)
	s_barrier
	v_lshlrev_b32 v60, 4, v79
	v_mov_b32 v64, 0
	s_mul_i32 s19, s27, 0x3c
	s_add_u32 s19, s19, 0xa4
	s_lshl_b32 s17, s38, 1
	s_add_u32 s19, s19, s17
	v_min_u32 v62, 7, v79
	v_lshrrev_b32 v74, 2, v62
	v_add_u32 v74, s19, v74
	v_lshlrev_b32 v74, 7, v74
	v_and_b32 v62, 3, v62
	v_lshlrev_b32 v62, 2, v62
	v_add_u32 v62, v62, v74
	s_mul_i32 s19, s27, 0x3c
	s_add_u32 s19, s19, 0xb8
	v_min_u32 v67, 31, v79
	v_lshrrev_b32 v74, 2, v67
	v_add_u32 v74, s19, v74
	v_lshlrev_b32 v74, 7, v74
	v_and_b32 v67, 3, v67
	v_lshlrev_b32 v67, 2, v67
	v_add_u32 v67, v67, v74
	s_lshl_b32 s30, s14, 7
	s_lshl_b32 s17, s15, 2
	s_add_u32 s30, s30, s17
	v_lshrrev_b32 v72, 3, v78
	v_mul_u32_u24 v72, 18432, v72
	v_lshlrev_b32 v73, 7, v77
	v_add_u32 v72, v72, v73
	v_lshlrev_b32 v73, 4, v76
	v_add_u32 v66, v72, v73
	s_mul_i32 s31, s27, 0x1000000
	s_add_u32 s31, s31, 0xaa80000
	s_lshl_b32 s17, s38, 16
	s_add_u32 s31, s31, s17
	s_mul_i32 s34, s27, 0x1200000
	s_add_u32 s34, s34, 0xca80000
	s_mul_i32 s17, s38, 73728
	s_add_u32 s34, s34, s17
	s_lshl_b32 s17, s39, 9
	s_add_u32 s34, s34, s17
	v_mov_b32 v74, 0
	s_mov_b32 s20, 400000
	v_and_b32 v72, 7, v79
	v_lshrrev_b32 v73, 2, v72
	v_mul_u32_u24 v73, 112, v73
	v_lshlrev_b32 v72, 2, v72
	v_add_u32 v72, v72, v73
	s_getpc_b64 s[18:19]
.ct_667:
	s_sub_u32 s18, s18, .ct_667-L_ATTB
	s_subb_u32 s19, s19, 0
	v_lshlrev_b32 v74, 7, v79
	s_lshl_b32 s17, s15, 13
	v_add_u32 v74, s17, v74
	s_mov_b32 s17, L_B3_CE-L_ATTB-4
	v_min_u32 v74, s17, v74
	global_load_dword v73, v74, s[18:19]
	v_mov_b32 v74, 0
	s_getpc_b64 s[18:19]
.ct_669:
	s_add_u32 s18, s18, L_RB0-.ct_669
	s_addc_u32 s19, s19, 0
	v_lshlrev_b32 v74, 7, v79
	s_lshl_b32 s17, s15, 13
	v_add_u32 v74, s17, v74
	s_mov_b32 s17, L_RB1_CE-L_RB0-4
	v_min_u32 v74, s17, v74
	global_load_dword v73, v74, s[18:19]
	v_mov_b32 v74, 0
.gbre_664:
	global_load_dword v73, v72, s[12:13] offset:16 sc1
	s_waitcnt vmcnt(0)
	v_readlane_b32 s17, v73, 0
	v_readlane_b32 s18, v73, 1
	s_nop 0
	s_add_u32 s17, s17, s18
	v_readlane_b32 s18, v73, 2
	s_nop 0
	s_add_u32 s17, s17, s18
	v_readlane_b32 s18, v73, 3
	s_nop 0
	s_add_u32 s17, s17, s18
	v_readlane_b32 s18, v73, 4
	s_nop 0
	s_add_u32 s17, s17, s18
	v_readlane_b32 s18, v73, 5
	s_nop 0
	s_add_u32 s17, s17, s18
	v_readlane_b32 s18, v73, 6
	s_nop 0
	s_add_u32 s17, s17, s18
	v_readlane_b32 s18, v73, 7
	s_nop 0
	s_add_u32 s17, s17, s18
	s_cmp_ge_u32 s17, 256
	s_cbranch_scc1 .gbok_665
	s_sub_u32 s20, s20, 1
	s_cmp_lg_u32 s20, 0
	s_cbranch_scc1 .gbre_664
	s_branch L_FAIL
.gbok_665:
	v_cmp_ne_u32 vcc, 32, v73
	s_cbranch_vccnz L_B3_DEV
	s_mul_i32 s17, s15, 16384
	s_add_u32 s31, s31, s17
	s_mov_b32 s32, s17
	s_lshl_b32 s44, s17, 1
	s_add_u32 s44, s44, 65536
	s_mov_b32 s33, 0
	s_mov_b32 s28, 0
	s_mov_b32 s29, 0
	s_mov_b32 s54, s31
	s_mov_b32 s56, 0
	s_mov_b32 s55, s34
.gloop_670:
	s_cmp_lg_u32 s29, 0
	s_cbranch_scc1 .gpref_671
	s_add_u32 s37, s28, 1
	s_mov_b32 s20, 400000
.pre_673:
	buffer_load_dword v63, v62, s[4:7], 0 offen sc1
	s_waitcnt vmcnt(0)
	v_cmp_gt_u32 vcc, s37, v63
	s_cbranch_vccz .pok_674
	s_sub_u32 s20, s20, 1
	s_cmp_lg_u32 s20, 0
	s_cbranch_scc1 .pre_673
	s_branch L_FAIL
.pok_674:
	s_and_b32 s31, s56, 3
	s_mul_i32 s31, s31, 262144
	s_add_u32 s31, s31, s54
	s_add_u32 s56, s56, 1
	s_add_u32 s17, s32, 0
	s_mov_b32 m0, s17
	s_add_u32 s18, s31, 0
	buffer_load_dwordx4 v60, s[4:7], s18 offen offset:0 sc1 lds
	buffer_load_dwordx4 v60, s[4:7], s18 offen offset:1024 sc1 lds
	buffer_load_dwordx4 v60, s[4:7], s18 offen offset:2048 sc1 lds
	buffer_load_dwordx4 v60, s[4:7], s18 offen offset:3072 sc1 lds
	s_add_u32 s17, s32, 4096
	s_mov_b32 m0, s17
	s_add_u32 s18, s31, 4096
	buffer_load_dwordx4 v60, s[4:7], s18 offen offset:0 sc1 lds
	buffer_load_dwordx4 v60, s[4:7], s18 offen offset:1024 sc1 lds
	buffer_load_dwordx4 v60, s[4:7], s18 offen offset:2048 sc1 lds
	buffer_load_dwordx4 v60, s[4:7], s18 offen offset:3072 sc1 lds
	s_add_u32 s17, s32, 8192
	s_mov_b32 m0, s17
	s_add_u32 s18, s31, 8192
	buffer_load_dwordx4 v60, s[4:7], s18 offen offset:0 sc1 lds
	buffer_load_dwordx4 v60, s[4:7], s18 offen offset:1024 sc1 lds
	buffer_load_dwordx4 v60, s[4:7], s18 offen offset:2048 sc1 lds
	buffer_load_dwordx4 v60, s[4:7], s18 offen offset:3072 sc1 lds
	s_add_u32 s17, s32, 12288
	s_mov_b32 m0, s17
	s_add_u32 s18, s31, 12288
	buffer_load_dwordx4 v60, s[4:7], s18 offen offset:0 sc1 lds
	buffer_load_dwordx4 v60, s[4:7], s18 offen offset:1024 sc1 lds
	buffer_load_dwordx4 v60, s[4:7], s18 offen offset:2048 sc1 lds
	buffer_load_dwordx4 v60, s[4:7], s18 offen offset:3072 sc1 lds
	s_sub_u32 s32, s44, s32
	s_waitcnt vmcnt(0)
	s_branch .ggo_672
.gpref_671:
	s_waitcnt vmcnt(6)
.ggo_672:
	s_barrier
	s_mov_b32 s29, 0
	v_add_u32 v61, s33, v60
	s_sub_u32 s33, 65536, s33
	buffer_load_dword v63, v62, s[4:7], 0 offen sc1
	buffer_load_dword v68, v67, s[4:7], 0 offen sc1
	ds_read_b128 v[24:27], v61 offset:0
	ds_read_b128 v[28:31], v61 offset:32768
	ds_read_b128 v[32:35], v61 offset:1024
	ds_read_b128 v[36:39], v61 offset:33792
	ds_read_b128 v[40:43], v61 offset:2048
	ds_read_b128 v[44:47], v61 offset:34816
	s_waitcnt lgkmcnt(4)
	v_mfma_f32_16x16x32_bf16 v[0:3], a[0:3], v[24:27], 0
	v_mfma_f32_16x16x32_bf16 v[4:7], a[0:3], v[28:31], 0
	v_mfma_f32_16x16x32_bf16 v[8:11], a[128:131], v[24:27], 0
	v_mfma_f32_16x16x32_bf16 v[12:15], a[128:131], v[28:31], 0
	v_mfma_f32_16x16x32_bf16 v[16:19], v[128:131], v[24:27], 0
	v_mfma_f32_16x16x32_bf16 v[20:23], v[128:131], v[28:31], 0
	ds_read_b128 v[24:27], v61 offset:3072
	ds_read_b128 v[28:31], v61 offset:35840
	s_waitcnt lgkmcnt(4)
	v_mfma_f32_16x16x32_bf16 v[0:3], a[4:7], v[32:35], v[0:3]
	v_mfma_f32_16x16x32_bf16 v[4:7], a[4:7], v[36:39], v[4:7]
	v_mfma_f32_16x16x32_bf16 v[8:11], a[132:135], v[32:35], v[8:11]
	v_mfma_f32_16x16x32_bf16 v[12:15], a[132:135], v[36:39], v[12:15]
	v_mfma_f32_16x16x32_bf16 v[16:19], v[132:135], v[32:35], v[16:19]
	v_mfma_f32_16x16x32_bf16 v[20:23], v[132:135], v[36:39], v[20:23]
	ds_read_b128 v[32:35], v61 offset:4096
	ds_read_b128 v[36:39], v61 offset:36864
	s_waitcnt lgkmcnt(4)
	v_mfma_f32_16x16x32_bf16 v[0:3], a[8:11], v[40:43], v[0:3]
	v_mfma_f32_16x16x32_bf16 v[4:7], a[8:11], v[44:47], v[4:7]
	v_mfma_f32_16x16x32_bf16 v[8:11], a[136:139], v[40:43], v[8:11]
	v_mfma_f32_16x16x32_bf16 v[12:15], a[136:139], v[44:47], v[12:15]
	v_mfma_f32_16x16x32_bf16 v[16:19], v[136:139], v[40:43], v[16:19]
	v_mfma_f32_16x16x32_bf16 v[20:23], v[136:139], v[44:47], v[20:23]
	ds_read_b128 v[40:43], v61 offset:5120
	ds_read_b128 v[44:47], v61 offset:37888
	s_waitcnt lgkmcnt(4)
	v_mfma_f32_16x16x32_bf16 v[0:3], a[12:15], v[24:27], v[0:3]
	v_mfma_f32_16x16x32_bf16 v[4:7], a[12:15], v[28:31], v[4:7]
	v_mfma_f32_16x16x32_bf16 v[8:11], a[140:143], v[24:27], v[8:11]
	v_mfma_f32_16x16x32_bf16 v[12:15], a[140:143], v[28:31], v[12:15]
	v_mfma_f32_16x16x32_bf16 v[16:19], v[140:143], v[24:27], v[16:19]
	v_mfma_f32_16x16x32_bf16 v[20:23], v[140:143], v[28:31], v[20:23]
	ds_read_b128 v[24:27], v61 offset:6144
	ds_read_b128 v[28:31], v61 offset:38912
	s_waitcnt lgkmcnt(4)
	v_mfma_f32_16x16x32_bf16 v[0:3], a[16:19], v[32:35], v[0:3]
	v_mfma_f32_16x16x32_bf16 v[4:7], a[16:19], v[36:39], v[4:7]
	v_mfma_f32_16x16x32_bf16 v[8:11], a[144:147], v[32:35], v[8:11]
	v_mfma_f32_16x16x32_bf16 v[12:15], a[144:147], v[36:39], v[12:15]
	v_mfma_f32_16x16x32_bf16 v[16:19], v[144:147], v[32:35], v[16:19]
	v_mfma_f32_16x16x32_bf16 v[20:23], v[144:147], v[36:39], v[20:23]
	ds_read_b128 v[32:35], v61 offset:7168
	ds_read_b128 v[36:39], v61 offset:39936
	s_waitcnt lgkmcnt(4)
	v_mfma_f32_16x16x32_bf16 v[0:3], a[20:23], v[40:43], v[0:3]
	v_mfma_f32_16x16x32_bf16 v[4:7], a[20:23], v[44:47], v[4:7]
	v_mfma_f32_16x16x32_bf16 v[8:11], a[148:151], v[40:43], v[8:11]
	v_mfma_f32_16x16x32_bf16 v[12:15], a[148:151], v[44:47], v[12:15]
	v_mfma_f32_16x16x32_bf16 v[16:19], v[148:151], v[40:43], v[16:19]
	v_mfma_f32_16x16x32_bf16 v[20:23], v[148:151], v[44:47], v[20:23]
	ds_read_b128 v[40:43], v61 offset:8192
	ds_read_b128 v[44:47], v61 offset:40960
	s_waitcnt lgkmcnt(4)
	v_mfma_f32_16x16x32_bf16 v[0:3], a[24:27], v[24:27], v[0:3]
	v_mfma_f32_16x16x32_bf16 v[4:7], a[24:27], v[28:31], v[4:7]
	v_mfma_f32_16x16x32_bf16 v[8:11], a[152:155], v[24:27], v[8:11]
	v_mfma_f32_16x16x32_bf16 v[12:15], a[152:155], v[28:31], v[12:15]
	v_mfma_f32_16x16x32_bf16 v[16:19], v[152:155], v[24:27], v[16:19]
	v_mfma_f32_16x16x32_bf16 v[20:23], v[152:155], v[28:31], v[20:23]
	ds_read_b128 v[24:27], v61 offset:9216
	ds_read_b128 v[28:31], v61 offset:41984
	s_waitcnt lgkmcnt(4)
	v_mfma_f32_16x16x32_bf16 v[0:3], a[28:31], v[32:35], v[0:3]
	v_mfma_f32_16x16x32_bf16 v[4:7], a[28:31], v[36:39], v[4:7]
	v_mfma_f32_16x16x32_bf16 v[8:11], a[156:159], v[32:35], v[8:11]
	v_mfma_f32_16x16x32_bf16 v[12:15], a[156:159], v[36:39], v[12:15]
	v_mfma_f32_16x16x32_bf16 v[16:19], v[156:159], v[32:35], v[16:19]
	v_mfma_f32_16x16x32_bf16 v[20:23], v[156:159], v[36:39], v[20:23]
	ds_read_b128 v[32:35], v61 offset:10240
	ds_read_b128 v[36:39], v61 offset:43008
	s_waitcnt lgkmcnt(4)
	v_mfma_f32_16x16x32_bf16 v[0:3], a[32:35], v[40:43], v[0:3]
	v_mfma_f32_16x16x32_bf16 v[4:7], a[32:35], v[44:47], v[4:7]
	v_mfma_f32_16x16x32_bf16 v[8:11], a[160:163], v[40:43], v[8:11]
	v_mfma_f32_16x16x32_bf16 v[12:15], a[160:163], v[44:47], v[12:15]
	v_mfma_f32_16x16x32_bf16 v[16:19], v[160:163], v[40:43], v[16:19]
	v_mfma_f32_16x16x32_bf16 v[20:23], v[160:163], v[44:47], v[20:23]
	ds_read_b128 v[40:43], v61 offset:11264
	ds_read_b128 v[44:47], v61 offset:44032
	s_waitcnt lgkmcnt(4)
	v_mfma_f32_16x16x32_bf16 v[0:3], a[36:39], v[24:27], v[0:3]
	v_mfma_f32_16x16x32_bf16 v[4:7], a[36:39], v[28:31], v[4:7]
	v_mfma_f32_16x16x32_bf16 v[8:11], a[164:167], v[24:27], v[8:11]
	v_mfma_f32_16x16x32_bf16 v[12:15], a[164:167], v[28:31], v[12:15]
	v_mfma_f32_16x16x32_bf16 v[16:19], v[164:167], v[24:27], v[16:19]
	v_mfma_f32_16x16x32_bf16 v[20:23], v[164:167], v[28:31], v[20:23]
	ds_read_b128 v[24:27], v61 offset:12288
	ds_read_b128 v[28:31], v61 offset:45056
	s_waitcnt vmcnt(0)
	v_mov_b32 v65, s28
	s_mov_b64 exec, 1
	buffer_store_dword v65, v64, s[4:7], s30 offen
	s_mov_b64 exec, -1
	s_cmp_ge_u32 s28, 63
	s_cbranch_scc1 .gnopf_675
	s_add_u32 s37, s28, 2
	v_cmp_gt_u32 vcc, s37, v63
	s_cbranch_vccnz .gnopf2_676
	s_mov_b32 s29, 1
	s_waitcnt lgkmcnt(4)
	v_mfma_f32_16x16x32_bf16 v[0:3], a[40:43], v[32:35], v[0:3]
	s_and_b32 s31, s56, 3
	s_mul_i32 s31, s31, 262144
	s_add_u32 s31, s31, s54
	s_add_u32 s56, s56, 1
	s_add_u32 s17, s32, 0
	s_mov_b32 m0, s17
	s_add_u32 s18, s31, 0
	buffer_load_dwordx4 v60, s[4:7], s18 offen offset:0 sc1 lds
	v_mfma_f32_16x16x32_bf16 v[4:7], a[40:43], v[36:39], v[4:7]
	buffer_load_dwordx4 v60, s[4:7], s18 offen offset:1024 sc1 lds
	v_mfma_f32_16x16x32_bf16 v[8:11], a[168:171], v[32:35], v[8:11]
	buffer_load_dwordx4 v60, s[4:7], s18 offen offset:2048 sc1 lds
	v_mfma_f32_16x16x32_bf16 v[12:15], a[168:171], v[36:39], v[12:15]
	buffer_load_dwordx4 v60, s[4:7], s18 offen offset:3072 sc1 lds
	v_mfma_f32_16x16x32_bf16 v[16:19], v[168:171], v[32:35], v[16:19]
	s_add_u32 s17, s32, 4096
	s_mov_b32 m0, s17
	s_add_u32 s18, s31, 4096
	buffer_load_dwordx4 v60, s[4:7], s18 offen offset:0 sc1 lds
	v_mfma_f32_16x16x32_bf16 v[20:23], v[168:171], v[36:39], v[20:23]
	buffer_load_dwordx4 v60, s[4:7], s18 offen offset:1024 sc1 lds
	ds_read_b128 v[32:35], v61 offset:13312
	ds_read_b128 v[36:39], v61 offset:46080
	s_waitcnt lgkmcnt(4)
	v_mfma_f32_16x16x32_bf16 v[0:3], a[44:47], v[40:43], v[0:3]
	buffer_load_dwordx4 v60, s[4:7], s18 offen offset:2048 sc1 lds
	v_mfma_f32_16x16x32_bf16 v[4:7], a[44:47], v[44:47], v[4:7]
	buffer_load_dwordx4 v60, s[4:7], s18 offen offset:3072 sc1 lds
	v_mfma_f32_16x16x32_bf16 v[8:11], a[172:175], v[40:43], v[8:11]
	s_add_u32 s17, s32, 8192
	s_mov_b32 m0, s17
	s_add_u32 s18, s31, 8192
	buffer_load_dwordx4 v60, s[4:7], s18 offen offset:0 sc1 lds
	v_mfma_f32_16x16x32_bf16 v[12:15], a[172:175], v[44:47], v[12:15]
	buffer_load_dwordx4 v60, s[4:7], s18 offen offset:1024 sc1 lds
	v_mfma_f32_16x16x32_bf16 v[16:19], v[172:175], v[40:43], v[16:19]
	buffer_load_dwordx4 v60, s[4:7], s18 offen offset:2048 sc1 lds
	v_mfma_f32_16x16x32_bf16 v[20:23], v[172:175], v[44:47], v[20:23]
	buffer_load_dwordx4 v60, s[4:7], s18 offen offset:3072 sc1 lds
	ds_read_b128 v[40:43], v61 offset:14336
	ds_read_b128 v[44:47], v61 offset:47104
	s_waitcnt lgkmcnt(4)
	v_mfma_f32_16x16x32_bf16 v[0:3], a[48:51], v[24:27], v[0:3]
	s_add_u32 s17, s32, 12288
	s_mov_b32 m0, s17
	s_add_u32 s18, s31, 12288
	buffer_load_dwordx4 v60, s[4:7], s18 offen offset:0 sc1 lds
	v_mfma_f32_16x16x32_bf16 v[4:7], a[48:51], v[28:31], v[4:7]
	buffer_load_dwordx4 v60, s[4:7], s18 offen offset:1024 sc1 lds
	v_mfma_f32_16x16x32_bf16 v[8:11], a[176:179], v[24:27], v[8:11]
	buffer_load_dwordx4 v60, s[4:7], s18 offen offset:2048 sc1 lds
	v_mfma_f32_16x16x32_bf16 v[12:15], a[176:179], v[28:31], v[12:15]
	buffer_load_dwordx4 v60, s[4:7], s18 offen offset:3072 sc1 lds
	s_sub_u32 s32, s44, s32
	v_mfma_f32_16x16x32_bf16 v[16:19], v[176:179], v[24:27], v[16:19]
	v_mfma_f32_16x16x32_bf16 v[20:23], v[176:179], v[28:31], v[20:23]
	ds_read_b128 v[24:27], v61 offset:15360
	ds_read_b128 v[28:31], v61 offset:48128
	s_branch .gaft_677
.gnopf2_676:
	buffer_load_dword v63, v62, s[4:7], 0 offen sc1
.gnopf_675:
	s_waitcnt lgkmcnt(4)
	v_mfma_f32_16x16x32_bf16 v[0:3], a[40:43], v[32:35], v[0:3]
	v_mfma_f32_16x16x32_bf16 v[4:7], a[40:43], v[36:39], v[4:7]
	v_mfma_f32_16x16x32_bf16 v[8:11], a[168:171], v[32:35], v[8:11]
	v_mfma_f32_16x16x32_bf16 v[12:15], a[168:171], v[36:39], v[12:15]
	v_mfma_f32_16x16x32_bf16 v[16:19], v[168:171], v[32:35], v[16:19]
	v_mfma_f32_16x16x32_bf16 v[20:23], v[168:171], v[36:39], v[20:23]
	ds_read_b128 v[32:35], v61 offset:13312
	ds_read_b128 v[36:39], v61 offset:46080
	s_waitcnt lgkmcnt(4)
	v_mfma_f32_16x16x32_bf16 v[0:3], a[44:47], v[40:43], v[0:3]
	v_mfma_f32_16x16x32_bf16 v[4:7], a[44:47], v[44:47], v[4:7]
	v_mfma_f32_16x16x32_bf16 v[8:11], a[172:175], v[40:43], v[8:11]
	v_mfma_f32_16x16x32_bf16 v[12:15], a[172:175], v[44:47], v[12:15]
	v_mfma_f32_16x16x32_bf16 v[16:19], v[172:175], v[40:43], v[16:19]
	v_mfma_f32_16x16x32_bf16 v[20:23], v[172:175], v[44:47], v[20:23]
	ds_read_b128 v[40:43], v61 offset:14336
	ds_read_b128 v[44:47], v61 offset:47104
	s_waitcnt lgkmcnt(4)
	v_mfma_f32_16x16x32_bf16 v[0:3], a[48:51], v[24:27], v[0:3]
	v_mfma_f32_16x16x32_bf16 v[4:7], a[48:51], v[28:31], v[4:7]
	v_mfma_f32_16x16x32_bf16 v[8:11], a[176:179], v[24:27], v[8:11]
	v_mfma_f32_16x16x32_bf16 v[12:15], a[176:179], v[28:31], v[12:15]
	v_mfma_f32_16x16x32_bf16 v[16:19], v[176:179], v[24:27], v[16:19]
	v_mfma_f32_16x16x32_bf16 v[20:23], v[176:179], v[28:31], v[20:23]
	ds_read_b128 v[24:27], v61 offset:15360
	ds_read_b128 v[28:31], v61 offset:48128
.gaft_677:
	s_waitcnt lgkmcnt(4)
	v_mfma_f32_16x16x32_bf16 v[0:3], a[52:55], v[32:35], v[0:3]
	v_mfma_f32_16x16x32_bf16 v[4:7], a[52:55], v[36:39], v[4:7]
	v_mfma_f32_16x16x32_bf16 v[8:11], a[180:183], v[32:35], v[8:11]
	v_mfma_f32_16x16x32_bf16 v[12:15], a[180:183], v[36:39], v[12:15]
	v_mfma_f32_16x16x32_bf16 v[16:19], v[180:183], v[32:35], v[16:19]
	v_mfma_f32_16x16x32_bf16 v[20:23], v[180:183], v[36:39], v[20:23]
	ds_read_b128 v[32:35], v61 offset:16384
	ds_read_b128 v[36:39], v61 offset:49152
	s_waitcnt lgkmcnt(4)
	v_mfma_f32_16x16x32_bf16 v[0:3], a[56:59], v[40:43], v[0:3]
	v_mfma_f32_16x16x32_bf16 v[4:7], a[56:59], v[44:47], v[4:7]
	v_mfma_f32_16x16x32_bf16 v[8:11], a[184:187], v[40:43], v[8:11]
	v_mfma_f32_16x16x32_bf16 v[12:15], a[184:187], v[44:47], v[12:15]
	v_mfma_f32_16x16x32_bf16 v[16:19], v[184:187], v[40:43], v[16:19]
	v_mfma_f32_16x16x32_bf16 v[20:23], v[184:187], v[44:47], v[20:23]
	ds_read_b128 v[40:43], v61 offset:17408
	ds_read_b128 v[44:47], v61 offset:50176
	s_waitcnt lgkmcnt(4)
	v_mfma_f32_16x16x32_bf16 v[0:3], a[60:63], v[24:27], v[0:3]
	v_mfma_f32_16x16x32_bf16 v[4:7], a[60:63], v[28:31], v[4:7]
	v_mfma_f32_16x16x32_bf16 v[8:11], a[188:191], v[24:27], v[8:11]
	v_mfma_f32_16x16x32_bf16 v[12:15], a[188:191], v[28:31], v[12:15]
	v_mfma_f32_16x16x32_bf16 v[16:19], v[188:191], v[24:27], v[16:19]
	v_mfma_f32_16x16x32_bf16 v[20:23], v[188:191], v[28:31], v[20:23]
	ds_read_b128 v[24:27], v61 offset:18432
	ds_read_b128 v[28:31], v61 offset:51200
	s_waitcnt lgkmcnt(4)
	v_mfma_f32_16x16x32_bf16 v[0:3], a[64:67], v[32:35], v[0:3]
	v_mfma_f32_16x16x32_bf16 v[4:7], a[64:67], v[36:39], v[4:7]
	v_mfma_f32_16x16x32_bf16 v[8:11], a[192:195], v[32:35], v[8:11]
	v_mfma_f32_16x16x32_bf16 v[12:15], a[192:195], v[36:39], v[12:15]
	v_mfma_f32_16x16x32_bf16 v[16:19], v[192:195], v[32:35], v[16:19]
	v_mfma_f32_16x16x32_bf16 v[20:23], v[192:195], v[36:39], v[20:23]
	ds_read_b128 v[32:35], v61 offset:19456
	ds_read_b128 v[36:39], v61 offset:52224
	s_cmp_lg_u32 s29, 0
	s_cbranch_scc1 .gnopf_678
	s_cmp_ge_u32 s28, 63
	s_cbranch_scc1 .gnopf_678
	s_waitcnt vmcnt(0)
	s_add_u32 s37, s28, 2
	v_cmp_gt_u32 vcc, s37, v63
	s_cbranch_vccnz .gnopf2_679
	s_mov_b32 s29, 1
	s_waitcnt lgkmcnt(4)
	v_mfma_f32_16x16x32_bf16 v[0:3], a[68:71], v[40:43], v[0:3]
	s_and_b32 s31, s56, 3
	s_mul_i32 s31, s31, 262144
	s_add_u32 s31, s31, s54
	s_add_u32 s56, s56, 1
	s_add_u32 s17, s32, 0
	s_mov_b32 m0, s17
	s_add_u32 s18, s31, 0
	buffer_load_dwordx4 v60, s[4:7], s18 offen offset:0 sc1 lds
	v_mfma_f32_16x16x32_bf16 v[4:7], a[68:71], v[44:47], v[4:7]
	buffer_load_dwordx4 v60, s[4:7], s18 offen offset:1024 sc1 lds
	v_mfma_f32_16x16x32_bf16 v[8:11], a[196:199], v[40:43], v[8:11]
	buffer_load_dwordx4 v60, s[4:7], s18 offen offset:2048 sc1 lds
	v_mfma_f32_16x16x32_bf16 v[12:15], a[196:199], v[44:47], v[12:15]
	buffer_load_dwordx4 v60, s[4:7], s18 offen offset:3072 sc1 lds
	v_mfma_f32_16x16x32_bf16 v[16:19], v[196:199], v[40:43], v[16:19]
	s_add_u32 s17, s32, 4096
	s_mov_b32 m0, s17
	s_add_u32 s18, s31, 4096
	buffer_load_dwordx4 v60, s[4:7], s18 offen offset:0 sc1 lds
	v_mfma_f32_16x16x32_bf16 v[20:23], v[196:199], v[44:47], v[20:23]
	buffer_load_dwordx4 v60, s[4:7], s18 offen offset:1024 sc1 lds
	ds_read_b128 v[40:43], v61 offset:20480
	ds_read_b128 v[44:47], v61 offset:53248
	s_waitcnt lgkmcnt(4)
	v_mfma_f32_16x16x32_bf16 v[0:3], a[72:75], v[24:27], v[0:3]
	buffer_load_dwordx4 v60, s[4:7], s18 offen offset:2048 sc1 lds
	v_mfma_f32_16x16x32_bf16 v[4:7], a[72:75], v[28:31], v[4:7]
	buffer_load_dwordx4 v60, s[4:7], s18 offen offset:3072 sc1 lds
	v_mfma_f32_16x16x32_bf16 v[8:11], a[200:203], v[24:27], v[8:11]
	s_add_u32 s17, s32, 8192
	s_mov_b32 m0, s17
	s_add_u32 s18, s31, 8192
	buffer_load_dwordx4 v60, s[4:7], s18 offen offset:0 sc1 lds
	v_mfma_f32_16x16x32_bf16 v[12:15], a[200:203], v[28:31], v[12:15]
	buffer_load_dwordx4 v60, s[4:7], s18 offen offset:1024 sc1 lds
	v_mfma_f32_16x16x32_bf16 v[16:19], v[200:203], v[24:27], v[16:19]
	buffer_load_dwordx4 v60, s[4:7], s18 offen offset:2048 sc1 lds
	v_mfma_f32_16x16x32_bf16 v[20:23], v[200:203], v[28:31], v[20:23]
	buffer_load_dwordx4 v60, s[4:7], s18 offen offset:3072 sc1 lds
	ds_read_b128 v[24:27], v61 offset:21504
	ds_read_b128 v[28:31], v61 offset:54272
	s_waitcnt lgkmcnt(4)
	v_mfma_f32_16x16x32_bf16 v[0:3], a[76:79], v[32:35], v[0:3]
	s_add_u32 s17, s32, 12288
	s_mov_b32 m0, s17
	s_add_u32 s18, s31, 12288
	buffer_load_dwordx4 v60, s[4:7], s18 offen offset:0 sc1 lds
	v_mfma_f32_16x16x32_bf16 v[4:7], a[76:79], v[36:39], v[4:7]
	buffer_load_dwordx4 v60, s[4:7], s18 offen offset:1024 sc1 lds
	v_mfma_f32_16x16x32_bf16 v[8:11], a[204:207], v[32:35], v[8:11]
	buffer_load_dwordx4 v60, s[4:7], s18 offen offset:2048 sc1 lds
	v_mfma_f32_16x16x32_bf16 v[12:15], a[204:207], v[36:39], v[12:15]
	buffer_load_dwordx4 v60, s[4:7], s18 offen offset:3072 sc1 lds
	s_sub_u32 s32, s44, s32
	v_mfma_f32_16x16x32_bf16 v[16:19], v[204:207], v[32:35], v[16:19]
	v_mfma_f32_16x16x32_bf16 v[20:23], v[204:207], v[36:39], v[20:23]
	ds_read_b128 v[32:35], v61 offset:22528
	ds_read_b128 v[36:39], v61 offset:55296
	s_branch .gaft_680
.gnopf2_679:
	buffer_load_dword v63, v62, s[4:7], 0 offen sc1
.gnopf_678:
	s_waitcnt lgkmcnt(4)
	v_mfma_f32_16x16x32_bf16 v[0:3], a[68:71], v[40:43], v[0:3]
	v_mfma_f32_16x16x32_bf16 v[4:7], a[68:71], v[44:47], v[4:7]
	v_mfma_f32_16x16x32_bf16 v[8:11], a[196:199], v[40:43], v[8:11]
	v_mfma_f32_16x16x32_bf16 v[12:15], a[196:199], v[44:47], v[12:15]
	v_mfma_f32_16x16x32_bf16 v[16:19], v[196:199], v[40:43], v[16:19]
	v_mfma_f32_16x16x32_bf16 v[20:23], v[196:199], v[44:47], v[20:23]
	ds_read_b128 v[40:43], v61 offset:20480
	ds_read_b128 v[44:47], v61 offset:53248
	s_waitcnt lgkmcnt(4)
	v_mfma_f32_16x16x32_bf16 v[0:3], a[72:75], v[24:27], v[0:3]
	v_mfma_f32_16x16x32_bf16 v[4:7], a[72:75], v[28:31], v[4:7]
	v_mfma_f32_16x16x32_bf16 v[8:11], a[200:203], v[24:27], v[8:11]
	v_mfma_f32_16x16x32_bf16 v[12:15], a[200:203], v[28:31], v[12:15]
	v_mfma_f32_16x16x32_bf16 v[16:19], v[200:203], v[24:27], v[16:19]
	v_mfma_f32_16x16x32_bf16 v[20:23], v[200:203], v[28:31], v[20:23]
	ds_read_b128 v[24:27], v61 offset:21504
	ds_read_b128 v[28:31], v61 offset:54272
	s_waitcnt lgkmcnt(4)
	v_mfma_f32_16x16x32_bf16 v[0:3], a[76:79], v[32:35], v[0:3]
	v_mfma_f32_16x16x32_bf16 v[4:7], a[76:79], v[36:39], v[4:7]
	v_mfma_f32_16x16x32_bf16 v[8:11], a[204:207], v[32:35], v[8:11]
	v_mfma_f32_16x16x32_bf16 v[12:15], a[204:207], v[36:39], v[12:15]
	v_mfma_f32_16x16x32_bf16 v[16:19], v[204:207], v[32:35], v[16:19]
	v_mfma_f32_16x16x32_bf16 v[20:23], v[204:207], v[36:39], v[20:23]
	ds_read_b128 v[32:35], v61 offset:22528
	ds_read_b128 v[36:39], v61 offset:55296
.gaft_680:
	s_waitcnt lgkmcnt(4)
	v_mfma_f32_16x16x32_bf16 v[0:3], a[80:83], v[40:43], v[0:3]
	v_mfma_f32_16x16x32_bf16 v[4:7], a[80:83], v[44:47], v[4:7]
	v_mfma_f32_16x16x32_bf16 v[8:11], a[208:211], v[40:43], v[8:11]
	v_mfma_f32_16x16x32_bf16 v[12:15], a[208:211], v[44:47], v[12:15]
	v_mfma_f32_16x16x32_bf16 v[16:19], v[208:211], v[40:43], v[16:19]
	v_mfma_f32_16x16x32_bf16 v[20:23], v[208:211], v[44:47], v[20:23]
	ds_read_b128 v[40:43], v61 offset:23552
	ds_read_b128 v[44:47], v61 offset:56320
	s_waitcnt lgkmcnt(4)
	v_mfma_f32_16x16x32_bf16 v[0:3], a[84:87], v[24:27], v[0:3]
	v_mfma_f32_16x16x32_bf16 v[4:7], a[84:87], v[28:31], v[4:7]
	v_mfma_f32_16x16x32_bf16 v[8:11], a[212:215], v[24:27], v[8:11]
	v_mfma_f32_16x16x32_bf16 v[12:15], a[212:215], v[28:31], v[12:15]
	v_mfma_f32_16x16x32_bf16 v[16:19], v[212:215], v[24:27], v[16:19]
	v_mfma_f32_16x16x32_bf16 v[20:23], v[212:215], v[28:31], v[20:23]
	ds_read_b128 v[24:27], v61 offset:24576
	ds_read_b128 v[28:31], v61 offset:57344
	s_waitcnt lgkmcnt(4)
	v_mfma_f32_16x16x32_bf16 v[0:3], a[88:91], v[32:35], v[0:3]
	v_mfma_f32_16x16x32_bf16 v[4:7], a[88:91], v[36:39], v[4:7]
	v_mfma_f32_16x16x32_bf16 v[8:11], a[216:219], v[32:35], v[8:11]
	v_mfma_f32_16x16x32_bf16 v[12:15], a[216:219], v[36:39], v[12:15]
	v_mfma_f32_16x16x32_bf16 v[16:19], v[216:219], v[32:35], v[16:19]
	v_mfma_f32_16x16x32_bf16 v[20:23], v[216:219], v[36:39], v[20:23]
	ds_read_b128 v[32:35], v61 offset:25600
	ds_read_b128 v[36:39], v61 offset:58368
	s_waitcnt lgkmcnt(4)
	v_mfma_f32_16x16x32_bf16 v[0:3], a[92:95], v[40:43], v[0:3]
	v_mfma_f32_16x16x32_bf16 v[4:7], a[92:95], v[44:47], v[4:7]
	v_mfma_f32_16x16x32_bf16 v[8:11], a[220:223], v[40:43], v[8:11]
	v_mfma_f32_16x16x32_bf16 v[12:15], a[220:223], v[44:47], v[12:15]
	v_mfma_f32_16x16x32_bf16 v[16:19], v[220:223], v[40:43], v[16:19]
	v_mfma_f32_16x16x32_bf16 v[20:23], v[220:223], v[44:47], v[20:23]
	ds_read_b128 v[40:43], v61 offset:26624
	ds_read_b128 v[44:47], v61 offset:59392
	s_cmp_lg_u32 s29, 0
	s_cbranch_scc1 .gnopf_681
	s_cmp_ge_u32 s28, 63
	s_cbranch_scc1 .gnopf_681
	s_waitcnt vmcnt(0)
	s_add_u32 s37, s28, 2
	v_cmp_gt_u32 vcc, s37, v63
	s_cbranch_vccnz .gnopf2_682
	s_mov_b32 s29, 1
	s_waitcnt lgkmcnt(4)
	v_mfma_f32_16x16x32_bf16 v[0:3], a[96:99], v[24:27], v[0:3]
	s_and_b32 s31, s56, 3
	s_mul_i32 s31, s31, 262144
	s_add_u32 s31, s31, s54
	s_add_u32 s56, s56, 1
	s_add_u32 s17, s32, 0
	s_mov_b32 m0, s17
	s_add_u32 s18, s31, 0
	buffer_load_dwordx4 v60, s[4:7], s18 offen offset:0 sc1 lds
	v_mfma_f32_16x16x32_bf16 v[4:7], a[96:99], v[28:31], v[4:7]
	buffer_load_dwordx4 v60, s[4:7], s18 offen offset:1024 sc1 lds
	v_mfma_f32_16x16x32_bf16 v[8:11], a[224:227], v[24:27], v[8:11]
	buffer_load_dwordx4 v60, s[4:7], s18 offen offset:2048 sc1 lds
	v_mfma_f32_16x16x32_bf16 v[12:15], a[224:227], v[28:31], v[12:15]
	buffer_load_dwordx4 v60, s[4:7], s18 offen offset:3072 sc1 lds
	v_mfma_f32_16x16x32_bf16 v[16:19], v[224:227], v[24:27], v[16:19]
	s_add_u32 s17, s32, 4096
	s_mov_b32 m0, s17
	s_add_u32 s18, s31, 4096
	buffer_load_dwordx4 v60, s[4:7], s18 offen offset:0 sc1 lds
	v_mfma_f32_16x16x32_bf16 v[20:23], v[224:227], v[28:31], v[20:23]
	buffer_load_dwordx4 v60, s[4:7], s18 offen offset:1024 sc1 lds
	ds_read_b128 v[24:27], v61 offset:27648
	ds_read_b128 v[28:31], v61 offset:60416
	s_waitcnt lgkmcnt(4)
	v_mfma_f32_16x16x32_bf16 v[0:3], a[100:103], v[32:35], v[0:3]
	buffer_load_dwordx4 v60, s[4:7], s18 offen offset:2048 sc1 lds
	v_mfma_f32_16x16x32_bf16 v[4:7], a[100:103], v[36:39], v[4:7]
	buffer_load_dwordx4 v60, s[4:7], s18 offen offset:3072 sc1 lds
	v_mfma_f32_16x16x32_bf16 v[8:11], a[228:231], v[32:35], v[8:11]
	s_add_u32 s17, s32, 8192
	s_mov_b32 m0, s17
	s_add_u32 s18, s31, 8192
	buffer_load_dwordx4 v60, s[4:7], s18 offen offset:0 sc1 lds
	v_mfma_f32_16x16x32_bf16 v[12:15], a[228:231], v[36:39], v[12:15]
	buffer_load_dwordx4 v60, s[4:7], s18 offen offset:1024 sc1 lds
	v_mfma_f32_16x16x32_bf16 v[16:19], v[228:231], v[32:35], v[16:19]
	buffer_load_dwordx4 v60, s[4:7], s18 offen offset:2048 sc1 lds
	v_mfma_f32_16x16x32_bf16 v[20:23], v[228:231], v[36:39], v[20:23]
	buffer_load_dwordx4 v60, s[4:7], s18 offen offset:3072 sc1 lds
	ds_read_b128 v[32:35], v61 offset:28672
	ds_read_b128 v[36:39], v61 offset:61440
	s_waitcnt lgkmcnt(4)
	v_mfma_f32_16x16x32_bf16 v[0:3], a[104:107], v[40:43], v[0:3]
	s_add_u32 s17, s32, 12288
	s_mov_b32 m0, s17
	s_add_u32 s18, s31, 12288
	buffer_load_dwordx4 v60, s[4:7], s18 offen offset:0 sc1 lds
	v_mfma_f32_16x16x32_bf16 v[4:7], a[104:107], v[44:47], v[4:7]
	buffer_load_dwordx4 v60, s[4:7], s18 offen offset:1024 sc1 lds
	v_mfma_f32_16x16x32_bf16 v[8:11], a[232:235], v[40:43], v[8:11]
	buffer_load_dwordx4 v60, s[4:7], s18 offen offset:2048 sc1 lds
	v_mfma_f32_16x16x32_bf16 v[12:15], a[232:235], v[44:47], v[12:15]
	buffer_load_dwordx4 v60, s[4:7], s18 offen offset:3072 sc1 lds
	s_sub_u32 s32, s44, s32
	v_mfma_f32_16x16x32_bf16 v[16:19], v[232:235], v[40:43], v[16:19]
	v_mfma_f32_16x16x32_bf16 v[20:23], v[232:235], v[44:47], v[20:23]
	ds_read_b128 v[40:43], v61 offset:29696
	ds_read_b128 v[44:47], v61 offset:62464
	s_branch .gaft_683
.gnopf2_682:
	buffer_load_dword v63, v62, s[4:7], 0 offen sc1
.gnopf_681:
	s_waitcnt lgkmcnt(4)
	v_mfma_f32_16x16x32_bf16 v[0:3], a[96:99], v[24:27], v[0:3]
	v_mfma_f32_16x16x32_bf16 v[4:7], a[96:99], v[28:31], v[4:7]
	v_mfma_f32_16x16x32_bf16 v[8:11], a[224:227], v[24:27], v[8:11]
	v_mfma_f32_16x16x32_bf16 v[12:15], a[224:227], v[28:31], v[12:15]
	v_mfma_f32_16x16x32_bf16 v[16:19], v[224:227], v[24:27], v[16:19]
	v_mfma_f32_16x16x32_bf16 v[20:23], v[224:227], v[28:31], v[20:23]
	ds_read_b128 v[24:27], v61 offset:27648
	ds_read_b128 v[28:31], v61 offset:60416
	s_waitcnt lgkmcnt(4)
	v_mfma_f32_16x16x32_bf16 v[0:3], a[100:103], v[32:35], v[0:3]
	v_mfma_f32_16x16x32_bf16 v[4:7], a[100:103], v[36:39], v[4:7]
	v_mfma_f32_16x16x32_bf16 v[8:11], a[228:231], v[32:35], v[8:11]
	v_mfma_f32_16x16x32_bf16 v[12:15], a[228:231], v[36:39], v[12:15]
	v_mfma_f32_16x16x32_bf16 v[16:19], v[228:231], v[32:35], v[16:19]
	v_mfma_f32_16x16x32_bf16 v[20:23], v[228:231], v[36:39], v[20:23]
	ds_read_b128 v[32:35], v61 offset:28672
	ds_read_b128 v[36:39], v61 offset:61440
	s_waitcnt lgkmcnt(4)
	v_mfma_f32_16x16x32_bf16 v[0:3], a[104:107], v[40:43], v[0:3]
	v_mfma_f32_16x16x32_bf16 v[4:7], a[104:107], v[44:47], v[4:7]
	v_mfma_f32_16x16x32_bf16 v[8:11], a[232:235], v[40:43], v[8:11]
	v_mfma_f32_16x16x32_bf16 v[12:15], a[232:235], v[44:47], v[12:15]
	v_mfma_f32_16x16x32_bf16 v[16:19], v[232:235], v[40:43], v[16:19]
	v_mfma_f32_16x16x32_bf16 v[20:23], v[232:235], v[44:47], v[20:23]
	ds_read_b128 v[40:43], v61 offset:29696
	ds_read_b128 v[44:47], v61 offset:62464
.gaft_683:
	s_waitcnt lgkmcnt(4)
	v_mfma_f32_16x16x32_bf16 v[0:3], a[108:111], v[24:27], v[0:3]
	v_mfma_f32_16x16x32_bf16 v[4:7], a[108:111], v[28:31], v[4:7]
	v_mfma_f32_16x16x32_bf16 v[8:11], a[236:239], v[24:27], v[8:11]
	v_mfma_f32_16x16x32_bf16 v[12:15], a[236:239], v[28:31], v[12:15]
	v_mfma_f32_16x16x32_bf16 v[16:19], v[236:239], v[24:27], v[16:19]
	v_mfma_f32_16x16x32_bf16 v[20:23], v[236:239], v[28:31], v[20:23]
	ds_read_b128 v[24:27], v61 offset:30720
	ds_read_b128 v[28:31], v61 offset:63488
	s_waitcnt lgkmcnt(4)
	v_mfma_f32_16x16x32_bf16 v[0:3], a[112:115], v[32:35], v[0:3]
	v_mfma_f32_16x16x32_bf16 v[4:7], a[112:115], v[36:39], v[4:7]
	v_mfma_f32_16x16x32_bf16 v[8:11], a[240:243], v[32:35], v[8:11]
	v_mfma_f32_16x16x32_bf16 v[12:15], a[240:243], v[36:39], v[12:15]
	v_mfma_f32_16x16x32_bf16 v[16:19], v[240:243], v[32:35], v[16:19]
	v_mfma_f32_16x16x32_bf16 v[20:23], v[240:243], v[36:39], v[20:23]
	ds_read_b128 v[32:35], v61 offset:31744
	ds_read_b128 v[36:39], v61 offset:64512
	s_waitcnt lgkmcnt(4)
	v_mfma_f32_16x16x32_bf16 v[0:3], a[116:119], v[40:43], v[0:3]
	v_mfma_f32_16x16x32_bf16 v[4:7], a[116:119], v[44:47], v[4:7]
	v_mfma_f32_16x16x32_bf16 v[8:11], a[244:247], v[40:43], v[8:11]
	v_mfma_f32_16x16x32_bf16 v[12:15], a[244:247], v[44:47], v[12:15]
	v_mfma_f32_16x16x32_bf16 v[16:19], v[244:247], v[40:43], v[16:19]
	v_mfma_f32_16x16x32_bf16 v[20:23], v[244:247], v[44:47], v[20:23]
	s_waitcnt lgkmcnt(2)
	v_mfma_f32_16x16x32_bf16 v[0:3], a[120:123], v[24:27], v[0:3]
	v_mfma_f32_16x16x32_bf16 v[4:7], a[120:123], v[28:31], v[4:7]
	v_mfma_f32_16x16x32_bf16 v[8:11], a[248:251], v[24:27], v[8:11]
	v_mfma_f32_16x16x32_bf16 v[12:15], a[248:251], v[28:31], v[12:15]
	v_mfma_f32_16x16x32_bf16 v[16:19], v[248:251], v[24:27], v[16:19]
	v_mfma_f32_16x16x32_bf16 v[20:23], v[248:251], v[28:31], v[20:23]
	s_waitcnt lgkmcnt(0)
	v_mfma_f32_16x16x32_bf16 v[0:3], a[124:127], v[32:35], v[0:3]
	v_mfma_f32_16x16x32_bf16 v[4:7], a[124:127], v[36:39], v[4:7]
	v_mfma_f32_16x16x32_bf16 v[8:11], a[252:255], v[32:35], v[8:11]
	v_mfma_f32_16x16x32_bf16 v[12:15], a[252:255], v[36:39], v[12:15]
	v_mfma_f32_16x16x32_bf16 v[16:19], v[252:255], v[32:35], v[16:19]
	v_mfma_f32_16x16x32_bf16 v[20:23], v[252:255], v[36:39], v[20:23]
	s_sub_i32 s57, s28, 4
	s_max_i32 s57, s57, 0
	s_cmp_eq_u32 s28, 4
	s_cselect_b32 s57, 1, s57
	v_cmp_gt_u32 vcc, s57, v68
	s_cbranch_vccz .pck_684
	s_mov_b32 s20, 400000
.pre_685:
	buffer_load_dword v68, v67, s[4:7], 0 offen sc1
	s_waitcnt vmcnt(0)
	v_cmp_gt_u32 vcc, s57, v68
	s_cbranch_vccz .pok_686
	s_sub_u32 s20, s20, 1
	s_cmp_lg_u32 s20, 0
	s_cbranch_scc1 .pre_685
	s_branch L_FAIL
.pok_686:
.pck_684:
	s_and_b32 s34, s28, 3
	s_mul_i32 s34, s34, 294912
	s_add_u32 s34, s34, s55
	s_add_u32 s35, s34, 36864
	buffer_store_dwordx4 v[0:3], v66, s[4:7], s34 offen offset:0
	buffer_store_dwordx4 v[4:7], v66, s[4:7], s35 offen offset:0
	buffer_store_dwordx4 v[8:11], v66, s[4:7], s34 offen offset:512
	buffer_store_dwordx4 v[12:15], v66, s[4:7], s35 offen offset:512
	buffer_store_dwordx4 v[16:19], v66, s[4:7], s34 offen offset:1024
	buffer_store_dwordx4 v[20:23], v66, s[4:7], s35 offen offset:1024
	s_add_u32 s34, s34, 294912
	s_add_u32 s28, s28, 1
	s_cmp_lg_u32 s29, 0
	s_cbranch_scc1 .gloop_670
	s_cmp_ge_u32 s28, 64
	s_cbranch_scc1 .gnofin_688
	s_waitcnt vmcnt(6)
	s_add_u32 s37, s28, 1
	v_cmp_gt_u32 vcc, s37, v63
	s_cbranch_vccnz .gnofin_688
	s_and_b32 s31, s56, 3
	s_mul_i32 s31, s31, 262144
	s_add_u32 s31, s31, s54
	s_add_u32 s56, s56, 1
	s_add_u32 s17, s32, 0
	s_mov_b32 m0, s17
	s_add_u32 s18, s31, 0
	buffer_load_dwordx4 v60, s[4:7], s18 offen offset:0 sc1 lds
	buffer_load_dwordx4 v60, s[4:7], s18 offen offset:1024 sc1 lds
	buffer_load_dwordx4 v60, s[4:7], s18 offen offset:2048 sc1 lds
	buffer_load_dwordx4 v60, s[4:7], s18 offen offset:3072 sc1 lds
	s_add_u32 s17, s32, 4096
	s_mov_b32 m0, s17
	s_add_u32 s18, s31, 4096
	buffer_load_dwordx4 v60, s[4:7], s18 offen offset:0 sc1 lds
	buffer_load_dwordx4 v60, s[4:7], s18 offen offset:1024 sc1 lds
	buffer_load_dwordx4 v60, s[4:7], s18 offen offset:2048 sc1 lds
	buffer_load_dwordx4 v60, s[4:7], s18 offen offset:3072 sc1 lds
	s_add_u32 s17, s32, 8192
	s_mov_b32 m0, s17
	s_add_u32 s18, s31, 8192
	buffer_load_dwordx4 v60, s[4:7], s18 offen offset:0 sc1 lds
	buffer_load_dwordx4 v60, s[4:7], s18 offen offset:1024 sc1 lds
	buffer_load_dwordx4 v60, s[4:7], s18 offen offset:2048 sc1 lds
	buffer_load_dwordx4 v60, s[4:7], s18 offen offset:3072 sc1 lds
	s_add_u32 s17, s32, 12288
	s_mov_b32 m0, s17
	s_add_u32 s18, s31, 12288
	buffer_load_dwordx4 v60, s[4:7], s18 offen offset:0 sc1 lds
	buffer_load_dwordx4 v60, s[4:7], s18 offen offset:1024 sc1 lds
	buffer_load_dwordx4 v60, s[4:7], s18 offen offset:2048 sc1 lds
	buffer_load_dwordx4 v60, s[4:7], s18 offen offset:3072 sc1 lds
	s_sub_u32 s32, s44, s32
	s_waitcnt vmcnt(16)
	v_mov_b32 v65, s28
	s_mov_b64 exec, 1
	buffer_store_dword v65, v64, s[4:7], s30 offen
	s_mov_b64 exec, -1
	s_waitcnt vmcnt(1)
	s_branch .ggo_672
.gnofin_688:
	s_waitcnt vmcnt(0)
	v_mov_b32 v65, s28
	s_mov_b64 exec, 1
	buffer_store_dword v65, v64, s[4:7], s30 offen
	s_mov_b64 exec, -1
	s_cmp_lt_u32 s28, 64
	s_cbranch_scc1 .gloop_670
	s_branch L_END
L_B3_CE:
L_B3_DEV:
	s_mul_i32 s17, s15, 16384
	s_add_u32 s31, s31, s17
	s_mov_b32 s32, s17
	s_lshl_b32 s44, s17, 1
	s_add_u32 s44, s44, 65536
	s_mov_b32 s33, 0
	s_mov_b32 s28, 0
	s_mov_b32 s29, 0
	s_mov_b32 s54, s31
	s_mov_b32 s56, 0
	s_mov_b32 s55, s34
.gloop_698:
	s_cmp_lg_u32 s29, 0
	s_cbranch_scc1 .gpref_699
	s_add_u32 s37, s28, 1
	s_mov_b32 s20, 400000
.pre_701:
	buffer_load_dword v63, v62, s[4:7], 0 offen sc1
	s_waitcnt vmcnt(0)
	v_cmp_gt_u32 vcc, s37, v63
	s_cbranch_vccz .pok_702
	s_sub_u32 s20, s20, 1
	s_cmp_lg_u32 s20, 0
	s_cbranch_scc1 .pre_701
	s_branch L_FAIL
.pok_702:
	s_and_b32 s31, s56, 3
	s_mul_i32 s31, s31, 262144
	s_add_u32 s31, s31, s54
	s_add_u32 s56, s56, 1
	s_add_u32 s17, s32, 0
	s_mov_b32 m0, s17
	s_add_u32 s18, s31, 0
	buffer_load_dwordx4 v60, s[4:7], s18 offen offset:0 sc1 lds
	buffer_load_dwordx4 v60, s[4:7], s18 offen offset:1024 sc1 lds
	buffer_load_dwordx4 v60, s[4:7], s18 offen offset:2048 sc1 lds
	buffer_load_dwordx4 v60, s[4:7], s18 offen offset:3072 sc1 lds
	s_add_u32 s17, s32, 4096
	s_mov_b32 m0, s17
	s_add_u32 s18, s31, 4096
	buffer_load_dwordx4 v60, s[4:7], s18 offen offset:0 sc1 lds
	buffer_load_dwordx4 v60, s[4:7], s18 offen offset:1024 sc1 lds
	buffer_load_dwordx4 v60, s[4:7], s18 offen offset:2048 sc1 lds
	buffer_load_dwordx4 v60, s[4:7], s18 offen offset:3072 sc1 lds
	s_add_u32 s17, s32, 8192
	s_mov_b32 m0, s17
	s_add_u32 s18, s31, 8192
	buffer_load_dwordx4 v60, s[4:7], s18 offen offset:0 sc1 lds
	buffer_load_dwordx4 v60, s[4:7], s18 offen offset:1024 sc1 lds
	buffer_load_dwordx4 v60, s[4:7], s18 offen offset:2048 sc1 lds
	buffer_load_dwordx4 v60, s[4:7], s18 offen offset:3072 sc1 lds
	s_add_u32 s17, s32, 12288
	s_mov_b32 m0, s17
	s_add_u32 s18, s31, 12288
	buffer_load_dwordx4 v60, s[4:7], s18 offen offset:0 sc1 lds
	buffer_load_dwordx4 v60, s[4:7], s18 offen offset:1024 sc1 lds
	buffer_load_dwordx4 v60, s[4:7], s18 offen offset:2048 sc1 lds
	buffer_load_dwordx4 v60, s[4:7], s18 offen offset:3072 sc1 lds
	s_sub_u32 s32, s44, s32
	s_waitcnt vmcnt(0)
	s_branch .ggo_700
.gpref_699:
	s_waitcnt vmcnt(6)
.ggo_700:
	s_barrier
	s_mov_b32 s29, 0
	v_add_u32 v61, s33, v60
	s_sub_u32 s33, 65536, s33
	buffer_load_dword v63, v62, s[4:7], 0 offen sc1
	buffer_load_dword v68, v67, s[4:7], 0 offen sc1
	ds_read_b128 v[24:27], v61 offset:0
	ds_read_b128 v[28:31], v61 offset:32768
	ds_read_b128 v[32:35], v61 offset:1024
	ds_read_b128 v[36:39], v61 offset:33792
	ds_read_b128 v[40:43], v61 offset:2048
	ds_read_b128 v[44:47], v61 offset:34816
	s_waitcnt lgkmcnt(4)
	v_mfma_f32_16x16x32_bf16 v[0:3], a[0:3], v[24:27], 0
	v_mfma_f32_16x16x32_bf16 v[4:7], a[0:3], v[28:31], 0
	v_mfma_f32_16x16x32_bf16 v[8:11], a[128:131], v[24:27], 0
	v_mfma_f32_16x16x32_bf16 v[12:15], a[128:131], v[28:31], 0
	v_mfma_f32_16x16x32_bf16 v[16:19], v[128:131], v[24:27], 0
	v_mfma_f32_16x16x32_bf16 v[20:23], v[128:131], v[28:31], 0
	ds_read_b128 v[24:27], v61 offset:3072
	ds_read_b128 v[28:31], v61 offset:35840
	s_waitcnt lgkmcnt(4)
	v_mfma_f32_16x16x32_bf16 v[0:3], a[4:7], v[32:35], v[0:3]
	v_mfma_f32_16x16x32_bf16 v[4:7], a[4:7], v[36:39], v[4:7]
	v_mfma_f32_16x16x32_bf16 v[8:11], a[132:135], v[32:35], v[8:11]
	v_mfma_f32_16x16x32_bf16 v[12:15], a[132:135], v[36:39], v[12:15]
	v_mfma_f32_16x16x32_bf16 v[16:19], v[132:135], v[32:35], v[16:19]
	v_mfma_f32_16x16x32_bf16 v[20:23], v[132:135], v[36:39], v[20:23]
	ds_read_b128 v[32:35], v61 offset:4096
	ds_read_b128 v[36:39], v61 offset:36864
	s_waitcnt lgkmcnt(4)
	v_mfma_f32_16x16x32_bf16 v[0:3], a[8:11], v[40:43], v[0:3]
	v_mfma_f32_16x16x32_bf16 v[4:7], a[8:11], v[44:47], v[4:7]
	v_mfma_f32_16x16x32_bf16 v[8:11], a[136:139], v[40:43], v[8:11]
	v_mfma_f32_16x16x32_bf16 v[12:15], a[136:139], v[44:47], v[12:15]
	v_mfma_f32_16x16x32_bf16 v[16:19], v[136:139], v[40:43], v[16:19]
	v_mfma_f32_16x16x32_bf16 v[20:23], v[136:139], v[44:47], v[20:23]
	ds_read_b128 v[40:43], v61 offset:5120
	ds_read_b128 v[44:47], v61 offset:37888
	s_waitcnt lgkmcnt(4)
	v_mfma_f32_16x16x32_bf16 v[0:3], a[12:15], v[24:27], v[0:3]
	v_mfma_f32_16x16x32_bf16 v[4:7], a[12:15], v[28:31], v[4:7]
	v_mfma_f32_16x16x32_bf16 v[8:11], a[140:143], v[24:27], v[8:11]
	v_mfma_f32_16x16x32_bf16 v[12:15], a[140:143], v[28:31], v[12:15]
	v_mfma_f32_16x16x32_bf16 v[16:19], v[140:143], v[24:27], v[16:19]
	v_mfma_f32_16x16x32_bf16 v[20:23], v[140:143], v[28:31], v[20:23]
	ds_read_b128 v[24:27], v61 offset:6144
	ds_read_b128 v[28:31], v61 offset:38912
	s_waitcnt lgkmcnt(4)
	v_mfma_f32_16x16x32_bf16 v[0:3], a[16:19], v[32:35], v[0:3]
	v_mfma_f32_16x16x32_bf16 v[4:7], a[16:19], v[36:39], v[4:7]
	v_mfma_f32_16x16x32_bf16 v[8:11], a[144:147], v[32:35], v[8:11]
	v_mfma_f32_16x16x32_bf16 v[12:15], a[144:147], v[36:39], v[12:15]
	v_mfma_f32_16x16x32_bf16 v[16:19], v[144:147], v[32:35], v[16:19]
	v_mfma_f32_16x16x32_bf16 v[20:23], v[144:147], v[36:39], v[20:23]
	ds_read_b128 v[32:35], v61 offset:7168
	ds_read_b128 v[36:39], v61 offset:39936
	s_waitcnt lgkmcnt(4)
	v_mfma_f32_16x16x32_bf16 v[0:3], a[20:23], v[40:43], v[0:3]
	v_mfma_f32_16x16x32_bf16 v[4:7], a[20:23], v[44:47], v[4:7]
	v_mfma_f32_16x16x32_bf16 v[8:11], a[148:151], v[40:43], v[8:11]
	v_mfma_f32_16x16x32_bf16 v[12:15], a[148:151], v[44:47], v[12:15]
	v_mfma_f32_16x16x32_bf16 v[16:19], v[148:151], v[40:43], v[16:19]
	v_mfma_f32_16x16x32_bf16 v[20:23], v[148:151], v[44:47], v[20:23]
	ds_read_b128 v[40:43], v61 offset:8192
	ds_read_b128 v[44:47], v61 offset:40960
	s_waitcnt lgkmcnt(4)
	v_mfma_f32_16x16x32_bf16 v[0:3], a[24:27], v[24:27], v[0:3]
	v_mfma_f32_16x16x32_bf16 v[4:7], a[24:27], v[28:31], v[4:7]
	v_mfma_f32_16x16x32_bf16 v[8:11], a[152:155], v[24:27], v[8:11]
	v_mfma_f32_16x16x32_bf16 v[12:15], a[152:155], v[28:31], v[12:15]
	v_mfma_f32_16x16x32_bf16 v[16:19], v[152:155], v[24:27], v[16:19]
	v_mfma_f32_16x16x32_bf16 v[20:23], v[152:155], v[28:31], v[20:23]
	ds_read_b128 v[24:27], v61 offset:9216
	ds_read_b128 v[28:31], v61 offset:41984
	s_waitcnt lgkmcnt(4)
	v_mfma_f32_16x16x32_bf16 v[0:3], a[28:31], v[32:35], v[0:3]
	v_mfma_f32_16x16x32_bf16 v[4:7], a[28:31], v[36:39], v[4:7]
	v_mfma_f32_16x16x32_bf16 v[8:11], a[156:159], v[32:35], v[8:11]
	v_mfma_f32_16x16x32_bf16 v[12:15], a[156:159], v[36:39], v[12:15]
	v_mfma_f32_16x16x32_bf16 v[16:19], v[156:159], v[32:35], v[16:19]
	v_mfma_f32_16x16x32_bf16 v[20:23], v[156:159], v[36:39], v[20:23]
	ds_read_b128 v[32:35], v61 offset:10240
	ds_read_b128 v[36:39], v61 offset:43008
	s_waitcnt lgkmcnt(4)
	v_mfma_f32_16x16x32_bf16 v[0:3], a[32:35], v[40:43], v[0:3]
	v_mfma_f32_16x16x32_bf16 v[4:7], a[32:35], v[44:47], v[4:7]
	v_mfma_f32_16x16x32_bf16 v[8:11], a[160:163], v[40:43], v[8:11]
	v_mfma_f32_16x16x32_bf16 v[12:15], a[160:163], v[44:47], v[12:15]
	v_mfma_f32_16x16x32_bf16 v[16:19], v[160:163], v[40:43], v[16:19]
	v_mfma_f32_16x16x32_bf16 v[20:23], v[160:163], v[44:47], v[20:23]
	ds_read_b128 v[40:43], v61 offset:11264
	ds_read_b128 v[44:47], v61 offset:44032
	s_waitcnt lgkmcnt(4)
	v_mfma_f32_16x16x32_bf16 v[0:3], a[36:39], v[24:27], v[0:3]
	v_mfma_f32_16x16x32_bf16 v[4:7], a[36:39], v[28:31], v[4:7]
	v_mfma_f32_16x16x32_bf16 v[8:11], a[164:167], v[24:27], v[8:11]
	v_mfma_f32_16x16x32_bf16 v[12:15], a[164:167], v[28:31], v[12:15]
	v_mfma_f32_16x16x32_bf16 v[16:19], v[164:167], v[24:27], v[16:19]
	v_mfma_f32_16x16x32_bf16 v[20:23], v[164:167], v[28:31], v[20:23]
	ds_read_b128 v[24:27], v61 offset:12288
	ds_read_b128 v[28:31], v61 offset:45056
	s_waitcnt vmcnt(0)
	v_mov_b32 v65, s28
	s_mov_b64 exec, 1
	buffer_store_dword v65, v64, s[4:7], s30 offen sc1
	s_mov_b64 exec, -1
	s_cmp_ge_u32 s28, 63
	s_cbranch_scc1 .gnopf_703
	s_add_u32 s37, s28, 2
	v_cmp_gt_u32 vcc, s37, v63
	s_cbranch_vccnz .gnopf2_704
	s_mov_b32 s29, 1
	s_waitcnt lgkmcnt(4)
	v_mfma_f32_16x16x32_bf16 v[0:3], a[40:43], v[32:35], v[0:3]
	s_and_b32 s31, s56, 3
	s_mul_i32 s31, s31, 262144
	s_add_u32 s31, s31, s54
	s_add_u32 s56, s56, 1
	s_add_u32 s17, s32, 0
	s_mov_b32 m0, s17
	s_add_u32 s18, s31, 0
	buffer_load_dwordx4 v60, s[4:7], s18 offen offset:0 sc1 lds
	v_mfma_f32_16x16x32_bf16 v[4:7], a[40:43], v[36:39], v[4:7]
	buffer_load_dwordx4 v60, s[4:7], s18 offen offset:1024 sc1 lds
	v_mfma_f32_16x16x32_bf16 v[8:11], a[168:171], v[32:35], v[8:11]
	buffer_load_dwordx4 v60, s[4:7], s18 offen offset:2048 sc1 lds
	v_mfma_f32_16x16x32_bf16 v[12:15], a[168:171], v[36:39], v[12:15]
	buffer_load_dwordx4 v60, s[4:7], s18 offen offset:3072 sc1 lds
	v_mfma_f32_16x16x32_bf16 v[16:19], v[168:171], v[32:35], v[16:19]
	s_add_u32 s17, s32, 4096
	s_mov_b32 m0, s17
	s_add_u32 s18, s31, 4096
	buffer_load_dwordx4 v60, s[4:7], s18 offen offset:0 sc1 lds
	v_mfma_f32_16x16x32_bf16 v[20:23], v[168:171], v[36:39], v[20:23]
	buffer_load_dwordx4 v60, s[4:7], s18 offen offset:1024 sc1 lds
	ds_read_b128 v[32:35], v61 offset:13312
	ds_read_b128 v[36:39], v61 offset:46080
	s_waitcnt lgkmcnt(4)
	v_mfma_f32_16x16x32_bf16 v[0:3], a[44:47], v[40:43], v[0:3]
	buffer_load_dwordx4 v60, s[4:7], s18 offen offset:2048 sc1 lds
	v_mfma_f32_16x16x32_bf16 v[4:7], a[44:47], v[44:47], v[4:7]
	buffer_load_dwordx4 v60, s[4:7], s18 offen offset:3072 sc1 lds
	v_mfma_f32_16x16x32_bf16 v[8:11], a[172:175], v[40:43], v[8:11]
	s_add_u32 s17, s32, 8192
	s_mov_b32 m0, s17
	s_add_u32 s18, s31, 8192
	buffer_load_dwordx4 v60, s[4:7], s18 offen offset:0 sc1 lds
	v_mfma_f32_16x16x32_bf16 v[12:15], a[172:175], v[44:47], v[12:15]
	buffer_load_dwordx4 v60, s[4:7], s18 offen offset:1024 sc1 lds
	v_mfma_f32_16x16x32_bf16 v[16:19], v[172:175], v[40:43], v[16:19]
	buffer_load_dwordx4 v60, s[4:7], s18 offen offset:2048 sc1 lds
	v_mfma_f32_16x16x32_bf16 v[20:23], v[172:175], v[44:47], v[20:23]
	buffer_load_dwordx4 v60, s[4:7], s18 offen offset:3072 sc1 lds
	ds_read_b128 v[40:43], v61 offset:14336
	ds_read_b128 v[44:47], v61 offset:47104
	s_waitcnt lgkmcnt(4)
	v_mfma_f32_16x16x32_bf16 v[0:3], a[48:51], v[24:27], v[0:3]
	s_add_u32 s17, s32, 12288
	s_mov_b32 m0, s17
	s_add_u32 s18, s31, 12288
	buffer_load_dwordx4 v60, s[4:7], s18 offen offset:0 sc1 lds
	v_mfma_f32_16x16x32_bf16 v[4:7], a[48:51], v[28:31], v[4:7]
	buffer_load_dwordx4 v60, s[4:7], s18 offen offset:1024 sc1 lds
	v_mfma_f32_16x16x32_bf16 v[8:11], a[176:179], v[24:27], v[8:11]
	buffer_load_dwordx4 v60, s[4:7], s18 offen offset:2048 sc1 lds
	v_mfma_f32_16x16x32_bf16 v[12:15], a[176:179], v[28:31], v[12:15]
	buffer_load_dwordx4 v60, s[4:7], s18 offen offset:3072 sc1 lds
	s_sub_u32 s32, s44, s32
	v_mfma_f32_16x16x32_bf16 v[16:19], v[176:179], v[24:27], v[16:19]
	v_mfma_f32_16x16x32_bf16 v[20:23], v[176:179], v[28:31], v[20:23]
	ds_read_b128 v[24:27], v61 offset:15360
	ds_read_b128 v[28:31], v61 offset:48128
	s_branch .gaft_705
.gnopf2_704:
	buffer_load_dword v63, v62, s[4:7], 0 offen sc1
.gnopf_703:
	s_waitcnt lgkmcnt(4)
	v_mfma_f32_16x16x32_bf16 v[0:3], a[40:43], v[32:35], v[0:3]
	v_mfma_f32_16x16x32_bf16 v[4:7], a[40:43], v[36:39], v[4:7]
	v_mfma_f32_16x16x32_bf16 v[8:11], a[168:171], v[32:35], v[8:11]
	v_mfma_f32_16x16x32_bf16 v[12:15], a[168:171], v[36:39], v[12:15]
	v_mfma_f32_16x16x32_bf16 v[16:19], v[168:171], v[32:35], v[16:19]
	v_mfma_f32_16x16x32_bf16 v[20:23], v[168:171], v[36:39], v[20:23]
	ds_read_b128 v[32:35], v61 offset:13312
	ds_read_b128 v[36:39], v61 offset:46080
	s_waitcnt lgkmcnt(4)
	v_mfma_f32_16x16x32_bf16 v[0:3], a[44:47], v[40:43], v[0:3]
	v_mfma_f32_16x16x32_bf16 v[4:7], a[44:47], v[44:47], v[4:7]
	v_mfma_f32_16x16x32_bf16 v[8:11], a[172:175], v[40:43], v[8:11]
	v_mfma_f32_16x16x32_bf16 v[12:15], a[172:175], v[44:47], v[12:15]
	v_mfma_f32_16x16x32_bf16 v[16:19], v[172:175], v[40:43], v[16:19]
	v_mfma_f32_16x16x32_bf16 v[20:23], v[172:175], v[44:47], v[20:23]
	ds_read_b128 v[40:43], v61 offset:14336
	ds_read_b128 v[44:47], v61 offset:47104
	s_waitcnt lgkmcnt(4)
	v_mfma_f32_16x16x32_bf16 v[0:3], a[48:51], v[24:27], v[0:3]
	v_mfma_f32_16x16x32_bf16 v[4:7], a[48:51], v[28:31], v[4:7]
	v_mfma_f32_16x16x32_bf16 v[8:11], a[176:179], v[24:27], v[8:11]
	v_mfma_f32_16x16x32_bf16 v[12:15], a[176:179], v[28:31], v[12:15]
	v_mfma_f32_16x16x32_bf16 v[16:19], v[176:179], v[24:27], v[16:19]
	v_mfma_f32_16x16x32_bf16 v[20:23], v[176:179], v[28:31], v[20:23]
	ds_read_b128 v[24:27], v61 offset:15360
	ds_read_b128 v[28:31], v61 offset:48128
.gaft_705:
	s_waitcnt lgkmcnt(4)
	v_mfma_f32_16x16x32_bf16 v[0:3], a[52:55], v[32:35], v[0:3]
	v_mfma_f32_16x16x32_bf16 v[4:7], a[52:55], v[36:39], v[4:7]
	v_mfma_f32_16x16x32_bf16 v[8:11], a[180:183], v[32:35], v[8:11]
	v_mfma_f32_16x16x32_bf16 v[12:15], a[180:183], v[36:39], v[12:15]
	v_mfma_f32_16x16x32_bf16 v[16:19], v[180:183], v[32:35], v[16:19]
	v_mfma_f32_16x16x32_bf16 v[20:23], v[180:183], v[36:39], v[20:23]
	ds_read_b128 v[32:35], v61 offset:16384
	ds_read_b128 v[36:39], v61 offset:49152
	s_waitcnt lgkmcnt(4)
	v_mfma_f32_16x16x32_bf16 v[0:3], a[56:59], v[40:43], v[0:3]
	v_mfma_f32_16x16x32_bf16 v[4:7], a[56:59], v[44:47], v[4:7]
	v_mfma_f32_16x16x32_bf16 v[8:11], a[184:187], v[40:43], v[8:11]
	v_mfma_f32_16x16x32_bf16 v[12:15], a[184:187], v[44:47], v[12:15]
	v_mfma_f32_16x16x32_bf16 v[16:19], v[184:187], v[40:43], v[16:19]
	v_mfma_f32_16x16x32_bf16 v[20:23], v[184:187], v[44:47], v[20:23]
	ds_read_b128 v[40:43], v61 offset:17408
	ds_read_b128 v[44:47], v61 offset:50176
	s_waitcnt lgkmcnt(4)
	v_mfma_f32_16x16x32_bf16 v[0:3], a[60:63], v[24:27], v[0:3]
	v_mfma_f32_16x16x32_bf16 v[4:7], a[60:63], v[28:31], v[4:7]
	v_mfma_f32_16x16x32_bf16 v[8:11], a[188:191], v[24:27], v[8:11]
	v_mfma_f32_16x16x32_bf16 v[12:15], a[188:191], v[28:31], v[12:15]
	v_mfma_f32_16x16x32_bf16 v[16:19], v[188:191], v[24:27], v[16:19]
	v_mfma_f32_16x16x32_bf16 v[20:23], v[188:191], v[28:31], v[20:23]
	ds_read_b128 v[24:27], v61 offset:18432
	ds_read_b128 v[28:31], v61 offset:51200
	s_waitcnt lgkmcnt(4)
	v_mfma_f32_16x16x32_bf16 v[0:3], a[64:67], v[32:35], v[0:3]
	v_mfma_f32_16x16x32_bf16 v[4:7], a[64:67], v[36:39], v[4:7]
	v_mfma_f32_16x16x32_bf16 v[8:11], a[192:195], v[32:35], v[8:11]
	v_mfma_f32_16x16x32_bf16 v[12:15], a[192:195], v[36:39], v[12:15]
	v_mfma_f32_16x16x32_bf16 v[16:19], v[192:195], v[32:35], v[16:19]
	v_mfma_f32_16x16x32_bf16 v[20:23], v[192:195], v[36:39], v[20:23]
	ds_read_b128 v[32:35], v61 offset:19456
	ds_read_b128 v[36:39], v61 offset:52224
	s_cmp_lg_u32 s29, 0
	s_cbranch_scc1 .gnopf_706
	s_cmp_ge_u32 s28, 63
	s_cbranch_scc1 .gnopf_706
	s_waitcnt vmcnt(0)
	s_add_u32 s37, s28, 2
	v_cmp_gt_u32 vcc, s37, v63
	s_cbranch_vccnz .gnopf2_707
	s_mov_b32 s29, 1
	s_waitcnt lgkmcnt(4)
	v_mfma_f32_16x16x32_bf16 v[0:3], a[68:71], v[40:43], v[0:3]
	s_and_b32 s31, s56, 3
	s_mul_i32 s31, s31, 262144
	s_add_u32 s31, s31, s54
	s_add_u32 s56, s56, 1
	s_add_u32 s17, s32, 0
	s_mov_b32 m0, s17
	s_add_u32 s18, s31, 0
	buffer_load_dwordx4 v60, s[4:7], s18 offen offset:0 sc1 lds
	v_mfma_f32_16x16x32_bf16 v[4:7], a[68:71], v[44:47], v[4:7]
	buffer_load_dwordx4 v60, s[4:7], s18 offen offset:1024 sc1 lds
	v_mfma_f32_16x16x32_bf16 v[8:11], a[196:199], v[40:43], v[8:11]
	buffer_load_dwordx4 v60, s[4:7], s18 offen offset:2048 sc1 lds
	v_mfma_f32_16x16x32_bf16 v[12:15], a[196:199], v[44:47], v[12:15]
	buffer_load_dwordx4 v60, s[4:7], s18 offen offset:3072 sc1 lds
	v_mfma_f32_16x16x32_bf16 v[16:19], v[196:199], v[40:43], v[16:19]
	s_add_u32 s17, s32, 4096
	s_mov_b32 m0, s17
	s_add_u32 s18, s31, 4096
	buffer_load_dwordx4 v60, s[4:7], s18 offen offset:0 sc1 lds
	v_mfma_f32_16x16x32_bf16 v[20:23], v[196:199], v[44:47], v[20:23]
	buffer_load_dwordx4 v60, s[4:7], s18 offen offset:1024 sc1 lds
	ds_read_b128 v[40:43], v61 offset:20480
	ds_read_b128 v[44:47], v61 offset:53248
	s_waitcnt lgkmcnt(4)
	v_mfma_f32_16x16x32_bf16 v[0:3], a[72:75], v[24:27], v[0:3]
	buffer_load_dwordx4 v60, s[4:7], s18 offen offset:2048 sc1 lds
	v_mfma_f32_16x16x32_bf16 v[4:7], a[72:75], v[28:31], v[4:7]
	buffer_load_dwordx4 v60, s[4:7], s18 offen offset:3072 sc1 lds
	v_mfma_f32_16x16x32_bf16 v[8:11], a[200:203], v[24:27], v[8:11]
	s_add_u32 s17, s32, 8192
	s_mov_b32 m0, s17
	s_add_u32 s18, s31, 8192
	buffer_load_dwordx4 v60, s[4:7], s18 offen offset:0 sc1 lds
	v_mfma_f32_16x16x32_bf16 v[12:15], a[200:203], v[28:31], v[12:15]
	buffer_load_dwordx4 v60, s[4:7], s18 offen offset:1024 sc1 lds
	v_mfma_f32_16x16x32_bf16 v[16:19], v[200:203], v[24:27], v[16:19]
	buffer_load_dwordx4 v60, s[4:7], s18 offen offset:2048 sc1 lds
	v_mfma_f32_16x16x32_bf16 v[20:23], v[200:203], v[28:31], v[20:23]
	buffer_load_dwordx4 v60, s[4:7], s18 offen offset:3072 sc1 lds
	ds_read_b128 v[24:27], v61 offset:21504
	ds_read_b128 v[28:31], v61 offset:54272
	s_waitcnt lgkmcnt(4)
	v_mfma_f32_16x16x32_bf16 v[0:3], a[76:79], v[32:35], v[0:3]
	s_add_u32 s17, s32, 12288
	s_mov_b32 m0, s17
	s_add_u32 s18, s31, 12288
	buffer_load_dwordx4 v60, s[4:7], s18 offen offset:0 sc1 lds
	v_mfma_f32_16x16x32_bf16 v[4:7], a[76:79], v[36:39], v[4:7]
	buffer_load_dwordx4 v60, s[4:7], s18 offen offset:1024 sc1 lds
	v_mfma_f32_16x16x32_bf16 v[8:11], a[204:207], v[32:35], v[8:11]
	buffer_load_dwordx4 v60, s[4:7], s18 offen offset:2048 sc1 lds
	v_mfma_f32_16x16x32_bf16 v[12:15], a[204:207], v[36:39], v[12:15]
	buffer_load_dwordx4 v60, s[4:7], s18 offen offset:3072 sc1 lds
	s_sub_u32 s32, s44, s32
	v_mfma_f32_16x16x32_bf16 v[16:19], v[204:207], v[32:35], v[16:19]
	v_mfma_f32_16x16x32_bf16 v[20:23], v[204:207], v[36:39], v[20:23]
	ds_read_b128 v[32:35], v61 offset:22528
	ds_read_b128 v[36:39], v61 offset:55296
	s_branch .gaft_708
.gnopf2_707:
	buffer_load_dword v63, v62, s[4:7], 0 offen sc1
.gnopf_706:
	s_waitcnt lgkmcnt(4)
	v_mfma_f32_16x16x32_bf16 v[0:3], a[68:71], v[40:43], v[0:3]
	v_mfma_f32_16x16x32_bf16 v[4:7], a[68:71], v[44:47], v[4:7]
	v_mfma_f32_16x16x32_bf16 v[8:11], a[196:199], v[40:43], v[8:11]
	v_mfma_f32_16x16x32_bf16 v[12:15], a[196:199], v[44:47], v[12:15]
	v_mfma_f32_16x16x32_bf16 v[16:19], v[196:199], v[40:43], v[16:19]
	v_mfma_f32_16x16x32_bf16 v[20:23], v[196:199], v[44:47], v[20:23]
	ds_read_b128 v[40:43], v61 offset:20480
	ds_read_b128 v[44:47], v61 offset:53248
	s_waitcnt lgkmcnt(4)
	v_mfma_f32_16x16x32_bf16 v[0:3], a[72:75], v[24:27], v[0:3]
	v_mfma_f32_16x16x32_bf16 v[4:7], a[72:75], v[28:31], v[4:7]
	v_mfma_f32_16x16x32_bf16 v[8:11], a[200:203], v[24:27], v[8:11]
	v_mfma_f32_16x16x32_bf16 v[12:15], a[200:203], v[28:31], v[12:15]
	v_mfma_f32_16x16x32_bf16 v[16:19], v[200:203], v[24:27], v[16:19]
	v_mfma_f32_16x16x32_bf16 v[20:23], v[200:203], v[28:31], v[20:23]
	ds_read_b128 v[24:27], v61 offset:21504
	ds_read_b128 v[28:31], v61 offset:54272
	s_waitcnt lgkmcnt(4)
	v_mfma_f32_16x16x32_bf16 v[0:3], a[76:79], v[32:35], v[0:3]
	v_mfma_f32_16x16x32_bf16 v[4:7], a[76:79], v[36:39], v[4:7]
	v_mfma_f32_16x16x32_bf16 v[8:11], a[204:207], v[32:35], v[8:11]
	v_mfma_f32_16x16x32_bf16 v[12:15], a[204:207], v[36:39], v[12:15]
	v_mfma_f32_16x16x32_bf16 v[16:19], v[204:207], v[32:35], v[16:19]
	v_mfma_f32_16x16x32_bf16 v[20:23], v[204:207], v[36:39], v[20:23]
	ds_read_b128 v[32:35], v61 offset:22528
	ds_read_b128 v[36:39], v61 offset:55296
.gaft_708:
	s_waitcnt lgkmcnt(4)
	v_mfma_f32_16x16x32_bf16 v[0:3], a[80:83], v[40:43], v[0:3]
	v_mfma_f32_16x16x32_bf16 v[4:7], a[80:83], v[44:47], v[4:7]
	v_mfma_f32_16x16x32_bf16 v[8:11], a[208:211], v[40:43], v[8:11]
	v_mfma_f32_16x16x32_bf16 v[12:15], a[208:211], v[44:47], v[12:15]
	v_mfma_f32_16x16x32_bf16 v[16:19], v[208:211], v[40:43], v[16:19]
	v_mfma_f32_16x16x32_bf16 v[20:23], v[208:211], v[44:47], v[20:23]
	ds_read_b128 v[40:43], v61 offset:23552
	ds_read_b128 v[44:47], v61 offset:56320
	s_waitcnt lgkmcnt(4)
	v_mfma_f32_16x16x32_bf16 v[0:3], a[84:87], v[24:27], v[0:3]
	v_mfma_f32_16x16x32_bf16 v[4:7], a[84:87], v[28:31], v[4:7]
	v_mfma_f32_16x16x32_bf16 v[8:11], a[212:215], v[24:27], v[8:11]
	v_mfma_f32_16x16x32_bf16 v[12:15], a[212:215], v[28:31], v[12:15]
	v_mfma_f32_16x16x32_bf16 v[16:19], v[212:215], v[24:27], v[16:19]
	v_mfma_f32_16x16x32_bf16 v[20:23], v[212:215], v[28:31], v[20:23]
	ds_read_b128 v[24:27], v61 offset:24576
	ds_read_b128 v[28:31], v61 offset:57344
	s_waitcnt lgkmcnt(4)
	v_mfma_f32_16x16x32_bf16 v[0:3], a[88:91], v[32:35], v[0:3]
	v_mfma_f32_16x16x32_bf16 v[4:7], a[88:91], v[36:39], v[4:7]
	v_mfma_f32_16x16x32_bf16 v[8:11], a[216:219], v[32:35], v[8:11]
	v_mfma_f32_16x16x32_bf16 v[12:15], a[216:219], v[36:39], v[12:15]
	v_mfma_f32_16x16x32_bf16 v[16:19], v[216:219], v[32:35], v[16:19]
	v_mfma_f32_16x16x32_bf16 v[20:23], v[216:219], v[36:39], v[20:23]
	ds_read_b128 v[32:35], v61 offset:25600
	ds_read_b128 v[36:39], v61 offset:58368
	s_waitcnt lgkmcnt(4)
	v_mfma_f32_16x16x32_bf16 v[0:3], a[92:95], v[40:43], v[0:3]
	v_mfma_f32_16x16x32_bf16 v[4:7], a[92:95], v[44:47], v[4:7]
	v_mfma_f32_16x16x32_bf16 v[8:11], a[220:223], v[40:43], v[8:11]
	v_mfma_f32_16x16x32_bf16 v[12:15], a[220:223], v[44:47], v[12:15]
	v_mfma_f32_16x16x32_bf16 v[16:19], v[220:223], v[40:43], v[16:19]
	v_mfma_f32_16x16x32_bf16 v[20:23], v[220:223], v[44:47], v[20:23]
	ds_read_b128 v[40:43], v61 offset:26624
	ds_read_b128 v[44:47], v61 offset:59392
	s_cmp_lg_u32 s29, 0
	s_cbranch_scc1 .gnopf_709
	s_cmp_ge_u32 s28, 63
	s_cbranch_scc1 .gnopf_709
	s_waitcnt vmcnt(0)
	s_add_u32 s37, s28, 2
	v_cmp_gt_u32 vcc, s37, v63
	s_cbranch_vccnz .gnopf2_710
	s_mov_b32 s29, 1
	s_waitcnt lgkmcnt(4)
	v_mfma_f32_16x16x32_bf16 v[0:3], a[96:99], v[24:27], v[0:3]
	s_and_b32 s31, s56, 3
	s_mul_i32 s31, s31, 262144
	s_add_u32 s31, s31, s54
	s_add_u32 s56, s56, 1
	s_add_u32 s17, s32, 0
	s_mov_b32 m0, s17
	s_add_u32 s18, s31, 0
	buffer_load_dwordx4 v60, s[4:7], s18 offen offset:0 sc1 lds
	v_mfma_f32_16x16x32_bf16 v[4:7], a[96:99], v[28:31], v[4:7]
	buffer_load_dwordx4 v60, s[4:7], s18 offen offset:1024 sc1 lds
	v_mfma_f32_16x16x32_bf16 v[8:11], a[224:227], v[24:27], v[8:11]
	buffer_load_dwordx4 v60, s[4:7], s18 offen offset:2048 sc1 lds
	v_mfma_f32_16x16x32_bf16 v[12:15], a[224:227], v[28:31], v[12:15]
	buffer_load_dwordx4 v60, s[4:7], s18 offen offset:3072 sc1 lds
	v_mfma_f32_16x16x32_bf16 v[16:19], v[224:227], v[24:27], v[16:19]
	s_add_u32 s17, s32, 4096
	s_mov_b32 m0, s17
	s_add_u32 s18, s31, 4096
	buffer_load_dwordx4 v60, s[4:7], s18 offen offset:0 sc1 lds
	v_mfma_f32_16x16x32_bf16 v[20:23], v[224:227], v[28:31], v[20:23]
	buffer_load_dwordx4 v60, s[4:7], s18 offen offset:1024 sc1 lds
	ds_read_b128 v[24:27], v61 offset:27648
	ds_read_b128 v[28:31], v61 offset:60416
	s_waitcnt lgkmcnt(4)
	v_mfma_f32_16x16x32_bf16 v[0:3], a[100:103], v[32:35], v[0:3]
	buffer_load_dwordx4 v60, s[4:7], s18 offen offset:2048 sc1 lds
	v_mfma_f32_16x16x32_bf16 v[4:7], a[100:103], v[36:39], v[4:7]
	buffer_load_dwordx4 v60, s[4:7], s18 offen offset:3072 sc1 lds
	v_mfma_f32_16x16x32_bf16 v[8:11], a[228:231], v[32:35], v[8:11]
	s_add_u32 s17, s32, 8192
	s_mov_b32 m0, s17
	s_add_u32 s18, s31, 8192
	buffer_load_dwordx4 v60, s[4:7], s18 offen offset:0 sc1 lds
	v_mfma_f32_16x16x32_bf16 v[12:15], a[228:231], v[36:39], v[12:15]
	buffer_load_dwordx4 v60, s[4:7], s18 offen offset:1024 sc1 lds
	v_mfma_f32_16x16x32_bf16 v[16:19], v[228:231], v[32:35], v[16:19]
	buffer_load_dwordx4 v60, s[4:7], s18 offen offset:2048 sc1 lds
	v_mfma_f32_16x16x32_bf16 v[20:23], v[228:231], v[36:39], v[20:23]
	buffer_load_dwordx4 v60, s[4:7], s18 offen offset:3072 sc1 lds
	ds_read_b128 v[32:35], v61 offset:28672
	ds_read_b128 v[36:39], v61 offset:61440
	s_waitcnt lgkmcnt(4)
	v_mfma_f32_16x16x32_bf16 v[0:3], a[104:107], v[40:43], v[0:3]
	s_add_u32 s17, s32, 12288
	s_mov_b32 m0, s17
	s_add_u32 s18, s31, 12288
	buffer_load_dwordx4 v60, s[4:7], s18 offen offset:0 sc1 lds
	v_mfma_f32_16x16x32_bf16 v[4:7], a[104:107], v[44:47], v[4:7]
	buffer_load_dwordx4 v60, s[4:7], s18 offen offset:1024 sc1 lds
	v_mfma_f32_16x16x32_bf16 v[8:11], a[232:235], v[40:43], v[8:11]
	buffer_load_dwordx4 v60, s[4:7], s18 offen offset:2048 sc1 lds
	v_mfma_f32_16x16x32_bf16 v[12:15], a[232:235], v[44:47], v[12:15]
	buffer_load_dwordx4 v60, s[4:7], s18 offen offset:3072 sc1 lds
	s_sub_u32 s32, s44, s32
	v_mfma_f32_16x16x32_bf16 v[16:19], v[232:235], v[40:43], v[16:19]
	v_mfma_f32_16x16x32_bf16 v[20:23], v[232:235], v[44:47], v[20:23]
	ds_read_b128 v[40:43], v61 offset:29696
	ds_read_b128 v[44:47], v61 offset:62464
	s_branch .gaft_711
.gnopf2_710:
	buffer_load_dword v63, v62, s[4:7], 0 offen sc1
.gnopf_709:
	s_waitcnt lgkmcnt(4)
	v_mfma_f32_16x16x32_bf16 v[0:3], a[96:99], v[24:27], v[0:3]
	v_mfma_f32_16x16x32_bf16 v[4:7], a[96:99], v[28:31], v[4:7]
	v_mfma_f32_16x16x32_bf16 v[8:11], a[224:227], v[24:27], v[8:11]
	v_mfma_f32_16x16x32_bf16 v[12:15], a[224:227], v[28:31], v[12:15]
	v_mfma_f32_16x16x32_bf16 v[16:19], v[224:227], v[24:27], v[16:19]
	v_mfma_f32_16x16x32_bf16 v[20:23], v[224:227], v[28:31], v[20:23]
	ds_read_b128 v[24:27], v61 offset:27648
	ds_read_b128 v[28:31], v61 offset:60416
	s_waitcnt lgkmcnt(4)
	v_mfma_f32_16x16x32_bf16 v[0:3], a[100:103], v[32:35], v[0:3]
	v_mfma_f32_16x16x32_bf16 v[4:7], a[100:103], v[36:39], v[4:7]
	v_mfma_f32_16x16x32_bf16 v[8:11], a[228:231], v[32:35], v[8:11]
	v_mfma_f32_16x16x32_bf16 v[12:15], a[228:231], v[36:39], v[12:15]
	v_mfma_f32_16x16x32_bf16 v[16:19], v[228:231], v[32:35], v[16:19]
	v_mfma_f32_16x16x32_bf16 v[20:23], v[228:231], v[36:39], v[20:23]
	ds_read_b128 v[32:35], v61 offset:28672
	ds_read_b128 v[36:39], v61 offset:61440
	s_waitcnt lgkmcnt(4)
	v_mfma_f32_16x16x32_bf16 v[0:3], a[104:107], v[40:43], v[0:3]
	v_mfma_f32_16x16x32_bf16 v[4:7], a[104:107], v[44:47], v[4:7]
	v_mfma_f32_16x16x32_bf16 v[8:11], a[232:235], v[40:43], v[8:11]
	v_mfma_f32_16x16x32_bf16 v[12:15], a[232:235], v[44:47], v[12:15]
	v_mfma_f32_16x16x32_bf16 v[16:19], v[232:235], v[40:43], v[16:19]
	v_mfma_f32_16x16x32_bf16 v[20:23], v[232:235], v[44:47], v[20:23]
	ds_read_b128 v[40:43], v61 offset:29696
	ds_read_b128 v[44:47], v61 offset:62464
.gaft_711:
	s_waitcnt lgkmcnt(4)
	v_mfma_f32_16x16x32_bf16 v[0:3], a[108:111], v[24:27], v[0:3]
	v_mfma_f32_16x16x32_bf16 v[4:7], a[108:111], v[28:31], v[4:7]
	v_mfma_f32_16x16x32_bf16 v[8:11], a[236:239], v[24:27], v[8:11]
	v_mfma_f32_16x16x32_bf16 v[12:15], a[236:239], v[28:31], v[12:15]
	v_mfma_f32_16x16x32_bf16 v[16:19], v[236:239], v[24:27], v[16:19]
	v_mfma_f32_16x16x32_bf16 v[20:23], v[236:239], v[28:31], v[20:23]
	ds_read_b128 v[24:27], v61 offset:30720
	ds_read_b128 v[28:31], v61 offset:63488
	s_waitcnt lgkmcnt(4)
	v_mfma_f32_16x16x32_bf16 v[0:3], a[112:115], v[32:35], v[0:3]
	v_mfma_f32_16x16x32_bf16 v[4:7], a[112:115], v[36:39], v[4:7]
	v_mfma_f32_16x16x32_bf16 v[8:11], a[240:243], v[32:35], v[8:11]
	v_mfma_f32_16x16x32_bf16 v[12:15], a[240:243], v[36:39], v[12:15]
	v_mfma_f32_16x16x32_bf16 v[16:19], v[240:243], v[32:35], v[16:19]
	v_mfma_f32_16x16x32_bf16 v[20:23], v[240:243], v[36:39], v[20:23]
	ds_read_b128 v[32:35], v61 offset:31744
	ds_read_b128 v[36:39], v61 offset:64512
	s_waitcnt lgkmcnt(4)
	v_mfma_f32_16x16x32_bf16 v[0:3], a[116:119], v[40:43], v[0:3]
	v_mfma_f32_16x16x32_bf16 v[4:7], a[116:119], v[44:47], v[4:7]
	v_mfma_f32_16x16x32_bf16 v[8:11], a[244:247], v[40:43], v[8:11]
	v_mfma_f32_16x16x32_bf16 v[12:15], a[244:247], v[44:47], v[12:15]
	v_mfma_f32_16x16x32_bf16 v[16:19], v[244:247], v[40:43], v[16:19]
	v_mfma_f32_16x16x32_bf16 v[20:23], v[244:247], v[44:47], v[20:23]
	s_waitcnt lgkmcnt(2)
	v_mfma_f32_16x16x32_bf16 v[0:3], a[120:123], v[24:27], v[0:3]
	v_mfma_f32_16x16x32_bf16 v[4:7], a[120:123], v[28:31], v[4:7]
	v_mfma_f32_16x16x32_bf16 v[8:11], a[248:251], v[24:27], v[8:11]
	v_mfma_f32_16x16x32_bf16 v[12:15], a[248:251], v[28:31], v[12:15]
	v_mfma_f32_16x16x32_bf16 v[16:19], v[248:251], v[24:27], v[16:19]
	v_mfma_f32_16x16x32_bf16 v[20:23], v[248:251], v[28:31], v[20:23]
	s_waitcnt lgkmcnt(0)
	v_mfma_f32_16x16x32_bf16 v[0:3], a[124:127], v[32:35], v[0:3]
	v_mfma_f32_16x16x32_bf16 v[4:7], a[124:127], v[36:39], v[4:7]
	v_mfma_f32_16x16x32_bf16 v[8:11], a[252:255], v[32:35], v[8:11]
	v_mfma_f32_16x16x32_bf16 v[12:15], a[252:255], v[36:39], v[12:15]
	v_mfma_f32_16x16x32_bf16 v[16:19], v[252:255], v[32:35], v[16:19]
	v_mfma_f32_16x16x32_bf16 v[20:23], v[252:255], v[36:39], v[20:23]
	s_sub_i32 s57, s28, 4
	s_max_i32 s57, s57, 0
	s_cmp_eq_u32 s28, 4
	s_cselect_b32 s57, 1, s57
	v_cmp_gt_u32 vcc, s57, v68
	s_cbranch_vccz .pck_712
	s_mov_b32 s20, 400000
.pre_713:
	buffer_load_dword v68, v67, s[4:7], 0 offen sc1
	s_waitcnt vmcnt(0)
	v_cmp_gt_u32 vcc, s57, v68
	s_cbranch_vccz .pok_714
	s_sub_u32 s20, s20, 1
	s_cmp_lg_u32 s20, 0
	s_cbranch_scc1 .pre_713
	s_branch L_FAIL
.pok_714:
.pck_712:
	s_and_b32 s34, s28, 3
	s_mul_i32 s34, s34, 294912
	s_add_u32 s34, s34, s55
	s_add_u32 s35, s34, 36864
	buffer_store_dwordx4 v[0:3], v66, s[4:7], s34 offen offset:0 sc1
	buffer_store_dwordx4 v[4:7], v66, s[4:7], s35 offen offset:0 sc1
	buffer_store_dwordx4 v[8:11], v66, s[4:7], s34 offen offset:512 sc1
	buffer_store_dwordx4 v[12:15], v66, s[4:7], s35 offen offset:512 sc1
	buffer_store_dwordx4 v[16:19], v66, s[4:7], s34 offen offset:1024 sc1
	buffer_store_dwordx4 v[20:23], v66, s[4:7], s35 offen offset:1024 sc1
	s_add_u32 s34, s34, 294912
	s_add_u32 s28, s28, 1
	s_cmp_lg_u32 s29, 0
	s_cbranch_scc1 .gloop_698
	s_cmp_ge_u32 s28, 64
	s_cbranch_scc1 .gnofin_716
	s_waitcnt vmcnt(6)
	s_add_u32 s37, s28, 1
	v_cmp_gt_u32 vcc, s37, v63
	s_cbranch_vccnz .gnofin_716
	s_and_b32 s31, s56, 3
	s_mul_i32 s31, s31, 262144
	s_add_u32 s31, s31, s54
	s_add_u32 s56, s56, 1
	s_add_u32 s17, s32, 0
	s_mov_b32 m0, s17
	s_add_u32 s18, s31, 0
	buffer_load_dwordx4 v60, s[4:7], s18 offen offset:0 sc1 lds
	buffer_load_dwordx4 v60, s[4:7], s18 offen offset:1024 sc1 lds
	buffer_load_dwordx4 v60, s[4:7], s18 offen offset:2048 sc1 lds
	buffer_load_dwordx4 v60, s[4:7], s18 offen offset:3072 sc1 lds
	s_add_u32 s17, s32, 4096
	s_mov_b32 m0, s17
	s_add_u32 s18, s31, 4096
	buffer_load_dwordx4 v60, s[4:7], s18 offen offset:0 sc1 lds
	buffer_load_dwordx4 v60, s[4:7], s18 offen offset:1024 sc1 lds
	buffer_load_dwordx4 v60, s[4:7], s18 offen offset:2048 sc1 lds
	buffer_load_dwordx4 v60, s[4:7], s18 offen offset:3072 sc1 lds
	s_add_u32 s17, s32, 8192
	s_mov_b32 m0, s17
	s_add_u32 s18, s31, 8192
	buffer_load_dwordx4 v60, s[4:7], s18 offen offset:0 sc1 lds
	buffer_load_dwordx4 v60, s[4:7], s18 offen offset:1024 sc1 lds
	buffer_load_dwordx4 v60, s[4:7], s18 offen offset:2048 sc1 lds
	buffer_load_dwordx4 v60, s[4:7], s18 offen offset:3072 sc1 lds
	s_add_u32 s17, s32, 12288
	s_mov_b32 m0, s17
	s_add_u32 s18, s31, 12288
	buffer_load_dwordx4 v60, s[4:7], s18 offen offset:0 sc1 lds
	buffer_load_dwordx4 v60, s[4:7], s18 offen offset:1024 sc1 lds
	buffer_load_dwordx4 v60, s[4:7], s18 offen offset:2048 sc1 lds
	buffer_load_dwordx4 v60, s[4:7], s18 offen offset:3072 sc1 lds
	s_sub_u32 s32, s44, s32
	s_waitcnt vmcnt(16)
	v_mov_b32 v65, s28
	s_mov_b64 exec, 1
	buffer_store_dword v65, v64, s[4:7], s30 offen sc1
	s_mov_b64 exec, -1
	s_waitcnt vmcnt(1)
	s_branch .ggo_700
.gnofin_716:
	s_waitcnt vmcnt(0)
	v_mov_b32 v65, s28
	s_mov_b64 exec, 1
	buffer_store_dword v65, v64, s[4:7], s30 offen sc1
	s_mov_b64 exec, -1
	s_cmp_lt_u32 s28, 64
	s_cbranch_scc1 .gloop_698
	s_branch L_END
.p2align 6
L_RA0:
	v_and_b32 v79, 63, v0
	v_mov_b32 v75, v0
	v_and_b32 v78, 15, v79
	v_lshrrev_b32 v77, 4, v79
	v_and_b32 v76, 7, v79
	s_lshr_b32 s47, s26, 2
	s_and_b32 s26, s26, 3
	v_bfe_u32 v72, v79, 3, 2
	v_lshrrev_b32 v73, 5, v79
	v_lshlrev_b32 v106, 10, v73
	v_lshlrev_b32 v74, 8, v72
	v_add_u32 v106, v106, v74
	v_lshlrev_b32 v74, 4, v76
	v_add_u32 v106, v106, v74
	s_mul_i32 s17, s15, 9
	v_add_u32 v73, s17, v73
	v_mul_u32_u24 v96, 1152, v76
	v_lshlrev_b32 v74, 5, v73
	v_add_u32 v96, v96, v74
	v_lshlrev_b32 v74, 3, v72
	v_add_u32 v96, v96, v74
	v_lshlrev_b32 v105, 4, v79
	s_mul_i32 s17, s15, 4608
	v_add_u32 v97, s17, v105
	v_lshrrev_b32 v98, 1, v73
	v_lshlrev_b32 v98, 9, v98
	v_and_b32 v74, 1, v73
	v_lshlrev_b32 v74, 3, v74
	v_add_u32 v98, v98, v74
	v_lshlrev_b32 v74, 7, v72
	v_add_u32 v98, v98, v74
	v_lshlrev_b32 v74, 4, v76
	v_add_u32 v98, v98, v74
	v_add_u32 v98, 10240, v98
	s_and_b32 s17, s26, 1
	s_lshr_b32 s18, s26, 1
	s_lshl_b32 s19, s17, 7
	v_add_u32 v106, s19, v106
	v_lshlrev_b32 v103, 3, v76
	v_mov_b32 v101, 0
	v_mov_b32 v104, 0xffff0000
	s_mul_i32 s38, s26, 9216
	s_mov_b32 s39, s38
	s_mul_i32 s40, s26, 18432
	s_mul_i32 s41, s18, 18432
	s_load_dwordx2 s[22:23], s[0:1], 0
	s_waitcnt lgkmcnt(0)
	s_mov_b32 s48, s22
	s_and_b32 s49, s23, 0xffff
	s_mov_b32 s50, 0x240000
	s_mov_b32 s51, 0x00020000
	s_mov_b32 s52, s4
	s_mov_b32 s53, s5
	s_mov_b32 s54, s6
	s_mov_b32 s55, s7
	s_add_u32 s39, s39, 0xa180000
	s_add_u32 s40, s40, 0x9880000
	v_min_u32 v99, 11, v79
	v_lshrrev_b32 v74, 2, v99
	v_add_u32 v74, 157, v74
	v_lshlrev_b32 v74, 7, v74
	v_and_b32 v99, 3, v99
	v_lshlrev_b32 v99, 2, v99
	v_add_u32 v99, v99, v74
	s_mov_b32 s56, -1
	s_mov_b32 s57, 0xffff
	s_add_u32 s41, s41, 0xa600000
	s_lshl_b32 s30, s14, 7
	s_lshl_b32 s17, s15, 2
	s_add_u32 s30, s30, s17
	s_mov_b32 s42, -1
	s_mov_b32 s43, 0
	s_lshl_b32 s60, s15, 10
	s_lshl_b32 s61, s15, 11
	v_add_u32 v111, s60, v105
	v_mov_b32 v74, 0
	s_mov_b32 s20, 400000
	v_and_b32 v72, 7, v79
	v_lshrrev_b32 v73, 2, v72
	v_mul_u32_u24 v73, 112, v73
	v_lshlrev_b32 v72, 2, v72
	v_add_u32 v72, v72, v73
	s_getpc_b64 s[18:19]
.ct_720:
	s_sub_u32 s18, s18, .ct_720-L_RA0
	s_subb_u32 s19, s19, 0
	v_lshlrev_b32 v74, 7, v79
	s_lshl_b32 s17, s15, 13
	v_add_u32 v74, s17, v74
	s_mov_b32 s17, L_RA0_CE-L_RA0-4
	v_min_u32 v74, s17, v74
	global_load_dword v73, v74, s[18:19]
	v_mov_b32 v74, 0
.gbre_717:
	global_load_dword v73, v72, s[12:13] offset:16 sc1
	s_waitcnt vmcnt(0)
	v_readlane_b32 s17, v73, 0
	v_readlane_b32 s18, v73, 1
	s_nop 0
	s_add_u32 s17, s17, s18
	v_readlane_b32 s18, v73, 2
	s_nop 0
	s_add_u32 s17, s17, s18
	v_readlane_b32 s18, v73, 3
	s_nop 0
	s_add_u32 s17, s17, s18
	v_readlane_b32 s18, v73, 4
	s_nop 0
	s_add_u32 s17, s17, s18
	v_readlane_b32 s18, v73, 5
	s_nop 0
	s_add_u32 s17, s17, s18
	v_readlane_b32 s18, v73, 6
	s_nop 0
	s_add_u32 s17, s17, s18
	v_readlane_b32 s18, v73, 7
	s_nop 0
	s_add_u32 s17, s17, s18
	s_cmp_ge_u32 s17, 256
	s_cbranch_scc1 .gbok_718
	s_sub_u32 s20, s20, 1
	s_cmp_lg_u32 s20, 0
	s_cbranch_scc1 .gbre_717
	s_branch L_FAIL
.gbok_718:
	s_mov_b32 s28, s47
	s_mov_b32 s46, 0
	buffer_load_dwordx2 v[30:31], v96, s[48:51], s38 offen offset:0
	buffer_load_dwordx2 v[32:33], v96, s[48:51], s38 offen offset:64
	buffer_load_dwordx2 v[34:35], v96, s[48:51], s38 offen offset:128
	buffer_load_dwordx2 v[36:37], v96, s[48:51], s38 offen offset:192
	s_mov_b64 exec, s[42:43]
	buffer_load_dwordx2 v[38:39], v96, s[48:51], s38 offen offset:256
	s_mov_b64 exec, -1
	s_add_u32 s38, s38, 36864
	s_mov_b32 s46, 1
	s_add_u32 s37, s28, 1
	buffer_load_dword v100, v99, s[4:7], 0 offen sc1
	s_waitcnt vmcnt(0)
	v_cmp_gt_u32 vcc, s37, v100
	s_cbranch_vccz .rok_721
	s_mov_b32 s20, 400000
.rre_722:
	buffer_load_dword v100, v99, s[4:7], 0 offen sc1
	s_waitcnt vmcnt(0)
	v_cmp_gt_u32 vcc, s37, v100
	s_cbranch_vccz .rok_721
	s_sub_u32 s20, s20, 1
	s_cmp_lg_u32 s20, 0
	s_cbranch_scc1 .rre_722
	s_branch L_FAIL
.rok_721:
.rloop_723:
	v_mov_b32 v20, v30
	v_mov_b32 v21, v31
	v_mov_b32 v22, v32
	v_mov_b32 v23, v33
	v_mov_b32 v24, v34
	v_mov_b32 v25, v35
	v_mov_b32 v26, v36
	v_mov_b32 v27, v37
	v_mov_b32 v28, v38
	v_mov_b32 v29, v39
	s_and_b32 s63, s28, 3
	s_mul_i32 s63, s63, 73728
	s_add_u32 s63, s63, s40
	s_add_u32 s17, s63, 0
	s_add_u32 s18, s17, 4096
	buffer_load_dwordx4 v[128:131], v97, s[4:7], s17 offen offset:0 sc1
	buffer_load_dwordx4 v[132:135], v97, s[4:7], s17 offen offset:1024 sc1
	buffer_load_dwordx4 v[136:139], v97, s[4:7], s17 offen offset:2048 sc1
	buffer_load_dwordx4 v[140:143], v97, s[4:7], s17 offen offset:3072 sc1
	s_mov_b64 exec, s[42:43]
	buffer_load_dwordx4 v[144:147], v97, s[4:7], s18 offen offset:0 sc1
	s_mov_b64 exec, -1
	s_mov_b32 s46, 0
	s_cmp_ge_u32 s28, 63
	s_cbranch_scc1 .rnopf_724
	buffer_load_dwordx2 v[30:31], v96, s[48:51], s38 offen offset:0
	buffer_load_dwordx2 v[32:33], v96, s[48:51], s38 offen offset:64
	buffer_load_dwordx2 v[34:35], v96, s[48:51], s38 offen offset:128
	buffer_load_dwordx2 v[36:37], v96, s[48:51], s38 offen offset:192
	s_mov_b64 exec, s[42:43]
	buffer_load_dwordx2 v[38:39], v96, s[48:51], s38 offen offset:256
	s_mov_b64 exec, -1
	s_add_u32 s38, s38, 36864
	s_mov_b32 s46, 1
	s_waitcnt vmcnt(5)
	s_branch .rpfd_725
.rnopf_724:
	s_waitcnt vmcnt(0)
.rpfd_725:
	v_lshlrev_b32 v0, 16, v20
	v_and_b32 v1, v104, v20
	v_lshlrev_b32 v2, 16, v21
	v_and_b32 v3, v104, v21
	v_cvt_pk_bf16_f32 v128, v128, v129
	v_cvt_pk_bf16_f32 v129, v130, v131
	v_and_b32 v130, v104, v128
	v_and_b32 v131, v104, v129
	v_lshlrev_b32 v128, 16, v128
	v_lshlrev_b32 v129, 16, v129
	v_add_f32 v0, v0, v128
	v_add_f32 v1, v1, v130
	v_add_f32 v2, v2, v129
	v_add_f32 v3, v3, v131
	v_cvt_pk_bf16_f32 v20, v0, v1
	v_cvt_pk_bf16_f32 v21, v2, v3
	ds_write_b64 v96, v[20:21] offset:1024
	v_lshlrev_b32 v0, 16, v20
	v_and_b32 v1, v104, v20
	v_lshlrev_b32 v2, 16, v21
	v_and_b32 v3, v104, v21
	v_lshlrev_b32 v4, 16, v22
	v_and_b32 v5, v104, v22
	v_lshlrev_b32 v6, 16, v23
	v_and_b32 v7, v104, v23
	v_cvt_pk_bf16_f32 v132, v132, v133
	v_cvt_pk_bf16_f32 v133, v134, v135
	v_and_b32 v134, v104, v132
	v_and_b32 v135, v104, v133
	v_lshlrev_b32 v132, 16, v132
	v_lshlrev_b32 v133, 16, v133
	v_add_f32 v4, v4, v132
	v_add_f32 v5, v5, v134
	v_add_f32 v6, v6, v133
	v_add_f32 v7, v7, v135
	v_cvt_pk_bf16_f32 v22, v4, v5
	v_cvt_pk_bf16_f32 v23, v6, v7
	ds_write_b64 v96, v[22:23] offset:1088
	v_lshlrev_b32 v4, 16, v22
	v_and_b32 v5, v104, v22
	v_lshlrev_b32 v6, 16, v23
	v_and_b32 v7, v104, v23
	v_lshlrev_b32 v8, 16, v24
	v_and_b32 v9, v104, v24
	v_lshlrev_b32 v10, 16, v25
	v_and_b32 v11, v104, v25
	v_cvt_pk_bf16_f32 v136, v136, v137
	v_cvt_pk_bf16_f32 v137, v138, v139
	v_and_b32 v138, v104, v136
	v_and_b32 v139, v104, v137
	v_lshlrev_b32 v136, 16, v136
	v_lshlrev_b32 v137, 16, v137
	v_add_f32 v8, v8, v136
	v_add_f32 v9, v9, v138
	v_add_f32 v10, v10, v137
	v_add_f32 v11, v11, v139
	v_cvt_pk_bf16_f32 v24, v8, v9
	v_cvt_pk_bf16_f32 v25, v10, v11
	ds_write_b64 v96, v[24:25] offset:1152
	v_lshlrev_b32 v8, 16, v24
	v_and_b32 v9, v104, v24
	v_lshlrev_b32 v10, 16, v25
	v_and_b32 v11, v104, v25
	v_lshlrev_b32 v12, 16, v26
	v_and_b32 v13, v104, v26
	v_lshlrev_b32 v14, 16, v27
	v_and_b32 v15, v104, v27
	v_cvt_pk_bf16_f32 v140, v140, v141
	v_cvt_pk_bf16_f32 v141, v142, v143
	v_and_b32 v142, v104, v140
	v_and_b32 v143, v104, v141
	v_lshlrev_b32 v140, 16, v140
	v_lshlrev_b32 v141, 16, v141
	v_add_f32 v12, v12, v140
	v_add_f32 v13, v13, v142
	v_add_f32 v14, v14, v141
	v_add_f32 v15, v15, v143
	v_cvt_pk_bf16_f32 v26, v12, v13
	v_cvt_pk_bf16_f32 v27, v14, v15
	ds_write_b64 v96, v[26:27] offset:1216
	v_lshlrev_b32 v12, 16, v26
	v_and_b32 v13, v104, v26
	v_lshlrev_b32 v14, 16, v27
	v_and_b32 v15, v104, v27
	s_mov_b64 exec, s[42:43]
	v_lshlrev_b32 v16, 16, v28
	v_and_b32 v17, v104, v28
	v_lshlrev_b32 v18, 16, v29
	v_and_b32 v19, v104, v29
	v_cvt_pk_bf16_f32 v144, v144, v145
	v_cvt_pk_bf16_f32 v145, v146, v147
	v_and_b32 v146, v104, v144
	v_and_b32 v147, v104, v145
	v_lshlrev_b32 v144, 16, v144
	v_lshlrev_b32 v145, 16, v145
	v_add_f32 v16, v16, v144
	v_add_f32 v17, v17, v146
	v_add_f32 v18, v18, v145
	v_add_f32 v19, v19, v147
	v_cvt_pk_bf16_f32 v28, v16, v17
	v_cvt_pk_bf16_f32 v29, v18, v19
	ds_write_b64 v96, v[28:29] offset:1280
	v_lshlrev_b32 v16, 16, v28
	v_and_b32 v17, v104, v28
	v_lshlrev_b32 v18, 16, v29
	v_and_b32 v19, v104, v29
	s_mov_b64 exec, -1
	v_pk_add_f32 v[44:45], v[0:1], v[2:3]
	v_pk_add_f32 v[44:45], v[44:45], v[4:5]
	v_pk_add_f32 v[44:45], v[44:45], v[6:7]
	v_pk_add_f32 v[44:45], v[44:45], v[8:9]
	v_pk_add_f32 v[44:45], v[44:45], v[10:11]
	v_pk_add_f32 v[44:45], v[44:45], v[12:13]
	v_pk_add_f32 v[44:45], v[44:45], v[14:15]
	s_mov_b64 exec, s[42:43]
	v_pk_add_f32 v[44:45], v[44:45], v[16:17]
	v_pk_add_f32 v[44:45], v[44:45], v[18:19]
	s_mov_b64 exec, -1
	v_add_f32 v40, v44, v45
	s_nop 1
	v_add_f32_dpp v40, v40, v40 row_ror:8 row_mask:0xf bank_mask:0xf
	v_mov_b32 v42, v40
	s_nop 1
	v_permlane16_swap_b32 v40, v42
	v_add_f32 v40, v40, v42
	v_mov_b32 v42, v40
	s_nop 1
	v_permlane32_swap_b32 v40, v42
	v_add_f32 v40, v40, v42
	v_mul_f32 v40, 0x3be38e39, v40
	v_mov_b32 v41, 0
	v_sub_f32 v46, v0, v40
	v_fmac_f32 v41, v46, v46
	v_sub_f32 v46, v1, v40
	v_fmac_f32 v41, v46, v46
	v_sub_f32 v46, v2, v40
	v_fmac_f32 v41, v46, v46
	v_sub_f32 v46, v3, v40
	v_fmac_f32 v41, v46, v46
	v_sub_f32 v46, v4, v40
	v_fmac_f32 v41, v46, v46
	v_sub_f32 v46, v5, v40
	v_fmac_f32 v41, v46, v46
	v_sub_f32 v46, v6, v40
	v_fmac_f32 v41, v46, v46
	v_sub_f32 v46, v7, v40
	v_fmac_f32 v41, v46, v46
	v_sub_f32 v46, v8, v40
	v_fmac_f32 v41, v46, v46
	v_sub_f32 v46, v9, v40
	v_fmac_f32 v41, v46, v46
	v_sub_f32 v46, v10, v40
	v_fmac_f32 v41, v46, v46
	v_sub_f32 v46, v11, v40
	v_fmac_f32 v41, v46, v46
	v_sub_f32 v46, v12, v40
	v_fmac_f32 v41, v46, v46
	v_sub_f32 v46, v13, v40
	v_fmac_f32 v41, v46, v46
	v_sub_f32 v46, v14, v40
	v_fmac_f32 v41, v46, v46
	v_sub_f32 v46, v15, v40
	v_fmac_f32 v41, v46, v46
	s_mov_b64 exec, s[42:43]
	v_sub_f32 v46, v16, v40
	v_fmac_f32 v41, v46, v46
	v_sub_f32 v46, v17, v40
	v_fmac_f32 v41, v46, v46
	v_sub_f32 v46, v18, v40
	v_fmac_f32 v41, v46, v46
	v_sub_f32 v46, v19, v40
	v_fmac_f32 v41, v46, v46
	s_mov_b64 exec, -1
	s_nop 0
	v_add_f32_dpp v41, v41, v41 row_ror:8 row_mask:0xf bank_mask:0xf
	v_mov_b32 v42, v41
	s_nop 1
	v_permlane16_swap_b32 v41, v42
	v_add_f32 v41, v41, v42
	v_mov_b32 v42, v41
	s_nop 1
	v_permlane32_swap_b32 v41, v42
	v_add_f32 v41, v41, v42
	s_lshl_b32 s17, s15, 6
	v_add_u32 v42, s17, v103
	s_mov_b64 exec, 0xff
	ds_write_b64 v42, v[40:41] offset:0
	s_mov_b64 exec, -1
	s_waitcnt lgkmcnt(0)
	s_barrier
	ds_read_b64 v[48:49], v103 offset:0
	ds_read_b64 v[50:51], v103 offset:64
	ds_read_b64 v[52:53], v103 offset:128
	ds_read_b64 v[54:55], v103 offset:192
	ds_read_b128 v[60:63], v111 offset:1024
	ds_read_b128 v[64:67], v111 offset:5120
	s_add_u32 s17, s39, s60
	s_add_u32 s18, s17, 4096
	s_cmp_lg_u32 s15, 0
	s_cbranch_scc1 .rex_726
	ds_read_b128 v[68:71], v105 offset:9216
	s_add_u32 s19, s39, 8192
	s_waitcnt lgkmcnt(0)
	buffer_store_dwordx4 v[68:71], v105, s[52:55], s19 offen sc1
.rex_726:
	s_waitcnt lgkmcnt(0)
	buffer_store_dwordx4 v[60:63], v105, s[52:55], s17 offen sc1
	buffer_store_dwordx4 v[64:67], v105, s[52:55], s18 offen sc1
	v_add_f32 v56, v48, v50
	v_add_f32 v57, v52, v54
	v_add_f32 v56, v56, v57
	v_mul_f32 v56, 0.25, v56
	v_add_f32 v57, v49, v51
	v_add_f32 v58, v53, v55
	v_add_f32 v57, v57, v58
	v_mov_b32 v58, 0
	v_sub_f32 v59, v48, v56
	v_fmac_f32 v58, v59, v59
	v_sub_f32 v59, v50, v56
	v_fmac_f32 v58, v59, v59
	v_sub_f32 v59, v52, v56
	v_fmac_f32 v58, v59, v59
	v_sub_f32 v59, v54, v56
	v_fmac_f32 v58, v59, v59
	v_fmac_f32 v57, 0x43100000, v58
	v_mov_b32 v59, 0x3727c5ac
	v_fmac_f32 v59, 0x3ae38e39, v57
	v_rsq_f32 v59, v59
	v_sub_f32 v0, v0, v56
	v_sub_f32 v1, v1, v56
	v_sub_f32 v2, v2, v56
	v_sub_f32 v3, v3, v56
	v_mul_f32 v0, v0, v59
	v_mul_f32 v1, v1, v59
	v_mul_f32 v2, v2, v59
	v_mul_f32 v3, v3, v59
	v_cvt_pk_bf16_f32 v0, v0, v1
	v_cvt_pk_bf16_f32 v1, v2, v3
	ds_write_b64 v98, v[0:1] offset:0
	v_sub_f32 v4, v4, v56
	v_sub_f32 v5, v5, v56
	v_sub_f32 v6, v6, v56
	v_sub_f32 v7, v7, v56
	v_mul_f32 v4, v4, v59
	v_mul_f32 v5, v5, v59
	v_mul_f32 v6, v6, v59
	v_mul_f32 v7, v7, v59
	v_cvt_pk_bf16_f32 v4, v4, v5
	v_cvt_pk_bf16_f32 v5, v6, v7
	ds_write_b64 v98, v[4:5] offset:512
	v_sub_f32 v8, v8, v56
	v_sub_f32 v9, v9, v56
	v_sub_f32 v10, v10, v56
	v_sub_f32 v11, v11, v56
	v_mul_f32 v8, v8, v59
	v_mul_f32 v9, v9, v59
	v_mul_f32 v10, v10, v59
	v_mul_f32 v11, v11, v59
	v_cvt_pk_bf16_f32 v8, v8, v9
	v_cvt_pk_bf16_f32 v9, v10, v11
	ds_write_b64 v98, v[8:9] offset:1024
	v_sub_f32 v12, v12, v56
	v_sub_f32 v13, v13, v56
	v_sub_f32 v14, v14, v56
	v_sub_f32 v15, v15, v56
	v_mul_f32 v12, v12, v59
	v_mul_f32 v13, v13, v59
	v_mul_f32 v14, v14, v59
	v_mul_f32 v15, v15, v59
	v_cvt_pk_bf16_f32 v12, v12, v13
	v_cvt_pk_bf16_f32 v13, v14, v15
	ds_write_b64 v98, v[12:13] offset:1536
	s_mov_b64 exec, s[42:43]
	v_sub_f32 v16, v16, v56
	v_sub_f32 v17, v17, v56
	v_sub_f32 v18, v18, v56
	v_sub_f32 v19, v19, v56
	v_mul_f32 v16, v16, v59
	v_mul_f32 v17, v17, v59
	v_mul_f32 v18, v18, v59
	v_mul_f32 v19, v19, v59
	v_cvt_pk_bf16_f32 v16, v16, v17
	v_cvt_pk_bf16_f32 v17, v18, v19
	ds_write_b64 v98, v[16:17] offset:2048
	s_mov_b64 exec, -1
	s_waitcnt lgkmcnt(0)
	s_barrier
	ds_read_b128 v[60:63], v111 offset:10240
	ds_read_b128 v[64:67], v111 offset:14336
	s_add_u32 s17, s41, s61
	s_add_u32 s18, s17, 8192
	s_cmp_lg_u32 s15, 1
	s_cbranch_scc1 .rex_728
	ds_read_b128 v[68:71], v105 offset:18432
	s_add_u32 s19, s41, 16384
	s_waitcnt lgkmcnt(0)
	buffer_store_dwordx4 v[68:71], v106, s[4:7], s19 offen sc1
.rex_728:
	s_waitcnt lgkmcnt(0)
	buffer_store_dwordx4 v[60:63], v106, s[4:7], s17 offen sc1
	buffer_store_dwordx4 v[64:67], v106, s[4:7], s18 offen sc1
	s_add_u32 s39, s39, 36864
	s_add_u32 s41, s41, 36864
	s_add_u32 s62, s28, 1
	s_add_u32 s28, s28, 1
	buffer_load_dword v100, v99, s[4:7], 0 offen sc1
	s_add_u32 s37, s28, 1
	s_waitcnt vmcnt(0)
	v_mov_b32 v102, s62
	s_mov_b64 exec, 1
	buffer_store_dword v102, v101, s[4:7], s30 offen sc1
	s_mov_b64 exec, -1
	s_cmp_ge_u32 s28, 64
	s_cbranch_scc1 L_END
	v_cmp_gt_u32 vcc, s37, v100
	s_cbranch_vccz .rok_730
	s_mov_b32 s20, 400000
.rre_731:
	buffer_load_dword v100, v99, s[4:7], 0 offen sc1
	s_waitcnt vmcnt(0)
	v_cmp_gt_u32 vcc, s37, v100
	s_cbranch_vccz .rok_730
	s_sub_u32 s20, s20, 1
	s_cmp_lg_u32 s20, 0
	s_cbranch_scc1 .rre_731
	s_branch L_FAIL
.rok_730:
	s_branch .rloop_723
L_RA0_CE:
.p2align 6
L_RB0:
	v_and_b32 v79, 63, v0
	v_mov_b32 v75, v0
	v_and_b32 v78, 15, v79
	v_lshrrev_b32 v77, 4, v79
	v_and_b32 v76, 7, v79
	s_lshr_b32 s47, s26, 2
	s_and_b32 s26, s26, 3
	v_bfe_u32 v72, v79, 3, 2
	v_lshrrev_b32 v73, 5, v79
	v_lshlrev_b32 v106, 10, v73
	v_lshlrev_b32 v74, 8, v72
	v_add_u32 v106, v106, v74
	v_lshlrev_b32 v74, 4, v76
	v_add_u32 v106, v106, v74
	s_mul_i32 s17, s15, 9
	v_add_u32 v73, s17, v73
	v_mul_u32_u24 v96, 1152, v76
	v_lshlrev_b32 v74, 5, v73
	v_add_u32 v96, v96, v74
	v_lshlrev_b32 v74, 3, v72
	v_add_u32 v96, v96, v74
	v_lshlrev_b32 v105, 4, v79
	s_mul_i32 s17, s15, 4608
	v_add_u32 v97, s17, v105
	v_lshrrev_b32 v98, 1, v73
	v_lshlrev_b32 v98, 9, v98
	v_and_b32 v74, 1, v73
	v_lshlrev_b32 v74, 3, v74
	v_add_u32 v98, v98, v74
	v_lshlrev_b32 v74, 7, v72
	v_add_u32 v98, v98, v74
	v_lshlrev_b32 v74, 4, v76
	v_add_u32 v98, v98, v74
	v_add_u32 v98, 10240, v98
	s_and_b32 s17, s26, 1
	s_lshr_b32 s18, s26, 1
	s_lshl_b32 s19, s17, 7
	v_add_u32 v106, s19, v106
	v_lshlrev_b32 v103, 3, v76
	v_mov_b32 v101, 0
	v_mov_b32 v104, 0xffff0000
	s_mul_i32 s38, s26, 9216
	s_mov_b32 s39, s38
	s_mul_i32 s40, s26, 18432
	s_mul_i32 s41, s18, 18432
	s_mov_b32 s48, s4
	s_mov_b32 s49, s5
	s_mov_b32 s50, s6
	s_mov_b32 s51, s7
	s_add_u32 s38, s38, 0xa180000
	s_mov_b32 s52, s4
	s_mov_b32 s53, s5
	s_mov_b32 s54, s6
	s_mov_b32 s55, s7
	s_add_u32 s39, s39, 0xee80000
	s_add_u32 s40, s40, 0xca80000
	v_min_u32 v99, 47, v79
	v_lshrrev_b32 v74, 2, v99
	v_add_u32 v74, 172, v74
	v_lshlrev_b32 v74, 7, v74
	v_and_b32 v99, 3, v99
	v_lshlrev_b32 v99, 2, v99
	v_add_u32 v99, v99, v74
	s_mov_b32 s56, -1
	s_mov_b32 s57, 0xffff
	v_and_b32 v72, 15, v79
	v_min_u32 v109, 15, v72
	v_lshrrev_b32 v74, 2, v109
	v_add_u32 v74, 128, v74
	v_lshlrev_b32 v74, 7, v74
	v_and_b32 v109, 3, v109
	v_lshlrev_b32 v109, 2, v109
	v_add_u32 v109, v109, v74
	v_cndmask_b32 v99, v109, v99, s[56:57]
	v_mov_b32 v108, 0
	v_cndmask_b32 v108, v108, 0, s[56:57]
	s_add_u32 s41, s41, 0x8440000
	s_lshl_b32 s30, s14, 7
	s_lshl_b32 s17, s15, 2
	s_add_u32 s30, s30, s17
	s_mov_b32 s42, -1
	s_mov_b32 s43, 0
	s_mul_i32 s17, s47, 36864
	s_add_u32 s38, s38, s17
	s_mul_i32 s17, s47, 36864
	s_add_u32 s39, s39, s17
	s_mul_i32 s17, s47, 36864
	s_add_u32 s41, s41, s17
	s_lshl_b32 s60, s15, 10
	s_lshl_b32 s61, s15, 11
	v_add_u32 v111, s60, v105
	v_mov_b32 v74, 0
	s_mov_b32 s20, 400000
	v_and_b32 v72, 7, v79
	v_lshrrev_b32 v73, 2, v72
	v_mul_u32_u24 v73, 112, v73
	v_lshlrev_b32 v72, 2, v72
	v_add_u32 v72, v72, v73
	s_getpc_b64 s[18:19]
.ct_735:
	s_sub_u32 s18, s18, .ct_735-L_RB0
	s_subb_u32 s19, s19, 0
	v_lshlrev_b32 v74, 7, v79
	s_lshl_b32 s17, s15, 13
	v_add_u32 v74, s17, v74
	s_mov_b32 s17, L_RB0_CE-L_RB0-4
	v_min_u32 v74, s17, v74
	global_load_dword v73, v74, s[18:19]
	v_mov_b32 v74, 0
.gbre_732:
	global_load_dword v73, v72, s[12:13] offset:16 sc1
	s_waitcnt vmcnt(0)
	v_readlane_b32 s17, v73, 0
	v_readlane_b32 s18, v73, 1
	s_nop 0
	s_add_u32 s17, s17, s18
	v_readlane_b32 s18, v73, 2
	s_nop 0
	s_add_u32 s17, s17, s18
	v_readlane_b32 s18, v73, 3
	s_nop 0
	s_add_u32 s17, s17, s18
	v_readlane_b32 s18, v73, 4
	s_nop 0
	s_add_u32 s17, s17, s18
	v_readlane_b32 s18, v73, 5
	s_nop 0
	s_add_u32 s17, s17, s18
	v_readlane_b32 s18, v73, 6
	s_nop 0
	s_add_u32 s17, s17, s18
	v_readlane_b32 s18, v73, 7
	s_nop 0
	s_add_u32 s17, s17, s18
	s_cmp_ge_u32 s17, 256
	s_cbranch_scc1 .gbok_733
	s_sub_u32 s20, s20, 1
	s_cmp_lg_u32 s20, 0
	s_cbranch_scc1 .gbre_732
	s_branch L_FAIL
.gbok_733:
	s_mov_b32 s28, s47
	s_mov_b32 s46, 0
	s_add_u32 s37, s28, 1
	s_add_u32 s18, s28, 3
	v_mov_b32 v107, s37
	v_mov_b32 v102, s18
	v_cndmask_b32 v107, v102, v107, s[56:57]
	buffer_load_dword v100, v99, s[4:7], 0 offen sc1
	s_waitcnt vmcnt(0)
	v_cmp_gt_u32 vcc, v107, v100
	s_nop 0
	s_and_b64 s[58:59], vcc, s[56:57]
	s_cbranch_scc0 .rok_736
	s_mov_b32 s20, 400000
.rre_737:
	buffer_load_dword v100, v99, s[4:7], 0 offen sc1
	s_waitcnt vmcnt(0)
	v_cmp_gt_u32 vcc, v107, v100
	s_nop 0
	s_and_b64 s[58:59], vcc, s[56:57]
	s_cbranch_scc0 .rok_736
	s_sub_u32 s20, s20, 1
	s_cmp_lg_u32 s20, 0
	s_cbranch_scc1 .rre_737
	s_branch L_FAIL
.rok_736:
.rloop_738:
	s_cmp_lg_u32 s46, 0
	s_cbranch_scc1 .rhave_739
	v_xor_b32 v109, v108, v99
	s_mov_b32 s20, 400000
.rxre_740:
	buffer_load_dword v110, v109, s[4:7], 0 offen sc1
	s_waitcnt vmcnt(0)
	v_cmp_gt_u32 vcc, s37, v110
	s_nop 0
	s_andn2_b64 s[58:59], vcc, s[56:57]
	s_cbranch_scc0 .rxok_741
	s_sub_u32 s20, s20, 1
	s_cmp_lg_u32 s20, 0
	s_cbranch_scc1 .rxre_740
	s_branch L_FAIL
.rxok_741:
	buffer_load_dwordx2 v[30:31], v96, s[48:51], s38 offen offset:0
	buffer_load_dwordx2 v[32:33], v96, s[48:51], s38 offen offset:64
	buffer_load_dwordx2 v[34:35], v96, s[48:51], s38 offen offset:128
	buffer_load_dwordx2 v[36:37], v96, s[48:51], s38 offen offset:192
	s_mov_b64 exec, s[42:43]
	buffer_load_dwordx2 v[38:39], v96, s[48:51], s38 offen offset:256
	s_mov_b64 exec, -1
	s_add_u32 s38, s38, 73728
	s_waitcnt vmcnt(0)
.rhave_739:
	v_mov_b32 v20, v30
	v_mov_b32 v21, v31
	v_mov_b32 v22, v32
	v_mov_b32 v23, v33
	v_mov_b32 v24, v34
	v_mov_b32 v25, v35
	v_mov_b32 v26, v36
	v_mov_b32 v27, v37
	v_mov_b32 v28, v38
	v_mov_b32 v29, v39
	s_and_b32 s63, s28, 3
	s_mul_i32 s63, s63, 294912
	s_add_u32 s63, s63, s40
	s_add_u32 s17, s63, 0
	s_add_u32 s18, s17, 4096
	buffer_load_dwordx4 v[128:131], v97, s[4:7], s17 offen offset:0 sc1
	buffer_load_dwordx4 v[132:135], v97, s[4:7], s17 offen offset:1024 sc1
	buffer_load_dwordx4 v[136:139], v97, s[4:7], s17 offen offset:2048 sc1
	buffer_load_dwordx4 v[140:143], v97, s[4:7], s17 offen offset:3072 sc1
	s_mov_b64 exec, s[42:43]
	buffer_load_dwordx4 v[144:147], v97, s[4:7], s18 offen offset:0 sc1
	s_mov_b64 exec, -1
	s_add_u32 s17, s63, 73728
	s_add_u32 s18, s17, 4096
	buffer_load_dwordx4 v[148:151], v97, s[4:7], s17 offen offset:0 sc1
	buffer_load_dwordx4 v[152:155], v97, s[4:7], s17 offen offset:1024 sc1
	buffer_load_dwordx4 v[156:159], v97, s[4:7], s17 offen offset:2048 sc1
	buffer_load_dwordx4 v[160:163], v97, s[4:7], s17 offen offset:3072 sc1
	s_mov_b64 exec, s[42:43]
	buffer_load_dwordx4 v[164:167], v97, s[4:7], s18 offen offset:0 sc1
	s_mov_b64 exec, -1
	s_add_u32 s17, s63, 147456
	s_add_u32 s18, s17, 4096
	buffer_load_dwordx4 v[168:171], v97, s[4:7], s17 offen offset:0 sc1
	buffer_load_dwordx4 v[172:175], v97, s[4:7], s17 offen offset:1024 sc1
	buffer_load_dwordx4 v[176:179], v97, s[4:7], s17 offen offset:2048 sc1
	buffer_load_dwordx4 v[180:183], v97, s[4:7], s17 offen offset:3072 sc1
	s_mov_b64 exec, s[42:43]
	buffer_load_dwordx4 v[184:187], v97, s[4:7], s18 offen offset:0 sc1
	s_mov_b64 exec, -1
	s_add_u32 s17, s63, 221184
	s_add_u32 s18, s17, 4096
	buffer_load_dwordx4 v[188:191], v97, s[4:7], s17 offen offset:0 sc1
	buffer_load_dwordx4 v[192:195], v97, s[4:7], s17 offen offset:1024 sc1
	buffer_load_dwordx4 v[196:199], v97, s[4:7], s17 offen offset:2048 sc1
	buffer_load_dwordx4 v[200:203], v97, s[4:7], s17 offen offset:3072 sc1
	s_mov_b64 exec, s[42:43]
	buffer_load_dwordx4 v[204:207], v97, s[4:7], s18 offen offset:0 sc1
	s_mov_b64 exec, -1
	s_mov_b32 s46, 0
	s_cmp_ge_u32 s28, 62
	s_cbranch_scc1 .rnopf_742
	v_cmp_gt_u32 vcc, v107, v100
	s_nop 0
	s_andn2_b64 s[58:59], vcc, s[56:57]
	s_cbranch_scc1 .rnopf_742
	buffer_load_dwordx2 v[30:31], v96, s[48:51], s38 offen offset:0
	buffer_load_dwordx2 v[32:33], v96, s[48:51], s38 offen offset:64
	buffer_load_dwordx2 v[34:35], v96, s[48:51], s38 offen offset:128
	buffer_load_dwordx2 v[36:37], v96, s[48:51], s38 offen offset:192
	s_mov_b64 exec, s[42:43]
	buffer_load_dwordx2 v[38:39], v96, s[48:51], s38 offen offset:256
	s_mov_b64 exec, -1
	s_add_u32 s38, s38, 73728
	s_mov_b32 s46, 1
	s_waitcnt vmcnt(5)
	s_branch .rpfd_743
.rnopf_742:
	s_waitcnt vmcnt(0)
.rpfd_743:
	v_lshlrev_b32 v0, 16, v20
	v_and_b32 v1, v104, v20
	v_lshlrev_b32 v2, 16, v21
	v_and_b32 v3, v104, v21
	v_pk_add_f32 v[128:129], v[128:129], v[148:149]
	v_pk_add_f32 v[130:131], v[130:131], v[150:151]
	v_pk_add_f32 v[168:169], v[168:169], v[188:189]
	v_pk_add_f32 v[170:171], v[170:171], v[190:191]
	v_pk_add_f32 v[128:129], v[128:129], v[168:169]
	v_pk_add_f32 v[130:131], v[130:131], v[170:171]
	v_cvt_pk_bf16_f32 v128, v128, v129
	v_cvt_pk_bf16_f32 v129, v130, v131
	v_and_b32 v130, v104, v128
	v_and_b32 v131, v104, v129
	v_lshlrev_b32 v128, 16, v128
	v_lshlrev_b32 v129, 16, v129
	v_add_f32 v0, v0, v128
	v_add_f32 v1, v1, v130
	v_add_f32 v2, v2, v129
	v_add_f32 v3, v3, v131
	v_cvt_pk_bf16_f32 v20, v0, v1
	v_cvt_pk_bf16_f32 v21, v2, v3
	ds_write_b64 v96, v[20:21] offset:1024
	v_lshlrev_b32 v0, 16, v20
	v_and_b32 v1, v104, v20
	v_lshlrev_b32 v2, 16, v21
	v_and_b32 v3, v104, v21
	v_lshlrev_b32 v4, 16, v22
	v_and_b32 v5, v104, v22
	v_lshlrev_b32 v6, 16, v23
	v_and_b32 v7, v104, v23
	v_pk_add_f32 v[132:133], v[132:133], v[152:153]
	v_pk_add_f32 v[134:135], v[134:135], v[154:155]
	v_pk_add_f32 v[172:173], v[172:173], v[192:193]
	v_pk_add_f32 v[174:175], v[174:175], v[194:195]
	v_pk_add_f32 v[132:133], v[132:133], v[172:173]
	v_pk_add_f32 v[134:135], v[134:135], v[174:175]
	v_cvt_pk_bf16_f32 v132, v132, v133
	v_cvt_pk_bf16_f32 v133, v134, v135
	v_and_b32 v134, v104, v132
	v_and_b32 v135, v104, v133
	v_lshlrev_b32 v132, 16, v132
	v_lshlrev_b32 v133, 16, v133
	v_add_f32 v4, v4, v132
	v_add_f32 v5, v5, v134
	v_add_f32 v6, v6, v133
	v_add_f32 v7, v7, v135
	v_cvt_pk_bf16_f32 v22, v4, v5
	v_cvt_pk_bf16_f32 v23, v6, v7
	ds_write_b64 v96, v[22:23] offset:1088
	v_lshlrev_b32 v4, 16, v22
	v_and_b32 v5, v104, v22
	v_lshlrev_b32 v6, 16, v23
	v_and_b32 v7, v104, v23
	v_lshlrev_b32 v8, 16, v24
	v_and_b32 v9, v104, v24
	v_lshlrev_b32 v10, 16, v25
	v_and_b32 v11, v104, v25
	v_pk_add_f32 v[136:137], v[136:137], v[156:157]
	v_pk_add_f32 v[138:139], v[138:139], v[158:159]
	v_pk_add_f32 v[176:177], v[176:177], v[196:197]
	v_pk_add_f32 v[178:179], v[178:179], v[198:199]
	v_pk_add_f32 v[136:137], v[136:137], v[176:177]
	v_pk_add_f32 v[138:139], v[138:139], v[178:179]
	v_cvt_pk_bf16_f32 v136, v136, v137
	v_cvt_pk_bf16_f32 v137, v138, v139
	v_and_b32 v138, v104, v136
	v_and_b32 v139, v104, v137
	v_lshlrev_b32 v136, 16, v136
	v_lshlrev_b32 v137, 16, v137
	v_add_f32 v8, v8, v136
	v_add_f32 v9, v9, v138
	v_add_f32 v10, v10, v137
	v_add_f32 v11, v11, v139
	v_cvt_pk_bf16_f32 v24, v8, v9
	v_cvt_pk_bf16_f32 v25, v10, v11
	ds_write_b64 v96, v[24:25] offset:1152
	v_lshlrev_b32 v8, 16, v24
	v_and_b32 v9, v104, v24
	v_lshlrev_b32 v10, 16, v25
	v_and_b32 v11, v104, v25
	v_lshlrev_b32 v12, 16, v26
	v_and_b32 v13, v104, v26
	v_lshlrev_b32 v14, 16, v27
	v_and_b32 v15, v104, v27
	v_pk_add_f32 v[140:141], v[140:141], v[160:161]
	v_pk_add_f32 v[142:143], v[142:143], v[162:163]
	v_pk_add_f32 v[180:181], v[180:181], v[200:201]
	v_pk_add_f32 v[182:183], v[182:183], v[202:203]
	v_pk_add_f32 v[140:141], v[140:141], v[180:181]
	v_pk_add_f32 v[142:143], v[142:143], v[182:183]
	v_cvt_pk_bf16_f32 v140, v140, v141
	v_cvt_pk_bf16_f32 v141, v142, v143
	v_and_b32 v142, v104, v140
	v_and_b32 v143, v104, v141
	v_lshlrev_b32 v140, 16, v140
	v_lshlrev_b32 v141, 16, v141
	v_add_f32 v12, v12, v140
	v_add_f32 v13, v13, v142
	v_add_f32 v14, v14, v141
	v_add_f32 v15, v15, v143
	v_cvt_pk_bf16_f32 v26, v12, v13
	v_cvt_pk_bf16_f32 v27, v14, v15
	ds_write_b64 v96, v[26:27] offset:1216
	v_lshlrev_b32 v12, 16, v26
	v_and_b32 v13, v104, v26
	v_lshlrev_b32 v14, 16, v27
	v_and_b32 v15, v104, v27
	s_mov_b64 exec, s[42:43]
	v_lshlrev_b32 v16, 16, v28
	v_and_b32 v17, v104, v28
	v_lshlrev_b32 v18, 16, v29
	v_and_b32 v19, v104, v29
	v_pk_add_f32 v[144:145], v[144:145], v[164:165]
	v_pk_add_f32 v[146:147], v[146:147], v[166:167]
	v_pk_add_f32 v[184:185], v[184:185], v[204:205]
	v_pk_add_f32 v[186:187], v[186:187], v[206:207]
	v_pk_add_f32 v[144:145], v[144:145], v[184:185]
	v_pk_add_f32 v[146:147], v[146:147], v[186:187]
	v_cvt_pk_bf16_f32 v144, v144, v145
	v_cvt_pk_bf16_f32 v145, v146, v147
	v_and_b32 v146, v104, v144
	v_and_b32 v147, v104, v145
	v_lshlrev_b32 v144, 16, v144
	v_lshlrev_b32 v145, 16, v145
	v_add_f32 v16, v16, v144
	v_add_f32 v17, v17, v146
	v_add_f32 v18, v18, v145
	v_add_f32 v19, v19, v147
	v_cvt_pk_bf16_f32 v28, v16, v17
	v_cvt_pk_bf16_f32 v29, v18, v19
	ds_write_b64 v96, v[28:29] offset:1280
	v_lshlrev_b32 v16, 16, v28
	v_and_b32 v17, v104, v28
	v_lshlrev_b32 v18, 16, v29
	v_and_b32 v19, v104, v29
	s_mov_b64 exec, -1
	v_pk_add_f32 v[44:45], v[0:1], v[2:3]
	v_pk_add_f32 v[44:45], v[44:45], v[4:5]
	v_pk_add_f32 v[44:45], v[44:45], v[6:7]
	v_pk_add_f32 v[44:45], v[44:45], v[8:9]
	v_pk_add_f32 v[44:45], v[44:45], v[10:11]
	v_pk_add_f32 v[44:45], v[44:45], v[12:13]
	v_pk_add_f32 v[44:45], v[44:45], v[14:15]
	s_mov_b64 exec, s[42:43]
	v_pk_add_f32 v[44:45], v[44:45], v[16:17]
	v_pk_add_f32 v[44:45], v[44:45], v[18:19]
	s_mov_b64 exec, -1
	v_add_f32 v40, v44, v45
	s_nop 1
	v_add_f32_dpp v40, v40, v40 row_ror:8 row_mask:0xf bank_mask:0xf
	v_mov_b32 v42, v40
	s_nop 1
	v_permlane16_swap_b32 v40, v42
	v_add_f32 v40, v40, v42
	v_mov_b32 v42, v40
	s_nop 1
	v_permlane32_swap_b32 v40, v42
	v_add_f32 v40, v40, v42
	v_mul_f32 v40, 0x3be38e39, v40
	v_mov_b32 v41, 0
	v_sub_f32 v46, v0, v40
	v_fmac_f32 v41, v46, v46
	v_sub_f32 v46, v1, v40
	v_fmac_f32 v41, v46, v46
	v_sub_f32 v46, v2, v40
	v_fmac_f32 v41, v46, v46
	v_sub_f32 v46, v3, v40
	v_fmac_f32 v41, v46, v46
	v_sub_f32 v46, v4, v40
	v_fmac_f32 v41, v46, v46
	v_sub_f32 v46, v5, v40
	v_fmac_f32 v41, v46, v46
	v_sub_f32 v46, v6, v40
	v_fmac_f32 v41, v46, v46
	v_sub_f32 v46, v7, v40
	v_fmac_f32 v41, v46, v46
	v_sub_f32 v46, v8, v40
	v_fmac_f32 v41, v46, v46
	v_sub_f32 v46, v9, v40
	v_fmac_f32 v41, v46, v46
	v_sub_f32 v46, v10, v40
	v_fmac_f32 v41, v46, v46
	v_sub_f32 v46, v11, v40
	v_fmac_f32 v41, v46, v46
	v_sub_f32 v46, v12, v40
	v_fmac_f32 v41, v46, v46
	v_sub_f32 v46, v13, v40
	v_fmac_f32 v41, v46, v46
	v_sub_f32 v46, v14, v40
	v_fmac_f32 v41, v46, v46
	v_sub_f32 v46, v15, v40
	v_fmac_f32 v41, v46, v46
	s_mov_b64 exec, s[42:43]
	v_sub_f32 v46, v16, v40
	v_fmac_f32 v41, v46, v46
	v_sub_f32 v46, v17, v40
	v_fmac_f32 v41, v46, v46
	v_sub_f32 v46, v18, v40
	v_fmac_f32 v41, v46, v46
	v_sub_f32 v46, v19, v40
	v_fmac_f32 v41, v46, v46
	s_mov_b64 exec, -1
	s_nop 0
	v_add_f32_dpp v41, v41, v41 row_ror:8 row_mask:0xf bank_mask:0xf
	v_mov_b32 v42, v41
	s_nop 1
	v_permlane16_swap_b32 v41, v42
	v_add_f32 v41, v41, v42
	v_mov_b32 v42, v41
	s_nop 1
	v_permlane32_swap_b32 v41, v42
	v_add_f32 v41, v41, v42
	s_lshl_b32 s17, s15, 6
	v_add_u32 v42, s17, v103
	s_mov_b64 exec, 0xff
	ds_write_b64 v42, v[40:41] offset:0
	s_mov_b64 exec, -1
	s_waitcnt lgkmcnt(0)
	s_barrier
	ds_read_b64 v[48:49], v103 offset:0
	ds_read_b64 v[50:51], v103 offset:64
	ds_read_b64 v[52:53], v103 offset:128
	ds_read_b64 v[54:55], v103 offset:192
	ds_read_b128 v[60:63], v111 offset:1024
	ds_read_b128 v[64:67], v111 offset:5120
	s_add_u32 s17, s39, s60
	s_add_u32 s18, s17, 4096
	s_cmp_lg_u32 s15, 0
	s_cbranch_scc1 .rex_744
	ds_read_b128 v[68:71], v105 offset:9216
	s_add_u32 s19, s39, 8192
	s_waitcnt lgkmcnt(0)
	buffer_store_dwordx4 v[68:71], v105, s[52:55], s19 offen sc1
.rex_744:
	s_waitcnt lgkmcnt(0)
	buffer_store_dwordx4 v[60:63], v105, s[52:55], s17 offen sc1
	buffer_store_dwordx4 v[64:67], v105, s[52:55], s18 offen sc1
	v_add_f32 v56, v48, v50
	v_add_f32 v57, v52, v54
	v_add_f32 v56, v56, v57
	v_mul_f32 v56, 0.25, v56
	v_add_f32 v57, v49, v51
	v_add_f32 v58, v53, v55
	v_add_f32 v57, v57, v58
	v_mov_b32 v58, 0
	v_sub_f32 v59, v48, v56
	v_fmac_f32 v58, v59, v59
	v_sub_f32 v59, v50, v56
	v_fmac_f32 v58, v59, v59
	v_sub_f32 v59, v52, v56
	v_fmac_f32 v58, v59, v59
	v_sub_f32 v59, v54, v56
	v_fmac_f32 v58, v59, v59
	v_fmac_f32 v57, 0x43100000, v58
	v_mov_b32 v59, 0x3727c5ac
	v_fmac_f32 v59, 0x3ae38e39, v57
	v_rsq_f32 v59, v59
	v_sub_f32 v0, v0, v56
	v_sub_f32 v1, v1, v56
	v_sub_f32 v2, v2, v56
	v_sub_f32 v3, v3, v56
	v_mul_f32 v0, v0, v59
	v_mul_f32 v1, v1, v59
	v_mul_f32 v2, v2, v59
	v_mul_f32 v3, v3, v59
	v_cvt_pk_bf16_f32 v0, v0, v1
	v_cvt_pk_bf16_f32 v1, v2, v3
	ds_write_b64 v98, v[0:1] offset:0
	v_sub_f32 v4, v4, v56
	v_sub_f32 v5, v5, v56
	v_sub_f32 v6, v6, v56
	v_sub_f32 v7, v7, v56
	v_mul_f32 v4, v4, v59
	v_mul_f32 v5, v5, v59
	v_mul_f32 v6, v6, v59
	v_mul_f32 v7, v7, v59
	v_cvt_pk_bf16_f32 v4, v4, v5
	v_cvt_pk_bf16_f32 v5, v6, v7
	ds_write_b64 v98, v[4:5] offset:512
	v_sub_f32 v8, v8, v56
	v_sub_f32 v9, v9, v56
	v_sub_f32 v10, v10, v56
	v_sub_f32 v11, v11, v56
	v_mul_f32 v8, v8, v59
	v_mul_f32 v9, v9, v59
	v_mul_f32 v10, v10, v59
	v_mul_f32 v11, v11, v59
	v_cvt_pk_bf16_f32 v8, v8, v9
	v_cvt_pk_bf16_f32 v9, v10, v11
	ds_write_b64 v98, v[8:9] offset:1024
	v_sub_f32 v12, v12, v56
	v_sub_f32 v13, v13, v56
	v_sub_f32 v14, v14, v56
	v_sub_f32 v15, v15, v56
	v_mul_f32 v12, v12, v59
	v_mul_f32 v13, v13, v59
	v_mul_f32 v14, v14, v59
	v_mul_f32 v15, v15, v59
	v_cvt_pk_bf16_f32 v12, v12, v13
	v_cvt_pk_bf16_f32 v13, v14, v15
	ds_write_b64 v98, v[12:13] offset:1536
	s_mov_b64 exec, s[42:43]
	v_sub_f32 v16, v16, v56
	v_sub_f32 v17, v17, v56
	v_sub_f32 v18, v18, v56
	v_sub_f32 v19, v19, v56
	v_mul_f32 v16, v16, v59
	v_mul_f32 v17, v17, v59
	v_mul_f32 v18, v18, v59
	v_mul_f32 v19, v19, v59
	v_cvt_pk_bf16_f32 v16, v16, v17
	v_cvt_pk_bf16_f32 v17, v18, v19
	ds_write_b64 v98, v[16:17] offset:2048
	s_mov_b64 exec, -1
	s_waitcnt lgkmcnt(0)
	s_barrier
	ds_read_b128 v[60:63], v111 offset:10240
	ds_read_b128 v[64:67], v111 offset:14336
	s_add_u32 s17, s41, s61
	s_add_u32 s18, s17, 8192
	s_cmp_lg_u32 s15, 1
	s_cbranch_scc1 .rex_746
	ds_read_b128 v[68:71], v105 offset:18432
	s_add_u32 s19, s41, 16384
	s_waitcnt lgkmcnt(0)
	buffer_store_dwordx4 v[68:71], v106, s[4:7], s19 offen sc1
.rex_746:
	s_waitcnt lgkmcnt(0)
	buffer_store_dwordx4 v[60:63], v106, s[4:7], s17 offen sc1
	buffer_store_dwordx4 v[64:67], v106, s[4:7], s18 offen sc1
	s_add_u32 s39, s39, 73728
	s_add_u32 s41, s41, 73728
	s_add_u32 s62, s28, 1
	s_add_u32 s28, s28, 2
	v_xor_b32 v99, v108, v99
	buffer_load_dword v100, v99, s[4:7], 0 offen sc1
	s_add_u32 s37, s28, 1
	s_add_u32 s18, s28, 3
	v_mov_b32 v107, s37
	v_mov_b32 v102, s18
	v_cndmask_b32 v107, v102, v107, s[56:57]
	s_waitcnt vmcnt(0)
	v_mov_b32 v102, s62
	s_mov_b64 exec, 1
	buffer_store_dword v102, v101, s[4:7], s30 offen sc1
	s_mov_b64 exec, -1
	s_cmp_ge_u32 s28, 64
	s_cbranch_scc1 L_END
	v_cmp_gt_u32 vcc, v107, v100
	s_nop 0
	s_and_b64 s[58:59], vcc, s[56:57]
	s_cbranch_scc0 .rok_748
	s_mov_b32 s20, 400000
.rre_749:
	buffer_load_dword v100, v99, s[4:7], 0 offen sc1
	s_waitcnt vmcnt(0)
	v_cmp_gt_u32 vcc, v107, v100
	s_nop 0
	s_and_b64 s[58:59], vcc, s[56:57]
	s_cbranch_scc0 .rok_748
	s_sub_u32 s20, s20, 1
	s_cmp_lg_u32 s20, 0
	s_cbranch_scc1 .rre_749
	s_branch L_FAIL
.rok_748:
	s_branch .rloop_738
L_RB0_CE:
.p2align 6
L_RA1:
	v_and_b32 v79, 63, v0
	v_mov_b32 v75, v0
	v_and_b32 v78, 15, v79
	v_lshrrev_b32 v77, 4, v79
	v_and_b32 v76, 7, v79
	s_lshr_b32 s47, s26, 2
	s_and_b32 s26, s26, 3
	v_bfe_u32 v72, v79, 3, 2
	v_lshrrev_b32 v73, 5, v79
	v_lshlrev_b32 v106, 10, v73
	v_lshlrev_b32 v74, 8, v72
	v_add_u32 v106, v106, v74
	v_lshlrev_b32 v74, 4, v76
	v_add_u32 v106, v106, v74
	s_mul_i32 s17, s15, 9
	v_add_u32 v73, s17, v73
	v_mul_u32_u24 v96, 1152, v76
	v_lshlrev_b32 v74, 5, v73
	v_add_u32 v96, v96, v74
	v_lshlrev_b32 v74, 3, v72
	v_add_u32 v96, v96, v74
	v_lshlrev_b32 v105, 4, v79
	s_mul_i32 s17, s15, 4608
	v_add_u32 v97, s17, v105
	v_lshrrev_b32 v98, 1, v73
	v_lshlrev_b32 v98, 9, v98
	v_and_b32 v74, 1, v73
	v_lshlrev_b32 v74, 3, v74
	v_add_u32 v98, v98, v74
	v_lshlrev_b32 v74, 7, v72
	v_add_u32 v98, v98, v74
	v_lshlrev_b32 v74, 4, v76
	v_add_u32 v98, v98, v74
	v_add_u32 v98, 10240, v98
	s_and_b32 s17, s26, 1
	s_lshr_b32 s18, s26, 1
	s_lshl_b32 s19, s17, 7
	v_add_u32 v106, s19, v106
	v_lshlrev_b32 v103, 3, v76
	v_mov_b32 v101, 0
	v_mov_b32 v104, 0xffff0000
	s_mul_i32 s38, s26, 9216
	s_mov_b32 s39, s38
	s_mul_i32 s40, s26, 18432
	s_mul_i32 s41, s18, 18432
	s_mov_b32 s48, s4
	s_mov_b32 s49, s5
	s_mov_b32 s50, s6
	s_mov_b32 s51, s7
	s_add_u32 s38, s38, 0xee80000
	s_mov_b32 s52, s4
	s_mov_b32 s53, s5
	s_mov_b32 s54, s6
	s_mov_b32 s55, s7
	s_add_u32 s39, s39, 0xa3c0000
	s_add_u32 s40, s40, 0x9d00000
	v_min_u32 v99, 11, v79
	v_lshrrev_b32 v74, 2, v99
	v_add_u32 v74, 221, v74
	v_lshlrev_b32 v74, 7, v74
	v_and_b32 v99, 3, v99
	v_lshlrev_b32 v99, 2, v99
	v_add_u32 v99, v99, v74
	s_mov_b32 s56, -1
	s_mov_b32 s57, 0xffff
	v_and_b32 v72, 15, v79
	v_min_u32 v109, 15, v72
	v_lshrrev_b32 v74, 2, v109
	v_add_u32 v74, 184, v74
	v_lshlrev_b32 v74, 7, v74
	v_and_b32 v109, 3, v109
	v_lshlrev_b32 v109, 2, v109
	v_add_u32 v109, v109, v74
	v_xor_b32 v109, 512, v109
	v_cndmask_b32 v99, v109, v99, s[56:57]
	v_mov_b32 v108, 512
	v_cndmask_b32 v108, v108, 0, s[56:57]
	s_add_u32 s41, s41, 0xa840000
	s_lshl_b32 s30, s14, 7
	s_lshl_b32 s17, s15, 2
	s_add_u32 s30, s30, s17
	s_mov_b32 s42, -1
	s_mov_b32 s43, 0
	s_lshl_b32 s60, s15, 10
	s_lshl_b32 s61, s15, 11
	v_add_u32 v111, s60, v105
	v_mov_b32 v74, 0
	s_mov_b32 s20, 400000
	v_and_b32 v72, 7, v79
	v_lshrrev_b32 v73, 2, v72
	v_mul_u32_u24 v73, 112, v73
	v_lshlrev_b32 v72, 2, v72
	v_add_u32 v72, v72, v73
	s_getpc_b64 s[18:19]
.ct_753:
	s_sub_u32 s18, s18, .ct_753-L_RA1
	s_subb_u32 s19, s19, 0
	v_lshlrev_b32 v74, 7, v79
	s_lshl_b32 s17, s15, 13
	v_add_u32 v74, s17, v74
	s_mov_b32 s17, L_RA1_CE-L_RA1-4
	v_min_u32 v74, s17, v74
	global_load_dword v73, v74, s[18:19]
	v_mov_b32 v74, 0
.gbre_750:
	global_load_dword v73, v72, s[12:13] offset:16 sc1
	s_waitcnt vmcnt(0)
	v_readlane_b32 s17, v73, 0
	v_readlane_b32 s18, v73, 1
	s_nop 0
	s_add_u32 s17, s17, s18
	v_readlane_b32 s18, v73, 2
	s_nop 0
	s_add_u32 s17, s17, s18
	v_readlane_b32 s18, v73, 3
	s_nop 0
	s_add_u32 s17, s17, s18
	v_readlane_b32 s18, v73, 4
	s_nop 0
	s_add_u32 s17, s17, s18
	v_readlane_b32 s18, v73, 5
	s_nop 0
	s_add_u32 s17, s17, s18
	v_readlane_b32 s18, v73, 6
	s_nop 0
	s_add_u32 s17, s17, s18
	v_readlane_b32 s18, v73, 7
	s_nop 0
	s_add_u32 s17, s17, s18
	s_cmp_ge_u32 s17, 256
	s_cbranch_scc1 .gbok_751
	s_sub_u32 s20, s20, 1
	s_cmp_lg_u32 s20, 0
	s_cbranch_scc1 .gbre_750
	s_branch L_FAIL
.gbok_751:
	s_mov_b32 s28, s47
	s_mov_b32 s46, 0
	s_add_u32 s37, s28, 1
	s_add_u32 s18, s28, 2
	v_mov_b32 v107, s37
	v_mov_b32 v102, s18
	v_cndmask_b32 v107, v102, v107, s[56:57]
	buffer_load_dword v100, v99, s[4:7], 0 offen sc1
	s_waitcnt vmcnt(0)
	v_cmp_gt_u32 vcc, v107, v100
	s_nop 0
	s_and_b64 s[58:59], vcc, s[56:57]
	s_cbranch_scc0 .rok_754
	s_mov_b32 s20, 400000
.rre_755:
	buffer_load_dword v100, v99, s[4:7], 0 offen sc1
	s_waitcnt vmcnt(0)
	v_cmp_gt_u32 vcc, v107, v100
	s_nop 0
	s_and_b64 s[58:59], vcc, s[56:57]
	s_cbranch_scc0 .rok_754
	s_sub_u32 s20, s20, 1
	s_cmp_lg_u32 s20, 0
	s_cbranch_scc1 .rre_755
	s_branch L_FAIL
.rok_754:
.rloop_756:
	s_cmp_lg_u32 s46, 0
	s_cbranch_scc1 .rhave_757
	v_xor_b32 v109, v108, v99
	s_mov_b32 s20, 400000
.rxre_758:
	buffer_load_dword v110, v109, s[4:7], 0 offen sc1
	s_waitcnt vmcnt(0)
	v_cmp_gt_u32 vcc, s37, v110
	s_nop 0
	s_andn2_b64 s[58:59], vcc, s[56:57]
	s_cbranch_scc0 .rxok_759
	s_sub_u32 s20, s20, 1
	s_cmp_lg_u32 s20, 0
	s_cbranch_scc1 .rxre_758
	s_branch L_FAIL
.rxok_759:
	buffer_load_dwordx2 v[30:31], v96, s[48:51], s38 offen offset:0
	buffer_load_dwordx2 v[32:33], v96, s[48:51], s38 offen offset:64
	buffer_load_dwordx2 v[34:35], v96, s[48:51], s38 offen offset:128
	buffer_load_dwordx2 v[36:37], v96, s[48:51], s38 offen offset:192
	s_mov_b64 exec, s[42:43]
	buffer_load_dwordx2 v[38:39], v96, s[48:51], s38 offen offset:256
	s_mov_b64 exec, -1
	s_add_u32 s38, s38, 36864
	s_waitcnt vmcnt(0)
.rhave_757:
	v_mov_b32 v20, v30
	v_mov_b32 v21, v31
	v_mov_b32 v22, v32
	v_mov_b32 v23, v33
	v_mov_b32 v24, v34
	v_mov_b32 v25, v35
	v_mov_b32 v26, v36
	v_mov_b32 v27, v37
	v_mov_b32 v28, v38
	v_mov_b32 v29, v39
	s_and_b32 s63, s28, 3
	s_mul_i32 s63, s63, 73728
	s_add_u32 s63, s63, s40
	s_add_u32 s17, s63, 0
	s_add_u32 s18, s17, 4096
	buffer_load_dwordx4 v[128:131], v97, s[4:7], s17 offen offset:0 sc1
	buffer_load_dwordx4 v[132:135], v97, s[4:7], s17 offen offset:1024 sc1
	buffer_load_dwordx4 v[136:139], v97, s[4:7], s17 offen offset:2048 sc1
	buffer_load_dwordx4 v[140:143], v97, s[4:7], s17 offen offset:3072 sc1
	s_mov_b64 exec, s[42:43]
	buffer_load_dwordx4 v[144:147], v97, s[4:7], s18 offen offset:0 sc1
	s_mov_b64 exec, -1
	s_mov_b32 s46, 0
	s_cmp_ge_u32 s28, 63
	s_cbranch_scc1 .rnopf_760
	v_cmp_gt_u32 vcc, v107, v100
	s_nop 0
	s_andn2_b64 s[58:59], vcc, s[56:57]
	s_cbranch_scc1 .rnopf_760
	buffer_load_dwordx2 v[30:31], v96, s[48:51], s38 offen offset:0
	buffer_load_dwordx2 v[32:33], v96, s[48:51], s38 offen offset:64
	buffer_load_dwordx2 v[34:35], v96, s[48:51], s38 offen offset:128
	buffer_load_dwordx2 v[36:37], v96, s[48:51], s38 offen offset:192
	s_mov_b64 exec, s[42:43]
	buffer_load_dwordx2 v[38:39], v96, s[48:51], s38 offen offset:256
	s_mov_b64 exec, -1
	s_add_u32 s38, s38, 36864
	s_mov_b32 s46, 1
	s_waitcnt vmcnt(5)
	s_branch .rpfd_761
.rnopf_760:
	s_waitcnt vmcnt(0)
.rpfd_761:
	v_lshlrev_b32 v0, 16, v20
	v_and_b32 v1, v104, v20
	v_lshlrev_b32 v2, 16, v21
	v_and_b32 v3, v104, v21
	v_cvt_pk_bf16_f32 v128, v128, v129
	v_cvt_pk_bf16_f32 v129, v130, v131
	v_and_b32 v130, v104, v128
	v_and_b32 v131, v104, v129
	v_lshlrev_b32 v128, 16, v128
	v_lshlrev_b32 v129, 16, v129
	v_add_f32 v0, v0, v128
	v_add_f32 v1, v1, v130
	v_add_f32 v2, v2, v129
	v_add_f32 v3, v3, v131
	v_cvt_pk_bf16_f32 v20, v0, v1
	v_cvt_pk_bf16_f32 v21, v2, v3
	ds_write_b64 v96, v[20:21] offset:1024
	v_lshlrev_b32 v0, 16, v20
	v_and_b32 v1, v104, v20
	v_lshlrev_b32 v2, 16, v21
	v_and_b32 v3, v104, v21
	v_lshlrev_b32 v4, 16, v22
	v_and_b32 v5, v104, v22
	v_lshlrev_b32 v6, 16, v23
	v_and_b32 v7, v104, v23
	v_cvt_pk_bf16_f32 v132, v132, v133
	v_cvt_pk_bf16_f32 v133, v134, v135
	v_and_b32 v134, v104, v132
	v_and_b32 v135, v104, v133
	v_lshlrev_b32 v132, 16, v132
	v_lshlrev_b32 v133, 16, v133
	v_add_f32 v4, v4, v132
	v_add_f32 v5, v5, v134
	v_add_f32 v6, v6, v133
	v_add_f32 v7, v7, v135
	v_cvt_pk_bf16_f32 v22, v4, v5
	v_cvt_pk_bf16_f32 v23, v6, v7
	ds_write_b64 v96, v[22:23] offset:1088
	v_lshlrev_b32 v4, 16, v22
	v_and_b32 v5, v104, v22
	v_lshlrev_b32 v6, 16, v23
	v_and_b32 v7, v104, v23
	v_lshlrev_b32 v8, 16, v24
	v_and_b32 v9, v104, v24
	v_lshlrev_b32 v10, 16, v25
	v_and_b32 v11, v104, v25
	v_cvt_pk_bf16_f32 v136, v136, v137
	v_cvt_pk_bf16_f32 v137, v138, v139
	v_and_b32 v138, v104, v136
	v_and_b32 v139, v104, v137
	v_lshlrev_b32 v136, 16, v136
	v_lshlrev_b32 v137, 16, v137
	v_add_f32 v8, v8, v136
	v_add_f32 v9, v9, v138
	v_add_f32 v10, v10, v137
	v_add_f32 v11, v11, v139
	v_cvt_pk_bf16_f32 v24, v8, v9
	v_cvt_pk_bf16_f32 v25, v10, v11
	ds_write_b64 v96, v[24:25] offset:1152
	v_lshlrev_b32 v8, 16, v24
	v_and_b32 v9, v104, v24
	v_lshlrev_b32 v10, 16, v25
	v_and_b32 v11, v104, v25
	v_lshlrev_b32 v12, 16, v26
	v_and_b32 v13, v104, v26
	v_lshlrev_b32 v14, 16, v27
	v_and_b32 v15, v104, v27
	v_cvt_pk_bf16_f32 v140, v140, v141
	v_cvt_pk_bf16_f32 v141, v142, v143
	v_and_b32 v142, v104, v140
	v_and_b32 v143, v104, v141
	v_lshlrev_b32 v140, 16, v140
	v_lshlrev_b32 v141, 16, v141
	v_add_f32 v12, v12, v140
	v_add_f32 v13, v13, v142
	v_add_f32 v14, v14, v141
	v_add_f32 v15, v15, v143
	v_cvt_pk_bf16_f32 v26, v12, v13
	v_cvt_pk_bf16_f32 v27, v14, v15
	ds_write_b64 v96, v[26:27] offset:1216
	v_lshlrev_b32 v12, 16, v26
	v_and_b32 v13, v104, v26
	v_lshlrev_b32 v14, 16, v27
	v_and_b32 v15, v104, v27
	s_mov_b64 exec, s[42:43]
	v_lshlrev_b32 v16, 16, v28
	v_and_b32 v17, v104, v28
	v_lshlrev_b32 v18, 16, v29
	v_and_b32 v19, v104, v29
	v_cvt_pk_bf16_f32 v144, v144, v145
	v_cvt_pk_bf16_f32 v145, v146, v147
	v_and_b32 v146, v104, v144
	v_and_b32 v147, v104, v145
	v_lshlrev_b32 v144, 16, v144
	v_lshlrev_b32 v145, 16, v145
	v_add_f32 v16, v16, v144
	v_add_f32 v17, v17, v146
	v_add_f32 v18, v18, v145
	v_add_f32 v19, v19, v147
	v_cvt_pk_bf16_f32 v28, v16, v17
	v_cvt_pk_bf16_f32 v29, v18, v19
	ds_write_b64 v96, v[28:29] offset:1280
	v_lshlrev_b32 v16, 16, v28
	v_and_b32 v17, v104, v28
	v_lshlrev_b32 v18, 16, v29
	v_and_b32 v19, v104, v29
	s_mov_b64 exec, -1
	v_pk_add_f32 v[44:45], v[0:1], v[2:3]
	v_pk_add_f32 v[44:45], v[44:45], v[4:5]
	v_pk_add_f32 v[44:45], v[44:45], v[6:7]
	v_pk_add_f32 v[44:45], v[44:45], v[8:9]
	v_pk_add_f32 v[44:45], v[44:45], v[10:11]
	v_pk_add_f32 v[44:45], v[44:45], v[12:13]
	v_pk_add_f32 v[44:45], v[44:45], v[14:15]
	s_mov_b64 exec, s[42:43]
	v_pk_add_f32 v[44:45], v[44:45], v[16:17]
	v_pk_add_f32 v[44:45], v[44:45], v[18:19]
	s_mov_b64 exec, -1
	v_add_f32 v40, v44, v45
	s_nop 1
	v_add_f32_dpp v40, v40, v40 row_ror:8 row_mask:0xf bank_mask:0xf
	v_mov_b32 v42, v40
	s_nop 1
	v_permlane16_swap_b32 v40, v42
	v_add_f32 v40, v40, v42
	v_mov_b32 v42, v40
	s_nop 1
	v_permlane32_swap_b32 v40, v42
	v_add_f32 v40, v40, v42
	v_mul_f32 v40, 0x3be38e39, v40
	v_mov_b32 v41, 0
	v_sub_f32 v46, v0, v40
	v_fmac_f32 v41, v46, v46
	v_sub_f32 v46, v1, v40
	v_fmac_f32 v41, v46, v46
	v_sub_f32 v46, v2, v40
	v_fmac_f32 v41, v46, v46
	v_sub_f32 v46, v3, v40
	v_fmac_f32 v41, v46, v46
	v_sub_f32 v46, v4, v40
	v_fmac_f32 v41, v46, v46
	v_sub_f32 v46, v5, v40
	v_fmac_f32 v41, v46, v46
	v_sub_f32 v46, v6, v40
	v_fmac_f32 v41, v46, v46
	v_sub_f32 v46, v7, v40
	v_fmac_f32 v41, v46, v46
	v_sub_f32 v46, v8, v40
	v_fmac_f32 v41, v46, v46
	v_sub_f32 v46, v9, v40
	v_fmac_f32 v41, v46, v46
	v_sub_f32 v46, v10, v40
	v_fmac_f32 v41, v46, v46
	v_sub_f32 v46, v11, v40
	v_fmac_f32 v41, v46, v46
	v_sub_f32 v46, v12, v40
	v_fmac_f32 v41, v46, v46
	v_sub_f32 v46, v13, v40
	v_fmac_f32 v41, v46, v46
	v_sub_f32 v46, v14, v40
	v_fmac_f32 v41, v46, v46
	v_sub_f32 v46, v15, v40
	v_fmac_f32 v41, v46, v46
	s_mov_b64 exec, s[42:43]
	v_sub_f32 v46, v16, v40
	v_fmac_f32 v41, v46, v46
	v_sub_f32 v46, v17, v40
	v_fmac_f32 v41, v46, v46
	v_sub_f32 v46, v18, v40
	v_fmac_f32 v41, v46, v46
	v_sub_f32 v46, v19, v40
	v_fmac_f32 v41, v46, v46
	s_mov_b64 exec, -1
	s_nop 0
	v_add_f32_dpp v41, v41, v41 row_ror:8 row_mask:0xf bank_mask:0xf
	v_mov_b32 v42, v41
	s_nop 1
	v_permlane16_swap_b32 v41, v42
	v_add_f32 v41, v41, v42
	v_mov_b32 v42, v41
	s_nop 1
	v_permlane32_swap_b32 v41, v42
	v_add_f32 v41, v41, v42
	s_lshl_b32 s17, s15, 6
	v_add_u32 v42, s17, v103
	s_mov_b64 exec, 0xff
	ds_write_b64 v42, v[40:41] offset:0
	s_mov_b64 exec, -1
	s_waitcnt lgkmcnt(0)
	s_barrier
	ds_read_b64 v[48:49], v103 offset:0
	ds_read_b64 v[50:51], v103 offset:64
	ds_read_b64 v[52:53], v103 offset:128
	ds_read_b64 v[54:55], v103 offset:192
	ds_read_b128 v[60:63], v111 offset:1024
	ds_read_b128 v[64:67], v111 offset:5120
	s_add_u32 s17, s39, s60
	s_add_u32 s18, s17, 4096
	s_cmp_lg_u32 s15, 0
	s_cbranch_scc1 .rex_762
	ds_read_b128 v[68:71], v105 offset:9216
	s_add_u32 s19, s39, 8192
	s_waitcnt lgkmcnt(0)
	buffer_store_dwordx4 v[68:71], v105, s[52:55], s19 offen sc1
.rex_762:
	s_waitcnt lgkmcnt(0)
	buffer_store_dwordx4 v[60:63], v105, s[52:55], s17 offen sc1
	buffer_store_dwordx4 v[64:67], v105, s[52:55], s18 offen sc1
	v_add_f32 v56, v48, v50
	v_add_f32 v57, v52, v54
	v_add_f32 v56, v56, v57
	v_mul_f32 v56, 0.25, v56
	v_add_f32 v57, v49, v51
	v_add_f32 v58, v53, v55
	v_add_f32 v57, v57, v58
	v_mov_b32 v58, 0
	v_sub_f32 v59, v48, v56
	v_fmac_f32 v58, v59, v59
	v_sub_f32 v59, v50, v56
	v_fmac_f32 v58, v59, v59
	v_sub_f32 v59, v52, v56
	v_fmac_f32 v58, v59, v59
	v_sub_f32 v59, v54, v56
	v_fmac_f32 v58, v59, v59
	v_fmac_f32 v57, 0x43100000, v58
	v_mov_b32 v59, 0x3727c5ac
	v_fmac_f32 v59, 0x3ae38e39, v57
	v_rsq_f32 v59, v59
	v_sub_f32 v0, v0, v56
	v_sub_f32 v1, v1, v56
	v_sub_f32 v2, v2, v56
	v_sub_f32 v3, v3, v56
	v_mul_f32 v0, v0, v59
	v_mul_f32 v1, v1, v59
	v_mul_f32 v2, v2, v59
	v_mul_f32 v3, v3, v59
	v_cvt_pk_bf16_f32 v0, v0, v1
	v_cvt_pk_bf16_f32 v1, v2, v3
	ds_write_b64 v98, v[0:1] offset:0
	v_sub_f32 v4, v4, v56
	v_sub_f32 v5, v5, v56
	v_sub_f32 v6, v6, v56
	v_sub_f32 v7, v7, v56
	v_mul_f32 v4, v4, v59
	v_mul_f32 v5, v5, v59
	v_mul_f32 v6, v6, v59
	v_mul_f32 v7, v7, v59
	v_cvt_pk_bf16_f32 v4, v4, v5
	v_cvt_pk_bf16_f32 v5, v6, v7
	ds_write_b64 v98, v[4:5] offset:512
	v_sub_f32 v8, v8, v56
	v_sub_f32 v9, v9, v56
	v_sub_f32 v10, v10, v56
	v_sub_f32 v11, v11, v56
	v_mul_f32 v8, v8, v59
	v_mul_f32 v9, v9, v59
	v_mul_f32 v10, v10, v59
	v_mul_f32 v11, v11, v59
	v_cvt_pk_bf16_f32 v8, v8, v9
	v_cvt_pk_bf16_f32 v9, v10, v11
	ds_write_b64 v98, v[8:9] offset:1024
	v_sub_f32 v12, v12, v56
	v_sub_f32 v13, v13, v56
	v_sub_f32 v14, v14, v56
	v_sub_f32 v15, v15, v56
	v_mul_f32 v12, v12, v59
	v_mul_f32 v13, v13, v59
	v_mul_f32 v14, v14, v59
	v_mul_f32 v15, v15, v59
	v_cvt_pk_bf16_f32 v12, v12, v13
	v_cvt_pk_bf16_f32 v13, v14, v15
	ds_write_b64 v98, v[12:13] offset:1536
	s_mov_b64 exec, s[42:43]
	v_sub_f32 v16, v16, v56
	v_sub_f32 v17, v17, v56
	v_sub_f32 v18, v18, v56
	v_sub_f32 v19, v19, v56
	v_mul_f32 v16, v16, v59
	v_mul_f32 v17, v17, v59
	v_mul_f32 v18, v18, v59
	v_mul_f32 v19, v19, v59
	v_cvt_pk_bf16_f32 v16, v16, v17
	v_cvt_pk_bf16_f32 v17, v18, v19
	ds_write_b64 v98, v[16:17] offset:2048
	s_mov_b64 exec, -1
	s_waitcnt lgkmcnt(0)
	s_barrier
	ds_read_b128 v[60:63], v111 offset:10240
	ds_read_b128 v[64:67], v111 offset:14336
	s_add_u32 s17, s41, s61
	s_add_u32 s18, s17, 8192
	s_cmp_lg_u32 s15, 1
	s_cbranch_scc1 .rex_764
	ds_read_b128 v[68:71], v105 offset:18432
	s_add_u32 s19, s41, 16384
	s_waitcnt lgkmcnt(0)
	buffer_store_dwordx4 v[68:71], v106, s[4:7], s19 offen sc1
.rex_764:
	s_waitcnt lgkmcnt(0)
	buffer_store_dwordx4 v[60:63], v106, s[4:7], s17 offen sc1
	buffer_store_dwordx4 v[64:67], v106, s[4:7], s18 offen sc1
	s_add_u32 s39, s39, 36864
	s_add_u32 s41, s41, 36864
	s_add_u32 s62, s28, 1
	s_add_u32 s28, s28, 1
	v_xor_b32 v99, v108, v99
	buffer_load_dword v100, v99, s[4:7], 0 offen sc1
	s_add_u32 s37, s28, 1
	s_add_u32 s18, s28, 2
	v_mov_b32 v107, s37
	v_mov_b32 v102, s18
	v_cndmask_b32 v107, v102, v107, s[56:57]
	s_waitcnt vmcnt(0)
	v_mov_b32 v102, s62
	s_mov_b64 exec, 1
	buffer_store_dword v102, v101, s[4:7], s30 offen sc1
	s_mov_b64 exec, -1
	s_cmp_ge_u32 s28, 64
	s_cbranch_scc1 L_END
	v_cmp_gt_u32 vcc, v107, v100
	s_nop 0
	s_and_b64 s[58:59], vcc, s[56:57]
	s_cbranch_scc0 .rok_766
	s_mov_b32 s20, 400000
.rre_767:
	buffer_load_dword v100, v99, s[4:7], 0 offen sc1
	s_waitcnt vmcnt(0)
	v_cmp_gt_u32 vcc, v107, v100
	s_nop 0
	s_and_b64 s[58:59], vcc, s[56:57]
	s_cbranch_scc0 .rok_766
	s_sub_u32 s20, s20, 1
	s_cmp_lg_u32 s20, 0
	s_cbranch_scc1 .rre_767
	s_branch L_FAIL
.rok_766:
	s_branch .rloop_756
L_RA1_CE:
.p2align 6
L_RB1:
	v_and_b32 v79, 63, v0
	v_mov_b32 v75, v0
	v_and_b32 v78, 15, v79
	v_lshrrev_b32 v77, 4, v79
	v_and_b32 v76, 7, v79
	s_lshr_b32 s47, s26, 2
	s_and_b32 s26, s26, 3
	v_bfe_u32 v72, v79, 3, 2
	v_lshrrev_b32 v73, 5, v79
	v_lshlrev_b32 v106, 10, v73
	v_lshlrev_b32 v74, 8, v72
	v_add_u32 v106, v106, v74
	v_lshlrev_b32 v74, 4, v76
	v_add_u32 v106, v106, v74
	s_mul_i32 s17, s15, 9
	v_add_u32 v73, s17, v73
	v_mul_u32_u24 v96, 1152, v76
	v_lshlrev_b32 v74, 5, v73
	v_add_u32 v96, v96, v74
	v_lshlrev_b32 v74, 3, v72
	v_add_u32 v96, v96, v74
	v_lshlrev_b32 v105, 4, v79
	s_mul_i32 s17, s15, 4608
	v_add_u32 v97, s17, v105
	v_lshrrev_b32 v98, 1, v73
	v_lshlrev_b32 v98, 9, v98
	v_and_b32 v74, 1, v73
	v_lshlrev_b32 v74, 3, v74
	v_add_u32 v98, v98, v74
	v_lshlrev_b32 v74, 7, v72
	v_add_u32 v98, v98, v74
	v_lshlrev_b32 v74, 4, v76
	v_add_u32 v98, v98, v74
	v_add_u32 v98, 10240, v98
	s_and_b32 s17, s26, 1
	s_lshr_b32 s18, s26, 1
	s_lshl_b32 s19, s17, 7
	v_add_u32 v106, s19, v106
	v_lshlrev_b32 v103, 3, v76
	v_mov_b32 v101, 0
	v_mov_b32 v104, 0xffff0000
	s_mul_i32 s38, s26, 9216
	s_mov_b32 s39, s38
	s_mul_i32 s40, s26, 18432
	s_mul_i32 s41, s18, 18432
	s_mov_b32 s48, s4
	s_mov_b32 s49, s5
	s_mov_b32 s50, s6
	s_mov_b32 s51, s7
	s_add_u32 s38, s38, 0xa3c0000
	s_load_dwordx2 s[22:23], s[0:1], 80
	s_waitcnt lgkmcnt(0)
	s_mov_b32 s52, s22
	s_and_b32 s53, s23, 0xffff
	s_mov_b32 s54, 0x240000
	s_mov_b32 s55, 0x00020000
	s_add_u32 s40, s40, 0xdc80000
	v_min_u32 v99, 47, v79
	v_lshrrev_b32 v74, 2, v99
	v_add_u32 v74, 232, v74
	v_lshlrev_b32 v74, 7, v74
	v_and_b32 v99, 3, v99
	v_lshlrev_b32 v99, 2, v99
	v_add_u32 v99, v99, v74
	s_mov_b32 s56, -1
	s_mov_b32 s57, 0xffff
	v_and_b32 v72, 15, v79
	v_min_u32 v109, 15, v72
	v_lshrrev_b32 v74, 2, v109
	v_add_u32 v74, 192, v74
	v_lshlrev_b32 v74, 7, v74
	v_and_b32 v109, 3, v109
	v_lshlrev_b32 v109, 2, v109
	v_add_u32 v109, v109, v74
	v_cndmask_b32 v99, v109, v99, s[56:57]
	v_mov_b32 v108, 0
	v_cndmask_b32 v108, v108, 0, s[56:57]
	s_lshl_b32 s30, s14, 7
	s_lshl_b32 s17, s15, 2
	s_add_u32 s30, s30, s17
	s_mov_b32 s42, -1
	s_mov_b32 s43, 0
	s_mul_i32 s17, s47, 36864
	s_add_u32 s38, s38, s17
	s_mul_i32 s17, s47, 36864
	s_add_u32 s39, s39, s17
	s_mul_i32 s17, s47, 36864
	s_add_u32 s41, s41, s17
	s_lshl_b32 s60, s15, 10
	s_lshl_b32 s61, s15, 11
	v_add_u32 v111, s60, v105
	v_mov_b32 v74, 0
	s_mov_b32 s20, 400000
	v_and_b32 v72, 7, v79
	v_lshrrev_b32 v73, 2, v72
	v_mul_u32_u24 v73, 112, v73
	v_lshlrev_b32 v72, 2, v72
	v_add_u32 v72, v72, v73
	s_getpc_b64 s[18:19]
.ct_771:
	s_sub_u32 s18, s18, .ct_771-L_RB1
	s_subb_u32 s19, s19, 0
	v_lshlrev_b32 v74, 7, v79
	s_lshl_b32 s17, s15, 13
	v_add_u32 v74, s17, v74
	s_mov_b32 s17, L_RB1_CE-L_RB1-4
	v_min_u32 v74, s17, v74
	global_load_dword v73, v74, s[18:19]
	v_mov_b32 v74, 0
.gbre_768:
	global_load_dword v73, v72, s[12:13] offset:16 sc1
	s_waitcnt vmcnt(0)
	v_readlane_b32 s17, v73, 0
	v_readlane_b32 s18, v73, 1
	s_nop 0
	s_add_u32 s17, s17, s18
	v_readlane_b32 s18, v73, 2
	s_nop 0
	s_add_u32 s17, s17, s18
	v_readlane_b32 s18, v73, 3
	s_nop 0
	s_add_u32 s17, s17, s18
	v_readlane_b32 s18, v73, 4
	s_nop 0
	s_add_u32 s17, s17, s18
	v_readlane_b32 s18, v73, 5
	s_nop 0
	s_add_u32 s17, s17, s18
	v_readlane_b32 s18, v73, 6
	s_nop 0
	s_add_u32 s17, s17, s18
	v_readlane_b32 s18, v73, 7
	s_nop 0
	s_add_u32 s17, s17, s18
	s_cmp_ge_u32 s17, 256
	s_cbranch_scc1 .gbok_769
	s_sub_u32 s20, s20, 1
	s_cmp_lg_u32 s20, 0
	s_cbranch_scc1 .gbre_768
	s_branch L_FAIL
.gbok_769:
	s_mov_b32 s28, s47
	s_mov_b32 s46, 0
	s_add_u32 s37, s28, 1
	s_add_u32 s18, s28, 3
	v_mov_b32 v107, s37
	v_mov_b32 v102, s18
	v_cndmask_b32 v107, v102, v107, s[56:57]
	buffer_load_dword v100, v99, s[4:7], 0 offen sc1
	s_waitcnt vmcnt(0)
	v_cmp_gt_u32 vcc, v107, v100
	s_nop 0
	s_and_b64 s[58:59], vcc, s[56:57]
	s_cbranch_scc0 .rok_772
	s_mov_b32 s20, 400000
.rre_773:
	buffer_load_dword v100, v99, s[4:7], 0 offen sc1
	s_waitcnt vmcnt(0)
	v_cmp_gt_u32 vcc, v107, v100
	s_nop 0
	s_and_b64 s[58:59], vcc, s[56:57]
	s_cbranch_scc0 .rok_772
	s_sub_u32 s20, s20, 1
	s_cmp_lg_u32 s20, 0
	s_cbranch_scc1 .rre_773
	s_branch L_FAIL
.rok_772:
.rloop_774:
	s_cmp_lg_u32 s46, 0
	s_cbranch_scc1 .rhave_775
	v_xor_b32 v109, v108, v99
	s_mov_b32 s20, 400000
.rxre_776:
	buffer_load_dword v110, v109, s[4:7], 0 offen sc1
	s_waitcnt vmcnt(0)
	v_cmp_gt_u32 vcc, s37, v110
	s_nop 0
	s_andn2_b64 s[58:59], vcc, s[56:57]
	s_cbranch_scc0 .rxok_777
	s_sub_u32 s20, s20, 1
	s_cmp_lg_u32 s20, 0
	s_cbranch_scc1 .rxre_776
	s_branch L_FAIL
.rxok_777:
	buffer_load_dwordx2 v[30:31], v96, s[48:51], s38 offen offset:0
	buffer_load_dwordx2 v[32:33], v96, s[48:51], s38 offen offset:64
	buffer_load_dwordx2 v[34:35], v96, s[48:51], s38 offen offset:128
	buffer_load_dwordx2 v[36:37], v96, s[48:51], s38 offen offset:192
	s_mov_b64 exec, s[42:43]
	buffer_load_dwordx2 v[38:39], v96, s[48:51], s38 offen offset:256
	s_mov_b64 exec, -1
	s_add_u32 s38, s38, 73728
	s_waitcnt vmcnt(0)
.rhave_775:
	v_mov_b32 v20, v30
	v_mov_b32 v21, v31
	v_mov_b32 v22, v32
	v_mov_b32 v23, v33
	v_mov_b32 v24, v34
	v_mov_b32 v25, v35
	v_mov_b32 v26, v36
	v_mov_b32 v27, v37
	v_mov_b32 v28, v38
	v_mov_b32 v29, v39
	s_and_b32 s63, s28, 3
	s_mul_i32 s63, s63, 294912
	s_add_u32 s63, s63, s40
	s_add_u32 s17, s63, 0
	s_add_u32 s18, s17, 4096
	buffer_load_dwordx4 v[128:131], v97, s[4:7], s17 offen offset:0 sc1
	buffer_load_dwordx4 v[132:135], v97, s[4:7], s17 offen offset:1024 sc1
	buffer_load_dwordx4 v[136:139], v97, s[4:7], s17 offen offset:2048 sc1
	buffer_load_dwordx4 v[140:143], v97, s[4:7], s17 offen offset:3072 sc1
	s_mov_b64 exec, s[42:43]
	buffer_load_dwordx4 v[144:147], v97, s[4:7], s18 offen offset:0 sc1
	s_mov_b64 exec, -1
	s_add_u32 s17, s63, 73728
	s_add_u32 s18, s17, 4096
	buffer_load_dwordx4 v[148:151], v97, s[4:7], s17 offen offset:0 sc1
	buffer_load_dwordx4 v[152:155], v97, s[4:7], s17 offen offset:1024 sc1
	buffer_load_dwordx4 v[156:159], v97, s[4:7], s17 offen offset:2048 sc1
	buffer_load_dwordx4 v[160:163], v97, s[4:7], s17 offen offset:3072 sc1
	s_mov_b64 exec, s[42:43]
	buffer_load_dwordx4 v[164:167], v97, s[4:7], s18 offen offset:0 sc1
	s_mov_b64 exec, -1
	s_add_u32 s17, s63, 147456
	s_add_u32 s18, s17, 4096
	buffer_load_dwordx4 v[168:171], v97, s[4:7], s17 offen offset:0 sc1
	buffer_load_dwordx4 v[172:175], v97, s[4:7], s17 offen offset:1024 sc1
	buffer_load_dwordx4 v[176:179], v97, s[4:7], s17 offen offset:2048 sc1
	buffer_load_dwordx4 v[180:183], v97, s[4:7], s17 offen offset:3072 sc1
	s_mov_b64 exec, s[42:43]
	buffer_load_dwordx4 v[184:187], v97, s[4:7], s18 offen offset:0 sc1
	s_mov_b64 exec, -1
	s_add_u32 s17, s63, 221184
	s_add_u32 s18, s17, 4096
	buffer_load_dwordx4 v[188:191], v97, s[4:7], s17 offen offset:0 sc1
	buffer_load_dwordx4 v[192:195], v97, s[4:7], s17 offen offset:1024 sc1
	buffer_load_dwordx4 v[196:199], v97, s[4:7], s17 offen offset:2048 sc1
	buffer_load_dwordx4 v[200:203], v97, s[4:7], s17 offen offset:3072 sc1
	s_mov_b64 exec, s[42:43]
	buffer_load_dwordx4 v[204:207], v97, s[4:7], s18 offen offset:0 sc1
	s_mov_b64 exec, -1
	s_mov_b32 s46, 0
	s_cmp_ge_u32 s28, 62
	s_cbranch_scc1 .rnopf_778
	v_cmp_gt_u32 vcc, v107, v100
	s_nop 0
	s_andn2_b64 s[58:59], vcc, s[56:57]
	s_cbranch_scc1 .rnopf_778
	buffer_load_dwordx2 v[30:31], v96, s[48:51], s38 offen offset:0
	buffer_load_dwordx2 v[32:33], v96, s[48:51], s38 offen offset:64
	buffer_load_dwordx2 v[34:35], v96, s[48:51], s38 offen offset:128
	buffer_load_dwordx2 v[36:37], v96, s[48:51], s38 offen offset:192
	s_mov_b64 exec, s[42:43]
	buffer_load_dwordx2 v[38:39], v96, s[48:51], s38 offen offset:256
	s_mov_b64 exec, -1
	s_add_u32 s38, s38, 73728
	s_mov_b32 s46, 1
	s_waitcnt vmcnt(5)
	s_branch .rpfd_779
.rnopf_778:
	s_waitcnt vmcnt(0)
.rpfd_779:
	s_barrier
	v_lshlrev_b32 v0, 16, v20
	v_and_b32 v1, v104, v20
	v_lshlrev_b32 v2, 16, v21
	v_and_b32 v3, v104, v21
	v_pk_add_f32 v[128:129], v[128:129], v[148:149]
	v_pk_add_f32 v[130:131], v[130:131], v[150:151]
	v_pk_add_f32 v[168:169], v[168:169], v[188:189]
	v_pk_add_f32 v[170:171], v[170:171], v[190:191]
	v_pk_add_f32 v[128:129], v[128:129], v[168:169]
	v_pk_add_f32 v[130:131], v[130:131], v[170:171]
	v_cvt_pk_bf16_f32 v128, v128, v129
	v_cvt_pk_bf16_f32 v129, v130, v131
	v_and_b32 v130, v104, v128
	v_and_b32 v131, v104, v129
	v_lshlrev_b32 v128, 16, v128
	v_lshlrev_b32 v129, 16, v129
	v_add_f32 v0, v0, v128
	v_add_f32 v1, v1, v130
	v_add_f32 v2, v2, v129
	v_add_f32 v3, v3, v131
	v_cvt_pk_bf16_f32 v20, v0, v1
	v_cvt_pk_bf16_f32 v21, v2, v3
	ds_write_b64 v96, v[20:21] offset:1024
	v_lshlrev_b32 v4, 16, v22
	v_and_b32 v5, v104, v22
	v_lshlrev_b32 v6, 16, v23
	v_and_b32 v7, v104, v23
	v_pk_add_f32 v[132:133], v[132:133], v[152:153]
	v_pk_add_f32 v[134:135], v[134:135], v[154:155]
	v_pk_add_f32 v[172:173], v[172:173], v[192:193]
	v_pk_add_f32 v[174:175], v[174:175], v[194:195]
	v_pk_add_f32 v[132:133], v[132:133], v[172:173]
	v_pk_add_f32 v[134:135], v[134:135], v[174:175]
	v_cvt_pk_bf16_f32 v132, v132, v133
	v_cvt_pk_bf16_f32 v133, v134, v135
	v_and_b32 v134, v104, v132
	v_and_b32 v135, v104, v133
	v_lshlrev_b32 v132, 16, v132
	v_lshlrev_b32 v133, 16, v133
	v_add_f32 v4, v4, v132
	v_add_f32 v5, v5, v134
	v_add_f32 v6, v6, v133
	v_add_f32 v7, v7, v135
	v_cvt_pk_bf16_f32 v22, v4, v5
	v_cvt_pk_bf16_f32 v23, v6, v7
	ds_write_b64 v96, v[22:23] offset:1088
	v_lshlrev_b32 v8, 16, v24
	v_and_b32 v9, v104, v24
	v_lshlrev_b32 v10, 16, v25
	v_and_b32 v11, v104, v25
	v_pk_add_f32 v[136:137], v[136:137], v[156:157]
	v_pk_add_f32 v[138:139], v[138:139], v[158:159]
	v_pk_add_f32 v[176:177], v[176:177], v[196:197]
	v_pk_add_f32 v[178:179], v[178:179], v[198:199]
	v_pk_add_f32 v[136:137], v[136:137], v[176:177]
	v_pk_add_f32 v[138:139], v[138:139], v[178:179]
	v_cvt_pk_bf16_f32 v136, v136, v137
	v_cvt_pk_bf16_f32 v137, v138, v139
	v_and_b32 v138, v104, v136
	v_and_b32 v139, v104, v137
	v_lshlrev_b32 v136, 16, v136
	v_lshlrev_b32 v137, 16, v137
	v_add_f32 v8, v8, v136
	v_add_f32 v9, v9, v138
	v_add_f32 v10, v10, v137
	v_add_f32 v11, v11, v139
	v_cvt_pk_bf16_f32 v24, v8, v9
	v_cvt_pk_bf16_f32 v25, v10, v11
	ds_write_b64 v96, v[24:25] offset:1152
	v_lshlrev_b32 v12, 16, v26
	v_and_b32 v13, v104, v26
	v_lshlrev_b32 v14, 16, v27
	v_and_b32 v15, v104, v27
	v_pk_add_f32 v[140:141], v[140:141], v[160:161]
	v_pk_add_f32 v[142:143], v[142:143], v[162:163]
	v_pk_add_f32 v[180:181], v[180:181], v[200:201]
	v_pk_add_f32 v[182:183], v[182:183], v[202:203]
	v_pk_add_f32 v[140:141], v[140:141], v[180:181]
	v_pk_add_f32 v[142:143], v[142:143], v[182:183]
	v_cvt_pk_bf16_f32 v140, v140, v141
	v_cvt_pk_bf16_f32 v141, v142, v143
	v_and_b32 v142, v104, v140
	v_and_b32 v143, v104, v141
	v_lshlrev_b32 v140, 16, v140
	v_lshlrev_b32 v141, 16, v141
	v_add_f32 v12, v12, v140
	v_add_f32 v13, v13, v142
	v_add_f32 v14, v14, v141
	v_add_f32 v15, v15, v143
	v_cvt_pk_bf16_f32 v26, v12, v13
	v_cvt_pk_bf16_f32 v27, v14, v15
	ds_write_b64 v96, v[26:27] offset:1216
	s_mov_b64 exec, s[42:43]
	v_lshlrev_b32 v16, 16, v28
	v_and_b32 v17, v104, v28
	v_lshlrev_b32 v18, 16, v29
	v_and_b32 v19, v104, v29
	v_pk_add_f32 v[144:145], v[144:145], v[164:165]
	v_pk_add_f32 v[146:147], v[146:147], v[166:167]
	v_pk_add_f32 v[184:185], v[184:185], v[204:205]
	v_pk_add_f32 v[186:187], v[186:187], v[206:207]
	v_pk_add_f32 v[144:145], v[144:145], v[184:185]
	v_pk_add_f32 v[146:147], v[146:147], v[186:187]
	v_cvt_pk_bf16_f32 v144, v144, v145
	v_cvt_pk_bf16_f32 v145, v146, v147
	v_and_b32 v146, v104, v144
	v_and_b32 v147, v104, v145
	v_lshlrev_b32 v144, 16, v144
	v_lshlrev_b32 v145, 16, v145
	v_add_f32 v16, v16, v144
	v_add_f32 v17, v17, v146
	v_add_f32 v18, v18, v145
	v_add_f32 v19, v19, v147
	v_cvt_pk_bf16_f32 v28, v16, v17
	v_cvt_pk_bf16_f32 v29, v18, v19
	ds_write_b64 v96, v[28:29] offset:1280
	s_mov_b64 exec, -1
	s_waitcnt lgkmcnt(0)
	s_barrier
	ds_read_b128 v[60:63], v111 offset:1024
	ds_read_b128 v[64:67], v111 offset:5120
	s_add_u32 s17, s39, s60
	s_add_u32 s18, s17, 4096
	s_cmp_lg_u32 s15, 0
	s_cbranch_scc1 .rex_780
	ds_read_b128 v[68:71], v105 offset:9216
	s_add_u32 s19, s39, 8192
	s_waitcnt lgkmcnt(0)
	buffer_store_dwordx4 v[68:71], v105, s[52:55], s19 offen
.rex_780:
	s_waitcnt lgkmcnt(0)
	buffer_store_dwordx4 v[60:63], v105, s[52:55], s17 offen
	buffer_store_dwordx4 v[64:67], v105, s[52:55], s18 offen
	s_add_u32 s39, s39, 73728
	s_add_u32 s41, s41, 73728
	s_add_u32 s62, s28, 1
	s_add_u32 s28, s28, 2
	v_xor_b32 v99, v108, v99
	buffer_load_dword v100, v99, s[4:7], 0 offen sc1
	s_add_u32 s37, s28, 1
	s_add_u32 s18, s28, 3
	v_mov_b32 v107, s37
	v_mov_b32 v102, s18
	v_cndmask_b32 v107, v102, v107, s[56:57]
	s_waitcnt vmcnt(0)
	v_mov_b32 v102, s62
	s_mov_b64 exec, 1
	buffer_store_dword v102, v101, s[4:7], s30 offen sc1
	s_mov_b64 exec, -1
	s_cmp_ge_u32 s28, 64
	s_cbranch_scc1 L_END
	v_cmp_gt_u32 vcc, v107, v100
	s_nop 0
	s_and_b64 s[58:59], vcc, s[56:57]
	s_cbranch_scc0 .rok_782
	s_mov_b32 s20, 400000
.rre_783:
	buffer_load_dword v100, v99, s[4:7], 0 offen sc1
	s_waitcnt vmcnt(0)
	v_cmp_gt_u32 vcc, v107, v100
	s_nop 0
	s_and_b64 s[58:59], vcc, s[56:57]
	s_cbranch_scc0 .rok_782
	s_sub_u32 s20, s20, 1
	s_cmp_lg_u32 s20, 0
	s_cbranch_scc1 .rre_783
	s_branch L_FAIL
.rok_782:
	s_branch .rloop_774
L_RB1_CE:
.p2align 6
L_R0:
	v_and_b32 v79, 63, v0
	v_mov_b32 v75, v0
	v_and_b32 v78, 15, v79
	v_lshrrev_b32 v77, 4, v79
	v_and_b32 v76, 7, v79
	s_lshr_b32 s47, s26, 2
	s_and_b32 s26, s26, 3
	v_bfe_u32 v72, v79, 3, 2
	v_lshrrev_b32 v73, 5, v79
	v_lshlrev_b32 v106, 10, v73
	v_lshlrev_b32 v74, 8, v72
	v_add_u32 v106, v106, v74
	v_lshlrev_b32 v74, 4, v76
	v_add_u32 v106, v106, v74
	s_mul_i32 s17, s15, 9
	v_add_u32 v73, s17, v73
	v_mul_u32_u24 v96, 1152, v76
	v_lshlrev_b32 v74, 5, v73
	v_add_u32 v96, v96, v74
	v_lshlrev_b32 v74, 3, v72
	v_add_u32 v96, v96, v74
	v_lshlrev_b32 v105, 4, v79
	s_mul_i32 s17, s15, 4608
	v_add_u32 v97, s17, v105
	v_lshrrev_b32 v98, 1, v73
	v_lshlrev_b32 v98, 9, v98
	v_and_b32 v74, 1, v73
	v_lshlrev_b32 v74, 3, v74
	v_add_u32 v98, v98, v74
	v_lshlrev_b32 v74, 7, v72
	v_add_u32 v98, v98, v74
	v_lshlrev_b32 v74, 4, v76
	v_add_u32 v98, v98, v74
	v_add_u32 v98, 10240, v98
	s_and_b32 s17, s26, 1
	s_lshr_b32 s18, s26, 1
	s_lshl_b32 s19, s17, 7
	v_add_u32 v106, s19, v106
	v_lshlrev_b32 v103, 3, v76
	v_mov_b32 v101, 0
	v_mov_b32 v104, 0xffff0000
	s_mul_i32 s38, s26, 9216
	s_mov_b32 s39, s38
	s_mul_i32 s40, s26, 18432
	s_mul_i32 s41, s18, 18432
	s_load_dwordx2 s[22:23], s[0:1], 0
	s_waitcnt lgkmcnt(0)
	s_mov_b32 s48, s22
	s_and_b32 s49, s23, 0xffff
	s_mov_b32 s50, 0x240000
	s_mov_b32 s51, 0x00020000
	s_mov_b32 s52, s4
	s_mov_b32 s53, s5
	s_mov_b32 s54, s6
	s_mov_b32 s55, s7
	s_add_u32 s41, s41, 0x8200000
	s_lshl_b32 s30, s14, 7
	s_lshl_b32 s17, s15, 2
	s_add_u32 s30, s30, s17
	s_mov_b32 s42, -1
	s_mov_b32 s43, 0
	s_lshl_b32 s60, s15, 10
	s_lshl_b32 s61, s15, 11
	v_add_u32 v111, s60, v105
	v_mov_b32 v74, 0
	s_mov_b32 s20, 400000
	v_and_b32 v72, 7, v79
	v_lshrrev_b32 v73, 2, v72
	v_mul_u32_u24 v73, 112, v73
	v_lshlrev_b32 v72, 2, v72
	v_add_u32 v72, v72, v73
	s_getpc_b64 s[18:19]
.ct_787:
	s_sub_u32 s18, s18, .ct_787-L_R0
	s_subb_u32 s19, s19, 0
	v_lshlrev_b32 v74, 7, v79
	s_lshl_b32 s17, s15, 13
	v_add_u32 v74, s17, v74
	s_mov_b32 s17, L_R0_CE-L_R0-4
	v_min_u32 v74, s17, v74
	global_load_dword v73, v74, s[18:19]
	v_mov_b32 v74, 0
.gbre_784:
	global_load_dword v73, v72, s[12:13] offset:16 sc1
	s_waitcnt vmcnt(0)
	v_readlane_b32 s17, v73, 0
	v_readlane_b32 s18, v73, 1
	s_nop 0
	s_add_u32 s17, s17, s18
	v_readlane_b32 s18, v73, 2
	s_nop 0
	s_add_u32 s17, s17, s18
	v_readlane_b32 s18, v73, 3
	s_nop 0
	s_add_u32 s17, s17, s18
	v_readlane_b32 s18, v73, 4
	s_nop 0
	s_add_u32 s17, s17, s18
	v_readlane_b32 s18, v73, 5
	s_nop 0
	s_add_u32 s17, s17, s18
	v_readlane_b32 s18, v73, 6
	s_nop 0
	s_add_u32 s17, s17, s18
	v_readlane_b32 s18, v73, 7
	s_nop 0
	s_add_u32 s17, s17, s18
	s_cmp_ge_u32 s17, 256
	s_cbranch_scc1 .gbok_785
	s_sub_u32 s20, s20, 1
	s_cmp_lg_u32 s20, 0
	s_cbranch_scc1 .gbre_784
	s_branch L_FAIL
.gbok_785:
	s_mov_b32 s28, s47
	s_mov_b32 s46, 0
	buffer_load_dwordx2 v[30:31], v96, s[48:51], s38 offen offset:0
	buffer_load_dwordx2 v[32:33], v96, s[48:51], s38 offen offset:64
	buffer_load_dwordx2 v[34:35], v96, s[48:51], s38 offen offset:128
	buffer_load_dwordx2 v[36:37], v96, s[48:51], s38 offen offset:192
	s_mov_b64 exec, s[42:43]
	buffer_load_dwordx2 v[38:39], v96, s[48:51], s38 offen offset:256
	s_mov_b64 exec, -1
	s_add_u32 s38, s38, 36864
	s_mov_b32 s46, 1
	s_add_u32 s37, s28, 1
	s_waitcnt vmcnt(0)
.rloop_788:
	v_mov_b32 v20, v30
	v_mov_b32 v21, v31
	v_mov_b32 v22, v32
	v_mov_b32 v23, v33
	v_mov_b32 v24, v34
	v_mov_b32 v25, v35
	v_mov_b32 v26, v36
	v_mov_b32 v27, v37
	v_mov_b32 v28, v38
	v_mov_b32 v29, v39
	s_mov_b32 s46, 0
	s_cmp_ge_u32 s28, 63
	s_cbranch_scc1 .rnopf_789
	buffer_load_dwordx2 v[30:31], v96, s[48:51], s38 offen offset:0
	buffer_load_dwordx2 v[32:33], v96, s[48:51], s38 offen offset:64
	buffer_load_dwordx2 v[34:35], v96, s[48:51], s38 offen offset:128
	buffer_load_dwordx2 v[36:37], v96, s[48:51], s38 offen offset:192
	s_mov_b64 exec, s[42:43]
	buffer_load_dwordx2 v[38:39], v96, s[48:51], s38 offen offset:256
	s_mov_b64 exec, -1
	s_add_u32 s38, s38, 36864
	s_mov_b32 s46, 1
	s_branch .rpfd_790
.rnopf_789:
.rpfd_790:
	v_lshlrev_b32 v0, 16, v20
	v_and_b32 v1, v104, v20
	v_lshlrev_b32 v2, 16, v21
	v_and_b32 v3, v104, v21
	v_lshlrev_b32 v4, 16, v22
	v_and_b32 v5, v104, v22
	v_lshlrev_b32 v6, 16, v23
	v_and_b32 v7, v104, v23
	v_lshlrev_b32 v8, 16, v24
	v_and_b32 v9, v104, v24
	v_lshlrev_b32 v10, 16, v25
	v_and_b32 v11, v104, v25
	v_lshlrev_b32 v12, 16, v26
	v_and_b32 v13, v104, v26
	v_lshlrev_b32 v14, 16, v27
	v_and_b32 v15, v104, v27
	s_mov_b64 exec, s[42:43]
	v_lshlrev_b32 v16, 16, v28
	v_and_b32 v17, v104, v28
	v_lshlrev_b32 v18, 16, v29
	v_and_b32 v19, v104, v29
	s_mov_b64 exec, -1
	v_pk_add_f32 v[44:45], v[0:1], v[2:3]
	v_pk_add_f32 v[44:45], v[44:45], v[4:5]
	v_pk_add_f32 v[44:45], v[44:45], v[6:7]
	v_pk_add_f32 v[44:45], v[44:45], v[8:9]
	v_pk_add_f32 v[44:45], v[44:45], v[10:11]
	v_pk_add_f32 v[44:45], v[44:45], v[12:13]
	v_pk_add_f32 v[44:45], v[44:45], v[14:15]
	s_mov_b64 exec, s[42:43]
	v_pk_add_f32 v[44:45], v[44:45], v[16:17]
	v_pk_add_f32 v[44:45], v[44:45], v[18:19]
	s_mov_b64 exec, -1
	v_add_f32 v40, v44, v45
	s_nop 1
	v_add_f32_dpp v40, v40, v40 row_ror:8 row_mask:0xf bank_mask:0xf
	v_mov_b32 v42, v40
	s_nop 1
	v_permlane16_swap_b32 v40, v42
	v_add_f32 v40, v40, v42
	v_mov_b32 v42, v40
	s_nop 1
	v_permlane32_swap_b32 v40, v42
	v_add_f32 v40, v40, v42
	v_mul_f32 v40, 0x3be38e39, v40
	v_mov_b32 v41, 0
	v_sub_f32 v46, v0, v40
	v_fmac_f32 v41, v46, v46
	v_sub_f32 v46, v1, v40
	v_fmac_f32 v41, v46, v46
	v_sub_f32 v46, v2, v40
	v_fmac_f32 v41, v46, v46
	v_sub_f32 v46, v3, v40
	v_fmac_f32 v41, v46, v46
	v_sub_f32 v46, v4, v40
	v_fmac_f32 v41, v46, v46
	v_sub_f32 v46, v5, v40
	v_fmac_f32 v41, v46, v46
	v_sub_f32 v46, v6, v40
	v_fmac_f32 v41, v46, v46
	v_sub_f32 v46, v7, v40
	v_fmac_f32 v41, v46, v46
	v_sub_f32 v46, v8, v40
	v_fmac_f32 v41, v46, v46
	v_sub_f32 v46, v9, v40
	v_fmac_f32 v41, v46, v46
	v_sub_f32 v46, v10, v40
	v_fmac_f32 v41, v46, v46
	v_sub_f32 v46, v11, v40
	v_fmac_f32 v41, v46, v46
	v_sub_f32 v46, v12, v40
	v_fmac_f32 v41, v46, v46
	v_sub_f32 v46, v13, v40
	v_fmac_f32 v41, v46, v46
	v_sub_f32 v46, v14, v40
	v_fmac_f32 v41, v46, v46
	v_sub_f32 v46, v15, v40
	v_fmac_f32 v41, v46, v46
	s_mov_b64 exec, s[42:43]
	v_sub_f32 v46, v16, v40
	v_fmac_f32 v41, v46, v46
	v_sub_f32 v46, v17, v40
	v_fmac_f32 v41, v46, v46
	v_sub_f32 v46, v18, v40
	v_fmac_f32 v41, v46, v46
	v_sub_f32 v46, v19, v40
	v_fmac_f32 v41, v46, v46
	s_mov_b64 exec, -1
	s_nop 0
	v_add_f32_dpp v41, v41, v41 row_ror:8 row_mask:0xf bank_mask:0xf
	v_mov_b32 v42, v41
	s_nop 1
	v_permlane16_swap_b32 v41, v42
	v_add_f32 v41, v41, v42
	v_mov_b32 v42, v41
	s_nop 1
	v_permlane32_swap_b32 v41, v42
	v_add_f32 v41, v41, v42
	s_lshl_b32 s17, s15, 6
	v_add_u32 v42, s17, v103
	s_mov_b64 exec, 0xff
	ds_write_b64 v42, v[40:41] offset:0
	s_mov_b64 exec, -1
	s_waitcnt lgkmcnt(0)
	s_barrier
	ds_read_b64 v[48:49], v103 offset:0
	ds_read_b64 v[50:51], v103 offset:64
	ds_read_b64 v[52:53], v103 offset:128
	ds_read_b64 v[54:55], v103 offset:192
	s_waitcnt lgkmcnt(0)
	v_add_f32 v56, v48, v50
	v_add_f32 v57, v52, v54
	v_add_f32 v56, v56, v57
	v_mul_f32 v56, 0.25, v56
	v_add_f32 v57, v49, v51
	v_add_f32 v58, v53, v55
	v_add_f32 v57, v57, v58
	v_mov_b32 v58, 0
	v_sub_f32 v59, v48, v56
	v_fmac_f32 v58, v59, v59
	v_sub_f32 v59, v50, v56
	v_fmac_f32 v58, v59, v59
	v_sub_f32 v59, v52, v56
	v_fmac_f32 v58, v59, v59
	v_sub_f32 v59, v54, v56
	v_fmac_f32 v58, v59, v59
	v_fmac_f32 v57, 0x43100000, v58
	v_mov_b32 v59, 0x3727c5ac
	v_fmac_f32 v59, 0x3ae38e39, v57
	v_rsq_f32 v59, v59
	v_sub_f32 v0, v0, v56
	v_sub_f32 v1, v1, v56
	v_sub_f32 v2, v2, v56
	v_sub_f32 v3, v3, v56
	v_mul_f32 v0, v0, v59
	v_mul_f32 v1, v1, v59
	v_mul_f32 v2, v2, v59
	v_mul_f32 v3, v3, v59
	v_cvt_pk_bf16_f32 v0, v0, v1
	v_cvt_pk_bf16_f32 v1, v2, v3
	ds_write_b64 v98, v[0:1] offset:0
	v_sub_f32 v4, v4, v56
	v_sub_f32 v5, v5, v56
	v_sub_f32 v6, v6, v56
	v_sub_f32 v7, v7, v56
	v_mul_f32 v4, v4, v59
	v_mul_f32 v5, v5, v59
	v_mul_f32 v6, v6, v59
	v_mul_f32 v7, v7, v59
	v_cvt_pk_bf16_f32 v4, v4, v5
	v_cvt_pk_bf16_f32 v5, v6, v7
	ds_write_b64 v98, v[4:5] offset:512
	v_sub_f32 v8, v8, v56
	v_sub_f32 v9, v9, v56
	v_sub_f32 v10, v10, v56
	v_sub_f32 v11, v11, v56
	v_mul_f32 v8, v8, v59
	v_mul_f32 v9, v9, v59
	v_mul_f32 v10, v10, v59
	v_mul_f32 v11, v11, v59
	v_cvt_pk_bf16_f32 v8, v8, v9
	v_cvt_pk_bf16_f32 v9, v10, v11
	ds_write_b64 v98, v[8:9] offset:1024
	v_sub_f32 v12, v12, v56
	v_sub_f32 v13, v13, v56
	v_sub_f32 v14, v14, v56
	v_sub_f32 v15, v15, v56
	v_mul_f32 v12, v12, v59
	v_mul_f32 v13, v13, v59
	v_mul_f32 v14, v14, v59
	v_mul_f32 v15, v15, v59
	v_cvt_pk_bf16_f32 v12, v12, v13
	v_cvt_pk_bf16_f32 v13, v14, v15
	ds_write_b64 v98, v[12:13] offset:1536
	s_mov_b64 exec, s[42:43]
	v_sub_f32 v16, v16, v56
	v_sub_f32 v17, v17, v56
	v_sub_f32 v18, v18, v56
	v_sub_f32 v19, v19, v56
	v_mul_f32 v16, v16, v59
	v_mul_f32 v17, v17, v59
	v_mul_f32 v18, v18, v59
	v_mul_f32 v19, v19, v59
	v_cvt_pk_bf16_f32 v16, v16, v17
	v_cvt_pk_bf16_f32 v17, v18, v19
	ds_write_b64 v98, v[16:17] offset:2048
	s_mov_b64 exec, -1
	s_waitcnt lgkmcnt(0)
	s_barrier
	ds_read_b128 v[60:63], v111 offset:10240
	ds_read_b128 v[64:67], v111 offset:14336
	s_add_u32 s17, s41, s61
	s_add_u32 s18, s17, 8192
	s_cmp_lg_u32 s15, 1
	s_cbranch_scc1 .rex_791
	ds_read_b128 v[68:71], v105 offset:18432
	s_add_u32 s19, s41, 16384
	s_waitcnt lgkmcnt(0)
	buffer_store_dwordx4 v[68:71], v106, s[4:7], s19 offen sc1
.rex_791:
	s_waitcnt lgkmcnt(0)
	buffer_store_dwordx4 v[60:63], v106, s[4:7], s17 offen sc1
	buffer_store_dwordx4 v[64:67], v106, s[4:7], s18 offen sc1
	s_add_u32 s39, s39, 36864
	s_add_u32 s41, s41, 36864
	s_add_u32 s62, s28, 1
	s_add_u32 s28, s28, 1
	s_add_u32 s37, s28, 1
	s_waitcnt vmcnt(0)
	v_mov_b32 v102, s62
	s_mov_b64 exec, 1
	buffer_store_dword v102, v101, s[4:7], s30 offen sc1
	s_mov_b64 exec, -1
	s_cmp_ge_u32 s28, 64
	s_cbranch_scc1 L_END
	s_branch .rloop_788
L_R0_CE:
L_OVER:
	s_mov_b32 s20, 400000
	v_and_b32 v2, 7, v0
	v_lshrrev_b32 v3, 2, v2
	v_mul_u32_u24 v3, 112, v3
	v_lshlrev_b32 v2, 2, v2
	v_add_u32 v2, v2, v3
.ovre_793:
	global_load_dword v3, v2, s[12:13] offset:16 sc1
	s_waitcnt vmcnt(0)
	v_readlane_b32 s17, v3, 0
	v_readlane_b32 s18, v3, 1
	s_nop 0
	s_add_u32 s17, s17, s18
	v_readlane_b32 s18, v3, 2
	s_nop 0
	s_add_u32 s17, s17, s18
	v_readlane_b32 s18, v3, 3
	s_nop 0
	s_add_u32 s17, s17, s18
	v_readlane_b32 s18, v3, 4
	s_nop 0
	s_add_u32 s17, s17, s18
	v_readlane_b32 s18, v3, 5
	s_nop 0
	s_add_u32 s17, s17, s18
	v_readlane_b32 s18, v3, 6
	s_nop 0
	s_add_u32 s17, s17, s18
	v_readlane_b32 s18, v3, 7
	s_nop 0
	s_add_u32 s17, s17, s18
	s_cmp_ge_u32 s17, 256
	s_cbranch_scc1 .ovok_794
	s_sub_u32 s20, s20, 1
	s_cmp_lg_u32 s20, 0
	s_cbranch_scc1 .ovre_793
	s_branch L_FAIL
.ovok_794:
	s_sub_u32 s14, s14, 32
	v_readlane_b32 s17, v3, 0
	s_nop 0
	s_max_u32 s17, s17, 32
	s_sub_u32 s17, s17, 32
	s_cmp_gt_u32 s16, 0
	s_cselect_b32 s17, s17, 0
	s_add_u32 s14, s14, s17
	v_readlane_b32 s17, v3, 1
	s_nop 0
	s_max_u32 s17, s17, 32
	s_sub_u32 s17, s17, 32
	s_cmp_gt_u32 s16, 1
	s_cselect_b32 s17, s17, 0
	s_add_u32 s14, s14, s17
	v_readlane_b32 s17, v3, 2
	s_nop 0
	s_max_u32 s17, s17, 32
	s_sub_u32 s17, s17, 32
	s_cmp_gt_u32 s16, 2
	s_cselect_b32 s17, s17, 0
	s_add_u32 s14, s14, s17
	v_readlane_b32 s17, v3, 3
	s_nop 0
	s_max_u32 s17, s17, 32
	s_sub_u32 s17, s17, 32
	s_cmp_gt_u32 s16, 3
	s_cselect_b32 s17, s17, 0
	s_add_u32 s14, s14, s17
	v_readlane_b32 s17, v3, 4
	s_nop 0
	s_max_u32 s17, s17, 32
	s_sub_u32 s17, s17, 32
	s_cmp_gt_u32 s16, 4
	s_cselect_b32 s17, s17, 0
	s_add_u32 s14, s14, s17
	v_readlane_b32 s17, v3, 5
	s_nop 0
	s_max_u32 s17, s17, 32
	s_sub_u32 s17, s17, 32
	s_cmp_gt_u32 s16, 5
	s_cselect_b32 s17, s17, 0
	s_add_u32 s14, s14, s17
	v_readlane_b32 s17, v3, 6
	s_nop 0
	s_max_u32 s17, s17, 32
	s_sub_u32 s17, s17, 32
	s_cmp_gt_u32 s16, 6
	s_cselect_b32 s17, s17, 0
	s_add_u32 s14, s14, s17
	v_readlane_b32 s17, v3, 0
	s_nop 0
	s_min_u32 s17, s17, 32
	s_sub_u32 s18, 32, s17
	s_cmp_ge_u32 s14, s18
	s_cbranch_scc1 .ovn_795
	s_add_u32 s14, s14, s17
	s_add_u32 s14, s14, 0
	s_branch L_HAVEROLE
.ovn_795:
	s_sub_u32 s14, s14, s18
	v_readlane_b32 s17, v3, 1
	s_nop 0
	s_min_u32 s17, s17, 32
	s_sub_u32 s18, 32, s17
	s_cmp_ge_u32 s14, s18
	s_cbranch_scc1 .ovn_796
	s_add_u32 s14, s14, s17
	s_add_u32 s14, s14, 32
	s_branch L_HAVEROLE
.ovn_796:
	s_sub_u32 s14, s14, s18
	v_readlane_b32 s17, v3, 2
	s_nop 0
	s_min_u32 s17, s17, 32
	s_sub_u32 s18, 32, s17
	s_cmp_ge_u32 s14, s18
	s_cbranch_scc1 .ovn_797
	s_add_u32 s14, s14, s17
	s_add_u32 s14, s14, 64
	s_branch L_HAVEROLE
.ovn_797:
	s_sub_u32 s14, s14, s18
	v_readlane_b32 s17, v3, 3
	s_nop 0
	s_min_u32 s17, s17, 32
	s_sub_u32 s18, 32, s17
	s_cmp_ge_u32 s14, s18
	s_cbranch_scc1 .ovn_798
	s_add_u32 s14, s14, s17
	s_add_u32 s14, s14, 96
	s_branch L_HAVEROLE
.ovn_798:
	s_sub_u32 s14, s14, s18
	v_readlane_b32 s17, v3, 4
	s_nop 0
	s_min_u32 s17, s17, 32
	s_sub_u32 s18, 32, s17
	s_cmp_ge_u32 s14, s18
	s_cbranch_scc1 .ovn_799
	s_add_u32 s14, s14, s17
	s_add_u32 s14, s14, 128
	s_branch L_HAVEROLE
.ovn_799:
	s_sub_u32 s14, s14, s18
	v_readlane_b32 s17, v3, 5
	s_nop 0
	s_min_u32 s17, s17, 32
	s_sub_u32 s18, 32, s17
	s_cmp_ge_u32 s14, s18
	s_cbranch_scc1 .ovn_800
	s_add_u32 s14, s14, s17
	s_add_u32 s14, s14, 160
	s_branch L_HAVEROLE
.ovn_800:
	s_sub_u32 s14, s14, s18
	v_readlane_b32 s17, v3, 6
	s_nop 0
	s_min_u32 s17, s17, 32
	s_sub_u32 s18, 32, s17
	s_cmp_ge_u32 s14, s18
	s_cbranch_scc1 .ovn_801
	s_add_u32 s14, s14, s17
	s_add_u32 s14, s14, 192
	s_branch L_HAVEROLE
.ovn_801:
	s_sub_u32 s14, s14, s18
	v_readlane_b32 s17, v3, 7
	s_nop 0
	s_min_u32 s17, s17, 32
	s_sub_u32 s18, 32, s17
	s_cmp_ge_u32 s14, s18
	s_cbranch_scc1 .ovn_802
	s_add_u32 s14, s14, s17
	s_add_u32 s14, s14, 224
	s_branch L_HAVEROLE
.ovn_802:
	s_sub_u32 s14, s14, s18
L_FAIL:
	s_mov_b64 exec, 1
	v_mov_b32 v1, 0
	v_mov_b32 v2, 0xdead0000
	v_or_b32 v2, s14, v2
	global_store_dword v1, v2, s[12:13] offset:160
L_END:
	s_endpgm
L_ENDT:
	s_endpgm
.section .rodata,"a"
.p2align 6
.amdhsa_kernel interleave_layers__sliding_block__memory_aug_recurrent_mem_tr__prompt_kernel
  .amdhsa_next_free_vgpr 512
  .amdhsa_next_free_sgpr 102
  .amdhsa_accum_offset 256
  .amdhsa_group_segment_fixed_size 0
  .amdhsa_kernarg_size 104
  .amdhsa_user_sgpr_count 2
  .amdhsa_user_sgpr_kernarg_segment_ptr 1
  .amdhsa_system_sgpr_workgroup_id_x 1
.end_amdhsa_kernel
```
